```python
import torch

def _softmax(x, axis=-1):
    return torch.softmax(x, dim=axis)
def _gelu(x):
    return torch.nn.functional.gelu(x, approximate="tanh")
def _silu(x):
    return torch.nn.functional.silu(x)
def _sigmoid(x):
    return torch.sigmoid(x)
def _layernorm(x, axis=-1, eps=1e-5):
    m = x.mean(dim=axis, keepdim=True)
    v = x.var(dim=axis, keepdim=True, unbiased=False)
    return (x - m) / torch.sqrt(v + eps)
def _scatter_add(tgt, idx, src, axis=0):
    return tgt.clone().index_add_(axis, idx, src)
def _segment_sum(src, seg, n):
    out = torch.zeros((n,) + src.shape[1:], dtype=src.dtype)
    return out.index_add_(0, seg, src)
def _pad(x, pw):
    flat = tuple(v for pair in reversed(pw) for v in pair)
    return torch.nn.functional.pad(x, flat)

kernel_name = 'recurrent_scan__mha_block_cached__dense_activation_relu__prompt'

def setup_inputs():

    _w = (lambda a: (lambda t: t.to(torch.bfloat16) if t.is_floating_point() else t)(torch.as_tensor(a)))
    def _A_setup():
        B, Sq, D = 1, 2048, 1024
        H, Sk, Dh = 32, 2048, 128
        return {
            "x": _w((lambda *s: torch.randn(*s, dtype=torch.bfloat16) * 0.05)(B, Sq, D)),
            "k_cache": _w((lambda *s: torch.randn(*s, dtype=torch.bfloat16) * 0.8)(B, H, Sk, Dh)),
            "v_cache": _w((lambda *s: torch.randn(*s, dtype=torch.bfloat16) * 0.2)(B, H, Sk, Dh)),
            "wq": _w((lambda *s: torch.randn(*s, dtype=torch.bfloat16) * 0.8)(D, H * Dh) * (D ** -0.5)),
            "wo": _w((lambda *s: torch.randn(*s, dtype=torch.bfloat16) * 0.2)(H * Dh, D) * ((H * Dh) ** -0.5)),
        }
    _A_in = _A_setup()

    def _B_setup():
        B, S, D, Dff = 1, 2048, 1024, 3584
        return {
            "x": _w((lambda *s: torch.randn(*s, dtype=torch.bfloat16) * 0.05)(B, S, D)),
            "w1": _w((lambda *s: torch.randn(*s, dtype=torch.bfloat16) * 0.1)(D, Dff)),
            "w2": _w((lambda *s: torch.randn(*s, dtype=torch.bfloat16) * 0.1)(Dff, D)),
        }
    _B_in = _B_setup()

    return {
        "A_x": _A_in["x"],
        "A_k_cache": _A_in["k_cache"],
        "A_v_cache": _A_in["v_cache"],
        "A_wq": _A_in["wq"],
        "A_wo": _A_in["wo"],
        "B_x": _B_in["x"],
        "B_w1": _B_in["w1"],
        "B_w2": _B_in["w2"],
    }

def reference(A_x, A_k_cache, A_v_cache, A_wq, A_wo, B_x, B_w1, B_w2):
    def _A_ref(x, k_cache, v_cache, wq, wo):
        B, Sq, D = x.shape
        H, Dh = 32, 128
        q = (lambda x, *d: x.permute(*d))((x @ wq).reshape(B, Sq, H, Dh), 0, 2, 1, 3)
        scores = torch.einsum("bhqd,bhkd->bhqk", q, k_cache) * (Dh ** -0.5)
        p = _softmax(scores, axis=-1)
        o = torch.einsum("bhqk,bhkd->bhqd", p, v_cache)
        return (lambda x, *d: x.permute(*d))(o, 0, 2, 1, 3).reshape(B, Sq, H * Dh) @ wo

    def _B_ref(x, w1, w2):
        h = torch.einsum("bsd,df->bsf", x, w1)
        zero = torch.zeros_like(h)
        h = torch.maximum(h, zero)
        return torch.einsum("bsf,fd->bsd", h, w2)

    x = A_x
    xn = _layernorm(x, axis=-1)
    s = _A_ref(xn, A_k_cache, A_v_cache, A_wq, A_wo)
    g = _silu(_B_ref(xn, B_w1, B_w2))
    return x + s * g
```

```asm
; @launch kernel=att_kernel grid=(256,1,1) block=(256,1,1) lds=163840
.amdgcn_target "amdgcn-amd-amdhsa--gfx950"
.text
.globl att_kernel
.p2align 8
.type att_kernel,@function
att_kernel:
  s_cmp_ge_u32 s2, 256
  s_cbranch_scc1 L_k2_end
  s_load_dwordx2 s[66:67], s[0:1], 0
  s_load_dwordx4 s[52:55], s[0:1], 8
  s_load_dwordx2 s[56:57], s[0:1], 24
  s_load_dwordx2 s[58:59], s[0:1], 48
  s_load_dwordx2 s[60:61], s[0:1], 80
  s_load_dwordx2 s[62:63], s[0:1], 72
  s_load_dwordx2 s[96:97], s[0:1], 32
  s_load_dwordx2 s[98:99], s[0:1], 56
  s_getpc_b64 s[100:101]
L_pc0:
  s_bfe_u32 s48, s2, 0x20003
  s_lshl_b32 s48, s48, 15
  v_lshl_add_u32 v2, v0, 7, s48
  v_min_u32 v2, L_code_end-L_pc0-4, v2
  global_load_dword v248, v2, s[100:101]
  v_lshrrev_b32 v1, 6, v0
  v_and_b32 v0, 63, v0
  s_and_b32 s32, s2, 7
  v_readfirstlane_b32 s3, v1
  s_lshl_b32 s32, s32, 2
  s_lshr_b32 s33, s2, 3
  s_and_b32 s34, s33, 3
  s_add_u32 s32, s32, s34
  s_lshr_b32 s33, s33, 2
  s_lshl_b32 s45, s3, 12
  s_add_u32 s46, s45, 16384
  s_lshl_b32 s35, s33, 3
  s_lshl_b32 s50, s3, 1
  s_add_u32 s35, s35, s50
  s_lshr_b32 s34, s32, 4
  s_add_u32 s50, s35, s34
  s_xor_b32 s51, s50, 1
  s_and_b32 s34, s32, 1
  s_lshl_b32 s47, s33, 13
  s_mov_b32 s43, 0
  s_mov_b32 s44, 0
  v_and_b32 v218, 7, v0
  v_lshrrev_b32 v217, 3, v0
  v_lshlrev_b32 v216, 11, v218
  v_lshl_add_u32 v216, v217, 4, v216
  v_lshrrev_b32 v112, 2, v217
  v_and_b32 v217, 3, v217
  v_lshlrev_b32 v217, 8, v217
  v_lshl_add_u32 v217, v112, 11, v217
  v_lshl_add_u32 v217, v218, 4, v217
  v_lshlrev_b32 v218, 5, v218
  v_add_u32 v218, 139264, v218
  s_lshl_b32 s36, s50, 16
  s_lshl_b32 s37, s51, 16
  s_mov_b32 s38, 0
  s_mov_b32 s39, 0
  s_mov_b32 s40, 0
  s_mov_b32 s41, 0
  v_lshlrev_b32 v166, 4, v0
  v_mov_b32 v221, 0
  s_mov_b32 s42, s2
  ds_write_b32 v218, v221 offset:512
  s_lshl_b32 s64, s42, 14
  s_lshl_b32 s48, s3, 9
  s_add_u32 s64, s64, s48
  s_lshr_b32 s65, s42, 2
  s_lshl_b32 s65, s65, 16
  s_and_b32 s48, s42, 2
  s_lshl_b32 s48, s48, 9
  s_add_u32 s65, s65, s48
  s_and_b32 s48, s42, 1
  s_lshl_b32 s48, s48, 7
  s_add_u32 s65, s65, s48
  s_lshl_b32 s48, s3, 14
  s_add_u32 s65, s65, s48
  s_waitcnt lgkmcnt(0)
  s_mov_b32 s72, s66
  s_mov_b32 s73, s67
  s_mov_b32 s74, 4194304
  s_mov_b32 s75, 0x20000
  s_mov_b32 s66, s64
  s_mov_b32 s67, s65
  buffer_load_dwordx4 v[64:67], v216, s[72:75], s66 offen offset:0
  buffer_load_dwordx4 v[68:71], v216, s[72:75], s66 offen offset:128
  buffer_load_dwordx4 v[72:75], v216, s[72:75], s66 offen offset:256
  buffer_load_dwordx4 v[76:79], v216, s[72:75], s66 offen offset:384
  s_add_u32 s28, s60, 50331648
  s_addc_u32 s29, s61, 0
  s_mov_b32 s30, 131072
  s_mov_b32 s31, 0x20000
  s_mov_b32 s24, s62
  s_mov_b32 s25, s63
  s_mov_b32 s26, 256
  s_mov_b32 s27, 0x20000
  s_and_b32 s48, s2, 31
  s_xor_b32 s49, s3, 3
  s_or_b32 s64, s48, s49
  s_cmp_lg_u32 s64, 0
  s_cbranch_scc1 L_nolead1
  s_add_u32 s48, s47, 4096
  v_mov_b32 v112, 0
  v_mov_b32 v113, 0
  v_mov_b32 v114, 0
  v_mov_b32 v115, 0
  v_lshlrev_b32 v116, 6, v0
  buffer_store_dwordx4 v[112:115], v116, s[28:31], s48 offen sc0 sc1
  buffer_store_dwordx4 v[112:115], v166, s[28:31], s47 offen sc0 sc1
L_nolead1:
  s_lshl_b32 s48, s32, 8
  s_add_u32 s8, s56, s48
  s_addc_u32 s9, s57, 0
  s_mov_b32 s10, 0
  s_mov_b32 s11, 0x20000
  s_sub_u32 s10, 0x800000, s48
  s_lshr_b32 s48, s32, 1
  s_mul_i32 s48, s48, 448
  s_add_u32 s12, s58, s48
  s_addc_u32 s13, s59, 0
  s_mov_b32 s14, 0
  s_mov_b32 s15, 0x20000
  s_sub_u32 s14, 0x700000, s48
  s_and_b32 s48, s2, 7
  s_cmp_lt_u32 s3, 2
  s_cselect_b32 s68, s56, s58
  s_cselect_b32 s69, s57, s59
  s_mov_b32 s70, 896
  s_cselect_b32 s70, 1024, s70
  s_cselect_b32 s49, 8, 7
  s_mul_i32 s48, s48, s70
  s_add_u32 s68, s68, s48
  s_addc_u32 s69, s69, 0
  s_lshl_b32 s65, s70, 3
  s_lshl_b32 s70, s70, 13
  s_sub_u32 s70, s70, s48
  s_mov_b32 s71, 0x20000
  v_lshrrev_b32 v210, 3, v0
  v_mul_lo_u32 v219, v210, s65
  v_and_b32 v213, 7, v0
  v_lshl_add_u32 v219, v213, 7, v219
  v_mov_b32 v210, 0x7fffffff
  v_cmp_le_u32 vcc, s49, v213
  s_lshr_b32 s56, s2, 3
  s_lshl_b32 s56, s56, 1
  v_cndmask_b32 v219, v219, v210, vcc
  s_and_b32 s49, s3, 1
  s_add_u32 s56, s56, s49
  s_mul_i32 s48, s56, 4
  s_add_u32 s48, s48, 0
  s_mul_i32 s48, s48, s65
  s_mov_b32 exec_lo, 0xffffffff
  s_mov_b32 exec_hi, 0x0
  buffer_load_dword v248, v219, s[68:71], s48 offen
  s_mov_b64 exec, -1
  v_mov_b32 v210, 0x7fffffff
  v_cmp_le_u32 vcc, 8, v0
  s_add_u32 s56, s56, 256
  s_mul_i32 s56, s56, s65
  v_cndmask_b32 v219, v219, v210, vcc
  s_lshl_b32 s57, s65, 6
  v_lshrrev_b32 v208, 4, v0
  v_and_b32 v209, 15, v0
  s_lshl_b32 s48, s3, 4
  v_add_u32 v211, s48, v208
  s_lshl_b32 s48, s34, 4
  s_sub_u32 s49, s34, 12
  v_mov_b32 v10, 0x7fffffff
  v_mul_u32_u24 v11, 7168, v211
  v_lshlrev_b32 v12, 2, v208
  v_xor_b32 v12, v12, v209
  v_lshlrev_b32 v12, 4, v12
  v_lshl_add_u32 v2, v211, 13, v12
  v_lshrrev_b32 v210, 3, v0
  v_and_b32 v212, 7, v0
  v_xor_b32 v212, v212, v208
  v_lshlrev_b32 v210, 11, v210
  v_lshl_add_u32 v58, v212, 4, v210
  v_xor_b32 v59, 64, v58
  v_add_u32 v60, 30720, v58
  v_add_u32 v61, 46080, v59
  v_add_u32 v59, 15360, v59
  v_or_b32 v210, 0, v208
  v_lshlrev_b32 v210, 1, v210
  v_xor_b32 v210, v210, v209
  v_add_u32 v212, s48, v210
  v_cmp_le_u32 vcc, 12, v210
  v_lshl_add_u32 v213, v210, 1, s49
  s_nop 0
  v_cndmask_b32 v212, v212, v213, vcc
  v_cmp_le_u32 vcc, 14, v210
  v_lshl_add_u32 v212, v212, 4, v11
  v_add_u32 v6, 0, v212
  s_nop 0
  v_cndmask_b32 v6, v6, v10, vcc
  v_add_u32 v7, 27648, v212
  v_add_u32 v3, 31744, v2
  v_cndmask_b32 v7, v7, v10, vcc
  v_or_b32 v210, 4, v208
  v_lshlrev_b32 v210, 1, v210
  v_xor_b32 v210, v210, v209
  v_add_u32 v212, s48, v210
  v_cmp_le_u32 vcc, 12, v210
  v_lshl_add_u32 v213, v210, 1, s49
  s_nop 0
  v_cndmask_b32 v212, v212, v213, vcc
  v_cmp_le_u32 vcc, 14, v210
  v_lshl_add_u32 v212, v212, 4, v11
  v_add_u32 v8, 55296, v212
  v_add_u32 v4, 63488, v2
  v_cndmask_b32 v8, v8, v10, vcc
  v_add_u32 v9, 82944, v212
  v_add_u32 v5, 95232, v2
  v_cndmask_b32 v9, v9, v10, vcc
  s_add_u32 s4, s60, 0
  s_addc_u32 s5, s61, 0
  s_mov_b32 s6, 4194304
  s_mov_b32 s7, 0x20000
  s_lshl_b32 s48, s32, 19
  s_add_u32 s16, s52, s48
  s_addc_u32 s17, s53, 0
  s_mov_b32 s18, 524288
  s_mov_b32 s19, 0x20000
  s_add_u32 s20, s54, s48
  s_addc_u32 s21, s55, 0
  s_mov_b32 s22, 524288
  s_mov_b32 s23, 0x20000
  s_mov_b32 s52, s72
  s_mov_b32 s53, s73
  s_load_dwordx2 s[54:55], s[0:1], 64
  s_mov_b32 s58, 32
  v_add_u32 v210, 0, v208
  v_xor_b32 v210, v210, v209
  v_lshlrev_b32 v210, 4, v210
  v_lshl_add_u32 v160, v211, 8, v210
  v_add_u32 v210, 4, v208
  v_xor_b32 v210, v210, v209
  v_lshlrev_b32 v210, 4, v210
  v_lshl_add_u32 v161, v211, 8, v210
  v_add_u32 v210, 8, v208
  v_xor_b32 v210, v210, v209
  v_lshlrev_b32 v210, 4, v210
  v_lshl_add_u32 v162, v211, 8, v210
  v_add_u32 v210, 12, v208
  v_xor_b32 v210, v210, v209
  v_lshlrev_b32 v210, 4, v210
  v_lshl_add_u32 v163, v211, 8, v210
  v_add_u32 v210, 0, v208
  v_lshlrev_b32 v210, 1, v210
  v_xor_b32 v210, v210, v209
  v_lshlrev_b32 v210, 4, v210
  v_lshl_add_u32 v164, v211, 8, v210
  v_add_u32 v210, 4, v208
  v_lshlrev_b32 v210, 1, v210
  v_xor_b32 v210, v210, v209
  v_lshlrev_b32 v210, 4, v210
  v_lshl_add_u32 v165, v211, 8, v210
  v_lshl_add_u32 v224, v211, 11, v12
  v_add_u32 v227, 21504, v224
  v_add_u32 v226, 14336, v224
  v_add_u32 v225, 7168, v224
  s_cmp_lg_u32 s64, 0
  s_cbranch_scc1 L_nolead2
  s_waitcnt vmcnt(1)
  v_mov_b32 v222, 1
  s_lshl_b32 s48, s33, 2
  s_mov_b64 exec, 1
  buffer_store_dword v222, v221, s[24:27], s48 offen sc0 sc1
  s_mov_b64 exec, -1
L_nolead2:
  s_mov_b32 s64, 0
  s_add_u32 s48, s3, 0
  s_and_b32 s48, s48, 3
  s_lshl_b32 s48, s48, 2
  v_add_u32 v210, s48, v208
  v_xor_b32 v210, v210, v209
  v_lshlrev_b32 v210, 4, v210
  v_lshl_add_u32 v148, v209, 8, v210
  v_add_u32 v148, 98304, v148
  s_add_u32 s48, s3, 1
  s_and_b32 s48, s48, 3
  s_lshl_b32 s48, s48, 2
  v_add_u32 v210, s48, v208
  v_xor_b32 v210, v210, v209
  v_lshlrev_b32 v210, 4, v210
  v_lshl_add_u32 v149, v209, 8, v210
  v_add_u32 v149, 98304, v149
  s_add_u32 s48, s3, 2
  s_and_b32 s48, s48, 3
  s_lshl_b32 s48, s48, 2
  v_add_u32 v210, s48, v208
  v_xor_b32 v210, v210, v209
  v_lshlrev_b32 v210, 4, v210
  v_lshl_add_u32 v150, v209, 8, v210
  v_add_u32 v150, 98304, v150
  s_add_u32 s48, s3, 3
  s_and_b32 s48, s48, 3
  s_lshl_b32 s48, s48, 2
  v_add_u32 v210, s48, v208
  v_xor_b32 v210, v210, v209
  v_lshlrev_b32 v210, 4, v210
  v_lshl_add_u32 v151, v209, 8, v210
  v_add_u32 v151, 98304, v151
  v_lshrrev_b32 v210, 1, v209
  v_xor_b32 v210, v210, v208
  v_lshlrev_b32 v210, 4, v210
  s_lshl1_add_u32 s48, s45, 98304
  v_lshl_add_u32 v210, v209, 7, v210
  v_add_u32 v52, s48, v210
  v_xor_b32 v53, 64, v52
  v_lshrrev_b32 v208, 4, v0
  v_bfe_u32 v209, v0, 2, 2
  v_and_b32 v210, 3, v0
  v_lshlrev_b32 v210, 3, v210
  v_lshl_add_u32 v211, v208, 2, v209
  v_and_b32 v212, 7, v211
  v_lshl_add_u32 v211, v211, 8, v210
  v_add_u32 v211, 32768, v211
  v_xor_b32 v213, 0, v212
  v_lshl_add_u32 v152, v213, 5, v211
  v_xor_b32 v213, 1, v212
  v_lshl_add_u32 v153, v213, 5, v211
  v_xor_b32 v213, 2, v212
  v_lshl_add_u32 v154, v213, 5, v211
  v_xor_b32 v213, 3, v212
  v_lshl_add_u32 v155, v213, 5, v211
  v_xor_b32 v213, 4, v212
  v_lshl_add_u32 v156, v213, 5, v211
  v_xor_b32 v213, 5, v212
  v_lshl_add_u32 v157, v213, 5, v211
  v_xor_b32 v213, 6, v212
  v_lshl_add_u32 v158, v213, 5, v211
  v_xor_b32 v213, 7, v212
  v_lshl_add_u32 v159, v213, 5, v211
  v_lshl_add_u32 v211, v208, 3, v209
  v_and_b32 v208, 1, v208
  v_lshl_or_b32 v212, v208, 2, v209
  v_lshl_add_u32 v211, v211, 8, v210
  s_cmp_eq_u32 s3, 3
  s_cselect_b32 s48, 0, s3
  s_lshl_b32 s48, s48, 1
  v_xor_b32 v213, s48, v212
  v_lshl_add_u32 v18, v213, 5, v211
  s_add_u32 s48, s48, 1
  v_xor_b32 v213, s48, v212
  v_lshl_add_u32 v19, v213, 5, v211
  s_add_u32 s48, s48, 1
  s_cmp_eq_u32 s48, 6
  s_cselect_b32 s48, 0, s48
  v_xor_b32 v213, s48, v212
  v_lshl_add_u32 v20, v213, 5, v211
  s_add_u32 s48, s48, 1
  v_xor_b32 v213, s48, v212
  v_lshl_add_u32 v21, v213, 5, v211
  s_add_u32 s48, s48, 1
  s_cmp_eq_u32 s48, 6
  s_cselect_b32 s48, 0, s48
  v_xor_b32 v213, s48, v212
  v_lshl_add_u32 v22, v213, 5, v211
  s_add_u32 s48, s48, 1
  v_xor_b32 v213, s48, v212
  v_lshl_add_u32 v23, v213, 5, v211
  v_xor_b32 v213, 6, v212
  v_lshl_add_u32 v24, v213, 5, v211
  v_add_u32 v211, v211, v210
  s_add_u32 s48, s3, 0
  s_and_b32 s48, s48, 3
  v_xor_b32 v213, s48, v209
  v_lshl_add_u32 v10, v213, 6, v211
  s_add_u32 s48, s3, 1
  s_and_b32 s48, s48, 3
  v_xor_b32 v213, s48, v209
  v_lshl_add_u32 v11, v213, 6, v211
  s_add_u32 s48, s3, 2
  s_and_b32 s48, s48, 3
  v_xor_b32 v213, s48, v209
  v_lshl_add_u32 v12, v213, 6, v211
  s_add_u32 s48, s3, 3
  s_and_b32 s48, s48, 3
  v_xor_b32 v213, s48, v209
  v_lshl_add_u32 v13, v213, 6, v211
  v_mov_b32 v14, v10
  v_mov_b32 v15, v11
  v_mov_b32 v16, v12
  v_mov_b32 v17, v13
  v_mov_b32 v25, v18
  v_mov_b32 v26, v19
  v_mov_b32 v27, v20
  v_mov_b32 v28, v21
  v_mov_b32 v29, v22
  v_mov_b32 v30, v23
  v_mov_b32 v31, v24
  v_mov_b64 v[32:33], 0
  v_mov_b64 v[36:37], 0
  v_mov_b64 v[40:41], 0
  v_mov_b64 v[44:45], 0
  v_mov_b64 v[48:49], 0
  s_bfe_u32 s48, s2, 0x20003
  s_lshl_b32 s48, s48, 2
  v_and_b32 v208, 2, v0
  v_lshl_add_u32 v223, v208, 3, s48
  s_lshl_b32 s49, s33, 2
  v_and_b32 v208, 3, v0
  v_mov_b32 v209, s49
  v_cmp_eq_u32 vcc, 0, v208
  v_mov_b32 v233, 1
  v_mov_b32 v232, 0
  v_cndmask_b32 v223, v223, v209, vcc
  s_mov_b32 s59, 0
  s_cmp_lt_u32 s2, 8
  s_cselect_b32 s95, 3, 1
  s_cmp_eq_u32 s3, 0
  s_cselect_b32 s95, s95, 99
  s_mov_b32 s94, 0
  v_and_b32 v237, 7, v0
  v_sub_u32 v237, 7, v237
  v_lshlrev_b32 v237, 1, v237
  v_and_b32 v237, 12, v237
  v_mov_b32 v239, 1
  v_mov_b32 v235, 1
  v_mov_b32 v234, 0x7fffffff
  v_mov_b32 v144, 0x3f803f80
  v_mov_b32 v145, 0x3f803f80
  v_mov_b32 v146, 0x3f803f80
  v_mov_b32 v147, 0x3f803f80
  v_and_b32 v236, 1, v0
  v_mul_u32_u24 v236, 0xaaaa, v236
  v_add_u32 v236, 0x4444, v236
  s_waitcnt vmcnt(1)
  v_lshlrev_b32 v80, 16, v64
  v_and_b32 v81, 0xffff0000, v64
  v_lshlrev_b32 v82, 16, v65
  v_and_b32 v83, 0xffff0000, v65
  v_lshlrev_b32 v84, 16, v66
  v_and_b32 v85, 0xffff0000, v66
  v_lshlrev_b32 v86, 16, v67
  v_and_b32 v87, 0xffff0000, v67
  v_lshlrev_b32 v88, 16, v68
  v_and_b32 v89, 0xffff0000, v68
  s_add_u32 m0, s40, s45
  s_nop 0
  buffer_load_dwordx4 v2, s[8:11], s38 offen offset:0 lds
  v_lshlrev_b32 v90, 16, v69
  v_and_b32 v91, 0xffff0000, v69
  v_lshlrev_b32 v92, 16, v70
  v_and_b32 v93, 0xffff0000, v70
  v_lshlrev_b32 v94, 16, v71
  v_and_b32 v95, 0xffff0000, v71
  v_lshlrev_b32 v96, 16, v72
  v_and_b32 v97, 0xffff0000, v72
  v_lshlrev_b32 v98, 16, v73
  v_and_b32 v99, 0xffff0000, v73
  buffer_load_dwordx4 v3, s[8:11], s38 offen offset:1024 lds
  v_lshlrev_b32 v100, 16, v74
  v_and_b32 v101, 0xffff0000, v74
  v_lshlrev_b32 v102, 16, v75
  v_and_b32 v103, 0xffff0000, v75
  v_lshlrev_b32 v104, 16, v76
  v_and_b32 v105, 0xffff0000, v76
  v_lshlrev_b32 v106, 16, v77
  v_and_b32 v107, 0xffff0000, v77
  v_lshlrev_b32 v108, 16, v78
  v_and_b32 v109, 0xffff0000, v78
  buffer_load_dwordx4 v4, s[8:11], s38 offen offset:2048 lds
  v_lshlrev_b32 v110, 16, v79
  v_and_b32 v111, 0xffff0000, v79
  v_pk_add_f32 v[112:113], v[80:81], v[82:83]
  v_pk_add_f32 v[114:115], v[84:85], v[86:87]
  v_pk_add_f32 v[116:117], v[88:89], v[90:91]
  v_pk_add_f32 v[118:119], v[92:93], v[94:95]
  v_pk_add_f32 v[120:121], v[96:97], v[98:99]
  v_pk_add_f32 v[122:123], v[100:101], v[102:103]
  v_pk_add_f32 v[124:125], v[104:105], v[106:107]
  v_pk_add_f32 v[126:127], v[108:109], v[110:111]
  buffer_load_dwordx4 v5, s[8:11], s38 offen offset:3072 lds
  s_add_u32 s38, s38, 0x80000
  v_pk_add_f32 v[112:113], v[112:113], v[114:115]
  v_pk_add_f32 v[114:115], v[116:117], v[118:119]
  v_pk_add_f32 v[116:117], v[120:121], v[122:123]
  v_pk_add_f32 v[118:119], v[124:125], v[126:127]
  v_pk_add_f32 v[112:113], v[112:113], v[114:115]
  v_pk_add_f32 v[114:115], v[116:117], v[118:119]
  v_pk_add_f32 v[112:113], v[112:113], v[114:115]
  v_add_f32 v64, v112, v113
  s_nop 1
  v_add_f32_dpp v64, v64, v64 row_ror:8 row_mask:0xf bank_mask:0xf
  s_add_u32 m0, s40, s46
  s_nop 0
  buffer_load_dwordx4 v6, s[12:15], s39 offen offset:0 lds
  v_mov_b32 v65, v64
  s_nop 1
  v_permlane16_swap_b32 v64, v65
  v_add_f32 v64, v64, v65
  v_mov_b32 v65, v64
  s_nop 1
  v_permlane32_swap_b32 v64, v65
  v_add_f32 v64, v64, v65
  v_mul_f32 v66, 0xbb800000, v64
  v_mul_f32 v64, 0x3b800000, v64
  buffer_load_dwordx4 v7, s[12:15], s39 offen offset:1024 lds
  v_mov_b32 v67, v66
  v_pk_add_f32 v[112:113], v[80:81], v[66:67]
  v_pk_add_f32 v[114:115], v[82:83], v[66:67]
  v_pk_add_f32 v[116:117], v[84:85], v[66:67]
  v_pk_add_f32 v[118:119], v[86:87], v[66:67]
  v_pk_add_f32 v[120:121], v[88:89], v[66:67]
  v_pk_add_f32 v[122:123], v[90:91], v[66:67]
  v_pk_add_f32 v[124:125], v[92:93], v[66:67]
  v_pk_add_f32 v[126:127], v[94:95], v[66:67]
  v_pk_add_f32 v[128:129], v[96:97], v[66:67]
  buffer_load_dwordx4 v8, s[12:15], s39 offen offset:2048 lds
  v_pk_add_f32 v[130:131], v[98:99], v[66:67]
  v_pk_add_f32 v[132:133], v[100:101], v[66:67]
  v_pk_add_f32 v[134:135], v[102:103], v[66:67]
  v_pk_add_f32 v[136:137], v[104:105], v[66:67]
  v_pk_add_f32 v[138:139], v[106:107], v[66:67]
  v_pk_add_f32 v[140:141], v[108:109], v[66:67]
  v_pk_add_f32 v[142:143], v[110:111], v[66:67]
  v_pk_mul_f32 v[68:69], v[112:113], v[112:113]
  v_pk_mul_f32 v[70:71], v[114:115], v[114:115]
  v_pk_mul_f32 v[72:73], v[116:117], v[116:117]
  buffer_load_dwordx4 v9, s[12:15], s39 offen offset:3072 lds
  s_add_u32 s39, s39, 0x70000
  s_mov_b32 s41, s49
  s_mov_b32 s49, s40
  s_add_u32 s40, s40, 32768
  s_cmp_lt_u32 s40, 98304
  s_cselect_b32 s40, s40, 0
  v_pk_mul_f32 v[74:75], v[118:119], v[118:119]
  v_pk_fma_f32 v[68:69], v[120:121], v[120:121], v[68:69]
  v_pk_fma_f32 v[70:71], v[122:123], v[122:123], v[70:71]
  v_pk_fma_f32 v[72:73], v[124:125], v[124:125], v[72:73]
  v_pk_fma_f32 v[74:75], v[126:127], v[126:127], v[74:75]
  v_pk_fma_f32 v[68:69], v[128:129], v[128:129], v[68:69]
  v_pk_fma_f32 v[70:71], v[130:131], v[130:131], v[70:71]
  v_pk_fma_f32 v[72:73], v[132:133], v[132:133], v[72:73]
  v_pk_fma_f32 v[74:75], v[134:135], v[134:135], v[74:75]
  v_pk_fma_f32 v[68:69], v[136:137], v[136:137], v[68:69]
  s_lshl1_add_u32 m0, s45, 98304
  s_nop 0
  buffer_load_dwordx4 v58, s[72:75], s36 offen offset:0 lds
  v_pk_fma_f32 v[70:71], v[138:139], v[138:139], v[70:71]
  v_pk_fma_f32 v[72:73], v[140:141], v[140:141], v[72:73]
  v_pk_fma_f32 v[74:75], v[142:143], v[142:143], v[74:75]
  v_pk_add_f32 v[68:69], v[68:69], v[70:71]
  v_pk_add_f32 v[72:73], v[72:73], v[74:75]
  v_pk_add_f32 v[68:69], v[68:69], v[72:73]
  v_add_f32 v65, v68, v69
  s_nop 1
  v_add_f32_dpp v65, v65, v65 row_ror:8 row_mask:0xf bank_mask:0xf
  v_mov_b32 v68, v65
  buffer_load_dwordx4 v59, s[72:75], s36 offen offset:1024 lds
  s_nop 1
  v_permlane16_swap_b32 v65, v68
  v_add_f32 v65, v65, v68
  v_mov_b32 v68, v65
  s_nop 1
  v_permlane32_swap_b32 v65, v68
  v_add_f32 v65, v65, v68
  s_lshl_b32 s48, s3, 3
  v_add_u32 v68, s48, v218
  s_mov_b64 exec, 0xff
  ds_write_b64 v68, v[64:65]
  s_mov_b64 exec, -1
  s_waitcnt lgkmcnt(0)
  s_barrier
  ds_read_b128 v[112:115], v218
  ds_read_b128 v[116:119], v218 offset:16
  s_waitcnt lgkmcnt(0)
  v_add_f32 v64, v112, v114
  v_add_f32 v65, v116, v118
  v_add_f32 v66, v113, v115
  buffer_load_dwordx4 v60, s[72:75], s36 offen offset:2048 lds
  v_add_f32 v67, v117, v119
  v_add_f32 v64, v64, v65
  v_add_f32 v66, v66, v67
  v_mul_f32 v64, 0.25, v64
  v_sub_f32 v112, v112, v64
  v_sub_f32 v114, v114, v64
  v_sub_f32 v116, v116, v64
  v_sub_f32 v118, v118, v64
  v_mul_f32 v112, v112, v112
  v_mul_f32 v116, v116, v116
  buffer_load_dwordx4 v61, s[72:75], s36 offen offset:3072 lds
  s_add_u32 s36, s36, 128
  v_fmac_f32 v112, v114, v114
  v_fmac_f32 v116, v118, v118
  v_add_f32 v112, v112, v116
  v_fmac_f32 v66, 0x43800000, v112
  v_mul_f32 v66, 0x3a800000, v66
  v_cvt_pk_bf16_f32 v65, v64, v66
  v_lshlrev_b32 v64, 16, v65
  v_and_b32 v66, 0xffff0000, v65
  v_add_f32 v66, 0x3727c5ac, v66
  v_cvt_pk_bf16_f32 v66, v66, v66
  s_lshl1_add_u32 m0, s45, 102400
  s_nop 0
  buffer_load_dwordx4 v58, s[72:75], s37 offen offset:0 lds
  v_and_b32 v66, 0xffff0000, v66
  v_sqrt_f32 v66, v66
  v_sub_f32 v112, 0, v64
  v_sub_f32 v113, 0, v64
  v_cvt_pk_bf16_f32 v66, v66, v66
  v_and_b32 v66, 0xffff0000, v66
  v_rcp_f32 v68, v66
  v_rcp_f32 v69, v66
  v_pk_add_f32 v[80:81], v[80:81], v[112:113]
  v_pk_add_f32 v[82:83], v[82:83], v[112:113]
  buffer_load_dwordx4 v59, s[72:75], s37 offen offset:1024 lds
  v_pk_add_f32 v[84:85], v[84:85], v[112:113]
  v_pk_add_f32 v[86:87], v[86:87], v[112:113]
  v_pk_add_f32 v[88:89], v[88:89], v[112:113]
  v_pk_add_f32 v[90:91], v[90:91], v[112:113]
  v_pk_add_f32 v[92:93], v[92:93], v[112:113]
  v_pk_add_f32 v[94:95], v[94:95], v[112:113]
  v_pk_add_f32 v[96:97], v[96:97], v[112:113]
  v_pk_add_f32 v[98:99], v[98:99], v[112:113]
  v_pk_add_f32 v[100:101], v[100:101], v[112:113]
  v_pk_add_f32 v[102:103], v[102:103], v[112:113]
  buffer_load_dwordx4 v60, s[72:75], s37 offen offset:2048 lds
  v_pk_add_f32 v[104:105], v[104:105], v[112:113]
  v_pk_add_f32 v[106:107], v[106:107], v[112:113]
  v_pk_add_f32 v[108:109], v[108:109], v[112:113]
  v_pk_add_f32 v[110:111], v[110:111], v[112:113]
  v_mul_f32 v114, 0x3e0293ee, v68
  v_mov_b32 v116, v68
  v_mov_b32 v117, v69
  v_mov_b32 v115, v114
  v_cvt_pk_bf16_f32 v64, v80, v81
  v_cvt_pk_bf16_f32 v65, v82, v83
  buffer_load_dwordx4 v61, s[72:75], s37 offen offset:3072 lds
  s_add_u32 s37, s37, 128
  v_cvt_pk_bf16_f32 v66, v84, v85
  v_cvt_pk_bf16_f32 v67, v86, v87
  v_cvt_pk_bf16_f32 v68, v88, v89
  v_cvt_pk_bf16_f32 v69, v90, v91
  v_cvt_pk_bf16_f32 v70, v92, v93
  v_cvt_pk_bf16_f32 v71, v94, v95
  v_cvt_pk_bf16_f32 v72, v96, v97
  v_cvt_pk_bf16_f32 v73, v98, v99
  v_cvt_pk_bf16_f32 v74, v100, v101
  v_cvt_pk_bf16_f32 v75, v102, v103
  v_cvt_pk_bf16_f32 v76, v104, v105
  v_cvt_pk_bf16_f32 v77, v106, v107
  v_cvt_pk_bf16_f32 v78, v108, v109
  v_cvt_pk_bf16_f32 v79, v110, v111
  buffer_load_dword v220, v223, s[24:27], 0 offen sc0 sc1
  s_lshl_b32 s48, s42, 7
  s_add_u32 s48, s48, 65536
  s_add_u32 s49, s48, 32768
  s_mov_b64 exec, 0xff
  buffer_store_dwordx4 v[112:115], v166, s[28:31], s48 offen sc0 sc1
  buffer_store_dwordx2 v[116:117], v166, s[28:31], s49 offen sc0 sc1
  s_mov_b64 exec, -1
  buffer_store_dwordx4 v[64:67], v217, s[4:7], s67 offen sc0 sc1
  s_add_u32 s67, s67, 4096
  buffer_store_dwordx4 v[68:71], v217, s[4:7], s67 offen sc0 sc1
  s_add_u32 s67, s67, 4096
  buffer_store_dwordx4 v[72:75], v217, s[4:7], s67 offen sc0 sc1
  s_add_u32 s67, s67, 4096
  buffer_store_dwordx4 v[76:79], v217, s[4:7], s67 offen sc0 sc1
L_p1go:
  s_mov_b32 s49, 32768
  s_waitcnt vmcnt(15) lgkmcnt(0)
  s_barrier
  ds_read_b64_tr_b16 a[192:193], v14 offset:0
  ds_read_b64_tr_b16 a[194:195], v14 offset:1024
  ds_read_b64_tr_b16 a[196:197], v14 offset:8192
  ds_read_b64_tr_b16 a[198:199], v14 offset:9216
  s_waitcnt vmcnt(7)
  ds_read_b128 a[128:131], v52 offset:0
  ds_read_b128 a[132:135], v53 offset:0
  ds_read_b128 a[136:139], v52 offset:2048
  ds_read_b128 a[140:143], v53 offset:2048
  ds_read_b128 a[144:147], v52 offset:4096
  ds_read_b128 a[148:151], v53 offset:4096
  ds_read_b128 a[152:155], v52 offset:6144
  ds_read_b128 a[156:159], v53 offset:6144
  ds_read_b64_tr_b16 a[200:201], v25 offset:16384
  ds_read_b64_tr_b16 a[202:203], v25 offset:17408
  ds_read_b64_tr_b16 a[204:205], v25 offset:24576
  ds_read_b64_tr_b16 a[206:207], v25 offset:25600
  s_waitcnt lgkmcnt(4)
  v_mfma_f32_16x16x32_bf16 a[0:3], a[192:195], a[128:131], 0
  v_mfma_f32_16x16x32_bf16 a[0:3], a[196:199], a[132:135], a[0:3]
  s_add_u32 m0, s40, s45
  v_mfma_f32_16x16x32_bf16 a[32:35], a[192:195], a[136:139], 0
  buffer_load_dwordx4 v2, s[8:11], s38 offen offset:0 lds
  v_mfma_f32_16x16x32_bf16 a[32:35], a[196:199], a[140:143], a[32:35]
  v_mfma_f32_16x16x32_bf16 a[64:67], a[192:195], a[144:147], 0
  ds_read_b64_tr_b16 a[208:209], v14 offset:8
  ds_read_b64_tr_b16 a[210:211], v14 offset:1032
  v_mfma_f32_16x16x32_bf16 a[64:67], a[196:199], a[148:151], a[64:67]
  buffer_load_dwordx4 v3, s[8:11], s38 offen offset:1024 lds
  v_mfma_f32_16x16x32_bf16 a[96:99], a[192:195], a[152:155], 0
  ds_read_b64_tr_b16 a[212:213], v14 offset:8200
  ds_read_b64_tr_b16 a[214:215], v14 offset:9224
  v_mfma_f32_16x16x32_bf16 a[96:99], a[196:199], a[156:159], a[96:99]
  v_smfmac_f32_16x16x64_bf16 v[32:35], v[144:147], a[192:199], v236
  s_waitcnt lgkmcnt(4)
  v_mfma_f32_16x16x32_bf16 v[64:67], a[200:203], a[128:131], 0
  buffer_load_dwordx4 v4, s[8:11], s38 offen offset:2048 lds
  v_mfma_f32_16x16x32_bf16 v[64:67], a[204:207], a[132:135], v[64:67]
  v_mfma_f32_16x16x32_bf16 v[72:75], a[200:203], a[136:139], 0
  buffer_load_dwordx4 v5, s[8:11], s38 offen offset:3072 lds
  v_mfma_f32_16x16x32_bf16 v[72:75], a[204:207], a[140:143], v[72:75]
  s_add_u32 s38, s38, 0x80000
  s_add_u32 m0, s40, s46
  v_mfma_f32_16x16x32_bf16 v[80:83], a[200:203], a[144:147], 0
  ds_read_b64_tr_b16 a[216:217], v26 offset:16384
  ds_read_b64_tr_b16 a[218:219], v26 offset:17408
  v_mfma_f32_16x16x32_bf16 v[80:83], a[204:207], a[148:151], v[80:83]
  buffer_load_dwordx4 v6, s[12:15], s39 offen offset:0 lds
  v_mfma_f32_16x16x32_bf16 v[88:91], a[200:203], a[152:155], 0
  ds_read_b64_tr_b16 a[220:221], v26 offset:24576
  ds_read_b64_tr_b16 a[222:223], v26 offset:25600
  v_mfma_f32_16x16x32_bf16 v[88:91], a[204:207], a[156:159], v[88:91]
  v_smfmac_f32_16x16x64_bf16 v[40:43], v[144:147], a[200:207], v236
  s_waitcnt lgkmcnt(4)
  v_mfma_f32_16x16x32_bf16 a[4:7], a[208:211], a[128:131], 0
  buffer_load_dwordx4 v7, s[12:15], s39 offen offset:1024 lds
  v_mfma_f32_16x16x32_bf16 a[4:7], a[212:215], a[132:135], a[4:7]
  v_mfma_f32_16x16x32_bf16 a[36:39], a[208:211], a[136:139], 0
  buffer_load_dwordx4 v8, s[12:15], s39 offen offset:2048 lds
  v_mfma_f32_16x16x32_bf16 a[36:39], a[212:215], a[140:143], a[36:39]
  v_mfma_f32_16x16x32_bf16 a[68:71], a[208:211], a[144:147], 0
  ds_read_b64_tr_b16 a[224:225], v15 offset:0
  ds_read_b64_tr_b16 a[226:227], v15 offset:1024
  v_mfma_f32_16x16x32_bf16 a[68:71], a[212:215], a[148:151], a[68:71]
  buffer_load_dwordx4 v9, s[12:15], s39 offen offset:3072 lds
  v_mfma_f32_16x16x32_bf16 a[100:103], a[208:211], a[152:155], 0
  s_add_u32 s39, s39, 0x70000
  s_mov_b32 s41, s49
  v_mfma_f32_16x16x32_bf16 a[100:103], a[212:215], a[156:159], a[100:103]
  s_mov_b32 s49, s40
  s_add_u32 s40, s40, 32768
  v_smfmac_f32_16x16x64_bf16 v[36:39], v[144:147], a[208:215], v236
  s_cmp_lt_u32 s40, 98304
  s_waitcnt lgkmcnt(2)
  v_mfma_f32_16x16x32_bf16 v[68:71], a[216:219], a[128:131], 0
  s_cselect_b32 s40, s40, 0
  s_lshl1_add_u32 m0, s45, 98304
  v_mfma_f32_16x16x32_bf16 v[68:71], a[220:223], a[132:135], v[68:71]
  buffer_load_dwordx4 v58, s[72:75], s36 offen offset:0 lds
  v_mfma_f32_16x16x32_bf16 v[76:79], a[216:219], a[136:139], 0
  buffer_load_dwordx4 v59, s[72:75], s36 offen offset:1024 lds
  v_mfma_f32_16x16x32_bf16 v[76:79], a[220:223], a[140:143], v[76:79]
  ds_read_b64_tr_b16 a[228:229], v15 offset:8192
  ds_read_b64_tr_b16 a[230:231], v15 offset:9216
  v_mfma_f32_16x16x32_bf16 v[84:87], a[216:219], a[144:147], 0
  ds_read_b64_tr_b16 a[192:193], v27 offset:16384
  ds_read_b64_tr_b16 a[194:195], v27 offset:17408
  v_mfma_f32_16x16x32_bf16 v[84:87], a[220:223], a[148:151], v[84:87]
  buffer_load_dwordx4 v60, s[72:75], s36 offen offset:2048 lds
  v_mfma_f32_16x16x32_bf16 v[92:95], a[216:219], a[152:155], 0
  ds_read_b64_tr_b16 a[196:197], v27 offset:24576
  ds_read_b64_tr_b16 a[198:199], v27 offset:25600
  v_mfma_f32_16x16x32_bf16 v[92:95], a[220:223], a[156:159], v[92:95]
  v_smfmac_f32_16x16x64_bf16 v[44:47], v[144:147], a[216:223], v236
  s_waitcnt lgkmcnt(4)
  v_mfma_f32_16x16x32_bf16 a[8:11], a[224:227], a[128:131], 0
  buffer_load_dwordx4 v61, s[72:75], s36 offen offset:3072 lds
  v_mfma_f32_16x16x32_bf16 a[8:11], a[228:231], a[132:135], a[8:11]
  s_add_u32 s36, s36, 128
  s_lshl1_add_u32 m0, s45, 102400
  v_mfma_f32_16x16x32_bf16 a[40:43], a[224:227], a[136:139], 0
  buffer_load_dwordx4 v58, s[72:75], s37 offen offset:0 lds
  v_mfma_f32_16x16x32_bf16 a[40:43], a[228:231], a[140:143], a[40:43]
  ds_read_b64_tr_b16 a[200:201], v15 offset:8
  ds_read_b64_tr_b16 a[202:203], v15 offset:1032
  v_mfma_f32_16x16x32_bf16 a[72:75], a[224:227], a[144:147], 0
  ds_read_b64_tr_b16 a[204:205], v15 offset:8200
  ds_read_b64_tr_b16 a[206:207], v15 offset:9224
  v_mfma_f32_16x16x32_bf16 a[72:75], a[228:231], a[148:151], a[72:75]
  buffer_load_dwordx4 v59, s[72:75], s37 offen offset:1024 lds
  v_mfma_f32_16x16x32_bf16 a[104:107], a[224:227], a[152:155], 0
  v_mfma_f32_16x16x32_bf16 a[104:107], a[228:231], a[156:159], a[104:107]
  s_waitcnt lgkmcnt(4)
  v_mfma_f32_16x16x32_bf16 v[96:99], a[192:195], a[128:131], 0
  buffer_load_dwordx4 v60, s[72:75], s37 offen offset:2048 lds
  v_mfma_f32_16x16x32_bf16 v[96:99], a[196:199], a[132:135], v[96:99]
  v_mfma_f32_16x16x32_bf16 v[104:107], a[192:195], a[136:139], 0
  ds_read_b64_tr_b16 a[208:209], v28 offset:16384
  ds_read_b64_tr_b16 a[210:211], v28 offset:17408
  v_mfma_f32_16x16x32_bf16 v[104:107], a[196:199], a[140:143], v[104:107]
  buffer_load_dwordx4 v61, s[72:75], s37 offen offset:3072 lds
  v_mfma_f32_16x16x32_bf16 v[112:115], a[192:195], a[144:147], 0
  s_add_u32 s37, s37, 128
  s_add_u32 m0, s40, s45
  v_mfma_f32_16x16x32_bf16 v[112:115], a[196:199], a[148:151], v[112:115]
  ds_read_b64_tr_b16 a[212:213], v28 offset:24576
  ds_read_b64_tr_b16 a[214:215], v28 offset:25600
  v_mfma_f32_16x16x32_bf16 v[120:123], a[192:195], a[152:155], 0
  buffer_load_dwordx4 v2, s[8:11], s38 offen offset:0 lds
  v_mfma_f32_16x16x32_bf16 v[120:123], a[196:199], a[156:159], v[120:123]
  s_waitcnt lgkmcnt(4)
  v_mfma_f32_16x16x32_bf16 a[12:15], a[200:203], a[128:131], 0
  v_mfma_f32_16x16x32_bf16 a[12:15], a[204:207], a[132:135], a[12:15]
  v_mfma_f32_16x16x32_bf16 a[44:47], a[200:203], a[136:139], 0
  ds_read_b64_tr_b16 a[216:217], v16 offset:0
  ds_read_b64_tr_b16 a[218:219], v16 offset:1024
  v_mfma_f32_16x16x32_bf16 a[44:47], a[204:207], a[140:143], a[44:47]
  ds_read_b64_tr_b16 a[220:221], v16 offset:8192
  ds_read_b64_tr_b16 a[222:223], v16 offset:9216
  v_mfma_f32_16x16x32_bf16 a[76:79], a[200:203], a[144:147], 0
  buffer_load_dwordx4 v3, s[8:11], s38 offen offset:1024 lds
  v_mfma_f32_16x16x32_bf16 a[76:79], a[204:207], a[148:151], a[76:79]
  v_mfma_f32_16x16x32_bf16 a[108:111], a[200:203], a[152:155], 0
  v_mfma_f32_16x16x32_bf16 a[108:111], a[204:207], a[156:159], a[108:111]
  s_waitcnt lgkmcnt(4)
  v_mfma_f32_16x16x32_bf16 v[100:103], a[208:211], a[128:131], 0
  s_waitcnt vmcnt(18)
  s_barrier
  s_cmp_eq_u32 s3, 0
  s_cbranch_scc1 L_post
L_postb:
  v_mfma_f32_16x16x32_bf16 v[100:103], a[212:215], a[132:135], v[100:103]
  ds_read_b64_tr_b16 a[224:225], v29 offset:16384
  ds_read_b64_tr_b16 a[226:227], v29 offset:17408
  v_mfma_f32_16x16x32_bf16 v[108:111], a[208:211], a[136:139], 0
  buffer_load_dwordx4 v4, s[8:11], s38 offen offset:2048 lds
  v_mfma_f32_16x16x32_bf16 v[108:111], a[212:215], a[140:143], v[108:111]
  ds_read_b64_tr_b16 a[228:229], v29 offset:24576
  ds_read_b64_tr_b16 a[230:231], v29 offset:25600
  v_mfma_f32_16x16x32_bf16 v[116:119], a[208:211], a[144:147], 0
  s_lshr_b32 s35, s32, 1
  v_mfma_f32_16x16x32_bf16 v[116:119], a[212:215], a[148:151], v[116:119]
  v_mfma_f32_16x16x32_bf16 v[124:127], a[208:211], a[152:155], 0
  s_mul_i32 s35, s35, 14336
  v_mfma_f32_16x16x32_bf16 v[124:127], a[212:215], a[156:159], v[124:127]
  s_mul_i32 s66, s50, 229376
  s_waitcnt lgkmcnt(4)
  v_mfma_f32_16x16x32_bf16 a[16:19], a[216:219], a[128:131], 0
  buffer_load_dwordx4 v5, s[8:11], s38 offen offset:3072 lds
  v_mfma_f32_16x16x32_bf16 a[16:19], a[220:223], a[132:135], a[16:19]
  s_add_u32 s38, s38, 0x80000
  ds_read_b64_tr_b16 a[192:193], v16 offset:8
  v_mfma_f32_16x16x32_bf16 a[48:51], a[216:219], a[136:139], 0
  ds_read_b64_tr_b16 a[194:195], v16 offset:1032
  ds_read_b64_tr_b16 a[196:197], v16 offset:8200
  v_mfma_f32_16x16x32_bf16 a[48:51], a[220:223], a[140:143], a[48:51]
  ds_read_b64_tr_b16 a[198:199], v16 offset:9224
  v_mfma_f32_16x16x32_bf16 a[80:83], a[216:219], a[144:147], 0
  s_mul_i32 s67, s51, 229376
  v_mfma_f32_16x16x32_bf16 a[80:83], a[220:223], a[148:151], a[80:83]
  s_add_u32 m0, s40, s46
  v_mfma_f32_16x16x32_bf16 a[112:115], a[216:219], a[152:155], 0
  buffer_load_dwordx4 v6, s[12:15], s39 offen offset:0 lds
  v_mfma_f32_16x16x32_bf16 a[112:115], a[220:223], a[156:159], a[112:115]
  s_add_u32 s66, s66, s35
  s_waitcnt lgkmcnt(4)
  v_mfma_f32_16x16x32_bf16 v[128:131], a[224:227], a[128:131], 0
  v_mfma_f32_16x16x32_bf16 v[128:131], a[228:231], a[132:135], v[128:131]
  s_add_u32 s67, s67, s35
  v_mfma_f32_16x16x32_bf16 v[136:139], a[224:227], a[136:139], 0
  ds_read_b64_tr_b16 a[200:201], v30 offset:16384
  ds_read_b64_tr_b16 a[202:203], v30 offset:17408
  v_mfma_f32_16x16x32_bf16 v[136:139], a[228:231], a[140:143], v[136:139]
  ds_read_b64_tr_b16 a[204:205], v30 offset:24576
  ds_read_b64_tr_b16 a[206:207], v30 offset:25600
  v_mfma_f32_16x16x32_bf16 v[172:175], a[224:227], a[144:147], 0
  buffer_load_dwordx4 v7, s[12:15], s39 offen offset:1024 lds
  v_mfma_f32_16x16x32_bf16 v[172:175], a[228:231], a[148:151], v[172:175]
  s_lshl_b32 s48, s34, 9
  v_mfma_f32_16x16x32_bf16 v[180:183], a[224:227], a[152:155], 0
  v_mfma_f32_16x16x32_bf16 v[180:183], a[228:231], a[156:159], v[180:183]
  s_add_u32 s48, s48, 6144
  s_waitcnt lgkmcnt(4)
  v_mfma_f32_16x16x32_bf16 a[20:23], a[192:195], a[128:131], 0
  v_and_b32 v171, 0x1f0, v166
  v_mfma_f32_16x16x32_bf16 a[20:23], a[196:199], a[132:135], a[20:23]
  ds_read_b64_tr_b16 a[208:209], v17 offset:0
  ds_read_b64_tr_b16 a[210:211], v17 offset:1024
  v_mfma_f32_16x16x32_bf16 a[52:55], a[192:195], a[136:139], 0
  buffer_load_dwordx4 v8, s[12:15], s39 offen offset:2048 lds
  v_mfma_f32_16x16x32_bf16 a[52:55], a[196:199], a[140:143], a[52:55]
  ds_read_b64_tr_b16 a[212:213], v17 offset:8192
  ds_read_b64_tr_b16 a[214:215], v17 offset:9216
  v_mfma_f32_16x16x32_bf16 a[84:87], a[192:195], a[144:147], 0
  v_lshrrev_b32 v210, 9, v166
  v_mfma_f32_16x16x32_bf16 a[84:87], a[196:199], a[148:151], a[84:87]
  v_mfma_f32_16x16x32_bf16 a[116:119], a[192:195], a[152:155], 0
  v_add_u32 v171, s48, v171
  v_mfma_f32_16x16x32_bf16 a[116:119], a[196:199], a[156:159], a[116:119]
  s_waitcnt vmcnt(7)
  s_waitcnt lgkmcnt(4)
  v_mfma_f32_16x16x32_bf16 v[132:135], a[200:203], a[128:131], 0
  ds_read_b128 a[160:163], v52 offset:0
  v_mfma_f32_16x16x32_bf16 v[132:135], a[204:207], a[132:135], v[132:135]
  ds_read_b128 a[164:167], v53 offset:0
  v_lshl_add_u32 v171, v210, 3, v171
  v_mfma_f32_16x16x32_bf16 v[140:143], a[200:203], a[136:139], 0
  ds_read_b128 a[168:171], v52 offset:2048
  ds_read_b64_tr_b16 a[216:217], v31 offset:16384
  v_mfma_f32_16x16x32_bf16 v[140:143], a[204:207], a[140:143], v[140:143]
  ds_read_b128 a[172:175], v53 offset:2048
  ds_read_b64_tr_b16 a[218:219], v31 offset:17408
  v_mfma_f32_16x16x32_bf16 v[176:179], a[200:203], a[144:147], 0
  ds_read_b128 a[176:179], v52 offset:4096
  ds_read_b64_tr_b16 a[220:221], v31 offset:24576
  v_mfma_f32_16x16x32_bf16 v[176:179], a[204:207], a[148:151], v[176:179]
  ds_read_b128 a[180:183], v53 offset:4096
  ds_read_b64_tr_b16 a[222:223], v31 offset:25600
  v_mfma_f32_16x16x32_bf16 v[184:187], a[200:203], a[152:155], 0
  ds_read_b128 a[184:187], v52 offset:6144
  s_lshl_b32 s48, s34, 13
  v_mfma_f32_16x16x32_bf16 v[184:187], a[204:207], a[156:159], v[184:187]
  ds_read_b128 a[188:191], v53 offset:6144
  s_waitcnt lgkmcnt(12)
  v_mfma_f32_16x16x32_bf16 a[24:27], a[208:211], a[128:131], 0
  buffer_load_dwordx4 v9, s[12:15], s39 offen offset:3072 lds
  v_mfma_f32_16x16x32_bf16 a[24:27], a[212:215], a[132:135], a[24:27]
  s_add_u32 s39, s39, 0x70000
  s_mov_b32 s41, s49
  v_mfma_f32_16x16x32_bf16 a[56:59], a[208:211], a[136:139], 0
  s_mov_b32 s49, s40
  s_add_u32 s40, s40, 32768
  v_mfma_f32_16x16x32_bf16 a[56:59], a[212:215], a[140:143], a[56:59]
  s_cmp_lt_u32 s40, 98304
  s_cselect_b32 s40, s40, 0
  v_mfma_f32_16x16x32_bf16 a[88:91], a[208:211], a[144:147], 0
  ds_read_b64_tr_b16 a[224:225], v17 offset:8
  ds_read_b64_tr_b16 a[226:227], v17 offset:1032
  v_mfma_f32_16x16x32_bf16 a[88:91], a[212:215], a[148:151], a[88:91]
  ds_read_b64_tr_b16 a[228:229], v17 offset:8200
  ds_read_b64_tr_b16 a[230:231], v17 offset:9224
  v_mfma_f32_16x16x32_bf16 a[120:123], a[208:211], a[152:155], 0
  v_add_u32 v210, s48, v166
  v_mfma_f32_16x16x32_bf16 a[120:123], a[212:215], a[156:159], a[120:123]
  s_waitcnt lgkmcnt(6)
  v_mfma_f32_16x16x32_bf16 v[188:191], a[216:219], a[128:131], 0
  s_waitcnt lgkmcnt(0)
  s_barrier
  v_mfma_f32_16x16x32_bf16 v[188:191], a[220:223], a[132:135], v[188:191]
  v_add_u32 v14, s41, v10
  v_add_u32 v25, s41, v18
  v_mfma_f32_16x16x32_bf16 v[192:195], a[216:219], a[136:139], 0
  v_add_u32 v26, s41, v19
  v_add_u32 v15, s41, v11
  v_mfma_f32_16x16x32_bf16 v[192:195], a[220:223], a[140:143], v[192:195]
  v_add_u32 v27, s41, v20
  v_add_u32 v28, s41, v21
  v_mfma_f32_16x16x32_bf16 v[196:199], a[216:219], a[144:147], 0
  v_add_u32 v16, s41, v12
  v_add_u32 v29, s41, v22
  v_mfma_f32_16x16x32_bf16 v[196:199], a[220:223], a[148:151], v[196:199]
  v_add_u32 v30, s41, v23
  v_add_u32 v17, s41, v13
  v_mfma_f32_16x16x32_bf16 v[200:203], a[216:219], a[152:155], 0
  ds_read_b64_tr_b16 a[192:193], v14 offset:0
  v_add_u32 v31, s41, v24
  v_mfma_f32_16x16x32_bf16 v[200:203], a[220:223], a[156:159], v[200:203]
  buffer_load_dword v248, v219, s[68:71], s56 offen
  v_smfmac_f32_16x16x64_bf16 v[48:51], v[144:147], a[216:223], v236
  s_add_u32 s56, s56, s57
  v_mfma_f32_16x16x32_bf16 a[28:31], a[224:227], a[128:131], 0
  ds_read_b64_tr_b16 a[194:195], v14 offset:1024
  ds_read_b64_tr_b16 a[196:197], v14 offset:8192
  v_mfma_f32_16x16x32_bf16 a[28:31], a[228:231], a[132:135], a[28:31]
  ds_read_b64_tr_b16 a[198:199], v14 offset:9216
  ds_read_b64_tr_b16 a[200:201], v25 offset:16384
  v_mfma_f32_16x16x32_bf16 a[60:63], a[224:227], a[136:139], 0
  s_cmp_eq_u32 s3, 3
  s_cselect_b32 s35, 0, s3
  v_mfma_f32_16x16x32_bf16 a[60:63], a[228:231], a[140:143], a[60:63]
  ds_read_b64_tr_b16 a[202:203], v25 offset:17408
  ds_read_b64_tr_b16 a[204:205], v25 offset:24576
  v_mfma_f32_16x16x32_bf16 a[92:95], a[224:227], a[144:147], 0
  ds_read_b64_tr_b16 a[206:207], v25 offset:25600
  s_lshl_b32 s48, s35, 11
  v_mfma_f32_16x16x32_bf16 a[92:95], a[228:231], a[148:151], a[92:95]
  v_add_u32 v168, s48, v210
  s_add_u32 s48, s48, 2048
  v_mfma_f32_16x16x32_bf16 a[124:127], a[224:227], a[152:155], 0
  v_mfma_f32_16x16x32_bf16 a[124:127], a[228:231], a[156:159], a[124:127]
  s_lshl1_add_u32 m0, s45, 98304
  s_waitcnt lgkmcnt(4)
  v_mfma_f32_16x16x32_bf16 a[0:3], a[192:195], a[160:163], a[0:3]
  s_cmp_eq_u32 s48, 6144
  s_cselect_b32 s48, 0, s48
  v_mfma_f32_16x16x32_bf16 a[0:3], a[196:199], a[164:167], a[0:3]
  v_add_u32 v169, s48, v210
  s_add_u32 s48, s48, 2048
  v_mfma_f32_16x16x32_bf16 a[32:35], a[192:195], a[168:171], a[32:35]
  buffer_load_dwordx4 v58, s[72:75], s36 offen offset:0 lds
  v_mfma_f32_16x16x32_bf16 a[32:35], a[196:199], a[172:175], a[32:35]
  s_cmp_eq_u32 s48, 6144
  s_cselect_b32 s48, 0, s48
  v_mfma_f32_16x16x32_bf16 a[64:67], a[192:195], a[176:179], a[64:67]
  ds_read_b64_tr_b16 a[208:209], v14 offset:8
  ds_read_b64_tr_b16 a[210:211], v14 offset:1032
  v_mfma_f32_16x16x32_bf16 a[64:67], a[196:199], a[180:183], a[64:67]
  ds_read_b64_tr_b16 a[212:213], v14 offset:8200
  ds_read_b64_tr_b16 a[214:215], v14 offset:9224
  v_mfma_f32_16x16x32_bf16 a[96:99], a[192:195], a[184:187], a[96:99]
  buffer_load_dwordx4 v59, s[72:75], s36 offen offset:1024 lds
  v_mfma_f32_16x16x32_bf16 a[96:99], a[196:199], a[188:191], a[96:99]
  v_add_u32 v170, s48, v210
  v_smfmac_f32_16x16x64_bf16 v[32:35], v[144:147], a[192:199], v236
  s_waitcnt lgkmcnt(4)
  v_mfma_f32_16x16x32_bf16 v[64:67], a[200:203], a[160:163], v[64:67]
  s_lshl_b32 s35, s35, 7
  v_mfma_f32_16x16x32_bf16 v[64:67], a[204:207], a[164:167], v[64:67]
  buffer_load_dwordx4 v60, s[72:75], s36 offen offset:2048 lds
  v_mfma_f32_16x16x32_bf16 v[72:75], a[200:203], a[168:171], v[72:75]
  v_mfma_f32_16x16x32_bf16 v[72:75], a[204:207], a[172:175], v[72:75]
  v_mfma_f32_16x16x32_bf16 v[80:83], a[200:203], a[176:179], v[80:83]
  s_add_u32 s35, s35, 141312
  s_lshl_b32 s48, s3, 7
  v_mfma_f32_16x16x32_bf16 v[80:83], a[204:207], a[180:183], v[80:83]
  buffer_load_dwordx4 v61, s[72:75], s36 offen offset:3072 lds
  v_mfma_f32_16x16x32_bf16 v[88:91], a[200:203], a[184:187], v[88:91]
  s_add_u32 s36, s36, 128
  ds_read_b64_tr_b16 a[216:217], v26 offset:16384
  v_mfma_f32_16x16x32_bf16 v[88:91], a[204:207], a[188:191], v[88:91]
  ds_read_b64_tr_b16 a[218:219], v26 offset:17408
  ds_read_b64_tr_b16 a[220:221], v26 offset:24576
  v_smfmac_f32_16x16x64_bf16 v[40:43], v[144:147], a[200:207], v236
  s_lshl1_add_u32 m0, s45, 102400
  s_waitcnt lgkmcnt(3)
  v_mfma_f32_16x16x32_bf16 a[4:7], a[208:211], a[160:163], a[4:7]
  buffer_load_dwordx4 v58, s[72:75], s37 offen offset:0 lds
  v_mfma_f32_16x16x32_bf16 a[4:7], a[212:215], a[164:167], a[4:7]
  ds_read_b64_tr_b16 a[222:223], v26 offset:25600
  s_add_u32 s48, s48, 140288
  v_mfma_f32_16x16x32_bf16 a[36:39], a[208:211], a[168:171], a[36:39]
  v_lshrrev_b32 v210, 2, v166
  v_mfma_f32_16x16x32_bf16 a[36:39], a[212:215], a[172:175], a[36:39]
  ds_read_b64_tr_b16 a[224:225], v15 offset:0
  ds_read_b64_tr_b16 a[226:227], v15 offset:1024
  v_mfma_f32_16x16x32_bf16 a[68:71], a[208:211], a[176:179], a[68:71]
  buffer_load_dwordx4 v59, s[72:75], s37 offen offset:1024 lds
  v_mfma_f32_16x16x32_bf16 a[68:71], a[212:215], a[180:183], a[68:71]
  ds_read_b64_tr_b16 a[228:229], v15 offset:8192
  ds_read_b64_tr_b16 a[230:231], v15 offset:9216
  v_mfma_f32_16x16x32_bf16 a[100:103], a[208:211], a[184:187], a[100:103]
  v_add_u32 v56, s48, v210
  v_mfma_f32_16x16x32_bf16 a[100:103], a[212:215], a[188:191], a[100:103]
  v_smfmac_f32_16x16x64_bf16 v[36:39], v[144:147], a[208:215], v236
  v_and_b32 v211, 0x7c, v210
  s_waitcnt lgkmcnt(4)
  v_mfma_f32_16x16x32_bf16 v[68:71], a[216:219], a[160:163], v[68:71]
  buffer_load_dwordx4 v60, s[72:75], s37 offen offset:2048 lds
  v_mfma_f32_16x16x32_bf16 v[68:71], a[220:223], a[164:167], v[68:71]
  v_mfma_f32_16x16x32_bf16 v[76:79], a[216:219], a[168:171], v[76:79]
  v_add_u32 v57, s35, v211
  v_mfma_f32_16x16x32_bf16 v[76:79], a[220:223], a[172:175], v[76:79]
  buffer_load_dwordx4 v61, s[72:75], s37 offen offset:3072 lds
  v_mfma_f32_16x16x32_bf16 v[84:87], a[216:219], a[176:179], v[84:87]
  s_add_u32 s37, s37, 128
  ds_read_b64_tr_b16 a[192:193], v27 offset:16384
  v_mfma_f32_16x16x32_bf16 v[84:87], a[220:223], a[180:183], v[84:87]
  ds_read_b64_tr_b16 a[194:195], v27 offset:17408
  ds_read_b64_tr_b16 a[196:197], v27 offset:24576
  v_mfma_f32_16x16x32_bf16 v[92:95], a[216:219], a[184:187], v[92:95]
  ds_read_b64_tr_b16 a[198:199], v27 offset:25600
  v_and_b32 v211, 0x3c, v210
  v_mfma_f32_16x16x32_bf16 v[92:95], a[220:223], a[188:191], v[92:95]
  v_smfmac_f32_16x16x64_bf16 v[44:47], v[144:147], a[216:223], v236
  v_and_b32 v210, 0x40, v210
  s_waitcnt lgkmcnt(4)
  v_mfma_f32_16x16x32_bf16 a[8:11], a[224:227], a[160:163], a[8:11]
  v_mfma_f32_16x16x32_bf16 a[8:11], a[228:231], a[164:167], a[8:11]
  v_add_u32 v54, s48, v211
  v_mfma_f32_16x16x32_bf16 a[40:43], a[224:227], a[168:171], a[40:43]
  ds_read_b64_tr_b16 a[200:201], v15 offset:8
  ds_read_b64_tr_b16 a[202:203], v15 offset:1032
  v_mfma_f32_16x16x32_bf16 a[40:43], a[228:231], a[172:175], a[40:43]
  ds_read_b64_tr_b16 a[204:205], v15 offset:8200
  ds_read_b64_tr_b16 a[206:207], v15 offset:9224
  v_mfma_f32_16x16x32_bf16 a[72:75], a[224:227], a[176:179], a[72:75]
  v_add_u32 v55, s35, v211
  v_mfma_f32_16x16x32_bf16 a[72:75], a[228:231], a[180:183], a[72:75]
  v_mfma_f32_16x16x32_bf16 a[104:107], a[224:227], a[184:187], a[104:107]
  v_mfma_f32_16x16x32_bf16 a[104:107], a[228:231], a[188:191], a[104:107]
  v_lshl_add_u32 v54, v210, 3, v54
  s_waitcnt lgkmcnt(4)
  v_mfma_f32_16x16x32_bf16 v[96:99], a[192:195], a[160:163], v[96:99]
  v_mfma_f32_16x16x32_bf16 v[96:99], a[196:199], a[164:167], v[96:99]
  v_mul_u32_u24 v210, 6, v210
  v_mfma_f32_16x16x32_bf16 v[104:107], a[192:195], a[168:171], v[104:107]
  ds_read_b64_tr_b16 a[208:209], v28 offset:16384
  ds_read_b64_tr_b16 a[210:211], v28 offset:17408
  v_mfma_f32_16x16x32_bf16 v[104:107], a[196:199], a[172:175], v[104:107]
  ds_read_b64_tr_b16 a[212:213], v28 offset:24576
  ds_read_b64_tr_b16 a[214:215], v28 offset:25600
  v_mfma_f32_16x16x32_bf16 v[112:115], a[192:195], a[176:179], v[112:115]
  v_mfma_f32_16x16x32_bf16 v[112:115], a[196:199], a[180:183], v[112:115]
  s_add_u32 m0, s40, s45
  v_add_u32 v55, v55, v210
  v_mfma_f32_16x16x32_bf16 v[120:123], a[192:195], a[184:187], v[120:123]
  buffer_load_dwordx4 v2, s[8:11], s38 offen offset:0 lds
  v_mfma_f32_16x16x32_bf16 v[120:123], a[196:199], a[188:191], v[120:123]
  v_lshlrev_b32 v167, 2, v166
  s_waitcnt lgkmcnt(4)
  v_mfma_f32_16x16x32_bf16 a[12:15], a[200:203], a[160:163], a[12:15]
  v_mfma_f32_16x16x32_bf16 a[12:15], a[204:207], a[164:167], a[12:15]
  v_and_b32 v210, 512, v166
  v_mfma_f32_16x16x32_bf16 a[44:47], a[200:203], a[168:171], a[44:47]
  ds_read_b64_tr_b16 a[216:217], v16 offset:0
  ds_read_b64_tr_b16 a[218:219], v16 offset:1024
  v_mfma_f32_16x16x32_bf16 a[44:47], a[204:207], a[172:175], a[44:47]
  ds_read_b64_tr_b16 a[220:221], v16 offset:8192
  ds_read_b64_tr_b16 a[222:223], v16 offset:9216
  v_mfma_f32_16x16x32_bf16 a[76:79], a[200:203], a[176:179], a[76:79]
  buffer_load_dwordx4 v3, s[8:11], s38 offen offset:1024 lds
  v_mfma_f32_16x16x32_bf16 a[76:79], a[204:207], a[180:183], a[76:79]
  v_lshl_add_u32 v167, v210, 22, v167
  v_mfma_f32_16x16x32_bf16 a[108:111], a[200:203], a[184:187], a[108:111]
  v_mfma_f32_16x16x32_bf16 a[108:111], a[204:207], a[188:191], a[108:111]
  s_waitcnt lgkmcnt(4)
  v_mfma_f32_16x16x32_bf16 v[100:103], a[208:211], a[160:163], v[100:103]
  v_mfma_f32_16x16x32_bf16 v[100:103], a[212:215], a[164:167], v[100:103]
  ds_read_b64_tr_b16 a[224:225], v29 offset:16384
  ds_read_b64_tr_b16 a[226:227], v29 offset:17408
  v_mfma_f32_16x16x32_bf16 v[108:111], a[208:211], a[168:171], v[108:111]
  buffer_load_dwordx4 v4, s[8:11], s38 offen offset:2048 lds
  v_mfma_f32_16x16x32_bf16 v[108:111], a[212:215], a[172:175], v[108:111]
  ds_read_b64_tr_b16 a[228:229], v29 offset:24576
  ds_read_b64_tr_b16 a[230:231], v29 offset:25600
  v_mfma_f32_16x16x32_bf16 v[116:119], a[208:211], a[176:179], v[116:119]
  v_mfma_f32_16x16x32_bf16 v[116:119], a[212:215], a[180:183], v[116:119]
  v_mfma_f32_16x16x32_bf16 v[124:127], a[208:211], a[184:187], v[124:127]
  v_mfma_f32_16x16x32_bf16 v[124:127], a[212:215], a[188:191], v[124:127]
  s_waitcnt lgkmcnt(4)
  v_mfma_f32_16x16x32_bf16 a[16:19], a[216:219], a[160:163], a[16:19]
  buffer_load_dwordx4 v5, s[8:11], s38 offen offset:3072 lds
  v_mfma_f32_16x16x32_bf16 a[16:19], a[220:223], a[164:167], a[16:19]
  s_add_u32 s38, s38, 0x80000
  ds_read_b64_tr_b16 a[192:193], v16 offset:8
  v_mfma_f32_16x16x32_bf16 a[48:51], a[216:219], a[168:171], a[48:51]
  ds_read_b64_tr_b16 a[194:195], v16 offset:1032
  ds_read_b64_tr_b16 a[196:197], v16 offset:8200
  v_mfma_f32_16x16x32_bf16 a[48:51], a[220:223], a[172:175], a[48:51]
  ds_read_b64_tr_b16 a[198:199], v16 offset:9224
  v_mfma_f32_16x16x32_bf16 a[80:83], a[216:219], a[176:179], a[80:83]
  v_mfma_f32_16x16x32_bf16 a[80:83], a[220:223], a[180:183], a[80:83]
  s_add_u32 m0, s40, s46
  v_mfma_f32_16x16x32_bf16 a[112:115], a[216:219], a[184:187], a[112:115]
  buffer_load_dwordx4 v6, s[12:15], s39 offen offset:0 lds
  v_mfma_f32_16x16x32_bf16 a[112:115], a[220:223], a[188:191], a[112:115]
  s_waitcnt lgkmcnt(4)
  v_mfma_f32_16x16x32_bf16 v[128:131], a[224:227], a[160:163], v[128:131]
  v_mfma_f32_16x16x32_bf16 v[128:131], a[228:231], a[164:167], v[128:131]
  v_mfma_f32_16x16x32_bf16 v[136:139], a[224:227], a[168:171], v[136:139]
  ds_read_b64_tr_b16 a[200:201], v30 offset:16384
  ds_read_b64_tr_b16 a[202:203], v30 offset:17408
  v_mfma_f32_16x16x32_bf16 v[136:139], a[228:231], a[172:175], v[136:139]
  ds_read_b64_tr_b16 a[204:205], v30 offset:24576
  ds_read_b64_tr_b16 a[206:207], v30 offset:25600
  v_mfma_f32_16x16x32_bf16 v[172:175], a[224:227], a[176:179], v[172:175]
  buffer_load_dwordx4 v7, s[12:15], s39 offen offset:1024 lds
  v_mfma_f32_16x16x32_bf16 v[172:175], a[228:231], a[180:183], v[172:175]
  v_mfma_f32_16x16x32_bf16 v[180:183], a[224:227], a[184:187], v[180:183]
  v_mfma_f32_16x16x32_bf16 v[180:183], a[228:231], a[188:191], v[180:183]
  s_waitcnt lgkmcnt(4)
  v_mfma_f32_16x16x32_bf16 a[20:23], a[192:195], a[160:163], a[20:23]
  v_mfma_f32_16x16x32_bf16 a[20:23], a[196:199], a[164:167], a[20:23]
  ds_read_b64_tr_b16 a[208:209], v17 offset:0
  ds_read_b64_tr_b16 a[210:211], v17 offset:1024
  v_mfma_f32_16x16x32_bf16 a[52:55], a[192:195], a[168:171], a[52:55]
  buffer_load_dwordx4 v8, s[12:15], s39 offen offset:2048 lds
  v_mfma_f32_16x16x32_bf16 a[52:55], a[196:199], a[172:175], a[52:55]
  ds_read_b64_tr_b16 a[212:213], v17 offset:8192
  ds_read_b64_tr_b16 a[214:215], v17 offset:9216
  v_mfma_f32_16x16x32_bf16 a[84:87], a[192:195], a[176:179], a[84:87]
  v_mfma_f32_16x16x32_bf16 a[84:87], a[196:199], a[180:183], a[84:87]
  v_mfma_f32_16x16x32_bf16 a[116:119], a[192:195], a[184:187], a[116:119]
  v_mfma_f32_16x16x32_bf16 a[116:119], a[196:199], a[188:191], a[116:119]
  s_waitcnt vmcnt(7)
  s_waitcnt lgkmcnt(4)
  v_mfma_f32_16x16x32_bf16 v[132:135], a[200:203], a[160:163], v[132:135]
  ds_read_b128 a[128:131], v52 offset:0
  v_mfma_f32_16x16x32_bf16 v[132:135], a[204:207], a[164:167], v[132:135]
  ds_read_b128 a[132:135], v53 offset:0
  v_mfma_f32_16x16x32_bf16 v[140:143], a[200:203], a[168:171], v[140:143]
  ds_read_b128 a[136:139], v52 offset:2048
  ds_read_b64_tr_b16 a[216:217], v31 offset:16384
  v_mfma_f32_16x16x32_bf16 v[140:143], a[204:207], a[172:175], v[140:143]
  ds_read_b128 a[140:143], v53 offset:2048
  ds_read_b64_tr_b16 a[218:219], v31 offset:17408
  v_mfma_f32_16x16x32_bf16 v[176:179], a[200:203], a[176:179], v[176:179]
  ds_read_b128 a[144:147], v52 offset:4096
  ds_read_b64_tr_b16 a[220:221], v31 offset:24576
  v_mfma_f32_16x16x32_bf16 v[176:179], a[204:207], a[180:183], v[176:179]
  ds_read_b128 a[148:151], v53 offset:4096
  ds_read_b64_tr_b16 a[222:223], v31 offset:25600
  v_mfma_f32_16x16x32_bf16 v[184:187], a[200:203], a[184:187], v[184:187]
  ds_read_b128 a[152:155], v52 offset:6144
  v_mfma_f32_16x16x32_bf16 v[184:187], a[204:207], a[188:191], v[184:187]
  ds_read_b128 a[156:159], v53 offset:6144
  s_waitcnt lgkmcnt(12)
  v_mfma_f32_16x16x32_bf16 a[24:27], a[208:211], a[160:163], a[24:27]
  buffer_load_dwordx4 v9, s[12:15], s39 offen offset:3072 lds
  v_mfma_f32_16x16x32_bf16 a[24:27], a[212:215], a[164:167], a[24:27]
  s_add_u32 s39, s39, 0x70000
  s_mov_b32 s41, s49
  v_mfma_f32_16x16x32_bf16 a[56:59], a[208:211], a[168:171], a[56:59]
  s_mov_b32 s49, s40
  s_add_u32 s40, s40, 32768
  v_mfma_f32_16x16x32_bf16 a[56:59], a[212:215], a[172:175], a[56:59]
  s_cmp_lt_u32 s40, 98304
  s_cselect_b32 s40, s40, 0
  v_mfma_f32_16x16x32_bf16 a[88:91], a[208:211], a[176:179], a[88:91]
  ds_read_b64_tr_b16 a[224:225], v17 offset:8
  ds_read_b64_tr_b16 a[226:227], v17 offset:1032
  v_mfma_f32_16x16x32_bf16 a[88:91], a[212:215], a[180:183], a[88:91]
  ds_read_b64_tr_b16 a[228:229], v17 offset:8200
  ds_read_b64_tr_b16 a[230:231], v17 offset:9224
  v_mfma_f32_16x16x32_bf16 a[120:123], a[208:211], a[184:187], a[120:123]
  v_mfma_f32_16x16x32_bf16 a[120:123], a[212:215], a[188:191], a[120:123]
  s_waitcnt lgkmcnt(6)
  v_mfma_f32_16x16x32_bf16 v[188:191], a[216:219], a[160:163], v[188:191]
  s_waitcnt lgkmcnt(0)
  s_barrier
  v_mfma_f32_16x16x32_bf16 v[188:191], a[220:223], a[164:167], v[188:191]
  v_add_u32 v14, s41, v10
  v_add_u32 v25, s41, v18
  v_mfma_f32_16x16x32_bf16 v[192:195], a[216:219], a[168:171], v[192:195]
  v_add_u32 v26, s41, v19
  v_add_u32 v15, s41, v11
  v_mfma_f32_16x16x32_bf16 v[192:195], a[220:223], a[172:175], v[192:195]
  v_add_u32 v27, s41, v20
  v_add_u32 v28, s41, v21
  v_mfma_f32_16x16x32_bf16 v[196:199], a[216:219], a[176:179], v[196:199]
  v_add_u32 v16, s41, v12
  v_add_u32 v29, s41, v22
  v_mfma_f32_16x16x32_bf16 v[196:199], a[220:223], a[180:183], v[196:199]
  v_add_u32 v30, s41, v23
  v_add_u32 v17, s41, v13
  v_mfma_f32_16x16x32_bf16 v[200:203], a[216:219], a[184:187], v[200:203]
  ds_read_b64_tr_b16 a[192:193], v14 offset:0
  v_add_u32 v31, s41, v24
  v_mfma_f32_16x16x32_bf16 v[200:203], a[220:223], a[188:191], v[200:203]
  buffer_load_dword v248, v219, s[68:71], s56 offen
  v_smfmac_f32_16x16x64_bf16 v[48:51], v[144:147], a[216:223], v236
  s_add_u32 s56, s56, s57
  v_mfma_f32_16x16x32_bf16 a[28:31], a[224:227], a[160:163], a[28:31]
  ds_read_b64_tr_b16 a[194:195], v14 offset:1024
  ds_read_b64_tr_b16 a[196:197], v14 offset:8192
  v_mfma_f32_16x16x32_bf16 a[28:31], a[228:231], a[164:167], a[28:31]
  ds_read_b64_tr_b16 a[198:199], v14 offset:9216
  ds_read_b64_tr_b16 a[200:201], v25 offset:16384
  v_mfma_f32_16x16x32_bf16 a[60:63], a[224:227], a[168:171], a[60:63]
  v_mfma_f32_16x16x32_bf16 a[60:63], a[228:231], a[172:175], a[60:63]
  ds_read_b64_tr_b16 a[202:203], v25 offset:17408
  ds_read_b64_tr_b16 a[204:205], v25 offset:24576
  v_mfma_f32_16x16x32_bf16 a[92:95], a[224:227], a[176:179], a[92:95]
  ds_read_b64_tr_b16 a[206:207], v25 offset:25600
  v_mfma_f32_16x16x32_bf16 a[92:95], a[228:231], a[180:183], a[92:95]
  v_mfma_f32_16x16x32_bf16 a[124:127], a[224:227], a[184:187], a[124:127]
  v_mfma_f32_16x16x32_bf16 a[124:127], a[228:231], a[188:191], a[124:127]
  s_lshl1_add_u32 m0, s45, 98304
  s_waitcnt lgkmcnt(4)
  v_mfma_f32_16x16x32_bf16 a[0:3], a[192:195], a[128:131], a[0:3]
  v_mfma_f32_16x16x32_bf16 a[0:3], a[196:199], a[132:135], a[0:3]
  v_mfma_f32_16x16x32_bf16 a[32:35], a[192:195], a[136:139], a[32:35]
  buffer_load_dwordx4 v58, s[72:75], s36 offen offset:0 lds
  v_mfma_f32_16x16x32_bf16 a[32:35], a[196:199], a[140:143], a[32:35]
  v_mfma_f32_16x16x32_bf16 a[64:67], a[192:195], a[144:147], a[64:67]
  ds_read_b64_tr_b16 a[208:209], v14 offset:8
  ds_read_b64_tr_b16 a[210:211], v14 offset:1032
  v_mfma_f32_16x16x32_bf16 a[64:67], a[196:199], a[148:151], a[64:67]
  ds_read_b64_tr_b16 a[212:213], v14 offset:8200
  ds_read_b64_tr_b16 a[214:215], v14 offset:9224
  v_mfma_f32_16x16x32_bf16 a[96:99], a[192:195], a[152:155], a[96:99]
  buffer_load_dwordx4 v59, s[72:75], s36 offen offset:1024 lds
  v_mfma_f32_16x16x32_bf16 a[96:99], a[196:199], a[156:159], a[96:99]
  v_smfmac_f32_16x16x64_bf16 v[32:35], v[144:147], a[192:199], v236
  s_waitcnt lgkmcnt(4)
  v_mfma_f32_16x16x32_bf16 v[64:67], a[200:203], a[128:131], v[64:67]
  v_mfma_f32_16x16x32_bf16 v[64:67], a[204:207], a[132:135], v[64:67]
  buffer_load_dwordx4 v60, s[72:75], s36 offen offset:2048 lds
  v_mfma_f32_16x16x32_bf16 v[72:75], a[200:203], a[136:139], v[72:75]
  v_mfma_f32_16x16x32_bf16 v[72:75], a[204:207], a[140:143], v[72:75]
  v_mfma_f32_16x16x32_bf16 v[80:83], a[200:203], a[144:147], v[80:83]
  v_mfma_f32_16x16x32_bf16 v[80:83], a[204:207], a[148:151], v[80:83]
  buffer_load_dwordx4 v61, s[72:75], s36 offen offset:3072 lds
  v_mfma_f32_16x16x32_bf16 v[88:91], a[200:203], a[152:155], v[88:91]
  s_add_u32 s36, s36, 128
  ds_read_b64_tr_b16 a[216:217], v26 offset:16384
  v_mfma_f32_16x16x32_bf16 v[88:91], a[204:207], a[156:159], v[88:91]
  ds_read_b64_tr_b16 a[218:219], v26 offset:17408
  ds_read_b64_tr_b16 a[220:221], v26 offset:24576
  v_smfmac_f32_16x16x64_bf16 v[40:43], v[144:147], a[200:207], v236
  s_lshl1_add_u32 m0, s45, 102400
  s_waitcnt lgkmcnt(3)
  v_mfma_f32_16x16x32_bf16 a[4:7], a[208:211], a[128:131], a[4:7]
  buffer_load_dwordx4 v58, s[72:75], s37 offen offset:0 lds
  v_mfma_f32_16x16x32_bf16 a[4:7], a[212:215], a[132:135], a[4:7]
  ds_read_b64_tr_b16 a[222:223], v26 offset:25600
  v_mfma_f32_16x16x32_bf16 a[36:39], a[208:211], a[136:139], a[36:39]
  v_mfma_f32_16x16x32_bf16 a[36:39], a[212:215], a[140:143], a[36:39]
  ds_read_b64_tr_b16 a[224:225], v15 offset:0
  ds_read_b64_tr_b16 a[226:227], v15 offset:1024
  v_mfma_f32_16x16x32_bf16 a[68:71], a[208:211], a[144:147], a[68:71]
  buffer_load_dwordx4 v59, s[72:75], s37 offen offset:1024 lds
  v_mfma_f32_16x16x32_bf16 a[68:71], a[212:215], a[148:151], a[68:71]
  ds_read_b64_tr_b16 a[228:229], v15 offset:8192
  ds_read_b64_tr_b16 a[230:231], v15 offset:9216
  v_mfma_f32_16x16x32_bf16 a[100:103], a[208:211], a[152:155], a[100:103]
  v_mfma_f32_16x16x32_bf16 a[100:103], a[212:215], a[156:159], a[100:103]
  v_smfmac_f32_16x16x64_bf16 v[36:39], v[144:147], a[208:215], v236
  s_waitcnt lgkmcnt(4)
  v_mfma_f32_16x16x32_bf16 v[68:71], a[216:219], a[128:131], v[68:71]
  buffer_load_dwordx4 v60, s[72:75], s37 offen offset:2048 lds
  v_mfma_f32_16x16x32_bf16 v[68:71], a[220:223], a[132:135], v[68:71]
  v_mfma_f32_16x16x32_bf16 v[76:79], a[216:219], a[136:139], v[76:79]
  v_mfma_f32_16x16x32_bf16 v[76:79], a[220:223], a[140:143], v[76:79]
  buffer_load_dwordx4 v61, s[72:75], s37 offen offset:3072 lds
  v_mfma_f32_16x16x32_bf16 v[84:87], a[216:219], a[144:147], v[84:87]
  s_add_u32 s37, s37, 128
  ds_read_b64_tr_b16 a[192:193], v27 offset:16384
  v_mfma_f32_16x16x32_bf16 v[84:87], a[220:223], a[148:151], v[84:87]
  ds_read_b64_tr_b16 a[194:195], v27 offset:17408
  ds_read_b64_tr_b16 a[196:197], v27 offset:24576
  v_mfma_f32_16x16x32_bf16 v[92:95], a[216:219], a[152:155], v[92:95]
  ds_read_b64_tr_b16 a[198:199], v27 offset:25600
  v_mfma_f32_16x16x32_bf16 v[92:95], a[220:223], a[156:159], v[92:95]
  v_smfmac_f32_16x16x64_bf16 v[44:47], v[144:147], a[216:223], v236
  s_waitcnt lgkmcnt(4)
  v_mfma_f32_16x16x32_bf16 a[8:11], a[224:227], a[128:131], a[8:11]
  v_mfma_f32_16x16x32_bf16 a[8:11], a[228:231], a[132:135], a[8:11]
  v_mfma_f32_16x16x32_bf16 a[40:43], a[224:227], a[136:139], a[40:43]
  ds_read_b64_tr_b16 a[200:201], v15 offset:8
  ds_read_b64_tr_b16 a[202:203], v15 offset:1032
  v_mfma_f32_16x16x32_bf16 a[40:43], a[228:231], a[140:143], a[40:43]
  ds_read_b64_tr_b16 a[204:205], v15 offset:8200
  ds_read_b64_tr_b16 a[206:207], v15 offset:9224
  v_mfma_f32_16x16x32_bf16 a[72:75], a[224:227], a[144:147], a[72:75]
  v_mfma_f32_16x16x32_bf16 a[72:75], a[228:231], a[148:151], a[72:75]
  v_mfma_f32_16x16x32_bf16 a[104:107], a[224:227], a[152:155], a[104:107]
  buffer_load_dword v222, v221, s[28:31], s47 offen offset:0 sc0 sc1
  v_mfma_f32_16x16x32_bf16 a[104:107], a[228:231], a[156:159], a[104:107]
  s_waitcnt lgkmcnt(4)
  v_mfma_f32_16x16x32_bf16 v[96:99], a[192:195], a[128:131], v[96:99]
  v_mfma_f32_16x16x32_bf16 v[96:99], a[196:199], a[132:135], v[96:99]
  v_mfma_f32_16x16x32_bf16 v[104:107], a[192:195], a[136:139], v[104:107]
  ds_read_b64_tr_b16 a[208:209], v28 offset:16384
  ds_read_b64_tr_b16 a[210:211], v28 offset:17408
  v_mfma_f32_16x16x32_bf16 v[104:107], a[196:199], a[140:143], v[104:107]
  ds_read_b64_tr_b16 a[212:213], v28 offset:24576
  ds_read_b64_tr_b16 a[214:215], v28 offset:25600
  v_mfma_f32_16x16x32_bf16 v[112:115], a[192:195], a[144:147], v[112:115]
  v_mfma_f32_16x16x32_bf16 v[112:115], a[196:199], a[148:151], v[112:115]
  s_add_u32 m0, s40, s45
  v_mfma_f32_16x16x32_bf16 v[120:123], a[192:195], a[152:155], v[120:123]
  buffer_load_dwordx4 v2, s[8:11], s38 offen offset:0 lds
  v_mfma_f32_16x16x32_bf16 v[120:123], a[196:199], a[156:159], v[120:123]
  s_waitcnt lgkmcnt(4)
  v_mfma_f32_16x16x32_bf16 a[12:15], a[200:203], a[128:131], a[12:15]
  v_mfma_f32_16x16x32_bf16 a[12:15], a[204:207], a[132:135], a[12:15]
  v_mfma_f32_16x16x32_bf16 a[44:47], a[200:203], a[136:139], a[44:47]
  ds_read_b64_tr_b16 a[216:217], v16 offset:0
  ds_read_b64_tr_b16 a[218:219], v16 offset:1024
  v_mfma_f32_16x16x32_bf16 a[44:47], a[204:207], a[140:143], a[44:47]
  ds_read_b64_tr_b16 a[220:221], v16 offset:8192
  ds_read_b64_tr_b16 a[222:223], v16 offset:9216
  v_mfma_f32_16x16x32_bf16 a[76:79], a[200:203], a[144:147], a[76:79]
  buffer_load_dwordx4 v3, s[8:11], s38 offen offset:1024 lds
  v_mfma_f32_16x16x32_bf16 a[76:79], a[204:207], a[148:151], a[76:79]
  v_mfma_f32_16x16x32_bf16 a[108:111], a[200:203], a[152:155], a[108:111]
  v_mfma_f32_16x16x32_bf16 a[108:111], a[204:207], a[156:159], a[108:111]
  s_waitcnt lgkmcnt(4)
  v_mfma_f32_16x16x32_bf16 v[100:103], a[208:211], a[128:131], v[100:103]
  v_mfma_f32_16x16x32_bf16 v[100:103], a[212:215], a[132:135], v[100:103]
  ds_read_b64_tr_b16 a[224:225], v29 offset:16384
  ds_read_b64_tr_b16 a[226:227], v29 offset:17408
  v_mfma_f32_16x16x32_bf16 v[108:111], a[208:211], a[136:139], v[108:111]
  buffer_load_dwordx4 v4, s[8:11], s38 offen offset:2048 lds
  v_mfma_f32_16x16x32_bf16 v[108:111], a[212:215], a[140:143], v[108:111]
  ds_read_b64_tr_b16 a[228:229], v29 offset:24576
  ds_read_b64_tr_b16 a[230:231], v29 offset:25600
  v_mfma_f32_16x16x32_bf16 v[116:119], a[208:211], a[144:147], v[116:119]
  v_mfma_f32_16x16x32_bf16 v[116:119], a[212:215], a[148:151], v[116:119]
  v_mfma_f32_16x16x32_bf16 v[124:127], a[208:211], a[152:155], v[124:127]
  v_mfma_f32_16x16x32_bf16 v[124:127], a[212:215], a[156:159], v[124:127]
  s_waitcnt lgkmcnt(4)
  v_mfma_f32_16x16x32_bf16 a[16:19], a[216:219], a[128:131], a[16:19]
  buffer_load_dwordx4 v5, s[8:11], s38 offen offset:3072 lds
  v_mfma_f32_16x16x32_bf16 a[16:19], a[220:223], a[132:135], a[16:19]
  s_add_u32 s38, s38, 0x80000
  ds_read_b64_tr_b16 a[192:193], v16 offset:8
  v_mfma_f32_16x16x32_bf16 a[48:51], a[216:219], a[136:139], a[48:51]
  ds_read_b64_tr_b16 a[194:195], v16 offset:1032
  ds_read_b64_tr_b16 a[196:197], v16 offset:8200
  v_mfma_f32_16x16x32_bf16 a[48:51], a[220:223], a[140:143], a[48:51]
  ds_read_b64_tr_b16 a[198:199], v16 offset:9224
  v_mfma_f32_16x16x32_bf16 a[80:83], a[216:219], a[144:147], a[80:83]
  v_mfma_f32_16x16x32_bf16 a[80:83], a[220:223], a[148:151], a[80:83]
  s_add_u32 m0, s40, s46
  v_mfma_f32_16x16x32_bf16 a[112:115], a[216:219], a[152:155], a[112:115]
  buffer_load_dwordx4 v6, s[12:15], s39 offen offset:0 lds
  v_mfma_f32_16x16x32_bf16 a[112:115], a[220:223], a[156:159], a[112:115]
  s_waitcnt lgkmcnt(4)
  v_mfma_f32_16x16x32_bf16 v[128:131], a[224:227], a[128:131], v[128:131]
  v_mfma_f32_16x16x32_bf16 v[128:131], a[228:231], a[132:135], v[128:131]
  v_mfma_f32_16x16x32_bf16 v[136:139], a[224:227], a[136:139], v[136:139]
  ds_read_b64_tr_b16 a[200:201], v30 offset:16384
  ds_read_b64_tr_b16 a[202:203], v30 offset:17408
  v_mfma_f32_16x16x32_bf16 v[136:139], a[228:231], a[140:143], v[136:139]
  ds_read_b64_tr_b16 a[204:205], v30 offset:24576
  ds_read_b64_tr_b16 a[206:207], v30 offset:25600
  v_mfma_f32_16x16x32_bf16 v[172:175], a[224:227], a[144:147], v[172:175]
  buffer_load_dwordx4 v7, s[12:15], s39 offen offset:1024 lds
  v_mfma_f32_16x16x32_bf16 v[172:175], a[228:231], a[148:151], v[172:175]
  s_lshl_b32 s36, s50, 16
  v_mfma_f32_16x16x32_bf16 v[180:183], a[224:227], a[152:155], v[180:183]
  s_add_u32 s36, s36, 16384
  v_mfma_f32_16x16x32_bf16 v[180:183], a[228:231], a[156:159], v[180:183]
  s_waitcnt lgkmcnt(4)
  v_mfma_f32_16x16x32_bf16 a[20:23], a[192:195], a[128:131], a[20:23]
  s_lshl_b32 s37, s51, 16
  v_mfma_f32_16x16x32_bf16 a[20:23], a[196:199], a[132:135], a[20:23]
  ds_read_b64_tr_b16 a[208:209], v17 offset:0
  ds_read_b64_tr_b16 a[210:211], v17 offset:1024
  v_mfma_f32_16x16x32_bf16 a[52:55], a[192:195], a[136:139], a[52:55]
  buffer_load_dwordx4 v8, s[12:15], s39 offen offset:2048 lds
  v_mfma_f32_16x16x32_bf16 a[52:55], a[196:199], a[140:143], a[52:55]
  ds_read_b64_tr_b16 a[212:213], v17 offset:8192
  ds_read_b64_tr_b16 a[214:215], v17 offset:9216
  v_mfma_f32_16x16x32_bf16 a[84:87], a[192:195], a[144:147], a[84:87]
  s_add_u32 s37, s37, 16384
  v_mfma_f32_16x16x32_bf16 a[84:87], a[196:199], a[148:151], a[84:87]
  v_mfma_f32_16x16x32_bf16 a[116:119], a[192:195], a[152:155], a[116:119]
  s_lshl_b32 s64, s50, 9
  v_mfma_f32_16x16x32_bf16 a[116:119], a[196:199], a[156:159], a[116:119]
  s_waitcnt vmcnt(8)
  s_waitcnt lgkmcnt(4)
  v_mfma_f32_16x16x32_bf16 v[132:135], a[200:203], a[128:131], v[132:135]
  ds_read_b128 a[160:163], v52 offset:0
  s_add_u32 s64, s64, 65536
  v_mfma_f32_16x16x32_bf16 v[132:135], a[204:207], a[132:135], v[132:135]
  ds_read_b128 a[164:167], v53 offset:0
  s_xor_b32 s65, s64, 512
  v_mfma_f32_16x16x32_bf16 v[140:143], a[200:203], a[136:139], v[140:143]
  ds_read_b128 a[168:171], v52 offset:2048
  ds_read_b64_tr_b16 a[216:217], v31 offset:16384
  v_mfma_f32_16x16x32_bf16 v[140:143], a[204:207], a[140:143], v[140:143]
  ds_read_b128 a[172:175], v53 offset:2048
  ds_read_b64_tr_b16 a[218:219], v31 offset:17408
  v_mfma_f32_16x16x32_bf16 v[176:179], a[200:203], a[144:147], v[176:179]
  ds_read_b128 a[176:179], v52 offset:4096
  ds_read_b64_tr_b16 a[220:221], v31 offset:24576
  v_mfma_f32_16x16x32_bf16 v[176:179], a[204:207], a[148:151], v[176:179]
  ds_read_b128 a[180:183], v53 offset:4096
  ds_read_b64_tr_b16 a[222:223], v31 offset:25600
  v_mfma_f32_16x16x32_bf16 v[184:187], a[200:203], a[152:155], v[184:187]
  ds_read_b128 a[184:187], v52 offset:6144
  ds_read_b64_tr_b16 a[224:225], v17 offset:8
  v_mfma_f32_16x16x32_bf16 v[184:187], a[204:207], a[156:159], v[184:187]
  ds_read_b128 a[188:191], v53 offset:6144
  s_waitcnt lgkmcnt(13)
  v_mfma_f32_16x16x32_bf16 a[24:27], a[208:211], a[128:131], a[24:27]
  buffer_load_dwordx4 v9, s[12:15], s39 offen offset:3072 lds
  v_mfma_f32_16x16x32_bf16 a[24:27], a[212:215], a[132:135], a[24:27]
  s_add_u32 s39, s39, 0x70000
  s_mov_b32 s41, s49
  v_mfma_f32_16x16x32_bf16 a[56:59], a[208:211], a[136:139], a[56:59]
  s_mov_b32 s49, s40
  s_add_u32 s40, s40, 32768
  v_mfma_f32_16x16x32_bf16 a[56:59], a[212:215], a[140:143], a[56:59]
  s_cmp_lt_u32 s40, 98304
  s_cselect_b32 s40, s40, 0
  ds_read_b64_tr_b16 a[226:227], v17 offset:1032
  v_mfma_f32_16x16x32_bf16 a[88:91], a[208:211], a[144:147], a[88:91]
  s_waitcnt vmcnt(8)
  v_readfirstlane_b32 s48, v222
  ds_read_b64_tr_b16 a[228:229], v17 offset:8200
  v_mfma_f32_16x16x32_bf16 a[88:91], a[212:215], a[148:151], a[88:91]
  s_cmp_lt_u32 s48, s58
  s_cbranch_scc1 L_spin
L_spinb:
  ds_read_b64_tr_b16 a[230:231], v17 offset:9224
  v_mfma_f32_16x16x32_bf16 a[120:123], a[208:211], a[152:155], a[120:123]
  v_and_b32 v208, 0xf0, v166
  v_mfma_f32_16x16x32_bf16 a[120:123], a[212:215], a[156:159], a[120:123]
  s_waitcnt lgkmcnt(6)
  v_mfma_f32_16x16x32_bf16 v[188:191], a[216:219], a[128:131], v[188:191]
  s_waitcnt lgkmcnt(0)
  s_barrier
  ds_read_b32 v222, v218 offset:512
  v_mfma_f32_16x16x32_bf16 v[188:191], a[220:223], a[132:135], v[188:191]
  v_add_u32 v14, s41, v10
  v_add_u32 v25, s41, v18
  v_mfma_f32_16x16x32_bf16 v[192:195], a[216:219], a[136:139], v[192:195]
  v_add_u32 v26, s41, v19
  v_add_u32 v15, s41, v11
  v_mfma_f32_16x16x32_bf16 v[192:195], a[220:223], a[140:143], v[192:195]
  v_add_u32 v27, s41, v20
  v_add_u32 v28, s41, v21
  v_mfma_f32_16x16x32_bf16 v[196:199], a[216:219], a[144:147], v[196:199]
  v_add_u32 v16, s41, v12
  v_add_u32 v29, s41, v22
  v_mfma_f32_16x16x32_bf16 v[196:199], a[220:223], a[148:151], v[196:199]
  v_add_u32 v30, s41, v23
  v_add_u32 v17, s41, v13
  v_mfma_f32_16x16x32_bf16 v[200:203], a[216:219], a[152:155], v[200:203]
  ds_read_b64_tr_b16 a[192:193], v14 offset:0
  v_add_u32 v31, s41, v24
  v_mfma_f32_16x16x32_bf16 v[200:203], a[220:223], a[156:159], v[200:203]
  buffer_load_dword v248, v219, s[68:71], s56 offen
  v_smfmac_f32_16x16x64_bf16 v[48:51], v[144:147], a[216:223], v236
  s_add_u32 s56, s56, s57
  v_mfma_f32_16x16x32_bf16 a[28:31], a[224:227], a[128:131], a[28:31]
  ds_read_b64_tr_b16 a[194:195], v14 offset:1024
  ds_read_b64_tr_b16 a[196:197], v14 offset:8192
  v_mfma_f32_16x16x32_bf16 a[28:31], a[228:231], a[132:135], a[28:31]
  ds_read_b64_tr_b16 a[198:199], v14 offset:9216
  ds_read_b64_tr_b16 a[200:201], v25 offset:16384
  v_mfma_f32_16x16x32_bf16 a[60:63], a[224:227], a[136:139], a[60:63]
  ds_read_b64_tr_b16 a[202:203], v25 offset:17408
  ds_read_b64_tr_b16 a[204:205], v25 offset:24576
  v_mfma_f32_16x16x32_bf16 a[60:63], a[228:231], a[140:143], a[60:63]
  s_waitcnt lgkmcnt(7)
  v_readfirstlane_b32 s48, v222
  v_mfma_f32_16x16x32_bf16 a[92:95], a[224:227], a[144:147], a[92:95]
  s_cmp_lg_u32 s48, 0
  s_cbranch_scc1 L_lnfb
  v_mfma_f32_16x16x32_bf16 a[92:95], a[228:231], a[148:151], a[92:95]
  ds_read_b64_tr_b16 a[206:207], v25 offset:25600
  v_mfma_f32_16x16x32_bf16 a[124:127], a[224:227], a[152:155], a[124:127]
  v_mfma_f32_16x16x32_bf16 a[124:127], a[228:231], a[156:159], a[124:127]
  s_waitcnt lgkmcnt(4)
  v_mfma_f32_16x16x32_bf16 a[0:3], a[192:195], a[160:163], a[0:3]
  v_mfma_f32_16x16x32_bf16 a[0:3], a[196:199], a[164:167], a[0:3]
  v_mfma_f32_16x16x32_bf16 a[32:35], a[192:195], a[168:171], a[32:35]
  buffer_load_dwordx4 a[128:131], v166, s[4:7], s36 offen offset:0 sc1
  v_mfma_f32_16x16x32_bf16 a[32:35], a[196:199], a[172:175], a[32:35]
  v_mfma_f32_16x16x32_bf16 a[64:67], a[192:195], a[176:179], a[64:67]
  ds_read_b64_tr_b16 a[208:209], v14 offset:8
  ds_read_b64_tr_b16 a[210:211], v14 offset:1032
  v_mfma_f32_16x16x32_bf16 a[64:67], a[196:199], a[180:183], a[64:67]
  ds_read_b64_tr_b16 a[212:213], v14 offset:8200
  ds_read_b64_tr_b16 a[214:215], v14 offset:9224
  v_mfma_f32_16x16x32_bf16 a[96:99], a[192:195], a[184:187], a[96:99]
  v_mfma_f32_16x16x32_bf16 a[96:99], a[196:199], a[188:191], a[96:99]
  buffer_load_dwordx4 a[136:139], v166, s[4:7], s36 offen offset:1024 sc1
  v_smfmac_f32_16x16x64_bf16 v[32:35], v[144:147], a[192:199], v236
  s_waitcnt lgkmcnt(4)
  v_mfma_f32_16x16x32_bf16 v[64:67], a[200:203], a[160:163], v[64:67]
  v_mfma_f32_16x16x32_bf16 v[64:67], a[204:207], a[164:167], v[64:67]
  v_mfma_f32_16x16x32_bf16 v[72:75], a[200:203], a[168:171], v[72:75]
  v_mfma_f32_16x16x32_bf16 v[72:75], a[204:207], a[172:175], v[72:75]
  buffer_load_dwordx4 a[132:135], v166, s[4:7], s36 offen offset:2048 sc1
  v_mfma_f32_16x16x32_bf16 v[80:83], a[200:203], a[176:179], v[80:83]
  ds_read_b64_tr_b16 a[216:217], v26 offset:16384
  ds_read_b64_tr_b16 a[218:219], v26 offset:17408
  v_mfma_f32_16x16x32_bf16 v[80:83], a[204:207], a[180:183], v[80:83]
  ds_read_b64_tr_b16 a[220:221], v26 offset:24576
  ds_read_b64_tr_b16 a[222:223], v26 offset:25600
  v_mfma_f32_16x16x32_bf16 v[88:91], a[200:203], a[184:187], v[88:91]
  v_mfma_f32_16x16x32_bf16 v[88:91], a[204:207], a[188:191], v[88:91]
  v_smfmac_f32_16x16x64_bf16 v[40:43], v[144:147], a[200:207], v236
  s_waitcnt lgkmcnt(4)
  v_mfma_f32_16x16x32_bf16 a[4:7], a[208:211], a[160:163], a[4:7]
  buffer_load_dwordx4 a[140:143], v166, s[4:7], s36 offen offset:3072 sc1
  v_mfma_f32_16x16x32_bf16 a[4:7], a[212:215], a[164:167], a[4:7]
  s_add_u32 s36, s36, 4096
  v_mfma_f32_16x16x32_bf16 a[36:39], a[208:211], a[168:171], a[36:39]
  v_mfma_f32_16x16x32_bf16 a[36:39], a[212:215], a[172:175], a[36:39]
  ds_read_b64_tr_b16 a[224:225], v15 offset:0
  ds_read_b64_tr_b16 a[226:227], v15 offset:1024
  v_mfma_f32_16x16x32_bf16 a[68:71], a[208:211], a[176:179], a[68:71]
  buffer_load_dwordx4 a[144:147], v166, s[4:7], s37 offen offset:0 sc1
  v_mfma_f32_16x16x32_bf16 a[68:71], a[212:215], a[180:183], a[68:71]
  ds_read_b64_tr_b16 a[228:229], v15 offset:8192
  ds_read_b64_tr_b16 a[230:231], v15 offset:9216
  v_mfma_f32_16x16x32_bf16 a[100:103], a[208:211], a[184:187], a[100:103]
  v_mfma_f32_16x16x32_bf16 a[100:103], a[212:215], a[188:191], a[100:103]
  v_smfmac_f32_16x16x64_bf16 v[36:39], v[144:147], a[208:215], v236
  s_waitcnt lgkmcnt(4)
  v_mfma_f32_16x16x32_bf16 v[68:71], a[216:219], a[160:163], v[68:71]
  buffer_load_dwordx4 a[152:155], v166, s[4:7], s37 offen offset:1024 sc1
  v_mfma_f32_16x16x32_bf16 v[68:71], a[220:223], a[164:167], v[68:71]
  v_mfma_f32_16x16x32_bf16 v[76:79], a[216:219], a[168:171], v[76:79]
  v_mfma_f32_16x16x32_bf16 v[76:79], a[220:223], a[172:175], v[76:79]
  ds_read_b64_tr_b16 a[192:193], v27 offset:16384
  ds_read_b64_tr_b16 a[194:195], v27 offset:17408
  v_mfma_f32_16x16x32_bf16 v[84:87], a[216:219], a[176:179], v[84:87]
  ds_read_b64_tr_b16 a[196:197], v27 offset:24576
  ds_read_b64_tr_b16 a[198:199], v27 offset:25600
  v_mfma_f32_16x16x32_bf16 v[84:87], a[220:223], a[180:183], v[84:87]
  buffer_load_dwordx4 a[148:151], v166, s[4:7], s37 offen offset:2048 sc1
  v_mfma_f32_16x16x32_bf16 v[92:95], a[216:219], a[184:187], v[92:95]
  v_mfma_f32_16x16x32_bf16 v[92:95], a[220:223], a[188:191], v[92:95]
  v_smfmac_f32_16x16x64_bf16 v[44:47], v[144:147], a[216:223], v236
  s_waitcnt lgkmcnt(4)
  v_mfma_f32_16x16x32_bf16 a[8:11], a[224:227], a[160:163], a[8:11]
  v_mfma_f32_16x16x32_bf16 a[8:11], a[228:231], a[164:167], a[8:11]
  buffer_load_dwordx4 a[156:159], v166, s[4:7], s37 offen offset:3072 sc1
  v_mfma_f32_16x16x32_bf16 a[40:43], a[224:227], a[168:171], a[40:43]
  s_add_u32 s37, s37, 4096
  ds_read_b64_tr_b16 a[200:201], v15 offset:8
  v_mfma_f32_16x16x32_bf16 a[40:43], a[228:231], a[172:175], a[40:43]
  ds_read_b64_tr_b16 a[202:203], v15 offset:1032
  ds_read_b64_tr_b16 a[204:205], v15 offset:8200
  v_mfma_f32_16x16x32_bf16 a[72:75], a[224:227], a[176:179], a[72:75]
  ds_read_b64_tr_b16 a[206:207], v15 offset:9224
  v_mfma_f32_16x16x32_bf16 a[72:75], a[228:231], a[180:183], a[72:75]
  buffer_load_dwordx4 v[204:207], v208, s[28:31], s64 offen offset:0 sc1
  v_mfma_f32_16x16x32_bf16 a[104:107], a[224:227], a[184:187], a[104:107]
  v_mfma_f32_16x16x32_bf16 a[104:107], a[228:231], a[188:191], a[104:107]
  s_waitcnt lgkmcnt(4)
  v_mfma_f32_16x16x32_bf16 v[96:99], a[192:195], a[160:163], v[96:99]
  buffer_load_dwordx4 v[220:223], v208, s[28:31], s64 offen offset:256 sc1
  v_mfma_f32_16x16x32_bf16 v[96:99], a[196:199], a[164:167], v[96:99]
  buffer_load_dwordx4 v[228:231], v208, s[28:31], s65 offen offset:0 sc1
  v_mfma_f32_16x16x32_bf16 v[104:107], a[192:195], a[168:171], v[104:107]
  ds_read_b64_tr_b16 a[208:209], v28 offset:16384
  ds_read_b64_tr_b16 a[210:211], v28 offset:17408
  v_mfma_f32_16x16x32_bf16 v[104:107], a[196:199], a[172:175], v[104:107]
  buffer_load_dwordx4 v[240:243], v208, s[28:31], s65 offen offset:256 sc1
  v_mfma_f32_16x16x32_bf16 v[112:115], a[192:195], a[176:179], v[112:115]
  ds_read_b64_tr_b16 a[212:213], v28 offset:24576
  ds_read_b64_tr_b16 a[214:215], v28 offset:25600
  v_mfma_f32_16x16x32_bf16 v[112:115], a[196:199], a[180:183], v[112:115]
  s_add_u32 m0, s40, s45
  v_mfma_f32_16x16x32_bf16 v[120:123], a[192:195], a[184:187], v[120:123]
  buffer_load_dwordx4 v2, s[8:11], s38 offen offset:0 lds
  v_mfma_f32_16x16x32_bf16 v[120:123], a[196:199], a[188:191], v[120:123]
  s_waitcnt lgkmcnt(4)
  v_mfma_f32_16x16x32_bf16 a[12:15], a[200:203], a[160:163], a[12:15]
  v_mfma_f32_16x16x32_bf16 a[12:15], a[204:207], a[164:167], a[12:15]
  v_mfma_f32_16x16x32_bf16 a[44:47], a[200:203], a[168:171], a[44:47]
  ds_read_b64_tr_b16 a[216:217], v16 offset:0
  ds_read_b64_tr_b16 a[218:219], v16 offset:1024
  v_mfma_f32_16x16x32_bf16 a[44:47], a[204:207], a[172:175], a[44:47]
  ds_read_b64_tr_b16 a[220:221], v16 offset:8192
  ds_read_b64_tr_b16 a[222:223], v16 offset:9216
  v_mfma_f32_16x16x32_bf16 a[76:79], a[200:203], a[176:179], a[76:79]
  buffer_load_dwordx4 v3, s[8:11], s38 offen offset:1024 lds
  v_mfma_f32_16x16x32_bf16 a[76:79], a[204:207], a[180:183], a[76:79]
  v_add_f32 v32, v32, v33
  v_add_f32 v36, v36, v37
  v_mfma_f32_16x16x32_bf16 a[108:111], a[200:203], a[184:187], a[108:111]
  v_add_f32 v40, v40, v41
  v_mfma_f32_16x16x32_bf16 a[108:111], a[204:207], a[188:191], a[108:111]
  s_waitcnt lgkmcnt(4)
  v_mfma_f32_16x16x32_bf16 v[100:103], a[208:211], a[160:163], v[100:103]
  v_add_f32 v44, v44, v45
  ds_write_b32 v54, v32 offset:0
  v_mfma_f32_16x16x32_bf16 v[100:103], a[212:215], a[164:167], v[100:103]
  ds_read_b64_tr_b16 a[224:225], v29 offset:16384
  ds_read_b64_tr_b16 a[226:227], v29 offset:17408
  v_mfma_f32_16x16x32_bf16 v[108:111], a[208:211], a[168:171], v[108:111]
  buffer_load_dwordx4 v4, s[8:11], s38 offen offset:2048 lds
  v_mfma_f32_16x16x32_bf16 v[108:111], a[212:215], a[172:175], v[108:111]
  ds_read_b64_tr_b16 a[228:229], v29 offset:24576
  ds_read_b64_tr_b16 a[230:231], v29 offset:25600
  v_mfma_f32_16x16x32_bf16 v[116:119], a[208:211], a[176:179], v[116:119]
  ds_write_b32 v54, v36 offset:64
  v_mfma_f32_16x16x32_bf16 v[116:119], a[212:215], a[180:183], v[116:119]
  v_mfma_f32_16x16x32_bf16 v[124:127], a[208:211], a[184:187], v[124:127]
  v_mfma_f32_16x16x32_bf16 v[124:127], a[212:215], a[188:191], v[124:127]
  ds_write_b32 v55, v40 offset:0
  s_waitcnt lgkmcnt(7)
  v_mfma_f32_16x16x32_bf16 a[16:19], a[216:219], a[160:163], a[16:19]
  buffer_load_dwordx4 v5, s[8:11], s38 offen offset:3072 lds
  v_mfma_f32_16x16x32_bf16 a[16:19], a[220:223], a[164:167], a[16:19]
  s_add_u32 s38, s38, 0x80000
  ds_read_b64_tr_b16 a[192:193], v16 offset:8
  v_mfma_f32_16x16x32_bf16 a[48:51], a[216:219], a[168:171], a[48:51]
  ds_read_b64_tr_b16 a[194:195], v16 offset:1032
  ds_read_b64_tr_b16 a[196:197], v16 offset:8200
  v_mfma_f32_16x16x32_bf16 a[48:51], a[220:223], a[172:175], a[48:51]
  ds_read_b64_tr_b16 a[198:199], v16 offset:9224
  ds_write_b32 v55, v44 offset:64
  v_mfma_f32_16x16x32_bf16 a[80:83], a[216:219], a[176:179], a[80:83]
  s_mov_b32 s72, s62
  v_mfma_f32_16x16x32_bf16 a[80:83], a[220:223], a[180:183], a[80:83]
  s_add_u32 m0, s40, s46
  s_mov_b32 s73, s63
  v_mfma_f32_16x16x32_bf16 a[112:115], a[216:219], a[184:187], a[112:115]
  buffer_load_dwordx4 v6, s[12:15], s39 offen offset:0 lds
  v_mfma_f32_16x16x32_bf16 a[112:115], a[220:223], a[188:191], a[112:115]
  s_mov_b32 s74, 256
  s_waitcnt lgkmcnt(7)
  v_mfma_f32_16x16x32_bf16 v[128:131], a[224:227], a[160:163], v[128:131]
  v_mfma_f32_16x16x32_bf16 v[128:131], a[228:231], a[164:167], v[128:131]
  s_mov_b32 s75, 0x20000
  v_mfma_f32_16x16x32_bf16 v[136:139], a[224:227], a[168:171], v[136:139]
  ds_read_b64_tr_b16 a[200:201], v30 offset:16384
  ds_read_b64_tr_b16 a[202:203], v30 offset:17408
  v_mfma_f32_16x16x32_bf16 v[136:139], a[228:231], a[172:175], v[136:139]
  ds_read_b64_tr_b16 a[204:205], v30 offset:24576
  ds_read_b64_tr_b16 a[206:207], v30 offset:25600
  v_mfma_f32_16x16x32_bf16 v[172:175], a[224:227], a[176:179], v[172:175]
  buffer_load_dwordx4 v7, s[12:15], s39 offen offset:1024 lds
  v_mfma_f32_16x16x32_bf16 v[172:175], a[228:231], a[180:183], v[172:175]
  s_add_u32 s24, s60, 4194304
  s_addc_u32 s25, s61, 0
  v_mfma_f32_16x16x32_bf16 v[180:183], a[224:227], a[184:187], v[180:183]
  v_mfma_f32_16x16x32_bf16 v[180:183], a[228:231], a[188:191], v[180:183]
  s_waitcnt lgkmcnt(5)
  v_mfma_f32_16x16x32_bf16 a[20:23], a[192:195], a[160:163], a[20:23]
  s_mov_b32 s26, 37748736
  s_mov_b32 s27, 0x20000
  v_mfma_f32_16x16x32_bf16 a[20:23], a[196:199], a[164:167], a[20:23]
  ds_read_b64_tr_b16 a[208:209], v17 offset:0
  ds_read_b64_tr_b16 a[210:211], v17 offset:1024
  v_mfma_f32_16x16x32_bf16 a[52:55], a[192:195], a[168:171], a[52:55]
  buffer_load_dwordx4 v8, s[12:15], s39 offen offset:2048 lds
  v_mfma_f32_16x16x32_bf16 a[52:55], a[196:199], a[172:175], a[52:55]
  ds_read_b64_tr_b16 a[212:213], v17 offset:8192
  ds_read_b64_tr_b16 a[214:215], v17 offset:9216
  v_mfma_f32_16x16x32_bf16 a[84:87], a[192:195], a[176:179], a[84:87]
  v_mfma_f32_16x16x32_bf16 a[84:87], a[196:199], a[180:183], a[84:87]
  s_add_u32 s28, s60, 20971520
  s_addc_u32 s29, s61, 0
  v_mfma_f32_16x16x32_bf16 a[116:119], a[192:195], a[184:187], a[116:119]
  v_mfma_f32_16x16x32_bf16 a[116:119], a[196:199], a[188:191], a[116:119]
  s_mov_b32 s30, 16777216
  s_waitcnt lgkmcnt(4)
  v_mfma_f32_16x16x32_bf16 v[132:135], a[200:203], a[160:163], v[132:135]
  buffer_load_dwordx4 v9, s[12:15], s39 offen offset:3072 lds
  v_mfma_f32_16x16x32_bf16 v[132:135], a[204:207], a[164:167], v[132:135]
  s_add_u32 s39, s39, 0x70000
  s_mov_b32 s41, s49
  v_mfma_f32_16x16x32_bf16 v[140:143], a[200:203], a[168:171], v[140:143]
  s_mov_b32 s49, s40
  s_add_u32 s40, s40, 32768
  v_mfma_f32_16x16x32_bf16 v[140:143], a[204:207], a[172:175], v[140:143]
  s_cmp_lt_u32 s40, 98304
  s_cselect_b32 s40, s40, 0
  v_mfma_f32_16x16x32_bf16 v[176:179], a[200:203], a[176:179], v[176:179]
  ds_read_b64_tr_b16 a[216:217], v31 offset:16384
  ds_read_b64_tr_b16 a[218:219], v31 offset:17408
  v_mfma_f32_16x16x32_bf16 v[176:179], a[204:207], a[180:183], v[176:179]
  ds_read_b64_tr_b16 a[220:221], v31 offset:24576
  ds_read_b64_tr_b16 a[222:223], v31 offset:25600
  v_mfma_f32_16x16x32_bf16 v[184:187], a[200:203], a[184:187], v[184:187]
  s_mov_b32 s31, 0x20000
  s_mov_b32 s64, 0
  v_mfma_f32_16x16x32_bf16 v[184:187], a[204:207], a[188:191], v[184:187]
  s_waitcnt lgkmcnt(4)
  v_mfma_f32_16x16x32_bf16 a[24:27], a[208:211], a[160:163], a[24:27]
  v_mfma_f32_16x16x32_bf16 a[24:27], a[212:215], a[164:167], a[24:27]
  v_mfma_f32_16x16x32_bf16 a[56:59], a[208:211], a[168:171], a[56:59]
  v_mfma_f32_16x16x32_bf16 a[56:59], a[212:215], a[172:175], a[56:59]
  ds_read_b64_tr_b16 a[224:225], v17 offset:8
  ds_read_b64_tr_b16 a[226:227], v17 offset:1032
  v_mfma_f32_16x16x32_bf16 a[88:91], a[208:211], a[176:179], a[88:91]
  ds_read_b64_tr_b16 a[228:229], v17 offset:8200
  ds_read_b64_tr_b16 a[230:231], v17 offset:9224
  v_mfma_f32_16x16x32_bf16 a[88:91], a[212:215], a[180:183], a[88:91]
  v_mfma_f32_16x16x32_bf16 a[120:123], a[208:211], a[184:187], a[120:123]
  v_mfma_f32_16x16x32_bf16 a[120:123], a[212:215], a[188:191], a[120:123]
  s_waitcnt lgkmcnt(4)
  v_mfma_f32_16x16x32_bf16 v[188:191], a[216:219], a[160:163], v[188:191]
  s_waitcnt vmcnt(21) lgkmcnt(0)
  s_barrier
  v_mfma_f32_16x16x32_bf16 v[188:191], a[220:223], a[164:167], v[188:191]
  v_add_u32 v14, s41, v10
  v_add_u32 v25, s41, v18
  v_mfma_f32_16x16x32_bf16 v[192:195], a[216:219], a[168:171], v[192:195]
  v_add_u32 v26, s41, v19
  v_add_u32 v15, s41, v11
  v_mfma_f32_16x16x32_bf16 v[192:195], a[220:223], a[172:175], v[192:195]
  v_add_u32 v27, s41, v20
  v_add_u32 v28, s41, v21
  v_mfma_f32_16x16x32_bf16 v[196:199], a[216:219], a[176:179], v[196:199]
  v_add_u32 v16, s41, v12
  v_add_u32 v29, s41, v22
  v_mfma_f32_16x16x32_bf16 v[196:199], a[220:223], a[180:183], v[196:199]
  v_add_u32 v30, s41, v23
  v_add_u32 v17, s41, v13
  v_mfma_f32_16x16x32_bf16 v[200:203], a[216:219], a[184:187], v[200:203]
  ds_read_b64_tr_b16 a[192:193], v14 offset:0
  v_add_u32 v31, s41, v24
  v_mfma_f32_16x16x32_bf16 v[200:203], a[220:223], a[188:191], v[200:203]
  buffer_load_dword v248, v219, s[68:71], s56 offen
  v_smfmac_f32_16x16x64_bf16 v[48:51], v[144:147], a[216:223], v236
  s_add_u32 s56, s56, s57
  v_mfma_f32_16x16x32_bf16 a[28:31], a[224:227], a[160:163], a[28:31]
  ds_read_b64_tr_b16 a[194:195], v14 offset:1024
  ds_read_b64_tr_b16 a[196:197], v14 offset:8192
  v_mfma_f32_16x16x32_bf16 a[28:31], a[228:231], a[164:167], a[28:31]
  ds_read_b64_tr_b16 a[198:199], v14 offset:9216
  ds_read_b64_tr_b16 a[200:201], v25 offset:16384
  v_mfma_f32_16x16x32_bf16 a[60:63], a[224:227], a[168:171], a[60:63]
  ds_read_b64_tr_b16 a[202:203], v25 offset:17408
  ds_read_b64_tr_b16 a[204:205], v25 offset:24576
  v_mfma_f32_16x16x32_bf16 a[60:63], a[228:231], a[172:175], a[60:63]
  ds_read_b64_tr_b16 a[206:207], v25 offset:25600
  v_mfma_f32_16x16x32_bf16 a[92:95], a[224:227], a[176:179], a[92:95]
  v_mfma_f32_16x16x32_bf16 a[92:95], a[228:231], a[180:183], a[92:95]
  v_mfma_f32_16x16x32_bf16 a[124:127], a[224:227], a[184:187], a[124:127]
  s_waitcnt vmcnt(13)
  v_mfma_f32_16x16x32_bf16 a[124:127], a[228:231], a[188:191], a[124:127]
  s_waitcnt lgkmcnt(4)
  s_mov_b32 s42, 5
L_p1:
  v_mfma_f32_16x16x32_bf16 a[0:3], a[192:195], a[128:131], a[0:3]
  v_mfma_f32_16x16x32_bf16 a[0:3], a[196:199], a[132:135], a[0:3]
  ds_read_b64_tr_b16 a[208:209], v14 offset:8
  ds_read_b64_tr_b16 a[210:211], v14 offset:1032
  v_mfma_f32_16x16x32_bf16 a[32:35], a[192:195], a[136:139], a[32:35]
  buffer_load_dwordx4 a[160:163], v166, s[4:7], s36 offen offset:0 sc1
  v_mfma_f32_16x16x32_bf16 a[32:35], a[196:199], a[140:143], a[32:35]
  ds_read_b64_tr_b16 a[212:213], v14 offset:8200
  ds_read_b64_tr_b16 a[214:215], v14 offset:9224
  v_mfma_f32_16x16x32_bf16 a[64:67], a[192:195], a[144:147], a[64:67]
  v_mfma_f32_16x16x32_bf16 a[64:67], a[196:199], a[148:151], a[64:67]
  v_mfma_f32_16x16x32_bf16 a[96:99], a[192:195], a[152:155], a[96:99]
  v_mfma_f32_16x16x32_bf16 a[96:99], a[196:199], a[156:159], a[96:99]
  s_waitcnt lgkmcnt(4)
  v_mfma_f32_16x16x32_bf16 v[64:67], a[200:203], a[128:131], v[64:67]
  buffer_load_dwordx4 a[168:171], v166, s[4:7], s36 offen offset:1024 sc1
  v_mfma_f32_16x16x32_bf16 v[64:67], a[204:207], a[132:135], v[64:67]
  v_mfma_f32_16x16x32_bf16 v[72:75], a[200:203], a[136:139], v[72:75]
  ds_read_b64_tr_b16 a[216:217], v26 offset:16384
  ds_read_b64_tr_b16 a[218:219], v26 offset:17408
  v_mfma_f32_16x16x32_bf16 v[72:75], a[204:207], a[140:143], v[72:75]
  ds_read_b64_tr_b16 a[220:221], v26 offset:24576
  ds_read_b64_tr_b16 a[222:223], v26 offset:25600
  v_mfma_f32_16x16x32_bf16 v[80:83], a[200:203], a[144:147], v[80:83]
  buffer_load_dwordx4 a[164:167], v166, s[4:7], s36 offen offset:2048 sc1
  v_mfma_f32_16x16x32_bf16 v[80:83], a[204:207], a[148:151], v[80:83]
  v_mfma_f32_16x16x32_bf16 v[88:91], a[200:203], a[152:155], v[88:91]
  v_mfma_f32_16x16x32_bf16 v[88:91], a[204:207], a[156:159], v[88:91]
  s_waitcnt lgkmcnt(4)
  v_mfma_f32_16x16x32_bf16 a[4:7], a[208:211], a[128:131], a[4:7]
  v_mfma_f32_16x16x32_bf16 a[4:7], a[212:215], a[132:135], a[4:7]
  buffer_load_dwordx4 a[172:175], v166, s[4:7], s36 offen offset:3072 sc1
  v_mfma_f32_16x16x32_bf16 a[36:39], a[208:211], a[136:139], a[36:39]
  s_add_u32 s36, s36, 4096
  ds_read_b64_tr_b16 a[224:225], v15 offset:0
  v_mfma_f32_16x16x32_bf16 a[36:39], a[212:215], a[140:143], a[36:39]
  ds_read_b64_tr_b16 a[226:227], v15 offset:1024
  ds_read_b64_tr_b16 a[228:229], v15 offset:8192
  v_mfma_f32_16x16x32_bf16 a[68:71], a[208:211], a[144:147], a[68:71]
  ds_read_b64_tr_b16 a[230:231], v15 offset:9216
  v_mfma_f32_16x16x32_bf16 a[68:71], a[212:215], a[148:151], a[68:71]
  v_mfma_f32_16x16x32_bf16 a[100:103], a[208:211], a[152:155], a[100:103]
  buffer_load_dwordx4 a[176:179], v166, s[4:7], s37 offen offset:0 sc1
  v_mfma_f32_16x16x32_bf16 a[100:103], a[212:215], a[156:159], a[100:103]
  s_waitcnt lgkmcnt(4)
  v_mfma_f32_16x16x32_bf16 v[68:71], a[216:219], a[128:131], v[68:71]
  v_mfma_f32_16x16x32_bf16 v[68:71], a[220:223], a[132:135], v[68:71]
  v_mfma_f32_16x16x32_bf16 v[76:79], a[216:219], a[136:139], v[76:79]
  ds_read_b64_tr_b16 a[192:193], v27 offset:16384
  ds_read_b64_tr_b16 a[194:195], v27 offset:17408
  v_mfma_f32_16x16x32_bf16 v[76:79], a[220:223], a[140:143], v[76:79]
  buffer_load_dwordx4 a[184:187], v166, s[4:7], s37 offen offset:1024 sc1
  v_mfma_f32_16x16x32_bf16 v[84:87], a[216:219], a[144:147], v[84:87]
  ds_read_b64_tr_b16 a[196:197], v27 offset:24576
  ds_read_b64_tr_b16 a[198:199], v27 offset:25600
  v_mfma_f32_16x16x32_bf16 v[84:87], a[220:223], a[148:151], v[84:87]
  v_mfma_f32_16x16x32_bf16 v[92:95], a[216:219], a[152:155], v[92:95]
  v_mfma_f32_16x16x32_bf16 v[92:95], a[220:223], a[156:159], v[92:95]
  s_waitcnt lgkmcnt(4)
  v_mfma_f32_16x16x32_bf16 a[8:11], a[224:227], a[128:131], a[8:11]
  buffer_load_dwordx4 a[180:183], v166, s[4:7], s37 offen offset:2048 sc1
  v_mfma_f32_16x16x32_bf16 a[8:11], a[228:231], a[132:135], a[8:11]
  v_mfma_f32_16x16x32_bf16 a[40:43], a[224:227], a[136:139], a[40:43]
  ds_read_b64_tr_b16 a[200:201], v15 offset:8
  ds_read_b64_tr_b16 a[202:203], v15 offset:1032
  v_mfma_f32_16x16x32_bf16 a[40:43], a[228:231], a[140:143], a[40:43]
  ds_read_b64_tr_b16 a[204:205], v15 offset:8200
  ds_read_b64_tr_b16 a[206:207], v15 offset:9224
  v_mfma_f32_16x16x32_bf16 a[72:75], a[224:227], a[144:147], a[72:75]
  v_mfma_f32_16x16x32_bf16 a[72:75], a[228:231], a[148:151], a[72:75]
  buffer_load_dwordx4 a[188:191], v166, s[4:7], s37 offen offset:3072 sc1
  v_mfma_f32_16x16x32_bf16 a[104:107], a[224:227], a[152:155], a[104:107]
  s_add_u32 s37, s37, 4096
  v_mfma_f32_16x16x32_bf16 a[104:107], a[228:231], a[156:159], a[104:107]
  s_add_u32 m0, s40, s45
  s_waitcnt lgkmcnt(4)
  v_mfma_f32_16x16x32_bf16 v[96:99], a[192:195], a[128:131], v[96:99]
  v_mfma_f32_16x16x32_bf16 v[96:99], a[196:199], a[132:135], v[96:99]
  ds_read_b64_tr_b16 a[208:209], v28 offset:16384
  ds_read_b64_tr_b16 a[210:211], v28 offset:17408
  v_mfma_f32_16x16x32_bf16 v[104:107], a[192:195], a[136:139], v[104:107]
  buffer_load_dwordx4 v2, s[8:11], s38 offen offset:0 lds
  v_mfma_f32_16x16x32_bf16 v[104:107], a[196:199], a[140:143], v[104:107]
  ds_read_b64_tr_b16 a[212:213], v28 offset:24576
  ds_read_b64_tr_b16 a[214:215], v28 offset:25600
  v_mfma_f32_16x16x32_bf16 v[112:115], a[192:195], a[144:147], v[112:115]
  v_mfma_f32_16x16x32_bf16 v[112:115], a[196:199], a[148:151], v[112:115]
  v_mfma_f32_16x16x32_bf16 v[120:123], a[192:195], a[152:155], v[120:123]
  v_mfma_f32_16x16x32_bf16 v[120:123], a[196:199], a[156:159], v[120:123]
  s_waitcnt lgkmcnt(4)
  v_mfma_f32_16x16x32_bf16 a[12:15], a[200:203], a[128:131], a[12:15]
  v_mfma_f32_16x16x32_bf16 a[12:15], a[204:207], a[132:135], a[12:15]
  buffer_load_dwordx4 v3, s[8:11], s38 offen offset:1024 lds
  v_mfma_f32_16x16x32_bf16 a[44:47], a[200:203], a[136:139], a[44:47]
  ds_read_b64_tr_b16 a[216:217], v16 offset:0
  ds_read_b64_tr_b16 a[218:219], v16 offset:1024
  v_mfma_f32_16x16x32_bf16 a[44:47], a[204:207], a[140:143], a[44:47]
  ds_read_b64_tr_b16 a[220:221], v16 offset:8192
  ds_read_b64_tr_b16 a[222:223], v16 offset:9216
  v_mfma_f32_16x16x32_bf16 a[76:79], a[200:203], a[144:147], a[76:79]
  v_mfma_f32_16x16x32_bf16 a[76:79], a[204:207], a[148:151], a[76:79]
  v_mfma_f32_16x16x32_bf16 a[108:111], a[200:203], a[152:155], a[108:111]
  v_mfma_f32_16x16x32_bf16 a[108:111], a[204:207], a[156:159], a[108:111]
  s_waitcnt lgkmcnt(4)
  v_mfma_f32_16x16x32_bf16 v[100:103], a[208:211], a[128:131], v[100:103]
  buffer_load_dwordx4 v4, s[8:11], s38 offen offset:2048 lds
  v_mfma_f32_16x16x32_bf16 v[100:103], a[212:215], a[132:135], v[100:103]
  v_mfma_f32_16x16x32_bf16 v[108:111], a[208:211], a[136:139], v[108:111]
  ds_read_b64_tr_b16 a[224:225], v29 offset:16384
  ds_read_b64_tr_b16 a[226:227], v29 offset:17408
  v_mfma_f32_16x16x32_bf16 v[108:111], a[212:215], a[140:143], v[108:111]
  ds_read_b64_tr_b16 a[228:229], v29 offset:24576
  ds_read_b64_tr_b16 a[230:231], v29 offset:25600
  v_mfma_f32_16x16x32_bf16 v[116:119], a[208:211], a[144:147], v[116:119]
  v_mfma_f32_16x16x32_bf16 v[116:119], a[212:215], a[148:151], v[116:119]
  v_mfma_f32_16x16x32_bf16 v[124:127], a[208:211], a[152:155], v[124:127]
  v_mfma_f32_16x16x32_bf16 v[124:127], a[212:215], a[156:159], v[124:127]
  s_waitcnt lgkmcnt(4)
  v_mfma_f32_16x16x32_bf16 a[16:19], a[216:219], a[128:131], a[16:19]
  buffer_load_dwordx4 v5, s[8:11], s38 offen offset:3072 lds
  v_mfma_f32_16x16x32_bf16 a[16:19], a[220:223], a[132:135], a[16:19]
  s_add_u32 s38, s38, 0x80000
  ds_read_b64_tr_b16 a[192:193], v16 offset:8
  v_mfma_f32_16x16x32_bf16 a[48:51], a[216:219], a[136:139], a[48:51]
  ds_read_b64_tr_b16 a[194:195], v16 offset:1032
  ds_read_b64_tr_b16 a[196:197], v16 offset:8200
  v_mfma_f32_16x16x32_bf16 a[48:51], a[220:223], a[140:143], a[48:51]
  ds_read_b64_tr_b16 a[198:199], v16 offset:9224
  v_mfma_f32_16x16x32_bf16 a[80:83], a[216:219], a[144:147], a[80:83]
  v_mfma_f32_16x16x32_bf16 a[80:83], a[220:223], a[148:151], a[80:83]
  s_add_u32 m0, s40, s46
  v_mfma_f32_16x16x32_bf16 a[112:115], a[216:219], a[152:155], a[112:115]
  buffer_load_dwordx4 v6, s[12:15], s39 offen offset:0 lds
  v_mfma_f32_16x16x32_bf16 a[112:115], a[220:223], a[156:159], a[112:115]
  s_waitcnt lgkmcnt(4)
  v_mfma_f32_16x16x32_bf16 v[128:131], a[224:227], a[128:131], v[128:131]
  v_mfma_f32_16x16x32_bf16 v[128:131], a[228:231], a[132:135], v[128:131]
  v_mfma_f32_16x16x32_bf16 v[136:139], a[224:227], a[136:139], v[136:139]
  ds_read_b64_tr_b16 a[200:201], v30 offset:16384
  ds_read_b64_tr_b16 a[202:203], v30 offset:17408
  v_mfma_f32_16x16x32_bf16 v[136:139], a[228:231], a[140:143], v[136:139]
  ds_read_b64_tr_b16 a[204:205], v30 offset:24576
  ds_read_b64_tr_b16 a[206:207], v30 offset:25600
  v_mfma_f32_16x16x32_bf16 v[172:175], a[224:227], a[144:147], v[172:175]
  v_mfma_f32_16x16x32_bf16 v[172:175], a[228:231], a[148:151], v[172:175]
  buffer_load_dwordx4 v7, s[12:15], s39 offen offset:1024 lds
  v_mfma_f32_16x16x32_bf16 v[180:183], a[224:227], a[152:155], v[180:183]
  v_mfma_f32_16x16x32_bf16 v[180:183], a[228:231], a[156:159], v[180:183]
  s_waitcnt lgkmcnt(4)
  v_mfma_f32_16x16x32_bf16 a[20:23], a[192:195], a[128:131], a[20:23]
  v_mfma_f32_16x16x32_bf16 a[20:23], a[196:199], a[132:135], a[20:23]
  v_mfma_f32_16x16x32_bf16 a[52:55], a[192:195], a[136:139], a[52:55]
  ds_read_b64_tr_b16 a[208:209], v17 offset:0
  ds_read_b64_tr_b16 a[210:211], v17 offset:1024
  v_mfma_f32_16x16x32_bf16 a[52:55], a[196:199], a[140:143], a[52:55]
  ds_read_b64_tr_b16 a[212:213], v17 offset:8192
  ds_read_b64_tr_b16 a[214:215], v17 offset:9216
  v_mfma_f32_16x16x32_bf16 a[84:87], a[192:195], a[144:147], a[84:87]
  buffer_load_dwordx4 v8, s[12:15], s39 offen offset:2048 lds
  v_mfma_f32_16x16x32_bf16 a[84:87], a[196:199], a[148:151], a[84:87]
  v_mfma_f32_16x16x32_bf16 a[116:119], a[192:195], a[152:155], a[116:119]
  v_mfma_f32_16x16x32_bf16 a[116:119], a[196:199], a[156:159], a[116:119]
  s_waitcnt lgkmcnt(4)
  v_mfma_f32_16x16x32_bf16 v[132:135], a[200:203], a[128:131], v[132:135]
  v_mfma_f32_16x16x32_bf16 v[132:135], a[204:207], a[132:135], v[132:135]
  v_mfma_f32_16x16x32_bf16 v[140:143], a[200:203], a[136:139], v[140:143]
  ds_read_b64_tr_b16 a[216:217], v31 offset:16384
  ds_read_b64_tr_b16 a[218:219], v31 offset:17408
  v_mfma_f32_16x16x32_bf16 v[140:143], a[204:207], a[140:143], v[140:143]
  buffer_load_dwordx4 v9, s[12:15], s39 offen offset:3072 lds
  v_mfma_f32_16x16x32_bf16 v[176:179], a[200:203], a[144:147], v[176:179]
  s_add_u32 s39, s39, 0x70000
  s_mov_b32 s41, s49
  v_mfma_f32_16x16x32_bf16 v[176:179], a[204:207], a[148:151], v[176:179]
  s_mov_b32 s49, s40
  s_add_u32 s40, s40, 32768
  v_mfma_f32_16x16x32_bf16 v[184:187], a[200:203], a[152:155], v[184:187]
  s_cmp_lt_u32 s40, 98304
  s_cselect_b32 s40, s40, 0
  v_mfma_f32_16x16x32_bf16 v[184:187], a[204:207], a[156:159], v[184:187]
  ds_read_b64_tr_b16 a[220:221], v31 offset:24576
  s_waitcnt lgkmcnt(3)
  v_mfma_f32_16x16x32_bf16 a[24:27], a[208:211], a[128:131], a[24:27]
  ds_read_b64_tr_b16 a[222:223], v31 offset:25600
  ds_read_b64_tr_b16 a[224:225], v17 offset:8
  v_mfma_f32_16x16x32_bf16 a[24:27], a[212:215], a[132:135], a[24:27]
  v_mfma_f32_16x16x32_bf16 a[56:59], a[208:211], a[136:139], a[56:59]
  ds_read_b64_tr_b16 a[226:227], v17 offset:1032
  ds_read_b64_tr_b16 a[228:229], v17 offset:8200
  v_mfma_f32_16x16x32_bf16 a[56:59], a[212:215], a[140:143], a[56:59]
  ds_read_b64_tr_b16 a[230:231], v17 offset:9224
  v_mfma_f32_16x16x32_bf16 a[88:91], a[208:211], a[144:147], a[88:91]
  v_mfma_f32_16x16x32_bf16 a[88:91], a[212:215], a[148:151], a[88:91]
  v_mfma_f32_16x16x32_bf16 a[120:123], a[208:211], a[152:155], a[120:123]
  v_mfma_f32_16x16x32_bf16 a[120:123], a[212:215], a[156:159], a[120:123]
  s_waitcnt vmcnt(17) lgkmcnt(0)
  s_barrier
  v_mfma_f32_16x16x32_bf16 v[188:191], a[216:219], a[128:131], v[188:191]
  v_add_u32 v14, s41, v10
  v_add_u32 v25, s41, v18
  v_mfma_f32_16x16x32_bf16 v[188:191], a[220:223], a[132:135], v[188:191]
  v_add_u32 v26, s41, v19
  v_add_u32 v15, s41, v11
  v_mfma_f32_16x16x32_bf16 v[192:195], a[216:219], a[136:139], v[192:195]
  v_add_u32 v27, s41, v20
  v_add_u32 v28, s41, v21
  v_mfma_f32_16x16x32_bf16 v[192:195], a[220:223], a[140:143], v[192:195]
  v_add_u32 v16, s41, v12
  v_add_u32 v29, s41, v22
  v_mfma_f32_16x16x32_bf16 v[196:199], a[216:219], a[144:147], v[196:199]
  v_add_u32 v30, s41, v23
  v_add_u32 v17, s41, v13
  v_mfma_f32_16x16x32_bf16 v[196:199], a[220:223], a[148:151], v[196:199]
  ds_read_b64_tr_b16 a[192:193], v14 offset:0
  v_add_u32 v31, s41, v24
  v_mfma_f32_16x16x32_bf16 v[200:203], a[216:219], a[152:155], v[200:203]
  buffer_load_dword v248, v219, s[68:71], s56 offen
  v_mfma_f32_16x16x32_bf16 v[200:203], a[220:223], a[156:159], v[200:203]
  s_add_u32 s56, s56, s57
  v_mfma_f32_16x16x32_bf16 a[28:31], a[224:227], a[128:131], a[28:31]
  ds_read_b64_tr_b16 a[194:195], v14 offset:1024
  ds_read_b64_tr_b16 a[196:197], v14 offset:8192
  v_mfma_f32_16x16x32_bf16 a[28:31], a[228:231], a[132:135], a[28:31]
  ds_read_b64_tr_b16 a[198:199], v14 offset:9216
  ds_read_b64_tr_b16 a[200:201], v25 offset:16384
  v_mfma_f32_16x16x32_bf16 a[60:63], a[224:227], a[136:139], a[60:63]
  ds_read_b64_tr_b16 a[202:203], v25 offset:17408
  ds_read_b64_tr_b16 a[204:205], v25 offset:24576
  v_mfma_f32_16x16x32_bf16 a[60:63], a[228:231], a[140:143], a[60:63]
  ds_read_b64_tr_b16 a[206:207], v25 offset:25600
  v_mfma_f32_16x16x32_bf16 a[92:95], a[224:227], a[144:147], a[92:95]
  v_mfma_f32_16x16x32_bf16 a[92:95], a[228:231], a[148:151], a[92:95]
  v_mfma_f32_16x16x32_bf16 a[124:127], a[224:227], a[152:155], a[124:127]
  s_waitcnt vmcnt(9)
  v_mfma_f32_16x16x32_bf16 a[124:127], a[228:231], a[156:159], a[124:127]
  s_waitcnt lgkmcnt(4)
  v_mfma_f32_16x16x32_bf16 a[0:3], a[192:195], a[160:163], a[0:3]
  v_mfma_f32_16x16x32_bf16 a[0:3], a[196:199], a[164:167], a[0:3]
  ds_read_b64_tr_b16 a[208:209], v14 offset:8
  ds_read_b64_tr_b16 a[210:211], v14 offset:1032
  v_mfma_f32_16x16x32_bf16 a[32:35], a[192:195], a[168:171], a[32:35]
  buffer_load_dwordx4 a[128:131], v166, s[4:7], s36 offen offset:0 sc1
  v_mfma_f32_16x16x32_bf16 a[32:35], a[196:199], a[172:175], a[32:35]
  ds_read_b64_tr_b16 a[212:213], v14 offset:8200
  ds_read_b64_tr_b16 a[214:215], v14 offset:9224
  v_mfma_f32_16x16x32_bf16 a[64:67], a[192:195], a[176:179], a[64:67]
  v_mfma_f32_16x16x32_bf16 a[64:67], a[196:199], a[180:183], a[64:67]
  v_mfma_f32_16x16x32_bf16 a[96:99], a[192:195], a[184:187], a[96:99]
  v_mfma_f32_16x16x32_bf16 a[96:99], a[196:199], a[188:191], a[96:99]
  s_waitcnt lgkmcnt(4)
  v_mfma_f32_16x16x32_bf16 v[64:67], a[200:203], a[160:163], v[64:67]
  buffer_load_dwordx4 a[136:139], v166, s[4:7], s36 offen offset:1024 sc1
  v_mfma_f32_16x16x32_bf16 v[64:67], a[204:207], a[164:167], v[64:67]
  v_mfma_f32_16x16x32_bf16 v[72:75], a[200:203], a[168:171], v[72:75]
  ds_read_b64_tr_b16 a[216:217], v26 offset:16384
  ds_read_b64_tr_b16 a[218:219], v26 offset:17408
  v_mfma_f32_16x16x32_bf16 v[72:75], a[204:207], a[172:175], v[72:75]
  ds_read_b64_tr_b16 a[220:221], v26 offset:24576
  ds_read_b64_tr_b16 a[222:223], v26 offset:25600
  v_mfma_f32_16x16x32_bf16 v[80:83], a[200:203], a[176:179], v[80:83]
  buffer_load_dwordx4 a[132:135], v166, s[4:7], s36 offen offset:2048 sc1
  v_mfma_f32_16x16x32_bf16 v[80:83], a[204:207], a[180:183], v[80:83]
  v_mfma_f32_16x16x32_bf16 v[88:91], a[200:203], a[184:187], v[88:91]
  v_mfma_f32_16x16x32_bf16 v[88:91], a[204:207], a[188:191], v[88:91]
  s_waitcnt lgkmcnt(4)
  v_mfma_f32_16x16x32_bf16 a[4:7], a[208:211], a[160:163], a[4:7]
  v_mfma_f32_16x16x32_bf16 a[4:7], a[212:215], a[164:167], a[4:7]
  buffer_load_dwordx4 a[140:143], v166, s[4:7], s36 offen offset:3072 sc1
  v_mfma_f32_16x16x32_bf16 a[36:39], a[208:211], a[168:171], a[36:39]
  s_add_u32 s36, s36, 4096
  ds_read_b64_tr_b16 a[224:225], v15 offset:0
  v_mfma_f32_16x16x32_bf16 a[36:39], a[212:215], a[172:175], a[36:39]
  ds_read_b64_tr_b16 a[226:227], v15 offset:1024
  ds_read_b64_tr_b16 a[228:229], v15 offset:8192
  v_mfma_f32_16x16x32_bf16 a[68:71], a[208:211], a[176:179], a[68:71]
  ds_read_b64_tr_b16 a[230:231], v15 offset:9216
  v_mfma_f32_16x16x32_bf16 a[68:71], a[212:215], a[180:183], a[68:71]
  v_mfma_f32_16x16x32_bf16 a[100:103], a[208:211], a[184:187], a[100:103]
  buffer_load_dwordx4 a[144:147], v166, s[4:7], s37 offen offset:0 sc1
  v_mfma_f32_16x16x32_bf16 a[100:103], a[212:215], a[188:191], a[100:103]
  s_waitcnt lgkmcnt(4)
  v_mfma_f32_16x16x32_bf16 v[68:71], a[216:219], a[160:163], v[68:71]
  v_mfma_f32_16x16x32_bf16 v[68:71], a[220:223], a[164:167], v[68:71]
  v_mfma_f32_16x16x32_bf16 v[76:79], a[216:219], a[168:171], v[76:79]
  ds_read_b64_tr_b16 a[192:193], v27 offset:16384
  ds_read_b64_tr_b16 a[194:195], v27 offset:17408
  v_mfma_f32_16x16x32_bf16 v[76:79], a[220:223], a[172:175], v[76:79]
  buffer_load_dwordx4 a[152:155], v166, s[4:7], s37 offen offset:1024 sc1
  v_mfma_f32_16x16x32_bf16 v[84:87], a[216:219], a[176:179], v[84:87]
  ds_read_b64_tr_b16 a[196:197], v27 offset:24576
  ds_read_b64_tr_b16 a[198:199], v27 offset:25600
  v_mfma_f32_16x16x32_bf16 v[84:87], a[220:223], a[180:183], v[84:87]
  v_mfma_f32_16x16x32_bf16 v[92:95], a[216:219], a[184:187], v[92:95]
  v_mfma_f32_16x16x32_bf16 v[92:95], a[220:223], a[188:191], v[92:95]
  s_waitcnt lgkmcnt(4)
  v_mfma_f32_16x16x32_bf16 a[8:11], a[224:227], a[160:163], a[8:11]
  buffer_load_dwordx4 a[148:151], v166, s[4:7], s37 offen offset:2048 sc1
  v_mfma_f32_16x16x32_bf16 a[8:11], a[228:231], a[164:167], a[8:11]
  v_mfma_f32_16x16x32_bf16 a[40:43], a[224:227], a[168:171], a[40:43]
  ds_read_b64_tr_b16 a[200:201], v15 offset:8
  ds_read_b64_tr_b16 a[202:203], v15 offset:1032
  v_mfma_f32_16x16x32_bf16 a[40:43], a[228:231], a[172:175], a[40:43]
  ds_read_b64_tr_b16 a[204:205], v15 offset:8200
  ds_read_b64_tr_b16 a[206:207], v15 offset:9224
  v_mfma_f32_16x16x32_bf16 a[72:75], a[224:227], a[176:179], a[72:75]
  v_mfma_f32_16x16x32_bf16 a[72:75], a[228:231], a[180:183], a[72:75]
  buffer_load_dwordx4 a[156:159], v166, s[4:7], s37 offen offset:3072 sc1
  v_mfma_f32_16x16x32_bf16 a[104:107], a[224:227], a[184:187], a[104:107]
  s_add_u32 s37, s37, 4096
  v_mfma_f32_16x16x32_bf16 a[104:107], a[228:231], a[188:191], a[104:107]
  s_add_u32 m0, s40, s45
  s_waitcnt lgkmcnt(4)
  v_mfma_f32_16x16x32_bf16 v[96:99], a[192:195], a[160:163], v[96:99]
  v_mfma_f32_16x16x32_bf16 v[96:99], a[196:199], a[164:167], v[96:99]
  ds_read_b64_tr_b16 a[208:209], v28 offset:16384
  ds_read_b64_tr_b16 a[210:211], v28 offset:17408
  v_mfma_f32_16x16x32_bf16 v[104:107], a[192:195], a[168:171], v[104:107]
  buffer_load_dwordx4 v2, s[8:11], s38 offen offset:0 lds
  v_mfma_f32_16x16x32_bf16 v[104:107], a[196:199], a[172:175], v[104:107]
  ds_read_b64_tr_b16 a[212:213], v28 offset:24576
  ds_read_b64_tr_b16 a[214:215], v28 offset:25600
  v_mfma_f32_16x16x32_bf16 v[112:115], a[192:195], a[176:179], v[112:115]
  v_mfma_f32_16x16x32_bf16 v[112:115], a[196:199], a[180:183], v[112:115]
  v_mfma_f32_16x16x32_bf16 v[120:123], a[192:195], a[184:187], v[120:123]
  v_mfma_f32_16x16x32_bf16 v[120:123], a[196:199], a[188:191], v[120:123]
  s_waitcnt lgkmcnt(4)
  v_mfma_f32_16x16x32_bf16 a[12:15], a[200:203], a[160:163], a[12:15]
  v_mfma_f32_16x16x32_bf16 a[12:15], a[204:207], a[164:167], a[12:15]
  buffer_load_dwordx4 v3, s[8:11], s38 offen offset:1024 lds
  v_mfma_f32_16x16x32_bf16 a[44:47], a[200:203], a[168:171], a[44:47]
  ds_read_b64_tr_b16 a[216:217], v16 offset:0
  ds_read_b64_tr_b16 a[218:219], v16 offset:1024
  v_mfma_f32_16x16x32_bf16 a[44:47], a[204:207], a[172:175], a[44:47]
  ds_read_b64_tr_b16 a[220:221], v16 offset:8192
  ds_read_b64_tr_b16 a[222:223], v16 offset:9216
  v_mfma_f32_16x16x32_bf16 a[76:79], a[200:203], a[176:179], a[76:79]
  v_mfma_f32_16x16x32_bf16 a[76:79], a[204:207], a[180:183], a[76:79]
  v_mfma_f32_16x16x32_bf16 a[108:111], a[200:203], a[184:187], a[108:111]
  v_mfma_f32_16x16x32_bf16 a[108:111], a[204:207], a[188:191], a[108:111]
  s_waitcnt lgkmcnt(4)
  v_mfma_f32_16x16x32_bf16 v[100:103], a[208:211], a[160:163], v[100:103]
  buffer_load_dwordx4 v4, s[8:11], s38 offen offset:2048 lds
  v_mfma_f32_16x16x32_bf16 v[100:103], a[212:215], a[164:167], v[100:103]
  v_mfma_f32_16x16x32_bf16 v[108:111], a[208:211], a[168:171], v[108:111]
  ds_read_b64_tr_b16 a[224:225], v29 offset:16384
  ds_read_b64_tr_b16 a[226:227], v29 offset:17408
  v_mfma_f32_16x16x32_bf16 v[108:111], a[212:215], a[172:175], v[108:111]
  ds_read_b64_tr_b16 a[228:229], v29 offset:24576
  ds_read_b64_tr_b16 a[230:231], v29 offset:25600
  v_mfma_f32_16x16x32_bf16 v[116:119], a[208:211], a[176:179], v[116:119]
  v_mfma_f32_16x16x32_bf16 v[116:119], a[212:215], a[180:183], v[116:119]
  v_mfma_f32_16x16x32_bf16 v[124:127], a[208:211], a[184:187], v[124:127]
  v_mfma_f32_16x16x32_bf16 v[124:127], a[212:215], a[188:191], v[124:127]
  s_waitcnt lgkmcnt(4)
  v_mfma_f32_16x16x32_bf16 a[16:19], a[216:219], a[160:163], a[16:19]
  buffer_load_dwordx4 v5, s[8:11], s38 offen offset:3072 lds
  v_mfma_f32_16x16x32_bf16 a[16:19], a[220:223], a[164:167], a[16:19]
  s_add_u32 s38, s38, 0x80000
  ds_read_b64_tr_b16 a[192:193], v16 offset:8
  v_mfma_f32_16x16x32_bf16 a[48:51], a[216:219], a[168:171], a[48:51]
  ds_read_b64_tr_b16 a[194:195], v16 offset:1032
  ds_read_b64_tr_b16 a[196:197], v16 offset:8200
  v_mfma_f32_16x16x32_bf16 a[48:51], a[220:223], a[172:175], a[48:51]
  ds_read_b64_tr_b16 a[198:199], v16 offset:9224
  v_mfma_f32_16x16x32_bf16 a[80:83], a[216:219], a[176:179], a[80:83]
  v_mfma_f32_16x16x32_bf16 a[80:83], a[220:223], a[180:183], a[80:83]
  s_add_u32 m0, s40, s46
  v_mfma_f32_16x16x32_bf16 a[112:115], a[216:219], a[184:187], a[112:115]
  buffer_load_dwordx4 v6, s[12:15], s39 offen offset:0 lds
  v_mfma_f32_16x16x32_bf16 a[112:115], a[220:223], a[188:191], a[112:115]
  s_waitcnt lgkmcnt(4)
  v_mfma_f32_16x16x32_bf16 v[128:131], a[224:227], a[160:163], v[128:131]
  v_mfma_f32_16x16x32_bf16 v[128:131], a[228:231], a[164:167], v[128:131]
  v_mfma_f32_16x16x32_bf16 v[136:139], a[224:227], a[168:171], v[136:139]
  ds_read_b64_tr_b16 a[200:201], v30 offset:16384
  ds_read_b64_tr_b16 a[202:203], v30 offset:17408
  v_mfma_f32_16x16x32_bf16 v[136:139], a[228:231], a[172:175], v[136:139]
  ds_read_b64_tr_b16 a[204:205], v30 offset:24576
  ds_read_b64_tr_b16 a[206:207], v30 offset:25600
  v_mfma_f32_16x16x32_bf16 v[172:175], a[224:227], a[176:179], v[172:175]
  v_mfma_f32_16x16x32_bf16 v[172:175], a[228:231], a[180:183], v[172:175]
  buffer_load_dwordx4 v7, s[12:15], s39 offen offset:1024 lds
  v_mfma_f32_16x16x32_bf16 v[180:183], a[224:227], a[184:187], v[180:183]
  v_mfma_f32_16x16x32_bf16 v[180:183], a[228:231], a[188:191], v[180:183]
  s_waitcnt lgkmcnt(4)
  v_mfma_f32_16x16x32_bf16 a[20:23], a[192:195], a[160:163], a[20:23]
  v_mfma_f32_16x16x32_bf16 a[20:23], a[196:199], a[164:167], a[20:23]
  v_mfma_f32_16x16x32_bf16 a[52:55], a[192:195], a[168:171], a[52:55]
  ds_read_b64_tr_b16 a[208:209], v17 offset:0
  ds_read_b64_tr_b16 a[210:211], v17 offset:1024
  v_mfma_f32_16x16x32_bf16 a[52:55], a[196:199], a[172:175], a[52:55]
  ds_read_b64_tr_b16 a[212:213], v17 offset:8192
  ds_read_b64_tr_b16 a[214:215], v17 offset:9216
  v_mfma_f32_16x16x32_bf16 a[84:87], a[192:195], a[176:179], a[84:87]
  buffer_load_dwordx4 v8, s[12:15], s39 offen offset:2048 lds
  v_mfma_f32_16x16x32_bf16 a[84:87], a[196:199], a[180:183], a[84:87]
  v_mfma_f32_16x16x32_bf16 a[116:119], a[192:195], a[184:187], a[116:119]
  v_mfma_f32_16x16x32_bf16 a[116:119], a[196:199], a[188:191], a[116:119]
  s_waitcnt lgkmcnt(4)
  v_mfma_f32_16x16x32_bf16 v[132:135], a[200:203], a[160:163], v[132:135]
  v_mfma_f32_16x16x32_bf16 v[132:135], a[204:207], a[164:167], v[132:135]
  v_mfma_f32_16x16x32_bf16 v[140:143], a[200:203], a[168:171], v[140:143]
  ds_read_b64_tr_b16 a[216:217], v31 offset:16384
  ds_read_b64_tr_b16 a[218:219], v31 offset:17408
  v_mfma_f32_16x16x32_bf16 v[140:143], a[204:207], a[172:175], v[140:143]
  buffer_load_dwordx4 v9, s[12:15], s39 offen offset:3072 lds
  v_mfma_f32_16x16x32_bf16 v[176:179], a[200:203], a[176:179], v[176:179]
  s_add_u32 s39, s39, 0x70000
  s_mov_b32 s41, s49
  v_mfma_f32_16x16x32_bf16 v[176:179], a[204:207], a[180:183], v[176:179]
  s_mov_b32 s49, s40
  s_add_u32 s40, s40, 32768
  v_mfma_f32_16x16x32_bf16 v[184:187], a[200:203], a[184:187], v[184:187]
  s_cmp_lt_u32 s40, 98304
  s_cselect_b32 s40, s40, 0
  v_mfma_f32_16x16x32_bf16 v[184:187], a[204:207], a[188:191], v[184:187]
  ds_read_b64_tr_b16 a[220:221], v31 offset:24576
  s_waitcnt lgkmcnt(3)
  v_mfma_f32_16x16x32_bf16 a[24:27], a[208:211], a[160:163], a[24:27]
  ds_read_b64_tr_b16 a[222:223], v31 offset:25600
  ds_read_b64_tr_b16 a[224:225], v17 offset:8
  v_mfma_f32_16x16x32_bf16 a[24:27], a[212:215], a[164:167], a[24:27]
  v_mfma_f32_16x16x32_bf16 a[56:59], a[208:211], a[168:171], a[56:59]
  ds_read_b64_tr_b16 a[226:227], v17 offset:1032
  ds_read_b64_tr_b16 a[228:229], v17 offset:8200
  v_mfma_f32_16x16x32_bf16 a[56:59], a[212:215], a[172:175], a[56:59]
  ds_read_b64_tr_b16 a[230:231], v17 offset:9224
  v_mfma_f32_16x16x32_bf16 a[88:91], a[208:211], a[176:179], a[88:91]
  v_mfma_f32_16x16x32_bf16 a[88:91], a[212:215], a[180:183], a[88:91]
  v_mfma_f32_16x16x32_bf16 a[120:123], a[208:211], a[184:187], a[120:123]
  v_mfma_f32_16x16x32_bf16 a[120:123], a[212:215], a[188:191], a[120:123]
  s_waitcnt vmcnt(17) lgkmcnt(0)
  s_barrier
  v_mfma_f32_16x16x32_bf16 v[188:191], a[216:219], a[160:163], v[188:191]
  v_add_u32 v14, s41, v10
  v_add_u32 v25, s41, v18
  v_mfma_f32_16x16x32_bf16 v[188:191], a[220:223], a[164:167], v[188:191]
  v_add_u32 v26, s41, v19
  v_add_u32 v15, s41, v11
  v_mfma_f32_16x16x32_bf16 v[192:195], a[216:219], a[168:171], v[192:195]
  v_add_u32 v27, s41, v20
  v_add_u32 v28, s41, v21
  v_mfma_f32_16x16x32_bf16 v[192:195], a[220:223], a[172:175], v[192:195]
  v_add_u32 v16, s41, v12
  v_add_u32 v29, s41, v22
  v_mfma_f32_16x16x32_bf16 v[196:199], a[216:219], a[176:179], v[196:199]
  v_add_u32 v30, s41, v23
  v_add_u32 v17, s41, v13
  v_mfma_f32_16x16x32_bf16 v[196:199], a[220:223], a[180:183], v[196:199]
  ds_read_b64_tr_b16 a[192:193], v14 offset:0
  v_add_u32 v31, s41, v24
  v_mfma_f32_16x16x32_bf16 v[200:203], a[216:219], a[184:187], v[200:203]
  buffer_load_dword v248, v219, s[68:71], s56 offen
  v_mfma_f32_16x16x32_bf16 v[200:203], a[220:223], a[188:191], v[200:203]
  s_add_u32 s56, s56, s57
  v_mfma_f32_16x16x32_bf16 a[28:31], a[224:227], a[160:163], a[28:31]
  ds_read_b64_tr_b16 a[194:195], v14 offset:1024
  ds_read_b64_tr_b16 a[196:197], v14 offset:8192
  v_mfma_f32_16x16x32_bf16 a[28:31], a[228:231], a[164:167], a[28:31]
  ds_read_b64_tr_b16 a[198:199], v14 offset:9216
  ds_read_b64_tr_b16 a[200:201], v25 offset:16384
  v_mfma_f32_16x16x32_bf16 a[60:63], a[224:227], a[168:171], a[60:63]
  ds_read_b64_tr_b16 a[202:203], v25 offset:17408
  ds_read_b64_tr_b16 a[204:205], v25 offset:24576
  v_mfma_f32_16x16x32_bf16 a[60:63], a[228:231], a[172:175], a[60:63]
  ds_read_b64_tr_b16 a[206:207], v25 offset:25600
  v_mfma_f32_16x16x32_bf16 a[92:95], a[224:227], a[176:179], a[92:95]
  v_mfma_f32_16x16x32_bf16 a[92:95], a[228:231], a[180:183], a[92:95]
  v_mfma_f32_16x16x32_bf16 a[124:127], a[224:227], a[184:187], a[124:127]
  s_waitcnt vmcnt(9)
  v_mfma_f32_16x16x32_bf16 a[124:127], a[228:231], a[188:191], a[124:127]
  s_waitcnt lgkmcnt(4)
  s_sub_u32 s42, s42, 1
  s_cmp_lg_u32 s42, 0
  s_cbranch_scc1 L_p1
  v_mfma_f32_16x16x32_bf16 a[0:3], a[192:195], a[128:131], a[0:3]
  v_mfma_f32_16x16x32_bf16 a[0:3], a[196:199], a[132:135], a[0:3]
  ds_read_b64_tr_b16 a[208:209], v14 offset:8
  ds_read_b64_tr_b16 a[210:211], v14 offset:1032
  v_mfma_f32_16x16x32_bf16 a[32:35], a[192:195], a[136:139], a[32:35]
  buffer_load_dwordx4 a[160:163], v166, s[4:7], s36 offen offset:0 sc1
  v_mfma_f32_16x16x32_bf16 a[32:35], a[196:199], a[140:143], a[32:35]
  ds_read_b64_tr_b16 a[212:213], v14 offset:8200
  ds_read_b64_tr_b16 a[214:215], v14 offset:9224
  v_mfma_f32_16x16x32_bf16 a[64:67], a[192:195], a[144:147], a[64:67]
  v_add_f32 v48, v48, v49
  ds_read_b32 v34, v57 offset:0
  v_mfma_f32_16x16x32_bf16 a[64:67], a[196:199], a[148:151], a[64:67]
  ds_read_b32 v35, v57 offset:128
  ds_read_b32 v36, v57 offset:256
  v_mfma_f32_16x16x32_bf16 a[96:99], a[192:195], a[152:155], a[96:99]
  buffer_load_dwordx4 a[168:171], v166, s[4:7], s36 offen offset:1024 sc1
  v_mfma_f32_16x16x32_bf16 a[96:99], a[196:199], a[156:159], a[96:99]
  ds_read_b32 v33, v56 offset:256
  s_waitcnt lgkmcnt(8)
  v_mfma_f32_16x16x32_bf16 v[64:67], a[200:203], a[128:131], v[64:67]
  ds_read_b32 v32, v56 offset:0
  v_mfma_f32_16x16x32_bf16 v[64:67], a[204:207], a[132:135], v[64:67]
  ds_read_b64_tr_b16 a[216:217], v26 offset:16384
  ds_read_b64_tr_b16 a[218:219], v26 offset:17408
  v_mfma_f32_16x16x32_bf16 v[72:75], a[200:203], a[136:139], v[72:75]
  buffer_load_dwordx4 a[164:167], v166, s[4:7], s36 offen offset:2048 sc1
  v_mfma_f32_16x16x32_bf16 v[72:75], a[204:207], a[140:143], v[72:75]
  ds_read_b64_tr_b16 a[220:221], v26 offset:24576
  ds_read_b64_tr_b16 a[222:223], v26 offset:25600
  v_mfma_f32_16x16x32_bf16 v[80:83], a[200:203], a[144:147], v[80:83]
  v_cmp_lt_u32 vcc, 511, v166
  v_and_b32 v210, 256, v166
  s_nop 0
  v_cndmask_b32 v37, v204, v220, vcc
  v_cndmask_b32 v38, v228, v240, vcc
  v_cndmask_b32 v208, v204, v228, vcc
  v_cndmask_b32 v209, v220, v240, vcc
  v_mfma_f32_16x16x32_bf16 v[80:83], a[204:207], a[148:151], v[80:83]
  v_mfma_f32_16x16x32_bf16 v[88:91], a[200:203], a[152:155], v[88:91]
  buffer_load_dwordx4 a[172:175], v166, s[4:7], s36 offen offset:3072 sc1
  v_mfma_f32_16x16x32_bf16 v[88:91], a[204:207], a[156:159], v[88:91]
  s_add_u32 s36, s36, 4096
  s_waitcnt lgkmcnt(9)
  v_mfma_f32_16x16x32_bf16 a[4:7], a[208:211], a[128:131], a[4:7]
  v_cmp_ne_u32 vcc, 0, v210
  s_nop 1
  v_cndmask_b32 v39, v208, v209, vcc
  v_mfma_f32_16x16x32_bf16 a[4:7], a[212:215], a[132:135], a[4:7]
  v_mfma_f32_16x16x32_bf16 a[36:39], a[208:211], a[136:139], a[36:39]
  buffer_load_dwordx4 a[176:179], v166, s[4:7], s37 offen offset:0 sc1
  v_mfma_f32_16x16x32_bf16 a[36:39], a[212:215], a[140:143], a[36:39]
  ds_read_b64_tr_b16 a[224:225], v15 offset:0
  ds_read_b64_tr_b16 a[226:227], v15 offset:1024
  v_mfma_f32_16x16x32_bf16 a[68:71], a[208:211], a[144:147], a[68:71]
  ds_read_b64_tr_b16 a[228:229], v15 offset:8192
  ds_read_b64_tr_b16 a[230:231], v15 offset:9216
  v_mfma_f32_16x16x32_bf16 a[68:71], a[212:215], a[148:151], a[68:71]
  v_mfma_f32_16x16x32_bf16 a[100:103], a[208:211], a[152:155], a[100:103]
  buffer_load_dwordx4 a[184:187], v166, s[4:7], s37 offen offset:1024 sc1
  v_mfma_f32_16x16x32_bf16 a[100:103], a[212:215], a[156:159], a[100:103]
  s_waitcnt lgkmcnt(4)
  v_mfma_f32_16x16x32_bf16 v[68:71], a[216:219], a[128:131], v[68:71]
  v_mfma_f32_16x16x32_bf16 v[68:71], a[220:223], a[132:135], v[68:71]
  v_mfma_f32_16x16x32_bf16 v[76:79], a[216:219], a[136:139], v[76:79]
  buffer_load_dwordx4 a[180:183], v166, s[4:7], s37 offen offset:2048 sc1
  v_mfma_f32_16x16x32_bf16 v[76:79], a[220:223], a[140:143], v[76:79]
  v_mfma_f32_16x16x32_bf16 v[84:87], a[216:219], a[144:147], v[84:87]
  v_mfma_f32_16x16x32_bf16 v[84:87], a[220:223], a[148:151], v[84:87]
  v_mfma_f32_16x16x32_bf16 v[92:95], a[216:219], a[152:155], v[92:95]
  buffer_load_dwordx4 a[188:191], v166, s[4:7], s37 offen offset:3072 sc1
  v_mfma_f32_16x16x32_bf16 v[92:95], a[220:223], a[156:159], v[92:95]
  s_add_u32 s37, s37, 4096
  ds_read_b64_tr_b16 a[192:193], v27 offset:16384
  v_mfma_f32_16x16x1_4b_f32 a[16:31], v33, v204, a[16:31]
  ds_read_b64_tr_b16 a[194:195], v27 offset:17408
  ds_read_b64_tr_b16 a[196:197], v27 offset:24576
  ds_read_b64_tr_b16 a[198:199], v27 offset:25600
  s_waitcnt lgkmcnt(4)
  v_mfma_f32_16x16x32_bf16 a[8:11], a[224:227], a[128:131], a[8:11]
  v_mfma_f32_16x16x32_bf16 a[8:11], a[228:231], a[132:135], a[8:11]
  v_mfma_f32_16x16x32_bf16 a[40:43], a[224:227], a[136:139], a[40:43]
  s_add_u32 m0, s45, 147456
  ds_read_b64_tr_b16 a[200:201], v15 offset:8
  v_mfma_f32_16x16x32_bf16 a[40:43], a[228:231], a[140:143], a[40:43]
  buffer_load_dwordx4 v160, s[16:19], s43 offen offset:0 lds
  v_mfma_f32_16x16x32_bf16 a[72:75], a[224:227], a[144:147], a[72:75]
  ds_read_b64_tr_b16 a[202:203], v15 offset:1032
  ds_read_b64_tr_b16 a[204:205], v15 offset:8200
  v_mfma_f32_16x16x32_bf16 a[72:75], a[228:231], a[148:151], a[72:75]
  ds_read_b64_tr_b16 a[206:207], v15 offset:9224
  v_mfma_f32_16x16x32_bf16 a[104:107], a[224:227], a[152:155], a[104:107]
  v_mfma_f32_16x16x32_bf16 a[104:107], a[228:231], a[156:159], a[104:107]
  s_and_b32 s35, s3, 1
  v_mfma_f32_16x16x1_4b_f32 v[64:79], v34, v37, v[64:79]
  buffer_load_dwordx4 v161, s[16:19], s43 offen offset:1024 lds
  v_mfma_f32_16x16x1_4b_f32 v[80:95], v34, v38, v[80:95]
  s_lshl_b32 s48, s2, 1
  s_waitcnt lgkmcnt(4)
  v_mfma_f32_16x16x32_bf16 v[96:99], a[192:195], a[128:131], v[96:99]
  v_mfma_f32_16x16x32_bf16 v[96:99], a[196:199], a[132:135], v[96:99]
  s_add_u32 s48, s48, s35
  v_mfma_f32_16x16x32_bf16 v[104:107], a[192:195], a[136:139], v[104:107]
  ds_read_b64_tr_b16 a[208:209], v28 offset:16384
  ds_read_b64_tr_b16 a[210:211], v28 offset:17408
  v_mfma_f32_16x16x32_bf16 v[104:107], a[196:199], a[140:143], v[104:107]
  ds_read_b64_tr_b16 a[212:213], v28 offset:24576
  ds_read_b64_tr_b16 a[214:215], v28 offset:25600
  v_mfma_f32_16x16x32_bf16 v[112:115], a[192:195], a[144:147], v[112:115]
  buffer_load_dwordx4 v162, s[16:19], s43 offen offset:2048 lds
  v_mfma_f32_16x16x32_bf16 v[112:115], a[196:199], a[148:151], v[112:115]
  s_cmp_lt_u32 s3, 2
  s_mov_b32 s70, 14336
  s_cselect_b32 s70, 16384, s70
  s_cselect_b32 s68, s96, s98
  s_cselect_b32 s69, s97, s99
  v_mfma_f32_16x16x32_bf16 v[120:123], a[192:195], a[152:155], v[120:123]
  v_mfma_f32_16x16x32_bf16 v[120:123], a[196:199], a[156:159], v[120:123]
  s_waitcnt lgkmcnt(4)
  v_mfma_f32_16x16x32_bf16 a[12:15], a[200:203], a[128:131], a[12:15]
  v_mfma_f32_16x16x32_bf16 a[12:15], a[204:207], a[132:135], a[12:15]
  buffer_load_dwordx4 v163, s[16:19], s43 offen offset:3072 lds
  v_mfma_f32_16x16x32_bf16 a[44:47], a[200:203], a[136:139], a[44:47]
  s_add_u32 s43, s43, 16384
  ds_read_b64_tr_b16 a[216:217], v16 offset:0
  v_mfma_f32_16x16x32_bf16 a[44:47], a[204:207], a[140:143], a[44:47]
  ds_read_b64_tr_b16 a[218:219], v16 offset:1024
  ds_read_b64_tr_b16 a[220:221], v16 offset:8192
  v_mfma_f32_16x16x32_bf16 a[76:79], a[200:203], a[144:147], a[76:79]
  ds_read_b64_tr_b16 a[222:223], v16 offset:9216
  v_mfma_f32_16x16x32_bf16 a[76:79], a[204:207], a[148:151], a[76:79]
  v_mfma_f32_16x16x32_bf16 a[108:111], a[200:203], a[152:155], a[108:111]
  v_mfma_f32_16x16x32_bf16 a[108:111], a[204:207], a[156:159], a[108:111]
  s_add_u32 m0, s45, 49152
  s_waitcnt lgkmcnt(4)
  v_mfma_f32_16x16x32_bf16 v[100:103], a[208:211], a[128:131], v[100:103]
  buffer_load_dwordx4 v164, s[20:23], s44 offen offset:0 lds
  v_mfma_f32_16x16x32_bf16 v[100:103], a[212:215], a[132:135], v[100:103]
  v_mfma_f32_16x16x32_bf16 v[108:111], a[208:211], a[136:139], v[108:111]
  s_mul_i32 s48, s48, s70
  v_mfma_f32_16x16x32_bf16 v[108:111], a[212:215], a[140:143], v[108:111]
  ds_read_b64_tr_b16 a[224:225], v29 offset:16384
  ds_read_b64_tr_b16 a[226:227], v29 offset:17408
  v_mfma_f32_16x16x32_bf16 v[116:119], a[208:211], a[144:147], v[116:119]
  buffer_load_dwordx4 v165, s[20:23], s44 offen offset:1024 lds
  v_mfma_f32_16x16x32_bf16 v[116:119], a[212:215], a[148:151], v[116:119]
  ds_read_b64_tr_b16 a[228:229], v29 offset:24576
  ds_read_b64_tr_b16 a[230:231], v29 offset:25600
  v_mfma_f32_16x16x32_bf16 v[124:127], a[208:211], a[152:155], v[124:127]
  s_add_u32 s68, s68, s48
  s_addc_u32 s69, s69, 0
  v_mfma_f32_16x16x32_bf16 v[124:127], a[212:215], a[156:159], v[124:127]
  s_waitcnt lgkmcnt(4)
  v_mfma_f32_16x16x32_bf16 a[16:19], a[216:219], a[128:131], a[16:19]
  v_mfma_f32_16x16x32_bf16 a[16:19], a[220:223], a[132:135], a[16:19]
  v_mfma_f32_16x16x32_bf16 a[48:51], a[216:219], a[136:139], a[48:51]
  buffer_load_dwordx4 v164, s[20:23], s44 offen offset:2048 lds
  v_mfma_f32_16x16x32_bf16 a[48:51], a[220:223], a[140:143], a[48:51]
  v_mfma_f32_16x16x32_bf16 a[80:83], a[216:219], a[144:147], a[80:83]
  s_mov_b32 s65, 0
  v_mfma_f32_16x16x32_bf16 a[80:83], a[220:223], a[148:151], a[80:83]
  ds_read_b64_tr_b16 a[192:193], v16 offset:8
  ds_read_b64_tr_b16 a[194:195], v16 offset:1032
  v_mfma_f32_16x16x32_bf16 a[112:115], a[216:219], a[152:155], a[112:115]
  ds_read_b64_tr_b16 a[196:197], v16 offset:8200
  ds_read_b64_tr_b16 a[198:199], v16 offset:9224
  v_mfma_f32_16x16x32_bf16 a[112:115], a[220:223], a[156:159], a[112:115]
  buffer_load_dwordx4 v165, s[20:23], s44 offen offset:3072 lds
  v_mfma_f32_16x16x1_4b_f32 v[96:111], v35, v37, v[96:111]
  s_add_u32 s44, s44, 16384
  s_add_u32 s4, s60, 50331648
  s_addc_u32 s5, s61, 0
  v_mfma_f32_16x16x1_4b_f32 v[112:127], v35, v38, v[112:127]
  s_waitcnt lgkmcnt(4)
  v_mfma_f32_16x16x32_bf16 v[128:131], a[224:227], a[128:131], v[128:131]
  v_mfma_f32_16x16x32_bf16 v[128:131], a[228:231], a[132:135], v[128:131]
  s_mov_b32 s6, 131072
  v_mfma_f32_16x16x32_bf16 v[136:139], a[224:227], a[136:139], v[136:139]
  s_add_u32 m0, s45, 98304
  ds_read_b64_tr_b16 a[200:201], v30 offset:16384
  v_mfma_f32_16x16x32_bf16 v[136:139], a[228:231], a[140:143], v[136:139]
  buffer_load_dwordx4 v160, s[16:19], s43 offen offset:0 lds
  v_mfma_f32_16x16x32_bf16 v[172:175], a[224:227], a[144:147], v[172:175]
  ds_read_b64_tr_b16 a[202:203], v30 offset:17408
  ds_read_b64_tr_b16 a[204:205], v30 offset:24576
  v_mfma_f32_16x16x32_bf16 v[172:175], a[228:231], a[148:151], v[172:175]
  ds_read_b64_tr_b16 a[206:207], v30 offset:25600
  s_mov_b32 s7, 0x20000
  v_mfma_f32_16x16x32_bf16 v[180:183], a[224:227], a[152:155], v[180:183]
  v_mfma_f32_16x16x32_bf16 v[180:183], a[228:231], a[156:159], v[180:183]
  v_mfma_f32_16x16x1_4b_f32 a[0:15], v32, v204, a[0:15]
  buffer_load_dwordx4 v161, s[16:19], s43 offen offset:1024 lds
  s_lshl_b32 s58, s50, 4
  s_waitcnt lgkmcnt(4)
  v_mfma_f32_16x16x32_bf16 a[20:23], a[192:195], a[128:131], a[20:23]
  v_mfma_f32_16x16x32_bf16 a[20:23], a[196:199], a[132:135], a[20:23]
  s_and_b32 s48, s32, 15
  v_mfma_f32_16x16x32_bf16 a[52:55], a[192:195], a[136:139], a[52:55]
  ds_read_b64_tr_b16 a[208:209], v17 offset:0
  ds_read_b64_tr_b16 a[210:211], v17 offset:1024
  v_mfma_f32_16x16x32_bf16 a[52:55], a[196:199], a[140:143], a[52:55]
  ds_read_b64_tr_b16 a[212:213], v17 offset:8192
  ds_read_b64_tr_b16 a[214:215], v17 offset:9216
  v_mfma_f32_16x16x32_bf16 a[84:87], a[192:195], a[144:147], a[84:87]
  s_add_u32 s58, s58, s48
  v_mfma_f32_16x16x32_bf16 a[84:87], a[196:199], a[148:151], a[84:87]
  buffer_load_dwordx4 v162, s[16:19], s43 offen offset:2048 lds
  v_mfma_f32_16x16x32_bf16 a[116:119], a[192:195], a[152:155], a[116:119]
  v_mfma_f32_16x16x32_bf16 a[116:119], a[196:199], a[156:159], a[116:119]
  s_waitcnt lgkmcnt(4)
  v_mfma_f32_16x16x32_bf16 v[132:135], a[200:203], a[128:131], v[132:135]
  s_lshl_b32 s58, s58, 12
  v_mfma_f32_16x16x32_bf16 v[132:135], a[204:207], a[132:135], v[132:135]
  v_mfma_f32_16x16x32_bf16 v[140:143], a[200:203], a[136:139], v[140:143]
  buffer_load_dwordx4 v163, s[16:19], s43 offen offset:3072 lds
  v_mfma_f32_16x16x32_bf16 v[140:143], a[204:207], a[140:143], v[140:143]
  s_add_u32 s43, s43, 16384
  ds_read_b64_tr_b16 a[216:217], v31 offset:16384
  v_mfma_f32_16x16x32_bf16 v[176:179], a[200:203], a[144:147], v[176:179]
  s_add_u32 s58, s58, 33554432
  v_mfma_f32_16x16x32_bf16 v[176:179], a[204:207], a[148:151], v[176:179]
  s_mov_b32 s41, s49
  ds_read_b64_tr_b16 a[218:219], v31 offset:17408
  v_mfma_f32_16x16x32_bf16 v[184:187], a[200:203], a[152:155], v[184:187]
  ds_read_b64_tr_b16 a[220:221], v31 offset:24576
  ds_read_b64_tr_b16 a[222:223], v31 offset:25600
  v_mfma_f32_16x16x32_bf16 v[184:187], a[204:207], a[156:159], v[184:187]
  s_add_u32 m0, s45, 114688
  s_waitcnt lgkmcnt(4)
  v_mfma_f32_16x16x32_bf16 a[24:27], a[208:211], a[128:131], a[24:27]
  buffer_load_dwordx4 v160, s[16:19], s43 offen offset:0 lds
  v_mfma_f32_16x16x32_bf16 a[24:27], a[212:215], a[132:135], a[24:27]
  v_mfma_f32_16x16x32_bf16 a[56:59], a[208:211], a[136:139], a[56:59]
  v_mfma_f32_16x16x32_bf16 a[56:59], a[212:215], a[140:143], a[56:59]
  v_mfma_f32_16x16x32_bf16 a[88:91], a[208:211], a[144:147], a[88:91]
  ds_read_b64_tr_b16 a[224:225], v17 offset:8
  ds_read_b64_tr_b16 a[226:227], v17 offset:1032
  v_mfma_f32_16x16x32_bf16 a[88:91], a[212:215], a[148:151], a[88:91]
  buffer_load_dwordx4 v161, s[16:19], s43 offen offset:1024 lds
  v_mfma_f32_16x16x32_bf16 a[120:123], a[208:211], a[152:155], a[120:123]
  ds_read_b64_tr_b16 a[228:229], v17 offset:8200
  ds_read_b64_tr_b16 a[230:231], v17 offset:9224
  v_mfma_f32_16x16x32_bf16 a[120:123], a[212:215], a[156:159], a[120:123]
  v_mfma_f32_16x16x1_4b_f32 v[128:143], v36, v37, v[128:143]
  v_mfma_f32_16x16x1_4b_f32 v[172:187], v36, v38, v[172:187]
  s_waitcnt vmcnt(23) lgkmcnt(0)
  s_barrier
  v_mfma_f32_16x16x32_bf16 v[188:191], a[216:219], a[128:131], v[188:191]
  v_add_u32 v25, s41, v18
  v_add_u32 v26, s41, v19
  v_mfma_f32_16x16x32_bf16 v[188:191], a[220:223], a[132:135], v[188:191]
  v_add_u32 v27, s41, v20
  v_add_u32 v28, s41, v21
  v_mfma_f32_16x16x32_bf16 v[192:195], a[216:219], a[136:139], v[192:195]
  v_add_u32 v29, s41, v22
  v_add_u32 v30, s41, v23
  v_mfma_f32_16x16x32_bf16 v[192:195], a[220:223], a[140:143], v[192:195]
  v_add_u32 v31, s41, v24
  v_add_u32 v14, s41, v10
  v_mfma_f32_16x16x32_bf16 v[196:199], a[216:219], a[144:147], v[196:199]
  v_add_u32 v15, s41, v11
  v_add_u32 v16, s41, v12
  v_mfma_f32_16x16x32_bf16 v[196:199], a[220:223], a[148:151], v[196:199]
  ds_read_b64_tr_b16 a[192:193], v25 offset:16384
  v_add_u32 v17, s41, v13
  v_mfma_f32_16x16x32_bf16 v[200:203], a[216:219], a[152:155], v[200:203]
  buffer_load_dwordx4 v162, s[16:19], s43 offen offset:2048 lds
  v_mfma_f32_16x16x32_bf16 v[200:203], a[220:223], a[156:159], v[200:203]
  ds_read_b64_tr_b16 a[194:195], v25 offset:17408
  v_mfma_f32_16x16x32_bf16 a[28:31], a[224:227], a[128:131], a[28:31]
  buffer_load_dwordx4 v163, s[16:19], s43 offen offset:3072 lds
  v_mfma_f32_16x16x32_bf16 a[28:31], a[228:231], a[132:135], a[28:31]
  s_add_u32 s43, s43, 16384
  ds_read_b64_tr_b16 a[196:197], v25 offset:24576
  v_mfma_f32_16x16x32_bf16 a[60:63], a[224:227], a[136:139], a[60:63]
  ds_read_b64_tr_b16 a[198:199], v25 offset:25600
  ds_read_b64_tr_b16 a[200:201], v26 offset:16384
  v_mfma_f32_16x16x32_bf16 a[60:63], a[228:231], a[140:143], a[60:63]
  ds_read_b64_tr_b16 a[202:203], v26 offset:17408
  ds_read_b64_tr_b16 a[204:205], v26 offset:24576
  v_mfma_f32_16x16x32_bf16 a[92:95], a[224:227], a[144:147], a[92:95]
  ds_read_b64_tr_b16 a[206:207], v26 offset:25600
  v_mfma_f32_16x16x32_bf16 a[92:95], a[228:231], a[148:151], a[92:95]
  v_mfma_f32_16x16x32_bf16 a[124:127], a[224:227], a[152:155], a[124:127]
  v_mfma_f32_16x16x32_bf16 a[124:127], a[228:231], a[156:159], a[124:127]
  s_add_u32 m0, s45, 65536
  s_waitcnt vmcnt(16)
  v_mfma_f32_16x16x1_4b_f32 v[188:203], v48, v39, v[188:203]
  s_waitcnt lgkmcnt(4)
  v_mfma_f32_16x16x32_bf16 v[64:67], a[192:195], a[160:163], v[64:67]
  v_mfma_f32_16x16x32_bf16 v[64:67], a[196:199], a[164:167], v[64:67]
  buffer_load_dwordx4 v164, s[20:23], s44 offen offset:0 lds
  v_mfma_f32_16x16x32_bf16 v[72:75], a[192:195], a[168:171], v[72:75]
  ds_read_b64_tr_b16 a[208:209], v27 offset:16384
  ds_read_b64_tr_b16 a[210:211], v27 offset:17408
  v_mfma_f32_16x16x32_bf16 v[72:75], a[196:199], a[172:175], v[72:75]
  ds_read_b64_tr_b16 a[212:213], v27 offset:24576
  ds_read_b64_tr_b16 a[214:215], v27 offset:25600
  v_mfma_f32_16x16x32_bf16 v[80:83], a[192:195], a[176:179], v[80:83]
  v_mfma_f32_16x16x32_bf16 v[80:83], a[196:199], a[180:183], v[80:83]
  v_mfma_f32_16x16x32_bf16 v[88:91], a[192:195], a[184:187], v[88:91]
  buffer_load_dwordx4 v165, s[20:23], s44 offen offset:1024 lds
  v_mfma_f32_16x16x32_bf16 v[88:91], a[196:199], a[188:191], v[88:91]
  s_waitcnt lgkmcnt(4)
  v_mfma_f32_16x16x32_bf16 v[68:71], a[200:203], a[160:163], v[68:71]
  v_mfma_f32_16x16x32_bf16 v[68:71], a[204:207], a[164:167], v[68:71]
  v_mfma_f32_16x16x32_bf16 v[76:79], a[200:203], a[168:171], v[76:79]
  ds_read_b64_tr_b16 a[216:217], v28 offset:16384
  ds_read_b64_tr_b16 a[218:219], v28 offset:17408
  v_mfma_f32_16x16x32_bf16 v[76:79], a[204:207], a[172:175], v[76:79]
  buffer_load_dwordx4 v164, s[20:23], s44 offen offset:2048 lds
  v_mfma_f32_16x16x32_bf16 v[84:87], a[200:203], a[176:179], v[84:87]
  ds_read_b64_tr_b16 a[220:221], v28 offset:24576
  ds_read_b64_tr_b16 a[222:223], v28 offset:25600
  v_mfma_f32_16x16x32_bf16 v[84:87], a[204:207], a[180:183], v[84:87]
  v_mfma_f32_16x16x32_bf16 v[92:95], a[200:203], a[184:187], v[92:95]
  v_mfma_f32_16x16x32_bf16 v[92:95], a[204:207], a[188:191], v[92:95]
  s_waitcnt lgkmcnt(4)
  v_mfma_f32_16x16x32_bf16 v[96:99], a[208:211], a[160:163], v[96:99]
  buffer_load_dwordx4 v165, s[20:23], s44 offen offset:3072 lds
  v_mfma_f32_16x16x32_bf16 v[96:99], a[212:215], a[164:167], v[96:99]
  s_add_u32 s44, s44, 16384
  ds_read_b64_tr_b16 a[224:225], v29 offset:16384
  v_mfma_f32_16x16x32_bf16 v[104:107], a[208:211], a[168:171], v[104:107]
  v_cvt_pk_bf16_f32 v64, v64, v65
  v_cvt_pk_bf16_f32 v65, v66, v67
  v_mfma_f32_16x16x32_bf16 v[104:107], a[212:215], a[172:175], v[104:107]
  v_cvt_pk_bf16_f32 v66, v68, v69
  v_cvt_pk_bf16_f32 v67, v70, v71
  v_mfma_f32_16x16x32_bf16 v[112:115], a[208:211], a[176:179], v[112:115]
  s_add_u32 m0, s45, 131072
  ds_read_b64_tr_b16 a[226:227], v29 offset:17408
  v_mfma_f32_16x16x32_bf16 v[112:115], a[212:215], a[180:183], v[112:115]
  buffer_load_dwordx4 v160, s[16:19], s43 offen offset:0 lds
  v_mfma_f32_16x16x32_bf16 v[120:123], a[208:211], a[184:187], v[120:123]
  ds_read_b64_tr_b16 a[228:229], v29 offset:24576
  ds_read_b64_tr_b16 a[230:231], v29 offset:25600
  v_mfma_f32_16x16x32_bf16 v[120:123], a[212:215], a[188:191], v[120:123]
  v_pk_max_i16 v64, v64, 0
  s_waitcnt lgkmcnt(4)
  v_mfma_f32_16x16x32_bf16 v[100:103], a[216:219], a[160:163], v[100:103]
  v_pk_max_i16 v65, v65, 0
  v_pk_max_i16 v66, v66, 0
  v_mfma_f32_16x16x32_bf16 v[100:103], a[220:223], a[164:167], v[100:103]
  ds_read_b64_tr_b16 a[192:193], v30 offset:16384
  ds_read_b64_tr_b16 a[194:195], v30 offset:17408
  v_mfma_f32_16x16x32_bf16 v[108:111], a[216:219], a[168:171], v[108:111]
  buffer_load_dwordx4 v161, s[16:19], s43 offen offset:1024 lds
  v_mfma_f32_16x16x32_bf16 v[108:111], a[220:223], a[172:175], v[108:111]
  ds_read_b64_tr_b16 a[196:197], v30 offset:24576
  ds_read_b64_tr_b16 a[198:199], v30 offset:25600
  v_mfma_f32_16x16x32_bf16 v[116:119], a[216:219], a[176:179], v[116:119]
  v_pk_max_i16 v67, v67, 0
  v_cvt_pk_bf16_f32 v72, v72, v73
  v_mfma_f32_16x16x32_bf16 v[116:119], a[220:223], a[180:183], v[116:119]
  v_cvt_pk_bf16_f32 v73, v74, v75
  v_cvt_pk_bf16_f32 v74, v76, v77
  v_mfma_f32_16x16x32_bf16 v[124:127], a[216:219], a[184:187], v[124:127]
  v_cvt_pk_bf16_f32 v75, v78, v79
  v_pk_max_i16 v72, v72, 0
  v_mfma_f32_16x16x32_bf16 v[124:127], a[220:223], a[188:191], v[124:127]
  v_pk_max_i16 v73, v73, 0
  s_waitcnt lgkmcnt(4)
  v_mfma_f32_16x16x32_bf16 v[128:131], a[224:227], a[160:163], v[128:131]
  buffer_load_dwordx4 v162, s[16:19], s43 offen offset:2048 lds
  v_mfma_f32_16x16x32_bf16 v[128:131], a[228:231], a[164:167], v[128:131]
  v_pk_max_i16 v74, v74, 0
  v_pk_max_i16 v75, v75, 0
  v_mfma_f32_16x16x32_bf16 v[136:139], a[224:227], a[168:171], v[136:139]
  ds_read_b64_tr_b16 a[200:201], v31 offset:16384
  ds_read_b64_tr_b16 a[202:203], v31 offset:17408
  v_mfma_f32_16x16x32_bf16 v[136:139], a[228:231], a[172:175], v[136:139]
  ds_read_b64_tr_b16 a[204:205], v31 offset:24576
  ds_read_b64_tr_b16 a[206:207], v31 offset:25600
  v_mfma_f32_16x16x32_bf16 v[172:175], a[224:227], a[176:179], v[172:175]
  buffer_load_dwordx4 v163, s[16:19], s43 offen offset:3072 lds
  v_mfma_f32_16x16x32_bf16 v[172:175], a[228:231], a[180:183], v[172:175]
  s_add_u32 s43, s43, 16384
  v_cvt_pk_bf16_f32 v80, v80, v81
  v_mfma_f32_16x16x32_bf16 v[180:183], a[224:227], a[184:187], v[180:183]
  v_cvt_pk_bf16_f32 v81, v82, v83
  v_cvt_pk_bf16_f32 v82, v84, v85
  v_mfma_f32_16x16x32_bf16 v[180:183], a[228:231], a[188:191], v[180:183]
  v_cvt_pk_bf16_f32 v83, v86, v87
  s_waitcnt lgkmcnt(4)
  v_mfma_f32_16x16x32_bf16 v[132:135], a[192:195], a[160:163], v[132:135]
  v_pk_max_i16 v80, v80, 0
  v_pk_max_i16 v81, v81, 0
  v_mfma_f32_16x16x32_bf16 v[132:135], a[196:199], a[164:167], v[132:135]
  v_pk_max_i16 v82, v82, 0
  v_pk_max_i16 v83, v83, 0
  v_mfma_f32_16x16x32_bf16 v[140:143], a[192:195], a[168:171], v[140:143]
  ds_read_b64_tr_b16 a[208:209], v14 offset:0
  ds_read_b64_tr_b16 a[210:211], v14 offset:1024
  v_mfma_f32_16x16x32_bf16 v[140:143], a[196:199], a[172:175], v[140:143]
  ds_read_b64_tr_b16 a[212:213], v14 offset:8192
  ds_read_b64_tr_b16 a[214:215], v14 offset:9216
  v_mfma_f32_16x16x32_bf16 v[176:179], a[192:195], a[176:179], v[176:179]
  v_cvt_pk_bf16_f32 v88, v88, v89
  v_cvt_pk_bf16_f32 v89, v90, v91
  v_mfma_f32_16x16x32_bf16 v[176:179], a[196:199], a[180:183], v[176:179]
  v_cvt_pk_bf16_f32 v90, v92, v93
  v_cvt_pk_bf16_f32 v91, v94, v95
  v_mfma_f32_16x16x32_bf16 v[184:187], a[192:195], a[184:187], v[184:187]
  v_pk_max_i16 v88, v88, 0
  v_pk_max_i16 v89, v89, 0
  v_mfma_f32_16x16x32_bf16 v[184:187], a[196:199], a[188:191], v[184:187]
  v_pk_max_i16 v90, v90, 0
  s_waitcnt lgkmcnt(4)
  v_mfma_f32_16x16x32_bf16 v[188:191], a[200:203], a[160:163], v[188:191]
  v_pk_max_i16 v91, v91, 0
  v_cvt_pk_bf16_f32 v96, v96, v97
  v_mfma_f32_16x16x32_bf16 v[188:191], a[204:207], a[164:167], v[188:191]
  v_cvt_pk_bf16_f32 v97, v98, v99
  v_cvt_pk_bf16_f32 v98, v100, v101
  v_mfma_f32_16x16x32_bf16 v[192:195], a[200:203], a[168:171], v[192:195]
  ds_read_b64_tr_b16 a[216:217], v14 offset:8
  ds_read_b64_tr_b16 a[218:219], v14 offset:1032
  v_mfma_f32_16x16x32_bf16 v[192:195], a[204:207], a[172:175], v[192:195]
  ds_read_b64_tr_b16 a[220:221], v14 offset:8200
  ds_read_b64_tr_b16 a[222:223], v14 offset:9224
  v_mfma_f32_16x16x32_bf16 v[196:199], a[200:203], a[176:179], v[196:199]
  v_cvt_pk_bf16_f32 v99, v102, v103
  v_pk_max_i16 v96, v96, 0
  v_mfma_f32_16x16x32_bf16 v[196:199], a[204:207], a[180:183], v[196:199]
  v_pk_max_i16 v97, v97, 0
  v_pk_max_i16 v98, v98, 0
  v_mfma_f32_16x16x32_bf16 v[200:203], a[200:203], a[184:187], v[200:203]
  v_pk_max_i16 v99, v99, 0
  v_cvt_pk_bf16_f32 v104, v104, v105
  v_mfma_f32_16x16x32_bf16 v[200:203], a[204:207], a[188:191], v[200:203]
  v_cvt_pk_bf16_f32 v105, v106, v107
  s_waitcnt lgkmcnt(4)
  v_mfma_f32_16x16x32_bf16 a[0:3], a[208:211], a[160:163], a[0:3]
  v_cvt_pk_bf16_f32 v106, v108, v109
  v_cvt_pk_bf16_f32 v107, v110, v111
  v_mfma_f32_16x16x32_bf16 a[0:3], a[212:215], a[164:167], a[0:3]
  v_pk_max_i16 v104, v104, 0
  v_pk_max_i16 v105, v105, 0
  v_mfma_f32_16x16x32_bf16 a[32:35], a[208:211], a[168:171], a[32:35]
  ds_read_b64_tr_b16 a[224:225], v15 offset:0
  ds_read_b64_tr_b16 a[226:227], v15 offset:1024
  v_mfma_f32_16x16x32_bf16 a[32:35], a[212:215], a[172:175], a[32:35]
  ds_read_b64_tr_b16 a[228:229], v15 offset:8192
  ds_read_b64_tr_b16 a[230:231], v15 offset:9216
  v_mfma_f32_16x16x32_bf16 a[64:67], a[208:211], a[176:179], a[64:67]
  v_pk_max_i16 v106, v106, 0
  v_pk_max_i16 v107, v107, 0
  v_mfma_f32_16x16x32_bf16 a[64:67], a[212:215], a[180:183], a[64:67]
  v_cvt_pk_bf16_f32 v112, v112, v113
  v_cvt_pk_bf16_f32 v113, v114, v115
  v_mfma_f32_16x16x32_bf16 a[96:99], a[208:211], a[184:187], a[96:99]
  v_cvt_pk_bf16_f32 v114, v116, v117
  v_cvt_pk_bf16_f32 v115, v118, v119
  v_mfma_f32_16x16x32_bf16 a[96:99], a[212:215], a[188:191], a[96:99]
  v_pk_max_i16 v112, v112, 0
  s_waitcnt lgkmcnt(4)
  v_mfma_f32_16x16x32_bf16 a[4:7], a[216:219], a[160:163], a[4:7]
  v_pk_max_i16 v113, v113, 0
  v_mfma_f32_16x16x32_bf16 a[4:7], a[220:223], a[164:167], a[4:7]
  v_pk_max_i16 v114, v114, 0
  v_pk_max_i16 v115, v115, 0
  v_mfma_f32_16x16x32_bf16 a[36:39], a[216:219], a[168:171], a[36:39]
  ds_read_b64_tr_b16 a[192:193], v15 offset:8
  ds_read_b64_tr_b16 a[194:195], v15 offset:1032
  v_mfma_f32_16x16x32_bf16 a[36:39], a[220:223], a[172:175], a[36:39]
  ds_read_b64_tr_b16 a[196:197], v15 offset:8200
  ds_read_b64_tr_b16 a[198:199], v15 offset:9224
  v_mfma_f32_16x16x32_bf16 a[68:71], a[216:219], a[176:179], a[68:71]
  v_cvt_pk_bf16_f32 v120, v120, v121
  v_cvt_pk_bf16_f32 v121, v122, v123
  v_mfma_f32_16x16x32_bf16 a[68:71], a[220:223], a[180:183], a[68:71]
  v_cvt_pk_bf16_f32 v122, v124, v125
  v_cvt_pk_bf16_f32 v123, v126, v127
  v_mfma_f32_16x16x32_bf16 a[100:103], a[216:219], a[184:187], a[100:103]
  v_pk_max_i16 v120, v120, 0
  v_mfma_f32_16x16x32_bf16 a[100:103], a[220:223], a[188:191], a[100:103]
  v_pk_max_i16 v121, v121, 0
  s_waitcnt lgkmcnt(4)
  v_mfma_f32_16x16x32_bf16 a[8:11], a[224:227], a[160:163], a[8:11]
  v_pk_max_i16 v122, v122, 0
  v_mfma_f32_16x16x32_bf16 a[8:11], a[228:231], a[164:167], a[8:11]
  v_pk_max_i16 v123, v123, 0
  v_cvt_pk_bf16_f32 v128, v128, v129
  v_mfma_f32_16x16x32_bf16 a[40:43], a[224:227], a[168:171], a[40:43]
  ds_read_b64_tr_b16 a[200:201], v16 offset:0
  ds_read_b64_tr_b16 a[202:203], v16 offset:1024
  v_mfma_f32_16x16x32_bf16 a[40:43], a[228:231], a[172:175], a[40:43]
  ds_read_b64_tr_b16 a[204:205], v16 offset:8192
  ds_read_b64_tr_b16 a[206:207], v16 offset:9216
  v_mfma_f32_16x16x32_bf16 a[72:75], a[224:227], a[176:179], a[72:75]
  v_cvt_pk_bf16_f32 v129, v130, v131
  v_cvt_pk_bf16_f32 v130, v132, v133
  v_mfma_f32_16x16x32_bf16 a[72:75], a[228:231], a[180:183], a[72:75]
  v_cvt_pk_bf16_f32 v131, v134, v135
  v_pk_max_i16 v128, v128, 0
  v_mfma_f32_16x16x32_bf16 a[104:107], a[224:227], a[184:187], a[104:107]
  v_pk_max_i16 v129, v129, 0
  v_mfma_f32_16x16x32_bf16 a[104:107], a[228:231], a[188:191], a[104:107]
  v_pk_max_i16 v130, v130, 0
  s_waitcnt lgkmcnt(4)
  v_mfma_f32_16x16x32_bf16 a[12:15], a[192:195], a[160:163], a[12:15]
  v_pk_max_i16 v131, v131, 0
  v_mfma_f32_16x16x32_bf16 a[12:15], a[196:199], a[164:167], a[12:15]
  v_cvt_pk_bf16_f32 v136, v136, v137
  v_cvt_pk_bf16_f32 v137, v138, v139
  v_mfma_f32_16x16x32_bf16 a[44:47], a[192:195], a[168:171], a[44:47]
  ds_read_b64_tr_b16 a[208:209], v16 offset:8
  ds_read_b64_tr_b16 a[210:211], v16 offset:1032
  v_mfma_f32_16x16x32_bf16 a[44:47], a[196:199], a[172:175], a[44:47]
  ds_read_b64_tr_b16 a[212:213], v16 offset:8200
  ds_read_b64_tr_b16 a[214:215], v16 offset:9224
  v_mfma_f32_16x16x32_bf16 a[76:79], a[192:195], a[176:179], a[76:79]
  v_cvt_pk_bf16_f32 v138, v140, v141
  v_cvt_pk_bf16_f32 v139, v142, v143
  v_mfma_f32_16x16x32_bf16 a[76:79], a[196:199], a[180:183], a[76:79]
  v_pk_max_i16 v136, v136, 0
  v_pk_max_i16 v137, v137, 0
  v_mfma_f32_16x16x32_bf16 a[108:111], a[192:195], a[184:187], a[108:111]
  v_pk_max_i16 v138, v138, 0
  v_mfma_f32_16x16x32_bf16 a[108:111], a[196:199], a[188:191], a[108:111]
  v_pk_max_i16 v139, v139, 0
  s_waitcnt lgkmcnt(4)
  v_mfma_f32_16x16x32_bf16 a[16:19], a[200:203], a[160:163], a[16:19]
  v_cvt_pk_bf16_f32 v172, v172, v173
  v_cvt_pk_bf16_f32 v173, v174, v175
  v_mfma_f32_16x16x32_bf16 a[16:19], a[204:207], a[164:167], a[16:19]
  v_cvt_pk_bf16_f32 v174, v176, v177
  v_cvt_pk_bf16_f32 v175, v178, v179
  v_mfma_f32_16x16x32_bf16 a[48:51], a[200:203], a[168:171], a[48:51]
  ds_read_b64_tr_b16 a[216:217], v17 offset:0
  ds_read_b64_tr_b16 a[218:219], v17 offset:1024
  v_mfma_f32_16x16x32_bf16 a[48:51], a[204:207], a[172:175], a[48:51]
  ds_read_b64_tr_b16 a[220:221], v17 offset:8192
  ds_read_b64_tr_b16 a[222:223], v17 offset:9216
  v_mfma_f32_16x16x32_bf16 a[80:83], a[200:203], a[176:179], a[80:83]
  v_pk_max_i16 v172, v172, 0
  v_pk_max_i16 v173, v173, 0
  v_mfma_f32_16x16x32_bf16 a[80:83], a[204:207], a[180:183], a[80:83]
  v_pk_max_i16 v174, v174, 0
  v_mfma_f32_16x16x32_bf16 a[112:115], a[200:203], a[184:187], a[112:115]
  v_pk_max_i16 v175, v175, 0
  v_mfma_f32_16x16x32_bf16 a[112:115], a[204:207], a[188:191], a[112:115]
  v_cvt_pk_bf16_f32 v180, v180, v181
  s_waitcnt lgkmcnt(4)
  v_mfma_f32_16x16x32_bf16 a[20:23], a[208:211], a[160:163], a[20:23]
  v_cvt_pk_bf16_f32 v181, v182, v183
  v_cvt_pk_bf16_f32 v182, v184, v185
  v_mfma_f32_16x16x32_bf16 a[20:23], a[212:215], a[164:167], a[20:23]
  v_cvt_pk_bf16_f32 v183, v186, v187
  v_pk_max_i16 v180, v180, 0
  v_mfma_f32_16x16x32_bf16 a[52:55], a[208:211], a[168:171], a[52:55]
  ds_read_b64_tr_b16 a[224:225], v17 offset:8
  ds_read_b64_tr_b16 a[226:227], v17 offset:1032
  v_mfma_f32_16x16x32_bf16 a[52:55], a[212:215], a[172:175], a[52:55]
  ds_read_b64_tr_b16 a[228:229], v17 offset:8200
  ds_read_b64_tr_b16 a[230:231], v17 offset:9224
  v_mfma_f32_16x16x32_bf16 a[84:87], a[208:211], a[176:179], a[84:87]
  v_pk_max_i16 v181, v181, 0
  v_pk_max_i16 v182, v182, 0
  v_mfma_f32_16x16x32_bf16 a[84:87], a[212:215], a[180:183], a[84:87]
  v_pk_max_i16 v183, v183, 0
  v_mfma_f32_16x16x32_bf16 a[116:119], a[208:211], a[184:187], a[116:119]
  v_cvt_pk_bf16_f32 v188, v188, v189
  v_cvt_pk_bf16_f32 v189, v190, v191
  v_mfma_f32_16x16x32_bf16 a[116:119], a[212:215], a[188:191], a[116:119]
  v_pk_max_i16 v188, v188, 0
  s_waitcnt lgkmcnt(4)
  v_mfma_f32_16x16x32_bf16 a[24:27], a[216:219], a[160:163], a[24:27]
  v_pk_max_i16 v189, v189, 0
  v_mfma_f32_16x16x32_bf16 a[24:27], a[220:223], a[164:167], a[24:27]
  v_cvt_pk_bf16_f32 v192, v192, v193
  v_mfma_f32_16x16x32_bf16 a[56:59], a[216:219], a[168:171], a[56:59]
  v_cvt_pk_bf16_f32 v193, v194, v195
  v_mfma_f32_16x16x32_bf16 a[56:59], a[220:223], a[172:175], a[56:59]
  v_pk_max_i16 v192, v192, 0
  v_pk_max_i16 v193, v193, 0
  v_mfma_f32_16x16x32_bf16 a[88:91], a[216:219], a[176:179], a[88:91]
  s_waitcnt vmcnt(20)
  s_barrier
  v_mfma_f32_16x16x32_bf16 a[88:91], a[220:223], a[180:183], a[88:91]
  v_cvt_pk_bf16_f32 v196, v196, v197
  v_cvt_pk_bf16_f32 v197, v198, v199
  v_mfma_f32_16x16x32_bf16 a[120:123], a[216:219], a[184:187], a[120:123]
  v_pk_max_i16 v196, v196, 0
  v_mfma_f32_16x16x32_bf16 a[120:123], a[220:223], a[188:191], a[120:123]
  v_pk_max_i16 v197, v197, 0
  s_waitcnt lgkmcnt(0)
  v_mfma_f32_16x16x32_bf16 a[28:31], a[224:227], a[160:163], a[28:31]
  v_cvt_pk_bf16_f32 v200, v200, v201
  v_mfma_f32_16x16x32_bf16 a[28:31], a[228:231], a[164:167], a[28:31]
  v_cvt_pk_bf16_f32 v201, v202, v203
  v_mfma_f32_16x16x32_bf16 a[60:63], a[224:227], a[168:171], a[60:63]
  v_pk_max_i16 v200, v200, 0
  v_mfma_f32_16x16x32_bf16 a[60:63], a[228:231], a[172:175], a[60:63]
  v_pk_max_i16 v201, v201, 0
  v_mfma_f32_16x16x32_bf16 a[92:95], a[224:227], a[176:179], a[92:95]
  v_mfma_f32_16x16x32_bf16 a[92:95], a[228:231], a[180:183], a[92:95]
  v_mfma_f32_16x16x32_bf16 a[124:127], a[224:227], a[184:187], a[124:127]
  v_mfma_f32_16x16x32_bf16 a[124:127], a[228:231], a[188:191], a[124:127]
L_qep:
  ds_read_b128 a[192:195], v148 offset:49152
  ds_read_b128 a[196:199], v149 offset:49152
  ds_read_b128 a[200:203], v150 offset:49152
  ds_read_b128 a[204:207], v151 offset:49152
  ds_read_b128 a[208:211], v148 offset:53248
  ds_read_b128 a[212:215], v149 offset:53248
  ds_read_b128 a[216:219], v150 offset:53248
  ds_read_b128 a[220:223], v151 offset:53248
  ds_read_b128 a[224:227], v148 offset:57344
  ds_read_b128 a[228:231], v149 offset:57344
  ds_read_b128 a[232:235], v150 offset:57344
  ds_read_b128 a[236:239], v151 offset:57344
  ds_read_b128 a[240:243], v148 offset:61440
  ds_read_b128 a[244:247], v149 offset:61440
  ds_read_b128 a[248:251], v150 offset:61440
  ds_read_b128 a[252:255], v151 offset:61440
  v_accvgpr_read_b32 v48, a0
  v_accvgpr_read_b32 v49, a1
  v_accvgpr_read_b32 v50, a2
  v_accvgpr_read_b32 v51, a3
  v_accvgpr_read_b32 v52, a4
  v_accvgpr_read_b32 v53, a5
  v_mfma_f32_16x16x1_4b_f32 a[32:47], v32, v220, a[32:47]
  v_accvgpr_read_b32 v54, a6
  v_accvgpr_read_b32 v55, a7
  v_pk_mul_f32 v[48:49], v[48:49], v[206:207]
  v_pk_mul_f32 v[50:51], v[50:51], v[206:207]
  v_pk_mul_f32 v[52:53], v[52:53], v[206:207]
  v_pk_mul_f32 v[54:55], v[54:55], v[206:207]
  v_cvt_pk_bf16_f32 v48, v48, v49
  v_cvt_pk_bf16_f32 v49, v50, v51
  v_cvt_pk_bf16_f32 v50, v52, v53
  v_cvt_pk_bf16_f32 v51, v54, v55
  v_mfma_f32_16x16x1_4b_f32 a[48:63], v33, v220, a[48:63]
  v_accvgpr_write_b32 a128, v48
  v_accvgpr_write_b32 a129, v49
  v_accvgpr_write_b32 a130, v50
  v_accvgpr_write_b32 a131, v51
  v_accvgpr_read_b32 v56, a8
  v_accvgpr_read_b32 v57, a9
  v_accvgpr_read_b32 v58, a10
  v_accvgpr_read_b32 v59, a11
  v_accvgpr_read_b32 v60, a12
  v_accvgpr_read_b32 v61, a13
  v_mfma_f32_16x16x1_4b_f32 a[64:79], v32, v228, a[64:79]
  v_accvgpr_read_b32 v62, a14
  v_accvgpr_read_b32 v63, a15
  v_pk_mul_f32 v[56:57], v[56:57], v[206:207]
  v_pk_mul_f32 v[58:59], v[58:59], v[206:207]
  v_pk_mul_f32 v[60:61], v[60:61], v[206:207]
  v_pk_mul_f32 v[62:63], v[62:63], v[206:207]
  v_cvt_pk_bf16_f32 v56, v56, v57
  v_cvt_pk_bf16_f32 v57, v58, v59
  v_cvt_pk_bf16_f32 v58, v60, v61
  v_cvt_pk_bf16_f32 v59, v62, v63
  v_mfma_f32_16x16x1_4b_f32 a[80:95], v33, v228, a[80:95]
  v_accvgpr_write_b32 a132, v56
  v_accvgpr_write_b32 a133, v57
  v_accvgpr_write_b32 a134, v58
  v_accvgpr_write_b32 a135, v59
  v_accvgpr_read_b32 v48, a16
  v_accvgpr_read_b32 v49, a17
  v_accvgpr_read_b32 v50, a18
  v_accvgpr_read_b32 v51, a19
  v_accvgpr_read_b32 v52, a20
  v_accvgpr_read_b32 v53, a21
  v_mfma_f32_16x16x1_4b_f32 a[96:111], v32, v240, a[96:111]
  v_accvgpr_read_b32 v54, a22
  v_accvgpr_read_b32 v55, a23
  v_pk_mul_f32 v[48:49], v[48:49], v[206:207]
  v_pk_mul_f32 v[50:51], v[50:51], v[206:207]
  v_pk_mul_f32 v[52:53], v[52:53], v[206:207]
  v_pk_mul_f32 v[54:55], v[54:55], v[206:207]
  v_cvt_pk_bf16_f32 v48, v48, v49
  v_cvt_pk_bf16_f32 v49, v50, v51
  v_cvt_pk_bf16_f32 v50, v52, v53
  v_cvt_pk_bf16_f32 v51, v54, v55
  v_mfma_f32_16x16x1_4b_f32 a[112:127], v33, v240, a[112:127]
  v_accvgpr_write_b32 a136, v48
  v_accvgpr_write_b32 a137, v49
  v_accvgpr_write_b32 a138, v50
  v_accvgpr_write_b32 a139, v51
  v_accvgpr_read_b32 v56, a24
  v_accvgpr_read_b32 v57, a25
  v_accvgpr_read_b32 v58, a26
  v_accvgpr_read_b32 v59, a27
  v_accvgpr_read_b32 v60, a28
  v_accvgpr_read_b32 v61, a29
  v_accvgpr_read_b32 v62, a30
  v_accvgpr_read_b32 v63, a31
  v_pk_mul_f32 v[56:57], v[56:57], v[206:207]
  v_pk_mul_f32 v[58:59], v[58:59], v[206:207]
  v_pk_mul_f32 v[60:61], v[60:61], v[206:207]
  v_pk_mul_f32 v[62:63], v[62:63], v[206:207]
  v_cvt_pk_bf16_f32 v56, v56, v57
  v_cvt_pk_bf16_f32 v57, v58, v59
  v_cvt_pk_bf16_f32 v58, v60, v61
  v_cvt_pk_bf16_f32 v59, v62, v63
  v_accvgpr_write_b32 a140, v56
  v_accvgpr_write_b32 a141, v57
  v_accvgpr_write_b32 a142, v58
  v_accvgpr_write_b32 a143, v59
  s_nop 0
  s_waitcnt lgkmcnt(0)
  v_mfma_f32_16x16x32_bf16 v[0:3], a[192:195], a[128:131], 0
  v_accvgpr_read_b32 v48, a32
  v_accvgpr_read_b32 v49, a33
  v_accvgpr_read_b32 v50, a34
  v_accvgpr_read_b32 v51, a35
  v_accvgpr_read_b32 v52, a36
  v_accvgpr_read_b32 v53, a37
  v_accvgpr_read_b32 v54, a38
  buffer_store_dwordx4 v[64:67], v168, s[24:27], s66 offen offset:0 sc1
  v_mfma_f32_16x16x32_bf16 v[0:3], a[196:199], a[132:135], v[0:3]
  v_accvgpr_read_b32 v55, a39
  v_mul_f32 v48, v222, v48
  v_mul_f32 v49, v222, v49
  v_mul_f32 v50, v222, v50
  v_mul_f32 v51, v222, v51
  v_mul_f32 v52, v222, v52
  v_mfma_f32_16x16x32_bf16 v[0:3], a[200:203], a[136:139], v[0:3]
  v_mul_f32 v53, v222, v53
  v_mul_f32 v54, v222, v54
  v_mul_f32 v55, v222, v55
  v_cvt_pk_bf16_f32 v48, v48, v49
  v_cvt_pk_bf16_f32 v49, v50, v51
  v_cvt_pk_bf16_f32 v50, v52, v53
  v_mfma_f32_16x16x32_bf16 v[0:3], a[204:207], a[140:143], v[0:3]
  v_cvt_pk_bf16_f32 v51, v54, v55
  v_accvgpr_write_b32 a144, v48
  v_accvgpr_write_b32 a145, v49
  v_accvgpr_write_b32 a146, v50
  v_accvgpr_write_b32 a147, v51
  v_accvgpr_read_b32 v56, a40
  v_mfma_f32_16x16x32_bf16 v[4:7], a[208:211], a[128:131], 0
  v_accvgpr_read_b32 v57, a41
  v_accvgpr_read_b32 v58, a42
  v_accvgpr_read_b32 v59, a43
  v_accvgpr_read_b32 v60, a44
  v_accvgpr_read_b32 v61, a45
  v_accvgpr_read_b32 v62, a46
  buffer_store_dwordx4 v[72:75], v168, s[24:27], s66 offen offset:1024 sc1
  v_mfma_f32_16x16x32_bf16 v[4:7], a[212:215], a[132:135], v[4:7]
  v_accvgpr_read_b32 v63, a47
  v_mul_f32 v56, v222, v56
  v_mul_f32 v57, v222, v57
  v_mul_f32 v58, v222, v58
  v_mul_f32 v59, v222, v59
  v_mul_f32 v60, v222, v60
  v_mfma_f32_16x16x32_bf16 v[4:7], a[216:219], a[136:139], v[4:7]
  v_mul_f32 v61, v222, v61
  v_mul_f32 v62, v222, v62
  v_mul_f32 v63, v222, v63
  v_cvt_pk_bf16_f32 v56, v56, v57
  v_cvt_pk_bf16_f32 v57, v58, v59
  v_cvt_pk_bf16_f32 v58, v60, v61
  v_mfma_f32_16x16x32_bf16 v[4:7], a[220:223], a[140:143], v[4:7]
  v_cvt_pk_bf16_f32 v59, v62, v63
  v_accvgpr_write_b32 a148, v56
  v_accvgpr_write_b32 a149, v57
  v_accvgpr_write_b32 a150, v58
  v_accvgpr_write_b32 a151, v59
  v_accvgpr_read_b32 v48, a48
  v_mfma_f32_16x16x32_bf16 v[8:11], a[224:227], a[128:131], 0
  v_accvgpr_read_b32 v49, a49
  v_accvgpr_read_b32 v50, a50
  v_accvgpr_read_b32 v51, a51
  v_accvgpr_read_b32 v52, a52
  v_accvgpr_read_b32 v53, a53
  v_accvgpr_read_b32 v54, a54
  buffer_store_dwordx4 v[80:83], v168, s[24:27], s67 offen offset:0 sc1
  v_mfma_f32_16x16x32_bf16 v[8:11], a[228:231], a[132:135], v[8:11]
  v_accvgpr_read_b32 v55, a55
  v_mul_f32 v48, v222, v48
  v_mul_f32 v49, v222, v49
  v_mul_f32 v50, v222, v50
  v_mul_f32 v51, v222, v51
  v_mul_f32 v52, v222, v52
  v_mfma_f32_16x16x32_bf16 v[8:11], a[232:235], a[136:139], v[8:11]
  v_mul_f32 v53, v222, v53
  v_mul_f32 v54, v222, v54
  v_mul_f32 v55, v222, v55
  v_cvt_pk_bf16_f32 v48, v48, v49
  v_cvt_pk_bf16_f32 v49, v50, v51
  v_cvt_pk_bf16_f32 v50, v52, v53
  v_mfma_f32_16x16x32_bf16 v[8:11], a[236:239], a[140:143], v[8:11]
  v_cvt_pk_bf16_f32 v51, v54, v55
  v_accvgpr_write_b32 a152, v48
  v_accvgpr_write_b32 a153, v49
  v_accvgpr_write_b32 a154, v50
  v_accvgpr_write_b32 a155, v51
  v_accvgpr_read_b32 v56, a56
  v_mfma_f32_16x16x32_bf16 v[12:15], a[240:243], a[128:131], 0
  v_accvgpr_read_b32 v57, a57
  v_accvgpr_read_b32 v58, a58
  v_accvgpr_read_b32 v59, a59
  v_accvgpr_read_b32 v60, a60
  v_accvgpr_read_b32 v61, a61
  v_accvgpr_read_b32 v62, a62
  buffer_store_dwordx4 v[88:91], v168, s[24:27], s67 offen offset:1024 sc1
  v_mfma_f32_16x16x32_bf16 v[12:15], a[244:247], a[132:135], v[12:15]
  v_accvgpr_read_b32 v63, a63
  v_mul_f32 v56, v222, v56
  v_mul_f32 v57, v222, v57
  v_mul_f32 v58, v222, v58
  v_mul_f32 v59, v222, v59
  v_mul_f32 v60, v222, v60
  v_mfma_f32_16x16x32_bf16 v[12:15], a[248:251], a[136:139], v[12:15]
  v_mul_f32 v61, v222, v61
  v_mul_f32 v62, v222, v62
  v_mul_f32 v63, v222, v63
  v_cvt_pk_bf16_f32 v56, v56, v57
  v_cvt_pk_bf16_f32 v57, v58, v59
  v_cvt_pk_bf16_f32 v58, v60, v61
  v_mfma_f32_16x16x32_bf16 v[12:15], a[252:255], a[140:143], v[12:15]
  v_cvt_pk_bf16_f32 v59, v62, v63
  v_accvgpr_write_b32 a156, v56
  v_accvgpr_write_b32 a157, v57
  v_accvgpr_write_b32 a158, v58
  v_accvgpr_write_b32 a159, v59
  s_nop 0
  v_mfma_f32_16x16x32_bf16 v[16:19], a[192:195], a[144:147], 0
  v_accvgpr_read_b32 v48, a64
  v_accvgpr_read_b32 v49, a65
  v_accvgpr_read_b32 v50, a66
  v_accvgpr_read_b32 v51, a67
  v_accvgpr_read_b32 v52, a68
  v_accvgpr_read_b32 v53, a69
  v_accvgpr_read_b32 v54, a70
  buffer_store_dwordx4 v[96:99], v169, s[24:27], s66 offen offset:0 sc1
  v_mfma_f32_16x16x32_bf16 v[16:19], a[196:199], a[148:151], v[16:19]
  v_accvgpr_read_b32 v55, a71
  v_mul_f32 v48, v230, v48
  v_mul_f32 v49, v230, v49
  v_mul_f32 v50, v230, v50
  v_mul_f32 v51, v230, v51
  v_mul_f32 v52, v230, v52
  v_mfma_f32_16x16x32_bf16 v[16:19], a[200:203], a[152:155], v[16:19]
  v_mul_f32 v53, v230, v53
  v_mul_f32 v54, v230, v54
  v_mul_f32 v55, v230, v55
  v_cvt_pk_bf16_f32 v48, v48, v49
  v_cvt_pk_bf16_f32 v49, v50, v51
  v_cvt_pk_bf16_f32 v50, v52, v53
  v_mfma_f32_16x16x32_bf16 v[16:19], a[204:207], a[156:159], v[16:19]
  v_cvt_pk_bf16_f32 v51, v54, v55
  v_accvgpr_write_b32 a160, v48
  v_accvgpr_write_b32 a161, v49
  v_accvgpr_write_b32 a162, v50
  v_accvgpr_write_b32 a163, v51
  v_accvgpr_read_b32 v56, a72
  v_mfma_f32_16x16x32_bf16 v[20:23], a[208:211], a[144:147], 0
  v_accvgpr_read_b32 v57, a73
  v_accvgpr_read_b32 v58, a74
  v_accvgpr_read_b32 v59, a75
  v_accvgpr_read_b32 v60, a76
  v_accvgpr_read_b32 v61, a77
  v_accvgpr_read_b32 v62, a78
  buffer_store_dwordx4 v[104:107], v169, s[24:27], s66 offen offset:1024 sc1
  v_mfma_f32_16x16x32_bf16 v[20:23], a[212:215], a[148:151], v[20:23]
  v_accvgpr_read_b32 v63, a79
  v_mul_f32 v56, v230, v56
  v_mul_f32 v57, v230, v57
  v_mul_f32 v58, v230, v58
  v_mul_f32 v59, v230, v59
  v_mul_f32 v60, v230, v60
  v_mfma_f32_16x16x32_bf16 v[20:23], a[216:219], a[152:155], v[20:23]
  v_mul_f32 v61, v230, v61
  v_mul_f32 v62, v230, v62
  v_mul_f32 v63, v230, v63
  v_cvt_pk_bf16_f32 v56, v56, v57
  v_cvt_pk_bf16_f32 v57, v58, v59
  v_cvt_pk_bf16_f32 v58, v60, v61
  v_mfma_f32_16x16x32_bf16 v[20:23], a[220:223], a[156:159], v[20:23]
  v_cvt_pk_bf16_f32 v59, v62, v63
  v_accvgpr_write_b32 a164, v56
  v_accvgpr_write_b32 a165, v57
  v_accvgpr_write_b32 a166, v58
  v_accvgpr_write_b32 a167, v59
  v_accvgpr_read_b32 v48, a80
  v_mfma_f32_16x16x32_bf16 v[24:27], a[224:227], a[144:147], 0
  v_accvgpr_read_b32 v49, a81
  v_accvgpr_read_b32 v50, a82
  v_accvgpr_read_b32 v51, a83
  v_accvgpr_read_b32 v52, a84
  v_accvgpr_read_b32 v53, a85
  v_accvgpr_read_b32 v54, a86
  buffer_store_dwordx4 v[112:115], v169, s[24:27], s67 offen offset:0 sc1
  v_mfma_f32_16x16x32_bf16 v[24:27], a[228:231], a[148:151], v[24:27]
  v_accvgpr_read_b32 v55, a87
  v_mul_f32 v48, v230, v48
  v_mul_f32 v49, v230, v49
  v_mul_f32 v50, v230, v50
  v_mul_f32 v51, v230, v51
  v_mul_f32 v52, v230, v52
  v_mfma_f32_16x16x32_bf16 v[24:27], a[232:235], a[152:155], v[24:27]
  v_mul_f32 v53, v230, v53
  v_mul_f32 v54, v230, v54
  v_mul_f32 v55, v230, v55
  v_cvt_pk_bf16_f32 v48, v48, v49
  v_cvt_pk_bf16_f32 v49, v50, v51
  v_cvt_pk_bf16_f32 v50, v52, v53
  v_mfma_f32_16x16x32_bf16 v[24:27], a[236:239], a[156:159], v[24:27]
  v_cvt_pk_bf16_f32 v51, v54, v55
  v_accvgpr_write_b32 a168, v48
  v_accvgpr_write_b32 a169, v49
  v_accvgpr_write_b32 a170, v50
  v_accvgpr_write_b32 a171, v51
  v_accvgpr_read_b32 v56, a88
  v_mfma_f32_16x16x32_bf16 v[28:31], a[240:243], a[144:147], 0
  v_accvgpr_read_b32 v57, a89
  v_accvgpr_read_b32 v58, a90
  v_accvgpr_read_b32 v59, a91
  v_accvgpr_read_b32 v60, a92
  v_accvgpr_read_b32 v61, a93
  v_accvgpr_read_b32 v62, a94
  buffer_store_dwordx4 v[120:123], v169, s[24:27], s67 offen offset:1024 sc1
  v_mfma_f32_16x16x32_bf16 v[28:31], a[244:247], a[148:151], v[28:31]
  v_accvgpr_read_b32 v63, a95
  v_mul_f32 v56, v230, v56
  v_mul_f32 v57, v230, v57
  v_mul_f32 v58, v230, v58
  v_mul_f32 v59, v230, v59
  v_mul_f32 v60, v230, v60
  v_mfma_f32_16x16x32_bf16 v[28:31], a[248:251], a[152:155], v[28:31]
  v_mul_f32 v61, v230, v61
  v_mul_f32 v62, v230, v62
  v_mul_f32 v63, v230, v63
  v_cvt_pk_bf16_f32 v56, v56, v57
  v_cvt_pk_bf16_f32 v57, v58, v59
  v_cvt_pk_bf16_f32 v58, v60, v61
  v_mfma_f32_16x16x32_bf16 v[28:31], a[252:255], a[156:159], v[28:31]
  v_cvt_pk_bf16_f32 v59, v62, v63
  v_accvgpr_write_b32 a172, v56
  v_accvgpr_write_b32 a173, v57
  v_accvgpr_write_b32 a174, v58
  v_accvgpr_write_b32 a175, v59
  s_nop 0
  v_mfma_f32_16x16x32_bf16 v[32:35], a[192:195], a[160:163], 0
  v_accvgpr_read_b32 v48, a96
  v_accvgpr_read_b32 v49, a97
  v_accvgpr_read_b32 v50, a98
  v_accvgpr_read_b32 v51, a99
  v_accvgpr_read_b32 v52, a100
  v_accvgpr_read_b32 v53, a101
  v_accvgpr_read_b32 v54, a102
  buffer_store_dwordx4 v[128:131], v170, s[24:27], s66 offen offset:0 sc1
  v_mfma_f32_16x16x32_bf16 v[32:35], a[196:199], a[164:167], v[32:35]
  v_accvgpr_read_b32 v55, a103
  v_mul_f32 v48, v242, v48
  v_mul_f32 v49, v242, v49
  v_mul_f32 v50, v242, v50
  v_mul_f32 v51, v242, v51
  v_mul_f32 v52, v242, v52
  v_mfma_f32_16x16x32_bf16 v[32:35], a[200:203], a[168:171], v[32:35]
  v_mul_f32 v53, v242, v53
  v_mul_f32 v54, v242, v54
  v_mul_f32 v55, v242, v55
  v_cvt_pk_bf16_f32 v48, v48, v49
  v_cvt_pk_bf16_f32 v49, v50, v51
  v_cvt_pk_bf16_f32 v50, v52, v53
  v_mfma_f32_16x16x32_bf16 v[32:35], a[204:207], a[172:175], v[32:35]
  v_cvt_pk_bf16_f32 v51, v54, v55
  v_accvgpr_write_b32 a176, v48
  v_accvgpr_write_b32 a177, v49
  v_accvgpr_write_b32 a178, v50
  v_accvgpr_write_b32 a179, v51
  v_accvgpr_read_b32 v56, a104
  v_mfma_f32_16x16x32_bf16 v[36:39], a[208:211], a[160:163], 0
  v_accvgpr_read_b32 v57, a105
  v_accvgpr_read_b32 v58, a106
  v_accvgpr_read_b32 v59, a107
  v_accvgpr_read_b32 v60, a108
  v_accvgpr_read_b32 v61, a109
  v_accvgpr_read_b32 v62, a110
  buffer_store_dwordx4 v[136:139], v170, s[24:27], s66 offen offset:1024 sc1
  v_mfma_f32_16x16x32_bf16 v[36:39], a[212:215], a[164:167], v[36:39]
  v_accvgpr_read_b32 v63, a111
  v_mul_f32 v56, v242, v56
  v_mul_f32 v57, v242, v57
  v_mul_f32 v58, v242, v58
  v_mul_f32 v59, v242, v59
  v_mul_f32 v60, v242, v60
  v_mfma_f32_16x16x32_bf16 v[36:39], a[216:219], a[168:171], v[36:39]
  v_mul_f32 v61, v242, v61
  v_mul_f32 v62, v242, v62
  v_mul_f32 v63, v242, v63
  v_cvt_pk_bf16_f32 v56, v56, v57
  v_cvt_pk_bf16_f32 v57, v58, v59
  v_cvt_pk_bf16_f32 v58, v60, v61
  v_mfma_f32_16x16x32_bf16 v[36:39], a[220:223], a[172:175], v[36:39]
  v_cvt_pk_bf16_f32 v59, v62, v63
  v_accvgpr_write_b32 a180, v56
  v_accvgpr_write_b32 a181, v57
  v_accvgpr_write_b32 a182, v58
  v_accvgpr_write_b32 a183, v59
  v_accvgpr_read_b32 v48, a112
  v_mfma_f32_16x16x32_bf16 v[40:43], a[224:227], a[160:163], 0
  v_accvgpr_read_b32 v49, a113
  v_accvgpr_read_b32 v50, a114
  v_accvgpr_read_b32 v51, a115
  v_accvgpr_read_b32 v52, a116
  v_accvgpr_read_b32 v53, a117
  v_accvgpr_read_b32 v54, a118
  buffer_store_dwordx4 v[172:175], v170, s[24:27], s67 offen offset:0 sc1
  v_mfma_f32_16x16x32_bf16 v[40:43], a[228:231], a[164:167], v[40:43]
  v_accvgpr_read_b32 v55, a119
  v_mul_f32 v48, v242, v48
  v_mul_f32 v49, v242, v49
  v_mul_f32 v50, v242, v50
  v_mul_f32 v51, v242, v51
  v_mul_f32 v52, v242, v52
  v_mfma_f32_16x16x32_bf16 v[40:43], a[232:235], a[168:171], v[40:43]
  v_mul_f32 v53, v242, v53
  v_mul_f32 v54, v242, v54
  v_mul_f32 v55, v242, v55
  v_cvt_pk_bf16_f32 v48, v48, v49
  v_cvt_pk_bf16_f32 v49, v50, v51
  v_cvt_pk_bf16_f32 v50, v52, v53
  v_mfma_f32_16x16x32_bf16 v[40:43], a[236:239], a[172:175], v[40:43]
  v_cvt_pk_bf16_f32 v51, v54, v55
  v_accvgpr_write_b32 a184, v48
  v_accvgpr_write_b32 a185, v49
  v_accvgpr_write_b32 a186, v50
  v_accvgpr_write_b32 a187, v51
  v_accvgpr_read_b32 v56, a120
  v_mfma_f32_16x16x32_bf16 v[44:47], a[240:243], a[160:163], 0
  v_accvgpr_read_b32 v57, a121
  v_accvgpr_read_b32 v58, a122
  v_accvgpr_read_b32 v59, a123
  v_accvgpr_read_b32 v60, a124
  v_accvgpr_read_b32 v61, a125
  v_accvgpr_read_b32 v62, a126
  buffer_store_dwordx4 v[180:183], v170, s[24:27], s67 offen offset:1024 sc1
  v_mfma_f32_16x16x32_bf16 v[44:47], a[244:247], a[164:167], v[44:47]
  v_accvgpr_read_b32 v63, a127
  v_mul_f32 v56, v242, v56
  v_mul_f32 v57, v242, v57
  v_mul_f32 v58, v242, v58
  v_mul_f32 v59, v242, v59
  v_mul_f32 v60, v242, v60
  v_mfma_f32_16x16x32_bf16 v[44:47], a[248:251], a[168:171], v[44:47]
  v_mul_f32 v61, v242, v61
  v_mul_f32 v62, v242, v62
  v_mul_f32 v63, v242, v63
  v_cvt_pk_bf16_f32 v56, v56, v57
  v_cvt_pk_bf16_f32 v57, v58, v59
  v_cvt_pk_bf16_f32 v58, v60, v61
  v_mfma_f32_16x16x32_bf16 v[44:47], a[252:255], a[172:175], v[44:47]
  v_cvt_pk_bf16_f32 v59, v62, v63
  v_accvgpr_write_b32 a188, v56
  v_accvgpr_write_b32 a189, v57
  v_accvgpr_write_b32 a190, v58
  v_accvgpr_write_b32 a191, v59
  s_nop 0
  v_mfma_f32_16x16x32_bf16 v[48:51], a[192:195], a[176:179], 0
  v_max3_f32 v209, v0, v1, v2
  v_max3_f32 v210, v16, v17, v18
  buffer_store_dwordx2 v[188:189], v171, s[24:27], s66 offen offset:0 sc1
  v_mfma_f32_16x16x32_bf16 v[48:51], a[196:199], a[180:183], v[48:51]
  v_max3_f32 v209, v209, v3, v4
  v_mfma_f32_16x16x32_bf16 v[48:51], a[200:203], a[184:187], v[48:51]
  v_max3_f32 v210, v210, v19, v20
  v_max3_f32 v209, v209, v5, v6
  v_mfma_f32_16x16x32_bf16 v[48:51], a[204:207], a[188:191], v[48:51]
  v_max3_f32 v210, v210, v21, v22
  v_mfma_f32_16x16x32_bf16 v[52:55], a[208:211], a[176:179], 0
  v_max3_f32 v209, v209, v7, v8
  v_max3_f32 v210, v210, v23, v24
  buffer_store_dwordx2 v[192:193], v171, s[24:27], s66 offen offset:1024 sc1
  v_mfma_f32_16x16x32_bf16 v[52:55], a[212:215], a[180:183], v[52:55]
  v_max3_f32 v209, v209, v9, v10
  v_mfma_f32_16x16x32_bf16 v[52:55], a[216:219], a[184:187], v[52:55]
  v_max3_f32 v210, v210, v25, v26
  v_max3_f32 v209, v209, v11, v12
  v_mfma_f32_16x16x32_bf16 v[52:55], a[220:223], a[188:191], v[52:55]
  v_max3_f32 v210, v210, v27, v28
  v_mfma_f32_16x16x32_bf16 v[56:59], a[224:227], a[176:179], 0
  v_max3_f32 v209, v209, v13, v14
  v_max3_f32 v210, v210, v29, v30
  buffer_store_dwordx2 v[196:197], v171, s[24:27], s67 offen offset:0 sc1
  v_mfma_f32_16x16x32_bf16 v[56:59], a[228:231], a[180:183], v[56:59]
  v_max_f32 v209, v209, v15
  v_mfma_f32_16x16x32_bf16 v[56:59], a[232:235], a[184:187], v[56:59]
  v_max_f32 v210, v210, v31
  v_max3_f32 v211, v32, v33, v34
  v_mfma_f32_16x16x32_bf16 v[56:59], a[236:239], a[188:191], v[56:59]
  v_max3_f32 v211, v211, v35, v36
  v_mfma_f32_16x16x32_bf16 v[60:63], a[240:243], a[176:179], 0
  v_max3_f32 v211, v211, v37, v38
  v_max3_f32 v211, v211, v39, v40
  buffer_store_dwordx2 v[200:201], v171, s[24:27], s67 offen offset:1024 sc1
  v_mfma_f32_16x16x32_bf16 v[60:63], a[244:247], a[180:183], v[60:63]
  v_max3_f32 v211, v211, v41, v42
  v_mfma_f32_16x16x32_bf16 v[60:63], a[248:251], a[184:187], v[60:63]
  v_max3_f32 v211, v211, v43, v44
  v_max3_f32 v211, v211, v45, v46
  v_mfma_f32_16x16x32_bf16 v[60:63], a[252:255], a[188:191], v[60:63]
  v_max_f32 v211, v211, v47
L_att_go:
  s_waitcnt vmcnt(28)
  s_barrier
  ds_read_b128 a[192:195], v148 offset:0
  ds_read_b128 a[196:199], v149 offset:0
  ds_read_b128 a[200:203], v150 offset:0
  ds_read_b128 a[204:207], v151 offset:0
  s_nop 4
  v_max3_f32 v212, v48, v49, v50
  v_max3_f32 v212, v212, v51, v52
  v_max3_f32 v212, v212, v53, v54
  v_max3_f32 v212, v212, v55, v56
  v_max3_f32 v212, v212, v57, v58
  v_max3_f32 v212, v212, v59, v60
  v_max3_f32 v212, v212, v61, v62
  v_max_f32 v212, v212, v63
  v_mov_b32 v213, v209
  v_mov_b32 v214, v210
  v_mov_b32 v215, v211
  v_mov_b32 v216, v212
  s_nop 1
  v_permlane32_swap_b32 v209, v213
  v_permlane32_swap_b32 v210, v214
  v_permlane32_swap_b32 v211, v215
  v_permlane32_swap_b32 v212, v216
  v_max_f32 v209, v209, v213
  v_max_f32 v210, v210, v214
  v_max_f32 v211, v211, v215
  v_max_f32 v212, v212, v216
  v_mov_b32 v213, v209
  v_mov_b32 v214, v210
  v_mov_b32 v215, v211
  v_mov_b32 v216, v212
  s_nop 1
  v_permlane16_swap_b32 v209, v213
  v_permlane16_swap_b32 v210, v214
  v_permlane16_swap_b32 v211, v215
  v_permlane16_swap_b32 v212, v216
  v_max_f32 v209, v209, v213
  v_max_f32 v210, v210, v214
  v_max_f32 v211, v211, v215
  v_max_f32 v212, v212, v216
  s_cmp_eq_u32 s64, 0
  s_cbranch_scc1 L_use_m0
  v_mov_b32 v209, v168
  v_mov_b32 v210, v169
  v_mov_b32 v211, v170
  v_mov_b32 v212, v171
  s_mov_b32 s26, 0
L_use_m0:
  v_sub_f32 v128, 0, v209
  v_sub_f32 v129, 0, v209
  v_sub_f32 v130, 0, v209
  v_sub_f32 v131, 0, v209
  v_sub_f32 v132, 0, v210
  v_sub_f32 v133, 0, v210
  v_sub_f32 v134, 0, v210
  v_sub_f32 v135, 0, v210
  v_sub_f32 v136, 0, v211
  v_sub_f32 v137, 0, v211
  v_sub_f32 v138, 0, v211
  v_sub_f32 v139, 0, v211
  v_sub_f32 v140, 0, v212
  v_sub_f32 v141, 0, v212
  v_sub_f32 v142, 0, v212
  v_sub_f32 v143, 0, v212
  v_pk_add_f32 v[0:1], v[0:1], v[128:129]
  v_pk_add_f32 v[2:3], v[2:3], v[128:129]
  v_pk_add_f32 v[16:17], v[16:17], v[132:133]
  v_pk_add_f32 v[18:19], v[18:19], v[132:133]
  v_pk_add_f32 v[32:33], v[32:33], v[136:137]
  v_pk_add_f32 v[34:35], v[34:35], v[136:137]
  v_pk_add_f32 v[48:49], v[48:49], v[140:141]
  v_pk_add_f32 v[50:51], v[50:51], v[140:141]
  v_pk_add_f32 v[4:5], v[4:5], v[128:129]
  v_pk_add_f32 v[6:7], v[6:7], v[128:129]
  v_pk_add_f32 v[20:21], v[20:21], v[132:133]
  v_pk_add_f32 v[22:23], v[22:23], v[132:133]
  v_pk_add_f32 v[36:37], v[36:37], v[136:137]
  v_pk_add_f32 v[38:39], v[38:39], v[136:137]
  v_pk_add_f32 v[52:53], v[52:53], v[140:141]
  v_pk_add_f32 v[54:55], v[54:55], v[140:141]
  v_pk_add_f32 v[8:9], v[8:9], v[128:129]
  v_pk_add_f32 v[10:11], v[10:11], v[128:129]
  v_pk_add_f32 v[24:25], v[24:25], v[132:133]
  v_pk_add_f32 v[26:27], v[26:27], v[132:133]
  v_pk_add_f32 v[40:41], v[40:41], v[136:137]
  v_pk_add_f32 v[42:43], v[42:43], v[136:137]
  v_pk_add_f32 v[56:57], v[56:57], v[140:141]
  v_pk_add_f32 v[58:59], v[58:59], v[140:141]
  v_pk_add_f32 v[12:13], v[12:13], v[128:129]
  v_pk_add_f32 v[14:15], v[14:15], v[128:129]
  v_pk_add_f32 v[28:29], v[28:29], v[132:133]
  v_pk_add_f32 v[30:31], v[30:31], v[132:133]
  v_pk_add_f32 v[44:45], v[44:45], v[136:137]
  v_pk_add_f32 v[46:47], v[46:47], v[136:137]
  v_pk_add_f32 v[60:61], v[60:61], v[140:141]
  v_pk_add_f32 v[62:63], v[62:63], v[140:141]
  v_exp_f32 v0, v0
  v_exp_f32 v1, v1
  v_exp_f32 v2, v2
  v_cvt_pk_bf16_f32 v0, v0, v1
  v_exp_f32 v3, v3
  s_nop 0
  v_cvt_pk_bf16_f32 v1, v2, v3
  v_exp_f32 v16, v16
  v_exp_f32 v17, v17
  s_nop 0
  v_cvt_pk_bf16_f32 v16, v16, v17
  v_exp_f32 v18, v18
  v_exp_f32 v19, v19
  v_exp_f32 v32, v32
  v_exp_f32 v33, v33
  v_exp_f32 v34, v34
  v_exp_f32 v35, v35
  v_exp_f32 v48, v48
  v_cvt_pk_bf16_f32 v17, v18, v19
  v_exp_f32 v49, v49
  v_exp_f32 v50, v50
  v_exp_f32 v51, v51
  v_cvt_pk_bf16_f32 v32, v32, v33
  v_exp_f32 v4, v4
  v_cvt_pk_bf16_f32 v33, v34, v35
  v_cvt_pk_bf16_f32 v48, v48, v49
  v_exp_f32 v5, v5
  v_exp_f32 v6, v6
  v_exp_f32 v7, v7
  v_exp_f32 v20, v20
  v_cvt_pk_bf16_f32 v49, v50, v51
  v_exp_f32 v21, v21
  v_exp_f32 v22, v22
  v_exp_f32 v23, v23
  v_exp_f32 v36, v36
  v_cvt_pk_bf16_f32 v2, v4, v5
  v_exp_f32 v37, v37
  v_exp_f32 v38, v38
  v_exp_f32 v39, v39
  v_cvt_pk_bf16_f32 v3, v6, v7
  v_cvt_pk_bf16_f32 v18, v20, v21
  v_exp_f32 v52, v52
  v_cvt_pk_bf16_f32 v19, v22, v23
  v_exp_f32 v53, v53
  v_cvt_pk_bf16_f32 v34, v36, v37
  v_cvt_pk_bf16_f32 v35, v38, v39
  v_exp_f32 v54, v54
  v_exp_f32 v55, v55
  v_exp_f32 v8, v8
  v_exp_f32 v9, v9
  v_exp_f32 v10, v10
  v_cvt_pk_bf16_f32 v50, v52, v53
  v_exp_f32 v11, v11
  v_cvt_pk_bf16_f32 v51, v54, v55
  v_cvt_pk_bf16_f32 v4, v8, v9
  v_exp_f32 v24, v24
  v_cvt_pk_bf16_f32 v5, v10, v11
  s_waitcnt lgkmcnt(0)
  s_mov_b32 s42, 8
  v_mfma_f32_16x16x32_bf16 v[64:67], a[192:195], a[128:131], v[128:131]
  v_exp_f32 v25, v25
  v_mfma_f32_16x16x32_bf16 v[64:67], a[196:199], a[132:135], v[64:67]
  v_cvt_pk_bf16_f32 v20, v24, v25
  v_mfma_f32_16x16x32_bf16 v[64:67], a[200:203], a[136:139], v[64:67]
  v_exp_f32 v26, v26
  v_mfma_f32_16x16x32_bf16 v[64:67], a[204:207], a[140:143], v[64:67]
  s_add_u32 m0, s45, 81920
  ds_read_b128 a[208:211], v148 offset:4096
  v_mfma_f32_16x16x32_bf16 v[80:83], a[192:195], a[144:147], v[132:135]
  buffer_load_dwordx4 v164, s[20:23], s44 offen offset:0 lds
  v_mfma_f32_16x16x32_bf16 v[80:83], a[196:199], a[148:151], v[80:83]
  v_exp_f32 v27, v27
  v_mfma_f32_16x16x32_bf16 v[80:83], a[200:203], a[152:155], v[80:83]
  v_exp_f32 v40, v40
  v_mfma_f32_16x16x32_bf16 v[80:83], a[204:207], a[156:159], v[80:83]
  ds_read_b128 a[212:215], v149 offset:4096
  ds_read_b128 a[216:219], v150 offset:4096
  v_mfma_f32_16x16x32_bf16 v[96:99], a[192:195], a[160:163], v[136:139]
  v_exp_f32 v41, v41
  v_mfma_f32_16x16x32_bf16 v[96:99], a[196:199], a[164:167], v[96:99]
  ds_read_b128 a[220:223], v151 offset:4096
  v_cvt_pk_bf16_f32 v21, v26, v27
  v_mfma_f32_16x16x32_bf16 v[96:99], a[200:203], a[168:171], v[96:99]
  v_exp_f32 v42, v42
  v_mfma_f32_16x16x32_bf16 v[96:99], a[204:207], a[172:175], v[96:99]
  v_cvt_pk_bf16_f32 v36, v40, v41
  v_mfma_f32_16x16x32_bf16 v[112:115], a[192:195], a[176:179], v[140:143]
  v_exp_f32 v43, v43
  v_mfma_f32_16x16x32_bf16 v[112:115], a[196:199], a[180:183], v[112:115]
  v_mfma_f32_16x16x32_bf16 v[112:115], a[200:203], a[184:187], v[112:115]
  v_exp_f32 v56, v56
  v_mfma_f32_16x16x32_bf16 v[112:115], a[204:207], a[188:191], v[112:115]
  v_cvt_pk_bf16_f32 v37, v42, v43
  s_waitcnt lgkmcnt(0)
  v_mfma_f32_16x16x32_bf16 v[68:71], a[208:211], a[128:131], v[128:131]
  v_exp_f32 v57, v57
  v_mfma_f32_16x16x32_bf16 v[68:71], a[212:215], a[132:135], v[68:71]
  ds_read_b128 a[192:195], v148 offset:8192
  ds_read_b128 a[196:199], v149 offset:8192
  v_mfma_f32_16x16x32_bf16 v[68:71], a[216:219], a[136:139], v[68:71]
  v_exp_f32 v58, v58
  v_mfma_f32_16x16x32_bf16 v[68:71], a[220:223], a[140:143], v[68:71]
  v_exp_f32 v59, v59
  v_mfma_f32_16x16x32_bf16 v[84:87], a[208:211], a[144:147], v[132:135]
  buffer_load_dwordx4 v165, s[20:23], s44 offen offset:1024 lds
  v_mfma_f32_16x16x32_bf16 v[84:87], a[212:215], a[148:151], v[84:87]
  ds_read_b128 a[200:203], v150 offset:8192
  ds_read_b128 a[204:207], v151 offset:8192
  v_mfma_f32_16x16x32_bf16 v[84:87], a[216:219], a[152:155], v[84:87]
  v_cvt_pk_bf16_f32 v52, v56, v57
  v_cvt_pk_bf16_f32 v53, v58, v59
  v_mfma_f32_16x16x32_bf16 v[84:87], a[220:223], a[156:159], v[84:87]
  v_exp_f32 v12, v12
  v_mfma_f32_16x16x32_bf16 v[100:103], a[208:211], a[160:163], v[136:139]
  v_mov_b64 v[176:177], 0
  v_mfma_f32_16x16x32_bf16 v[100:103], a[212:215], a[164:167], v[100:103]
  v_exp_f32 v13, v13
  v_mfma_f32_16x16x32_bf16 v[100:103], a[216:219], a[168:171], v[100:103]
  v_cvt_pk_bf16_f32 v6, v12, v13
  v_mfma_f32_16x16x32_bf16 v[100:103], a[220:223], a[172:175], v[100:103]
  v_exp_f32 v14, v14
  v_mfma_f32_16x16x32_bf16 v[116:119], a[208:211], a[176:179], v[140:143]
  v_mov_b64 v[180:181], 0
  v_mfma_f32_16x16x32_bf16 v[116:119], a[212:215], a[180:183], v[116:119]
  v_exp_f32 v15, v15
  v_mfma_f32_16x16x32_bf16 v[116:119], a[216:219], a[184:187], v[116:119]
  v_exp_f32 v28, v28
  v_mfma_f32_16x16x32_bf16 v[116:119], a[220:223], a[188:191], v[116:119]
  v_cvt_pk_bf16_f32 v7, v14, v15
  s_waitcnt lgkmcnt(0)
  v_mfma_f32_16x16x32_bf16 v[72:75], a[192:195], a[128:131], v[128:131]
  v_mov_b64 v[184:185], 0
  v_mfma_f32_16x16x32_bf16 v[72:75], a[196:199], a[132:135], v[72:75]
  v_exp_f32 v29, v29
  v_mfma_f32_16x16x32_bf16 v[72:75], a[200:203], a[136:139], v[72:75]
  ds_read_b128 a[208:211], v148 offset:12288
  ds_read_b128 a[212:215], v149 offset:12288
  v_mfma_f32_16x16x32_bf16 v[72:75], a[204:207], a[140:143], v[72:75]
  v_exp_f32 v30, v30
  v_mfma_f32_16x16x32_bf16 v[88:91], a[192:195], a[144:147], v[132:135]
  v_exp_f32 v31, v31
  v_mfma_f32_16x16x32_bf16 v[88:91], a[196:199], a[148:151], v[88:91]
  buffer_load_dwordx4 v164, s[20:23], s44 offen offset:2048 lds
  v_mfma_f32_16x16x32_bf16 v[88:91], a[200:203], a[152:155], v[88:91]
  ds_read_b128 a[216:219], v150 offset:12288
  ds_read_b128 a[220:223], v151 offset:12288
  v_mfma_f32_16x16x32_bf16 v[88:91], a[204:207], a[156:159], v[88:91]
  v_exp_f32 v44, v44
  v_mfma_f32_16x16x32_bf16 v[104:107], a[192:195], a[160:163], v[136:139]
  v_cvt_pk_bf16_f32 v22, v28, v29
  v_cvt_pk_bf16_f32 v23, v30, v31
  v_mfma_f32_16x16x32_bf16 v[104:107], a[196:199], a[164:167], v[104:107]
  v_exp_f32 v45, v45
  v_mfma_f32_16x16x32_bf16 v[104:107], a[200:203], a[168:171], v[104:107]
  v_cvt_pk_bf16_f32 v38, v44, v45
  v_mfma_f32_16x16x32_bf16 v[104:107], a[204:207], a[172:175], v[104:107]
  v_exp_f32 v46, v46
  v_mfma_f32_16x16x32_bf16 v[120:123], a[192:195], a[176:179], v[140:143]
  v_mov_b64 v[188:189], 0
  v_mfma_f32_16x16x32_bf16 v[120:123], a[196:199], a[180:183], v[120:123]
  v_exp_f32 v47, v47
  v_mfma_f32_16x16x32_bf16 v[120:123], a[200:203], a[184:187], v[120:123]
  v_exp_f32 v60, v60
  v_mfma_f32_16x16x32_bf16 v[120:123], a[204:207], a[188:191], v[120:123]
  v_cvt_pk_bf16_f32 v39, v46, v47
  s_waitcnt lgkmcnt(0)
  v_mfma_f32_16x16x32_bf16 v[76:79], a[208:211], a[128:131], v[128:131]
  v_mfma_f32_16x16x32_bf16 v[76:79], a[212:215], a[132:135], v[76:79]
  v_exp_f32 v61, v61
  v_mfma_f32_16x16x32_bf16 v[76:79], a[216:219], a[136:139], v[76:79]
  ds_read_b64_tr_b16 a[192:193], v152 offset:16384
  ds_read_b64_tr_b16 a[194:195], v152 offset:20480
  v_mfma_f32_16x16x32_bf16 v[76:79], a[220:223], a[140:143], v[76:79]
  v_exp_f32 v62, v62
  v_mfma_f32_16x16x32_bf16 v[92:95], a[208:211], a[144:147], v[132:135]
  v_exp_f32 v63, v63
  v_mfma_f32_16x16x32_bf16 v[92:95], a[212:215], a[148:151], v[92:95]
  buffer_load_dwordx4 v165, s[20:23], s44 offen offset:3072 lds
  v_mfma_f32_16x16x32_bf16 v[92:95], a[216:219], a[152:155], v[92:95]
  s_add_u32 s44, s44, 16384
  ds_read_b64_tr_b16 a[196:197], v152 offset:24576
  v_mfma_f32_16x16x32_bf16 v[92:95], a[220:223], a[156:159], v[92:95]
  v_mov_b64 v[192:193], -1
  ds_read_b64_tr_b16 a[198:199], v152 offset:28672
  v_cvt_pk_bf16_f32 v54, v60, v61
  v_mfma_f32_16x16x32_bf16 v[108:111], a[208:211], a[160:163], v[136:139]
  v_exp_f32 v64, v64
  v_mfma_f32_16x16x32_bf16 v[108:111], a[212:215], a[164:167], v[108:111]
  ds_read_b64_tr_b16 a[200:201], v153 offset:16384
  ds_read_b64_tr_b16 a[202:203], v153 offset:20480
  v_mfma_f32_16x16x32_bf16 v[108:111], a[216:219], a[168:171], v[108:111]
  v_exp_f32 v65, v65
  v_mfma_f32_16x16x32_bf16 v[108:111], a[220:223], a[172:175], v[108:111]
  ds_read_b64_tr_b16 a[204:205], v153 offset:24576
  ds_read_b64_tr_b16 a[206:207], v153 offset:28672
  v_mfma_f32_16x16x32_bf16 v[124:127], a[208:211], a[176:179], v[140:143]
  v_exp_f32 v66, v66
  v_mfma_f32_16x16x32_bf16 v[124:127], a[212:215], a[180:183], v[124:127]
  v_cvt_pk_bf16_f32 v55, v62, v63
  v_cvt_pk_bf16_f32 v64, v64, v65
  v_mfma_f32_16x16x32_bf16 v[124:127], a[216:219], a[184:187], v[124:127]
  v_exp_f32 v67, v67
  v_mfma_f32_16x16x32_bf16 v[124:127], a[220:223], a[188:191], v[124:127]
  v_cvt_pk_bf16_f32 v65, v66, v67
  s_waitcnt lgkmcnt(4)
  v_mfma_f32_16x16x32_bf16 a[0:3], a[192:195], v[0:3], 0
  v_exp_f32 v80, v80
  v_mfma_f32_16x16x32_bf16 a[0:3], a[196:199], v[4:7], a[0:3]
  v_mov_b64 v[194:195], -1
  v_mfma_f32_16x16x32_bf16 a[4:7], a[192:195], v[16:19], 0
  v_exp_f32 v81, v81
  v_mfma_f32_16x16x32_bf16 a[4:7], a[196:199], v[20:23], a[4:7]
  v_cvt_pk_bf16_f32 v80, v80, v81
  v_mfma_f32_16x16x32_bf16 a[8:11], a[192:195], v[32:35], 0
  v_exp_f32 v82, v82
  v_mfma_f32_16x16x32_bf16 a[8:11], a[196:199], v[36:39], a[8:11]
  s_add_u32 m0, s45, 147456
  ds_read_b64_tr_b16 a[208:209], v154 offset:16384
  v_mfma_f32_16x16x32_bf16 a[12:15], a[192:195], v[48:51], 0
  buffer_load_dwordx4 v160, s[16:19], s43 offen offset:0 lds
  v_mfma_f32_16x16x32_bf16 a[12:15], a[196:199], v[52:55], a[12:15]
  ds_read_b64_tr_b16 a[210:211], v154 offset:20480
  s_waitcnt lgkmcnt(2)
  v_mfma_f32_16x16x32_bf16 a[16:19], a[200:203], v[0:3], 0
  v_exp_f32 v83, v83
  v_mfma_f32_16x16x32_bf16 a[16:19], a[204:207], v[4:7], a[16:19]
  v_exp_f32 v96, v96
  v_mfma_f32_16x16x32_bf16 a[20:23], a[200:203], v[16:19], 0
  v_exp_f32 v97, v97
  v_mfma_f32_16x16x32_bf16 a[20:23], a[204:207], v[20:23], a[20:23]
  buffer_store_dwordx4 v[192:195], v166, s[24:27], s58 offen offset:0 sc1
  ds_read_b64_tr_b16 a[212:213], v154 offset:24576
  ds_read_b64_tr_b16 a[214:215], v154 offset:28672
  v_mfma_f32_16x16x32_bf16 a[24:27], a[200:203], v[32:35], 0
  v_exp_f32 v98, v98
  v_mfma_f32_16x16x32_bf16 a[24:27], a[204:207], v[36:39], a[24:27]
  ds_read_b64_tr_b16 a[216:217], v155 offset:16384
  ds_read_b64_tr_b16 a[218:219], v155 offset:20480
  v_mfma_f32_16x16x32_bf16 a[28:31], a[200:203], v[48:51], 0
  v_exp_f32 v99, v99
  v_mfma_f32_16x16x32_bf16 a[28:31], a[204:207], v[52:55], a[28:31]
  v_exp_f32 v112, v112
  v_smfmac_f32_16x16x64_bf16 v[176:179], v[144:147], v[0:7], v236
  ds_read_b64_tr_b16 a[220:221], v155 offset:24576
  s_waitcnt lgkmcnt(3)
  v_mfma_f32_16x16x32_bf16 a[32:35], a[208:211], v[0:3], 0
  ds_read_b64_tr_b16 a[222:223], v155 offset:28672
  v_cvt_pk_bf16_f32 v81, v82, v83
  v_mfma_f32_16x16x32_bf16 a[32:35], a[212:215], v[4:7], a[32:35]
  v_exp_f32 v113, v113
  v_mfma_f32_16x16x32_bf16 a[36:39], a[208:211], v[16:19], 0
  ds_read_b64_tr_b16 a[192:193], v156 offset:16384
  ds_read_b64_tr_b16 a[194:195], v156 offset:20480
  v_mfma_f32_16x16x32_bf16 a[36:39], a[212:215], v[20:23], a[36:39]
  v_exp_f32 v114, v114
  v_mfma_f32_16x16x32_bf16 a[40:43], a[208:211], v[32:35], 0
  v_exp_f32 v115, v115
  v_mfma_f32_16x16x32_bf16 a[40:43], a[212:215], v[36:39], a[40:43]
  buffer_load_dwordx4 v161, s[16:19], s43 offen offset:1024 lds
  v_mfma_f32_16x16x32_bf16 a[44:47], a[208:211], v[48:51], 0
  buffer_store_dwordx4 v[192:195], v166, s[24:27], s58 offen offset:1024 sc1
  ds_read_b64_tr_b16 a[196:197], v156 offset:24576
  ds_read_b64_tr_b16 a[198:199], v156 offset:28672
  v_mfma_f32_16x16x32_bf16 a[44:47], a[212:215], v[52:55], a[44:47]
  v_cvt_pk_bf16_f32 v96, v96, v97
  s_waitcnt lgkmcnt(4)
  v_mfma_f32_16x16x32_bf16 a[48:51], a[216:219], v[0:3], 0
  v_exp_f32 v68, v68
  v_mfma_f32_16x16x32_bf16 a[48:51], a[220:223], v[4:7], a[48:51]
  v_cvt_pk_bf16_f32 v97, v98, v99
  v_cvt_pk_bf16_f32 v112, v112, v113
  v_mfma_f32_16x16x32_bf16 a[52:55], a[216:219], v[16:19], 0
  v_exp_f32 v69, v69
  v_mfma_f32_16x16x32_bf16 a[52:55], a[220:223], v[20:23], a[52:55]
  ds_read_b64_tr_b16 a[200:201], v157 offset:16384
  ds_read_b64_tr_b16 a[202:203], v157 offset:20480
  v_mfma_f32_16x16x32_bf16 a[56:59], a[216:219], v[32:35], 0
  v_exp_f32 v70, v70
  v_mfma_f32_16x16x32_bf16 a[56:59], a[220:223], v[36:39], a[56:59]
  buffer_store_dwordx4 v[192:195], v166, s[24:27], s58 offen offset:2048 sc1
  ds_read_b64_tr_b16 a[204:205], v157 offset:24576
  ds_read_b64_tr_b16 a[206:207], v157 offset:28672
  v_mfma_f32_16x16x32_bf16 a[60:63], a[216:219], v[48:51], 0
  v_exp_f32 v71, v71
  v_mfma_f32_16x16x32_bf16 a[60:63], a[220:223], v[52:55], a[60:63]
  v_exp_f32 v84, v84
  v_smfmac_f32_16x16x64_bf16 v[180:183], v[144:147], v[16:23], v236
  v_cvt_pk_bf16_f32 v113, v114, v115
  s_waitcnt lgkmcnt(4)
  v_mfma_f32_16x16x32_bf16 a[64:67], a[192:195], v[0:3], 0
  ds_read_b64_tr_b16 a[208:209], v158 offset:16384
  ds_read_b64_tr_b16 a[210:211], v158 offset:20480
  v_mfma_f32_16x16x32_bf16 a[64:67], a[196:199], v[4:7], a[64:67]
  v_exp_f32 v85, v85
  v_mfma_f32_16x16x32_bf16 a[68:71], a[192:195], v[16:19], 0
  v_exp_f32 v86, v86
  v_mfma_f32_16x16x32_bf16 a[68:71], a[196:199], v[20:23], a[68:71]
  s_waitcnt vmcnt(29)
  s_barrier
  v_mfma_f32_16x16x32_bf16 a[72:75], a[192:195], v[32:35], 0
  v_exp_f32 v87, v87
  v_mfma_f32_16x16x32_bf16 a[72:75], a[196:199], v[36:39], a[72:75]
  buffer_load_dwordx4 v162, s[16:19], s43 offen offset:2048 lds
  v_mfma_f32_16x16x32_bf16 a[76:79], a[192:195], v[48:51], 0
  v_exp_f32 v100, v100
  v_mfma_f32_16x16x32_bf16 a[76:79], a[196:199], v[52:55], a[76:79]
  ds_read_b64_tr_b16 a[212:213], v158 offset:24576
  s_waitcnt lgkmcnt(3)
  v_mfma_f32_16x16x32_bf16 a[80:83], a[200:203], v[0:3], 0
  buffer_store_dwordx4 v[192:195], v166, s[24:27], s58 offen offset:3072 sc1
  ds_read_b64_tr_b16 a[214:215], v158 offset:28672
  v_cvt_pk_bf16_f32 v66, v68, v69
  v_mfma_f32_16x16x32_bf16 a[80:83], a[204:207], v[4:7], a[80:83]
  v_exp_f32 v101, v101
  v_mfma_f32_16x16x32_bf16 a[84:87], a[200:203], v[16:19], 0
  ds_read_b64_tr_b16 a[216:217], v159 offset:16384
  ds_read_b64_tr_b16 a[218:219], v159 offset:20480
  v_mfma_f32_16x16x32_bf16 a[84:87], a[204:207], v[20:23], a[84:87]
  v_exp_f32 v102, v102
  v_mfma_f32_16x16x32_bf16 a[88:91], a[200:203], v[32:35], 0
  ds_read_b64_tr_b16 a[220:221], v159 offset:24576
  ds_read_b64_tr_b16 a[222:223], v159 offset:28672
  v_mfma_f32_16x16x32_bf16 a[88:91], a[204:207], v[36:39], a[88:91]
  v_exp_f32 v103, v103
  v_mfma_f32_16x16x32_bf16 a[92:95], a[200:203], v[48:51], 0
  v_cvt_pk_bf16_f32 v67, v70, v71
  v_cvt_pk_bf16_f32 v82, v84, v85
  v_mfma_f32_16x16x32_bf16 a[92:95], a[204:207], v[52:55], a[92:95]
  v_exp_f32 v116, v116
  v_smfmac_f32_16x16x64_bf16 v[184:187], v[144:147], v[32:39], v236
  v_cvt_pk_bf16_f32 v83, v86, v87
  s_waitcnt lgkmcnt(4)
  v_mfma_f32_16x16x32_bf16 a[96:99], a[208:211], v[0:3], 0
  v_exp_f32 v117, v117
  v_mfma_f32_16x16x32_bf16 a[96:99], a[212:215], v[4:7], a[96:99]
  v_cvt_pk_bf16_f32 v98, v100, v101
  v_cvt_pk_bf16_f32 v99, v102, v103
  v_mfma_f32_16x16x32_bf16 a[100:103], a[208:211], v[16:19], 0
  v_exp_f32 v118, v118
  v_mfma_f32_16x16x32_bf16 a[100:103], a[212:215], v[20:23], a[100:103]
  v_exp_f32 v119, v119
  v_mfma_f32_16x16x32_bf16 a[104:107], a[208:211], v[32:35], 0
  buffer_load_dwordx4 v163, s[16:19], s43 offen offset:3072 lds
  v_mfma_f32_16x16x32_bf16 a[104:107], a[212:215], v[36:39], a[104:107]
  s_add_u32 s43, s43, 16384
  ds_read_b128 a[192:195], v148 offset:16384
  v_mfma_f32_16x16x32_bf16 a[108:111], a[208:211], v[48:51], 0
  v_exp_f32 v72, v72
  v_mfma_f32_16x16x32_bf16 a[108:111], a[212:215], v[52:55], a[108:111]
  ds_read_b128 a[196:199], v149 offset:16384
  s_waitcnt lgkmcnt(2)
  v_mfma_f32_16x16x32_bf16 a[112:115], a[216:219], v[0:3], 0
  ds_read_b128 a[200:203], v150 offset:16384
  ds_read_b128 a[204:207], v151 offset:16384
  v_mfma_f32_16x16x32_bf16 a[112:115], a[220:223], v[4:7], a[112:115]
  v_exp_f32 v73, v73
  v_mfma_f32_16x16x32_bf16 a[116:119], a[216:219], v[16:19], 0
  v_exp_f32 v74, v74
  v_mfma_f32_16x16x32_bf16 a[116:119], a[220:223], v[20:23], a[116:119]
  v_mfma_f32_16x16x32_bf16 a[120:123], a[216:219], v[32:35], 0
  v_cvt_pk_bf16_f32 v114, v116, v117
  v_mfma_f32_16x16x32_bf16 a[120:123], a[220:223], v[36:39], a[120:123]
  v_exp_f32 v75, v75
  v_mfma_f32_16x16x32_bf16 a[124:127], a[216:219], v[48:51], 0
  v_cvt_pk_bf16_f32 v115, v118, v119
  v_cvt_pk_bf16_f32 v68, v72, v73
  v_mfma_f32_16x16x32_bf16 a[124:127], a[220:223], v[52:55], a[124:127]
  v_exp_f32 v88, v88
  v_smfmac_f32_16x16x64_bf16 v[188:191], v[144:147], v[48:55], v236
  v_cvt_pk_bf16_f32 v69, v74, v75
  s_waitcnt lgkmcnt(0)
  s_branch L_att1
L_att:
  v_mfma_f32_16x16x32_bf16 v[64:67], a[192:195], a[128:131], v[128:131]
  v_exp_f32 v25, v25
  v_mfma_f32_16x16x32_bf16 v[64:67], a[196:199], a[132:135], v[64:67]
  v_cvt_pk_bf16_f32 v20, v24, v25
  v_mfma_f32_16x16x32_bf16 v[64:67], a[200:203], a[136:139], v[64:67]
  v_exp_f32 v26, v26
  v_mfma_f32_16x16x32_bf16 v[64:67], a[204:207], a[140:143], v[64:67]
  s_add_u32 m0, s45, 81920
  ds_read_b128 a[208:211], v148 offset:4096
  v_mfma_f32_16x16x32_bf16 v[80:83], a[192:195], a[144:147], v[132:135]
  buffer_load_dwordx4 v164, s[20:23], s44 offen offset:0 lds
  v_mfma_f32_16x16x32_bf16 v[80:83], a[196:199], a[148:151], v[80:83]
  v_exp_f32 v27, v27
  v_mfma_f32_16x16x32_bf16 v[80:83], a[200:203], a[152:155], v[80:83]
  v_exp_f32 v40, v40
  v_mfma_f32_16x16x32_bf16 v[80:83], a[204:207], a[156:159], v[80:83]
  ds_read_b128 a[212:215], v149 offset:4096
  ds_read_b128 a[216:219], v150 offset:4096
  v_mfma_f32_16x16x32_bf16 v[96:99], a[192:195], a[160:163], v[136:139]
  v_exp_f32 v41, v41
  v_mfma_f32_16x16x32_bf16 v[96:99], a[196:199], a[164:167], v[96:99]
  ds_read_b128 a[220:223], v151 offset:4096
  v_cvt_pk_bf16_f32 v21, v26, v27
  v_mfma_f32_16x16x32_bf16 v[96:99], a[200:203], a[168:171], v[96:99]
  v_exp_f32 v42, v42
  v_mfma_f32_16x16x32_bf16 v[96:99], a[204:207], a[172:175], v[96:99]
  v_cvt_pk_bf16_f32 v36, v40, v41
  v_mfma_f32_16x16x32_bf16 v[112:115], a[192:195], a[176:179], v[140:143]
  v_exp_f32 v43, v43
  v_mfma_f32_16x16x32_bf16 v[112:115], a[196:199], a[180:183], v[112:115]
  v_mfma_f32_16x16x32_bf16 v[112:115], a[200:203], a[184:187], v[112:115]
  v_exp_f32 v56, v56
  v_mfma_f32_16x16x32_bf16 v[112:115], a[204:207], a[188:191], v[112:115]
  v_cvt_pk_bf16_f32 v37, v42, v43
  s_waitcnt lgkmcnt(0)
  v_mfma_f32_16x16x32_bf16 v[68:71], a[208:211], a[128:131], v[128:131]
  v_exp_f32 v57, v57
  v_mfma_f32_16x16x32_bf16 v[68:71], a[212:215], a[132:135], v[68:71]
  ds_read_b128 a[192:195], v148 offset:8192
  ds_read_b128 a[196:199], v149 offset:8192
  v_mfma_f32_16x16x32_bf16 v[68:71], a[216:219], a[136:139], v[68:71]
  v_exp_f32 v58, v58
  v_mfma_f32_16x16x32_bf16 v[68:71], a[220:223], a[140:143], v[68:71]
  v_exp_f32 v59, v59
  v_mfma_f32_16x16x32_bf16 v[84:87], a[208:211], a[144:147], v[132:135]
  buffer_load_dwordx4 v165, s[20:23], s44 offen offset:1024 lds
  v_mfma_f32_16x16x32_bf16 v[84:87], a[212:215], a[148:151], v[84:87]
  ds_read_b128 a[200:203], v150 offset:8192
  ds_read_b128 a[204:207], v151 offset:8192
  v_mfma_f32_16x16x32_bf16 v[84:87], a[216:219], a[152:155], v[84:87]
  v_cvt_pk_bf16_f32 v52, v56, v57
  v_cvt_pk_bf16_f32 v53, v58, v59
  v_mfma_f32_16x16x32_bf16 v[84:87], a[220:223], a[156:159], v[84:87]
  v_exp_f32 v12, v12
  v_mfma_f32_16x16x32_bf16 v[100:103], a[208:211], a[160:163], v[136:139]
  v_mfma_f32_16x16x32_bf16 v[100:103], a[212:215], a[164:167], v[100:103]
  v_exp_f32 v13, v13
  v_mfma_f32_16x16x32_bf16 v[100:103], a[216:219], a[168:171], v[100:103]
  v_cvt_pk_bf16_f32 v6, v12, v13
  v_mfma_f32_16x16x32_bf16 v[100:103], a[220:223], a[172:175], v[100:103]
  v_exp_f32 v14, v14
  v_mfma_f32_16x16x32_bf16 v[116:119], a[208:211], a[176:179], v[140:143]
  v_mfma_f32_16x16x32_bf16 v[116:119], a[212:215], a[180:183], v[116:119]
  v_exp_f32 v15, v15
  v_mfma_f32_16x16x32_bf16 v[116:119], a[216:219], a[184:187], v[116:119]
  v_exp_f32 v28, v28
  v_mfma_f32_16x16x32_bf16 v[116:119], a[220:223], a[188:191], v[116:119]
  v_cvt_pk_bf16_f32 v7, v14, v15
  s_waitcnt lgkmcnt(0)
  v_mfma_f32_16x16x32_bf16 v[72:75], a[192:195], a[128:131], v[128:131]
  v_mfma_f32_16x16x32_bf16 v[72:75], a[196:199], a[132:135], v[72:75]
  v_exp_f32 v29, v29
  v_mfma_f32_16x16x32_bf16 v[72:75], a[200:203], a[136:139], v[72:75]
  ds_read_b128 a[208:211], v148 offset:12288
  ds_read_b128 a[212:215], v149 offset:12288
  v_mfma_f32_16x16x32_bf16 v[72:75], a[204:207], a[140:143], v[72:75]
  v_exp_f32 v30, v30
  v_mfma_f32_16x16x32_bf16 v[88:91], a[192:195], a[144:147], v[132:135]
  v_exp_f32 v31, v31
  v_mfma_f32_16x16x32_bf16 v[88:91], a[196:199], a[148:151], v[88:91]
  buffer_load_dwordx4 v164, s[20:23], s44 offen offset:2048 lds
  v_mfma_f32_16x16x32_bf16 v[88:91], a[200:203], a[152:155], v[88:91]
  ds_read_b128 a[216:219], v150 offset:12288
  ds_read_b128 a[220:223], v151 offset:12288
  v_mfma_f32_16x16x32_bf16 v[88:91], a[204:207], a[156:159], v[88:91]
  v_exp_f32 v44, v44
  v_mfma_f32_16x16x32_bf16 v[104:107], a[192:195], a[160:163], v[136:139]
  v_cvt_pk_bf16_f32 v22, v28, v29
  v_cvt_pk_bf16_f32 v23, v30, v31
  v_mfma_f32_16x16x32_bf16 v[104:107], a[196:199], a[164:167], v[104:107]
  v_exp_f32 v45, v45
  v_mfma_f32_16x16x32_bf16 v[104:107], a[200:203], a[168:171], v[104:107]
  v_cvt_pk_bf16_f32 v38, v44, v45
  v_mfma_f32_16x16x32_bf16 v[104:107], a[204:207], a[172:175], v[104:107]
  v_exp_f32 v46, v46
  v_mfma_f32_16x16x32_bf16 v[120:123], a[192:195], a[176:179], v[140:143]
  v_mfma_f32_16x16x32_bf16 v[120:123], a[196:199], a[180:183], v[120:123]
  v_exp_f32 v47, v47
  v_mfma_f32_16x16x32_bf16 v[120:123], a[200:203], a[184:187], v[120:123]
  v_exp_f32 v60, v60
  v_mfma_f32_16x16x32_bf16 v[120:123], a[204:207], a[188:191], v[120:123]
  v_cvt_pk_bf16_f32 v39, v46, v47
  s_waitcnt lgkmcnt(0)
  v_mfma_f32_16x16x32_bf16 v[76:79], a[208:211], a[128:131], v[128:131]
  v_mfma_f32_16x16x32_bf16 v[76:79], a[212:215], a[132:135], v[76:79]
  v_exp_f32 v61, v61
  v_mfma_f32_16x16x32_bf16 v[76:79], a[216:219], a[136:139], v[76:79]
  ds_read_b64_tr_b16 a[192:193], v152 offset:16384
  ds_read_b64_tr_b16 a[194:195], v152 offset:20480
  v_mfma_f32_16x16x32_bf16 v[76:79], a[220:223], a[140:143], v[76:79]
  v_exp_f32 v62, v62
  v_mfma_f32_16x16x32_bf16 v[92:95], a[208:211], a[144:147], v[132:135]
  v_exp_f32 v63, v63
  v_mfma_f32_16x16x32_bf16 v[92:95], a[212:215], a[148:151], v[92:95]
  buffer_load_dwordx4 v165, s[20:23], s44 offen offset:3072 lds
  v_mfma_f32_16x16x32_bf16 v[92:95], a[216:219], a[152:155], v[92:95]
  s_add_u32 s44, s44, 16384
  ds_read_b64_tr_b16 a[196:197], v152 offset:24576
  v_mfma_f32_16x16x32_bf16 v[92:95], a[220:223], a[156:159], v[92:95]
  ds_read_b64_tr_b16 a[198:199], v152 offset:28672
  v_cvt_pk_bf16_f32 v54, v60, v61
  v_mfma_f32_16x16x32_bf16 v[108:111], a[208:211], a[160:163], v[136:139]
  v_exp_f32 v64, v64
  v_mfma_f32_16x16x32_bf16 v[108:111], a[212:215], a[164:167], v[108:111]
  ds_read_b64_tr_b16 a[200:201], v153 offset:16384
  ds_read_b64_tr_b16 a[202:203], v153 offset:20480
  v_mfma_f32_16x16x32_bf16 v[108:111], a[216:219], a[168:171], v[108:111]
  v_exp_f32 v65, v65
  v_mfma_f32_16x16x32_bf16 v[108:111], a[220:223], a[172:175], v[108:111]
  ds_read_b64_tr_b16 a[204:205], v153 offset:24576
  ds_read_b64_tr_b16 a[206:207], v153 offset:28672
  v_mfma_f32_16x16x32_bf16 v[124:127], a[208:211], a[176:179], v[140:143]
  v_exp_f32 v66, v66
  v_mfma_f32_16x16x32_bf16 v[124:127], a[212:215], a[180:183], v[124:127]
  v_cvt_pk_bf16_f32 v55, v62, v63
  v_cvt_pk_bf16_f32 v64, v64, v65
  v_mfma_f32_16x16x32_bf16 v[124:127], a[216:219], a[184:187], v[124:127]
  v_exp_f32 v67, v67
  v_mfma_f32_16x16x32_bf16 v[124:127], a[220:223], a[188:191], v[124:127]
  v_cvt_pk_bf16_f32 v65, v66, v67
  s_waitcnt lgkmcnt(4)
  v_mfma_f32_16x16x32_bf16 a[0:3], a[192:195], v[0:3], a[0:3]
  v_exp_f32 v80, v80
  v_mfma_f32_16x16x32_bf16 a[0:3], a[196:199], v[4:7], a[0:3]
  v_mfma_f32_16x16x32_bf16 a[4:7], a[192:195], v[16:19], a[4:7]
  v_exp_f32 v81, v81
  v_mfma_f32_16x16x32_bf16 a[4:7], a[196:199], v[20:23], a[4:7]
  v_cvt_pk_bf16_f32 v80, v80, v81
  v_mfma_f32_16x16x32_bf16 a[8:11], a[192:195], v[32:35], a[8:11]
  v_exp_f32 v82, v82
  v_mfma_f32_16x16x32_bf16 a[8:11], a[196:199], v[36:39], a[8:11]
  s_add_u32 m0, s45, 147456
  ds_read_b64_tr_b16 a[208:209], v154 offset:16384
  v_mfma_f32_16x16x32_bf16 a[12:15], a[192:195], v[48:51], a[12:15]
  buffer_load_dwordx4 v160, s[16:19], s43 offen offset:0 lds
  v_mfma_f32_16x16x32_bf16 a[12:15], a[196:199], v[52:55], a[12:15]
  ds_read_b64_tr_b16 a[210:211], v154 offset:20480
  s_waitcnt lgkmcnt(2)
  v_mfma_f32_16x16x32_bf16 a[16:19], a[200:203], v[0:3], a[16:19]
  v_exp_f32 v83, v83
  v_mfma_f32_16x16x32_bf16 a[16:19], a[204:207], v[4:7], a[16:19]
  v_exp_f32 v96, v96
  v_mfma_f32_16x16x32_bf16 a[20:23], a[200:203], v[16:19], a[20:23]
  v_exp_f32 v97, v97
  v_mfma_f32_16x16x32_bf16 a[20:23], a[204:207], v[20:23], a[20:23]
  ds_read_b64_tr_b16 a[212:213], v154 offset:24576
  ds_read_b64_tr_b16 a[214:215], v154 offset:28672
  v_mfma_f32_16x16x32_bf16 a[24:27], a[200:203], v[32:35], a[24:27]
  v_exp_f32 v98, v98
  v_mfma_f32_16x16x32_bf16 a[24:27], a[204:207], v[36:39], a[24:27]
  ds_read_b64_tr_b16 a[216:217], v155 offset:16384
  ds_read_b64_tr_b16 a[218:219], v155 offset:20480
  v_mfma_f32_16x16x32_bf16 a[28:31], a[200:203], v[48:51], a[28:31]
  v_exp_f32 v99, v99
  v_mfma_f32_16x16x32_bf16 a[28:31], a[204:207], v[52:55], a[28:31]
  v_exp_f32 v112, v112
  v_smfmac_f32_16x16x64_bf16 v[176:179], v[144:147], v[0:7], v236
  ds_read_b64_tr_b16 a[220:221], v155 offset:24576
  s_waitcnt lgkmcnt(3)
  v_mfma_f32_16x16x32_bf16 a[32:35], a[208:211], v[0:3], a[32:35]
  ds_read_b64_tr_b16 a[222:223], v155 offset:28672
  v_cvt_pk_bf16_f32 v81, v82, v83
  v_mfma_f32_16x16x32_bf16 a[32:35], a[212:215], v[4:7], a[32:35]
  v_exp_f32 v113, v113
  v_mfma_f32_16x16x32_bf16 a[36:39], a[208:211], v[16:19], a[36:39]
  ds_read_b64_tr_b16 a[192:193], v156 offset:16384
  ds_read_b64_tr_b16 a[194:195], v156 offset:20480
  v_mfma_f32_16x16x32_bf16 a[36:39], a[212:215], v[20:23], a[36:39]
  v_exp_f32 v114, v114
  v_mfma_f32_16x16x32_bf16 a[40:43], a[208:211], v[32:35], a[40:43]
  v_exp_f32 v115, v115
  v_mfma_f32_16x16x32_bf16 a[40:43], a[212:215], v[36:39], a[40:43]
  buffer_load_dwordx4 v161, s[16:19], s43 offen offset:1024 lds
  v_mfma_f32_16x16x32_bf16 a[44:47], a[208:211], v[48:51], a[44:47]
  ds_read_b64_tr_b16 a[196:197], v156 offset:24576
  ds_read_b64_tr_b16 a[198:199], v156 offset:28672
  v_mfma_f32_16x16x32_bf16 a[44:47], a[212:215], v[52:55], a[44:47]
  v_cvt_pk_bf16_f32 v96, v96, v97
  s_waitcnt lgkmcnt(4)
  v_mfma_f32_16x16x32_bf16 a[48:51], a[216:219], v[0:3], a[48:51]
  v_exp_f32 v68, v68
  v_mfma_f32_16x16x32_bf16 a[48:51], a[220:223], v[4:7], a[48:51]
  v_cvt_pk_bf16_f32 v97, v98, v99
  v_cvt_pk_bf16_f32 v112, v112, v113
  v_mfma_f32_16x16x32_bf16 a[52:55], a[216:219], v[16:19], a[52:55]
  v_exp_f32 v69, v69
  v_mfma_f32_16x16x32_bf16 a[52:55], a[220:223], v[20:23], a[52:55]
  ds_read_b64_tr_b16 a[200:201], v157 offset:16384
  ds_read_b64_tr_b16 a[202:203], v157 offset:20480
  v_mfma_f32_16x16x32_bf16 a[56:59], a[216:219], v[32:35], a[56:59]
  v_exp_f32 v70, v70
  v_mfma_f32_16x16x32_bf16 a[56:59], a[220:223], v[36:39], a[56:59]
  ds_read_b64_tr_b16 a[204:205], v157 offset:24576
  ds_read_b64_tr_b16 a[206:207], v157 offset:28672
  v_mfma_f32_16x16x32_bf16 a[60:63], a[216:219], v[48:51], a[60:63]
  v_exp_f32 v71, v71
  v_mfma_f32_16x16x32_bf16 a[60:63], a[220:223], v[52:55], a[60:63]
  v_exp_f32 v84, v84
  v_smfmac_f32_16x16x64_bf16 v[180:183], v[144:147], v[16:23], v236
  v_cvt_pk_bf16_f32 v113, v114, v115
  s_waitcnt lgkmcnt(4)
  v_mfma_f32_16x16x32_bf16 a[64:67], a[192:195], v[0:3], a[64:67]
  ds_read_b64_tr_b16 a[208:209], v158 offset:16384
  ds_read_b64_tr_b16 a[210:211], v158 offset:20480
  v_mfma_f32_16x16x32_bf16 a[64:67], a[196:199], v[4:7], a[64:67]
  v_exp_f32 v85, v85
  v_mfma_f32_16x16x32_bf16 a[68:71], a[192:195], v[16:19], a[68:71]
  v_exp_f32 v86, v86
  v_mfma_f32_16x16x32_bf16 a[68:71], a[196:199], v[20:23], a[68:71]
  s_waitcnt vmcnt(10)
  s_barrier
  v_mfma_f32_16x16x32_bf16 a[72:75], a[192:195], v[32:35], a[72:75]
  v_exp_f32 v87, v87
  v_mfma_f32_16x16x32_bf16 a[72:75], a[196:199], v[36:39], a[72:75]
  buffer_load_dwordx4 v162, s[16:19], s43 offen offset:2048 lds
  v_mfma_f32_16x16x32_bf16 a[76:79], a[192:195], v[48:51], a[76:79]
  v_exp_f32 v100, v100
  v_mfma_f32_16x16x32_bf16 a[76:79], a[196:199], v[52:55], a[76:79]
  ds_read_b64_tr_b16 a[212:213], v158 offset:24576
  s_waitcnt lgkmcnt(3)
  v_mfma_f32_16x16x32_bf16 a[80:83], a[200:203], v[0:3], a[80:83]
  ds_read_b64_tr_b16 a[214:215], v158 offset:28672
  v_cvt_pk_bf16_f32 v66, v68, v69
  v_mfma_f32_16x16x32_bf16 a[80:83], a[204:207], v[4:7], a[80:83]
  v_exp_f32 v101, v101
  v_mfma_f32_16x16x32_bf16 a[84:87], a[200:203], v[16:19], a[84:87]
  ds_read_b64_tr_b16 a[216:217], v159 offset:16384
  ds_read_b64_tr_b16 a[218:219], v159 offset:20480
  v_mfma_f32_16x16x32_bf16 a[84:87], a[204:207], v[20:23], a[84:87]
  v_exp_f32 v102, v102
  v_mfma_f32_16x16x32_bf16 a[88:91], a[200:203], v[32:35], a[88:91]
  ds_read_b64_tr_b16 a[220:221], v159 offset:24576
  ds_read_b64_tr_b16 a[222:223], v159 offset:28672
  v_mfma_f32_16x16x32_bf16 a[88:91], a[204:207], v[36:39], a[88:91]
  v_exp_f32 v103, v103
  v_mfma_f32_16x16x32_bf16 a[92:95], a[200:203], v[48:51], a[92:95]
  v_cvt_pk_bf16_f32 v67, v70, v71
  v_cvt_pk_bf16_f32 v82, v84, v85
  v_mfma_f32_16x16x32_bf16 a[92:95], a[204:207], v[52:55], a[92:95]
  v_exp_f32 v116, v116
  v_smfmac_f32_16x16x64_bf16 v[184:187], v[144:147], v[32:39], v236
  v_cvt_pk_bf16_f32 v83, v86, v87
  s_waitcnt lgkmcnt(4)
  v_mfma_f32_16x16x32_bf16 a[96:99], a[208:211], v[0:3], a[96:99]
  v_exp_f32 v117, v117
  v_mfma_f32_16x16x32_bf16 a[96:99], a[212:215], v[4:7], a[96:99]
  v_cvt_pk_bf16_f32 v98, v100, v101
  v_cvt_pk_bf16_f32 v99, v102, v103
  v_mfma_f32_16x16x32_bf16 a[100:103], a[208:211], v[16:19], a[100:103]
  v_exp_f32 v118, v118
  v_mfma_f32_16x16x32_bf16 a[100:103], a[212:215], v[20:23], a[100:103]
  v_exp_f32 v119, v119
  v_mfma_f32_16x16x32_bf16 a[104:107], a[208:211], v[32:35], a[104:107]
  buffer_load_dwordx4 v163, s[16:19], s43 offen offset:3072 lds
  v_mfma_f32_16x16x32_bf16 a[104:107], a[212:215], v[36:39], a[104:107]
  s_add_u32 s43, s43, 16384
  ds_read_b128 a[192:195], v148 offset:16384
  v_mfma_f32_16x16x32_bf16 a[108:111], a[208:211], v[48:51], a[108:111]
  v_exp_f32 v72, v72
  v_mfma_f32_16x16x32_bf16 a[108:111], a[212:215], v[52:55], a[108:111]
  ds_read_b128 a[196:199], v149 offset:16384
  s_waitcnt lgkmcnt(2)
  v_mfma_f32_16x16x32_bf16 a[112:115], a[216:219], v[0:3], a[112:115]
  ds_read_b128 a[200:203], v150 offset:16384
  ds_read_b128 a[204:207], v151 offset:16384
  v_mfma_f32_16x16x32_bf16 a[112:115], a[220:223], v[4:7], a[112:115]
  v_exp_f32 v73, v73
  v_mfma_f32_16x16x32_bf16 a[116:119], a[216:219], v[16:19], a[116:119]
  v_exp_f32 v74, v74
  v_mfma_f32_16x16x32_bf16 a[116:119], a[220:223], v[20:23], a[116:119]
  v_mfma_f32_16x16x32_bf16 a[120:123], a[216:219], v[32:35], a[120:123]
  v_cvt_pk_bf16_f32 v114, v116, v117
  v_mfma_f32_16x16x32_bf16 a[120:123], a[220:223], v[36:39], a[120:123]
  v_exp_f32 v75, v75
  v_mfma_f32_16x16x32_bf16 a[124:127], a[216:219], v[48:51], a[124:127]
  v_cvt_pk_bf16_f32 v115, v118, v119
  v_cvt_pk_bf16_f32 v68, v72, v73
  v_mfma_f32_16x16x32_bf16 a[124:127], a[220:223], v[52:55], a[124:127]
  v_exp_f32 v88, v88
  v_smfmac_f32_16x16x64_bf16 v[188:191], v[144:147], v[48:55], v236
  v_cvt_pk_bf16_f32 v69, v74, v75
  s_waitcnt lgkmcnt(0)
L_att1:
  v_mfma_f32_16x16x32_bf16 v[0:3], a[192:195], a[128:131], v[128:131]
  v_exp_f32 v89, v89
  v_mfma_f32_16x16x32_bf16 v[0:3], a[196:199], a[132:135], v[0:3]
  v_cvt_pk_bf16_f32 v84, v88, v89
  v_mfma_f32_16x16x32_bf16 v[0:3], a[200:203], a[136:139], v[0:3]
  v_exp_f32 v90, v90
  v_mfma_f32_16x16x32_bf16 v[0:3], a[204:207], a[140:143], v[0:3]
  s_add_u32 m0, s45, 32768
  ds_read_b128 a[208:211], v148 offset:20480
  v_mfma_f32_16x16x32_bf16 v[16:19], a[192:195], a[144:147], v[132:135]
  buffer_load_dwordx4 v164, s[20:23], s44 offen offset:0 lds
  v_mfma_f32_16x16x32_bf16 v[16:19], a[196:199], a[148:151], v[16:19]
  v_exp_f32 v91, v91
  v_mfma_f32_16x16x32_bf16 v[16:19], a[200:203], a[152:155], v[16:19]
  v_exp_f32 v104, v104
  v_mfma_f32_16x16x32_bf16 v[16:19], a[204:207], a[156:159], v[16:19]
  ds_read_b128 a[212:215], v149 offset:20480
  ds_read_b128 a[216:219], v150 offset:20480
  v_mfma_f32_16x16x32_bf16 v[32:35], a[192:195], a[160:163], v[136:139]
  v_exp_f32 v105, v105
  v_mfma_f32_16x16x32_bf16 v[32:35], a[196:199], a[164:167], v[32:35]
  ds_read_b128 a[220:223], v151 offset:20480
  v_cvt_pk_bf16_f32 v85, v90, v91
  v_mfma_f32_16x16x32_bf16 v[32:35], a[200:203], a[168:171], v[32:35]
  v_exp_f32 v106, v106
  v_mfma_f32_16x16x32_bf16 v[32:35], a[204:207], a[172:175], v[32:35]
  v_cvt_pk_bf16_f32 v100, v104, v105
  v_mfma_f32_16x16x32_bf16 v[48:51], a[192:195], a[176:179], v[140:143]
  v_exp_f32 v107, v107
  v_mfma_f32_16x16x32_bf16 v[48:51], a[196:199], a[180:183], v[48:51]
  v_mfma_f32_16x16x32_bf16 v[48:51], a[200:203], a[184:187], v[48:51]
  v_exp_f32 v120, v120
  v_mfma_f32_16x16x32_bf16 v[48:51], a[204:207], a[188:191], v[48:51]
  v_cvt_pk_bf16_f32 v101, v106, v107
  s_waitcnt lgkmcnt(0)
  v_mfma_f32_16x16x32_bf16 v[4:7], a[208:211], a[128:131], v[128:131]
  v_exp_f32 v121, v121
  v_mfma_f32_16x16x32_bf16 v[4:7], a[212:215], a[132:135], v[4:7]
  ds_read_b128 a[192:195], v148 offset:24576
  ds_read_b128 a[196:199], v149 offset:24576
  v_mfma_f32_16x16x32_bf16 v[4:7], a[216:219], a[136:139], v[4:7]
  v_exp_f32 v122, v122
  v_mfma_f32_16x16x32_bf16 v[4:7], a[220:223], a[140:143], v[4:7]
  v_exp_f32 v123, v123
  v_mfma_f32_16x16x32_bf16 v[20:23], a[208:211], a[144:147], v[132:135]
  buffer_load_dwordx4 v165, s[20:23], s44 offen offset:1024 lds
  v_mfma_f32_16x16x32_bf16 v[20:23], a[212:215], a[148:151], v[20:23]
  ds_read_b128 a[200:203], v150 offset:24576
  ds_read_b128 a[204:207], v151 offset:24576
  v_mfma_f32_16x16x32_bf16 v[20:23], a[216:219], a[152:155], v[20:23]
  v_cvt_pk_bf16_f32 v116, v120, v121
  v_cvt_pk_bf16_f32 v117, v122, v123
  v_mfma_f32_16x16x32_bf16 v[20:23], a[220:223], a[156:159], v[20:23]
  v_exp_f32 v76, v76
  v_mfma_f32_16x16x32_bf16 v[36:39], a[208:211], a[160:163], v[136:139]
  v_mfma_f32_16x16x32_bf16 v[36:39], a[212:215], a[164:167], v[36:39]
  v_exp_f32 v77, v77
  v_mfma_f32_16x16x32_bf16 v[36:39], a[216:219], a[168:171], v[36:39]
  v_cvt_pk_bf16_f32 v70, v76, v77
  v_mfma_f32_16x16x32_bf16 v[36:39], a[220:223], a[172:175], v[36:39]
  v_exp_f32 v78, v78
  v_mfma_f32_16x16x32_bf16 v[52:55], a[208:211], a[176:179], v[140:143]
  v_mfma_f32_16x16x32_bf16 v[52:55], a[212:215], a[180:183], v[52:55]
  v_exp_f32 v79, v79
  v_mfma_f32_16x16x32_bf16 v[52:55], a[216:219], a[184:187], v[52:55]
  v_exp_f32 v92, v92
  v_mfma_f32_16x16x32_bf16 v[52:55], a[220:223], a[188:191], v[52:55]
  v_cvt_pk_bf16_f32 v71, v78, v79
  s_waitcnt lgkmcnt(0)
  v_mfma_f32_16x16x32_bf16 v[8:11], a[192:195], a[128:131], v[128:131]
  v_mfma_f32_16x16x32_bf16 v[8:11], a[196:199], a[132:135], v[8:11]
  v_exp_f32 v93, v93
  v_mfma_f32_16x16x32_bf16 v[8:11], a[200:203], a[136:139], v[8:11]
  ds_read_b128 a[208:211], v148 offset:28672
  ds_read_b128 a[212:215], v149 offset:28672
  v_mfma_f32_16x16x32_bf16 v[8:11], a[204:207], a[140:143], v[8:11]
  v_exp_f32 v94, v94
  v_mfma_f32_16x16x32_bf16 v[24:27], a[192:195], a[144:147], v[132:135]
  v_exp_f32 v95, v95
  v_mfma_f32_16x16x32_bf16 v[24:27], a[196:199], a[148:151], v[24:27]
  buffer_load_dwordx4 v164, s[20:23], s44 offen offset:2048 lds
  v_mfma_f32_16x16x32_bf16 v[24:27], a[200:203], a[152:155], v[24:27]
  ds_read_b128 a[216:219], v150 offset:28672
  ds_read_b128 a[220:223], v151 offset:28672
  v_mfma_f32_16x16x32_bf16 v[24:27], a[204:207], a[156:159], v[24:27]
  v_exp_f32 v108, v108
  v_mfma_f32_16x16x32_bf16 v[40:43], a[192:195], a[160:163], v[136:139]
  v_cvt_pk_bf16_f32 v86, v92, v93
  v_cvt_pk_bf16_f32 v87, v94, v95
  v_mfma_f32_16x16x32_bf16 v[40:43], a[196:199], a[164:167], v[40:43]
  v_exp_f32 v109, v109
  v_mfma_f32_16x16x32_bf16 v[40:43], a[200:203], a[168:171], v[40:43]
  v_cvt_pk_bf16_f32 v102, v108, v109
  v_mfma_f32_16x16x32_bf16 v[40:43], a[204:207], a[172:175], v[40:43]
  v_exp_f32 v110, v110
  v_mfma_f32_16x16x32_bf16 v[56:59], a[192:195], a[176:179], v[140:143]
  v_mfma_f32_16x16x32_bf16 v[56:59], a[196:199], a[180:183], v[56:59]
  v_exp_f32 v111, v111
  v_mfma_f32_16x16x32_bf16 v[56:59], a[200:203], a[184:187], v[56:59]
  v_exp_f32 v124, v124
  v_mfma_f32_16x16x32_bf16 v[56:59], a[204:207], a[188:191], v[56:59]
  v_cvt_pk_bf16_f32 v103, v110, v111
  s_waitcnt lgkmcnt(0)
  v_mfma_f32_16x16x32_bf16 v[12:15], a[208:211], a[128:131], v[128:131]
  v_mfma_f32_16x16x32_bf16 v[12:15], a[212:215], a[132:135], v[12:15]
  v_exp_f32 v125, v125
  v_mfma_f32_16x16x32_bf16 v[12:15], a[216:219], a[136:139], v[12:15]
  ds_read_b64_tr_b16 a[192:193], v152 offset:32768
  ds_read_b64_tr_b16 a[194:195], v152 offset:36864
  v_mfma_f32_16x16x32_bf16 v[12:15], a[220:223], a[140:143], v[12:15]
  v_exp_f32 v126, v126
  v_mfma_f32_16x16x32_bf16 v[28:31], a[208:211], a[144:147], v[132:135]
  v_exp_f32 v127, v127
  v_mfma_f32_16x16x32_bf16 v[28:31], a[212:215], a[148:151], v[28:31]
  buffer_load_dwordx4 v165, s[20:23], s44 offen offset:3072 lds
  v_mfma_f32_16x16x32_bf16 v[28:31], a[216:219], a[152:155], v[28:31]
  s_add_u32 s44, s44, 16384
  ds_read_b64_tr_b16 a[196:197], v152 offset:40960
  v_mfma_f32_16x16x32_bf16 v[28:31], a[220:223], a[156:159], v[28:31]
  ds_read_b64_tr_b16 a[198:199], v152 offset:45056
  v_cvt_pk_bf16_f32 v118, v124, v125
  v_mfma_f32_16x16x32_bf16 v[44:47], a[208:211], a[160:163], v[136:139]
  v_exp_f32 v0, v0
  v_mfma_f32_16x16x32_bf16 v[44:47], a[212:215], a[164:167], v[44:47]
  ds_read_b64_tr_b16 a[200:201], v153 offset:32768
  ds_read_b64_tr_b16 a[202:203], v153 offset:36864
  v_mfma_f32_16x16x32_bf16 v[44:47], a[216:219], a[168:171], v[44:47]
  v_exp_f32 v1, v1
  v_mfma_f32_16x16x32_bf16 v[44:47], a[220:223], a[172:175], v[44:47]
  ds_read_b64_tr_b16 a[204:205], v153 offset:40960
  ds_read_b64_tr_b16 a[206:207], v153 offset:45056
  v_mfma_f32_16x16x32_bf16 v[60:63], a[208:211], a[176:179], v[140:143]
  v_exp_f32 v2, v2
  v_mfma_f32_16x16x32_bf16 v[60:63], a[212:215], a[180:183], v[60:63]
  v_cvt_pk_bf16_f32 v119, v126, v127
  v_cvt_pk_bf16_f32 v0, v0, v1
  v_mfma_f32_16x16x32_bf16 v[60:63], a[216:219], a[184:187], v[60:63]
  v_exp_f32 v3, v3
  v_mfma_f32_16x16x32_bf16 v[60:63], a[220:223], a[188:191], v[60:63]
  v_cvt_pk_bf16_f32 v1, v2, v3
  s_waitcnt lgkmcnt(4)
  v_mfma_f32_16x16x32_bf16 a[0:3], a[192:195], v[64:67], a[0:3]
  v_exp_f32 v16, v16
  v_mfma_f32_16x16x32_bf16 a[0:3], a[196:199], v[68:71], a[0:3]
  v_mfma_f32_16x16x32_bf16 a[4:7], a[192:195], v[80:83], a[4:7]
  v_exp_f32 v17, v17
  v_mfma_f32_16x16x32_bf16 a[4:7], a[196:199], v[84:87], a[4:7]
  v_cvt_pk_bf16_f32 v16, v16, v17
  v_mfma_f32_16x16x32_bf16 a[8:11], a[192:195], v[96:99], a[8:11]
  v_exp_f32 v18, v18
  v_mfma_f32_16x16x32_bf16 a[8:11], a[196:199], v[100:103], a[8:11]
  s_add_u32 m0, s45, 98304
  ds_read_b64_tr_b16 a[208:209], v154 offset:32768
  v_mfma_f32_16x16x32_bf16 a[12:15], a[192:195], v[112:115], a[12:15]
  buffer_load_dwordx4 v160, s[16:19], s43 offen offset:0 lds
  v_mfma_f32_16x16x32_bf16 a[12:15], a[196:199], v[116:119], a[12:15]
  ds_read_b64_tr_b16 a[210:211], v154 offset:36864
  s_waitcnt lgkmcnt(2)
  v_mfma_f32_16x16x32_bf16 a[16:19], a[200:203], v[64:67], a[16:19]
  v_exp_f32 v19, v19
  v_mfma_f32_16x16x32_bf16 a[16:19], a[204:207], v[68:71], a[16:19]
  v_exp_f32 v32, v32
  v_mfma_f32_16x16x32_bf16 a[20:23], a[200:203], v[80:83], a[20:23]
  v_exp_f32 v33, v33
  v_mfma_f32_16x16x32_bf16 a[20:23], a[204:207], v[84:87], a[20:23]
  ds_read_b64_tr_b16 a[212:213], v154 offset:40960
  ds_read_b64_tr_b16 a[214:215], v154 offset:45056
  v_mfma_f32_16x16x32_bf16 a[24:27], a[200:203], v[96:99], a[24:27]
  v_exp_f32 v34, v34
  v_mfma_f32_16x16x32_bf16 a[24:27], a[204:207], v[100:103], a[24:27]
  ds_read_b64_tr_b16 a[216:217], v155 offset:32768
  ds_read_b64_tr_b16 a[218:219], v155 offset:36864
  v_mfma_f32_16x16x32_bf16 a[28:31], a[200:203], v[112:115], a[28:31]
  v_exp_f32 v35, v35
  v_mfma_f32_16x16x32_bf16 a[28:31], a[204:207], v[116:119], a[28:31]
  v_exp_f32 v48, v48
  v_smfmac_f32_16x16x64_bf16 v[176:179], v[144:147], v[64:71], v236
  ds_read_b64_tr_b16 a[220:221], v155 offset:40960
  s_waitcnt lgkmcnt(3)
  v_mfma_f32_16x16x32_bf16 a[32:35], a[208:211], v[64:67], a[32:35]
  ds_read_b64_tr_b16 a[222:223], v155 offset:45056
  v_cvt_pk_bf16_f32 v17, v18, v19
  v_mfma_f32_16x16x32_bf16 a[32:35], a[212:215], v[68:71], a[32:35]
  v_exp_f32 v49, v49
  v_mfma_f32_16x16x32_bf16 a[36:39], a[208:211], v[80:83], a[36:39]
  ds_read_b64_tr_b16 a[192:193], v156 offset:32768
  ds_read_b64_tr_b16 a[194:195], v156 offset:36864
  v_mfma_f32_16x16x32_bf16 a[36:39], a[212:215], v[84:87], a[36:39]
  v_exp_f32 v50, v50
  v_mfma_f32_16x16x32_bf16 a[40:43], a[208:211], v[96:99], a[40:43]
  v_exp_f32 v51, v51
  v_mfma_f32_16x16x32_bf16 a[40:43], a[212:215], v[100:103], a[40:43]
  buffer_load_dwordx4 v161, s[16:19], s43 offen offset:1024 lds
  v_mfma_f32_16x16x32_bf16 a[44:47], a[208:211], v[112:115], a[44:47]
  ds_read_b64_tr_b16 a[196:197], v156 offset:40960
  ds_read_b64_tr_b16 a[198:199], v156 offset:45056
  v_mfma_f32_16x16x32_bf16 a[44:47], a[212:215], v[116:119], a[44:47]
  v_cvt_pk_bf16_f32 v32, v32, v33
  s_waitcnt lgkmcnt(4)
  v_mfma_f32_16x16x32_bf16 a[48:51], a[216:219], v[64:67], a[48:51]
  v_exp_f32 v4, v4
  v_mfma_f32_16x16x32_bf16 a[48:51], a[220:223], v[68:71], a[48:51]
  v_cvt_pk_bf16_f32 v33, v34, v35
  v_cvt_pk_bf16_f32 v48, v48, v49
  v_mfma_f32_16x16x32_bf16 a[52:55], a[216:219], v[80:83], a[52:55]
  v_exp_f32 v5, v5
  v_mfma_f32_16x16x32_bf16 a[52:55], a[220:223], v[84:87], a[52:55]
  ds_read_b64_tr_b16 a[200:201], v157 offset:32768
  ds_read_b64_tr_b16 a[202:203], v157 offset:36864
  v_mfma_f32_16x16x32_bf16 a[56:59], a[216:219], v[96:99], a[56:59]
  v_exp_f32 v6, v6
  v_mfma_f32_16x16x32_bf16 a[56:59], a[220:223], v[100:103], a[56:59]
  ds_read_b64_tr_b16 a[204:205], v157 offset:40960
  ds_read_b64_tr_b16 a[206:207], v157 offset:45056
  v_mfma_f32_16x16x32_bf16 a[60:63], a[216:219], v[112:115], a[60:63]
  v_exp_f32 v7, v7
  v_mfma_f32_16x16x32_bf16 a[60:63], a[220:223], v[116:119], a[60:63]
  v_exp_f32 v20, v20
  v_smfmac_f32_16x16x64_bf16 v[180:183], v[144:147], v[80:87], v236
  v_cvt_pk_bf16_f32 v49, v50, v51
  s_waitcnt lgkmcnt(4)
  v_mfma_f32_16x16x32_bf16 a[64:67], a[192:195], v[64:67], a[64:67]
  ds_read_b64_tr_b16 a[208:209], v158 offset:32768
  ds_read_b64_tr_b16 a[210:211], v158 offset:36864
  v_mfma_f32_16x16x32_bf16 a[64:67], a[196:199], v[68:71], a[64:67]
  v_exp_f32 v21, v21
  v_mfma_f32_16x16x32_bf16 a[68:71], a[192:195], v[80:83], a[68:71]
  v_exp_f32 v22, v22
  v_mfma_f32_16x16x32_bf16 a[68:71], a[196:199], v[84:87], a[68:71]
  s_waitcnt vmcnt(10)
  s_barrier
  v_mfma_f32_16x16x32_bf16 a[72:75], a[192:195], v[96:99], a[72:75]
  v_exp_f32 v23, v23
  v_mfma_f32_16x16x32_bf16 a[72:75], a[196:199], v[100:103], a[72:75]
  buffer_load_dwordx4 v162, s[16:19], s43 offen offset:2048 lds
  v_mfma_f32_16x16x32_bf16 a[76:79], a[192:195], v[112:115], a[76:79]
  v_exp_f32 v36, v36
  v_mfma_f32_16x16x32_bf16 a[76:79], a[196:199], v[116:119], a[76:79]
  ds_read_b64_tr_b16 a[212:213], v158 offset:40960
  s_waitcnt lgkmcnt(3)
  v_mfma_f32_16x16x32_bf16 a[80:83], a[200:203], v[64:67], a[80:83]
  ds_read_b64_tr_b16 a[214:215], v158 offset:45056
  v_cvt_pk_bf16_f32 v2, v4, v5
  v_mfma_f32_16x16x32_bf16 a[80:83], a[204:207], v[68:71], a[80:83]
  v_exp_f32 v37, v37
  v_mfma_f32_16x16x32_bf16 a[84:87], a[200:203], v[80:83], a[84:87]
  ds_read_b64_tr_b16 a[216:217], v159 offset:32768
  ds_read_b64_tr_b16 a[218:219], v159 offset:36864
  v_mfma_f32_16x16x32_bf16 a[84:87], a[204:207], v[84:87], a[84:87]
  v_exp_f32 v38, v38
  v_mfma_f32_16x16x32_bf16 a[88:91], a[200:203], v[96:99], a[88:91]
  ds_read_b64_tr_b16 a[220:221], v159 offset:40960
  ds_read_b64_tr_b16 a[222:223], v159 offset:45056
  v_mfma_f32_16x16x32_bf16 a[88:91], a[204:207], v[100:103], a[88:91]
  v_exp_f32 v39, v39
  v_mfma_f32_16x16x32_bf16 a[92:95], a[200:203], v[112:115], a[92:95]
  v_cvt_pk_bf16_f32 v3, v6, v7
  v_cvt_pk_bf16_f32 v18, v20, v21
  v_mfma_f32_16x16x32_bf16 a[92:95], a[204:207], v[116:119], a[92:95]
  v_exp_f32 v52, v52
  v_smfmac_f32_16x16x64_bf16 v[184:187], v[144:147], v[96:103], v236
  v_cvt_pk_bf16_f32 v19, v22, v23
  s_waitcnt lgkmcnt(4)
  v_mfma_f32_16x16x32_bf16 a[96:99], a[208:211], v[64:67], a[96:99]
  v_exp_f32 v53, v53
  v_mfma_f32_16x16x32_bf16 a[96:99], a[212:215], v[68:71], a[96:99]
  v_cvt_pk_bf16_f32 v34, v36, v37
  v_cvt_pk_bf16_f32 v35, v38, v39
  v_mfma_f32_16x16x32_bf16 a[100:103], a[208:211], v[80:83], a[100:103]
  v_exp_f32 v54, v54
  v_mfma_f32_16x16x32_bf16 a[100:103], a[212:215], v[84:87], a[100:103]
  v_exp_f32 v55, v55
  v_mfma_f32_16x16x32_bf16 a[104:107], a[208:211], v[96:99], a[104:107]
  buffer_load_dwordx4 v163, s[16:19], s43 offen offset:3072 lds
  v_mfma_f32_16x16x32_bf16 a[104:107], a[212:215], v[100:103], a[104:107]
  s_add_u32 s43, s43, 16384
  ds_read_b128 a[192:195], v148 offset:32768
  v_mfma_f32_16x16x32_bf16 a[108:111], a[208:211], v[112:115], a[108:111]
  v_exp_f32 v8, v8
  v_mfma_f32_16x16x32_bf16 a[108:111], a[212:215], v[116:119], a[108:111]
  ds_read_b128 a[196:199], v149 offset:32768
  s_waitcnt lgkmcnt(2)
  v_mfma_f32_16x16x32_bf16 a[112:115], a[216:219], v[64:67], a[112:115]
  ds_read_b128 a[200:203], v150 offset:32768
  ds_read_b128 a[204:207], v151 offset:32768
  v_mfma_f32_16x16x32_bf16 a[112:115], a[220:223], v[68:71], a[112:115]
  v_exp_f32 v9, v9
  v_mfma_f32_16x16x32_bf16 a[116:119], a[216:219], v[80:83], a[116:119]
  v_exp_f32 v10, v10
  v_mfma_f32_16x16x32_bf16 a[116:119], a[220:223], v[84:87], a[116:119]
  buffer_load_dword v248, v167, s[68:71], s65 offen
  v_mfma_f32_16x16x32_bf16 a[120:123], a[216:219], v[96:99], a[120:123]
  s_add_u32 s65, s65, 2048
  v_cvt_pk_bf16_f32 v50, v52, v53
  v_mfma_f32_16x16x32_bf16 a[120:123], a[220:223], v[100:103], a[120:123]
  v_exp_f32 v11, v11
  v_mfma_f32_16x16x32_bf16 a[124:127], a[216:219], v[112:115], a[124:127]
  v_cvt_pk_bf16_f32 v51, v54, v55
  v_cvt_pk_bf16_f32 v4, v8, v9
  v_mfma_f32_16x16x32_bf16 a[124:127], a[220:223], v[116:119], a[124:127]
  v_exp_f32 v24, v24
  v_smfmac_f32_16x16x64_bf16 v[188:191], v[144:147], v[112:119], v236
  v_cvt_pk_bf16_f32 v5, v10, v11
  s_waitcnt lgkmcnt(0)
  v_mfma_f32_16x16x32_bf16 v[64:67], a[192:195], a[128:131], v[128:131]
  v_exp_f32 v25, v25
  v_mfma_f32_16x16x32_bf16 v[64:67], a[196:199], a[132:135], v[64:67]
  v_cvt_pk_bf16_f32 v20, v24, v25
  v_mfma_f32_16x16x32_bf16 v[64:67], a[200:203], a[136:139], v[64:67]
  v_exp_f32 v26, v26
  v_mfma_f32_16x16x32_bf16 v[64:67], a[204:207], a[140:143], v[64:67]
  s_add_u32 m0, s45, 49152
  ds_read_b128 a[208:211], v148 offset:36864
  v_mfma_f32_16x16x32_bf16 v[80:83], a[192:195], a[144:147], v[132:135]
  buffer_load_dwordx4 v164, s[20:23], s44 offen offset:0 lds
  v_mfma_f32_16x16x32_bf16 v[80:83], a[196:199], a[148:151], v[80:83]
  v_exp_f32 v27, v27
  v_mfma_f32_16x16x32_bf16 v[80:83], a[200:203], a[152:155], v[80:83]
  v_exp_f32 v40, v40
  v_mfma_f32_16x16x32_bf16 v[80:83], a[204:207], a[156:159], v[80:83]
  ds_read_b128 a[212:215], v149 offset:36864
  ds_read_b128 a[216:219], v150 offset:36864
  v_mfma_f32_16x16x32_bf16 v[96:99], a[192:195], a[160:163], v[136:139]
  v_exp_f32 v41, v41
  v_mfma_f32_16x16x32_bf16 v[96:99], a[196:199], a[164:167], v[96:99]
  ds_read_b128 a[220:223], v151 offset:36864
  v_cvt_pk_bf16_f32 v21, v26, v27
  v_mfma_f32_16x16x32_bf16 v[96:99], a[200:203], a[168:171], v[96:99]
  v_exp_f32 v42, v42
  v_mfma_f32_16x16x32_bf16 v[96:99], a[204:207], a[172:175], v[96:99]
  v_cvt_pk_bf16_f32 v36, v40, v41
  v_mfma_f32_16x16x32_bf16 v[112:115], a[192:195], a[176:179], v[140:143]
  v_exp_f32 v43, v43
  v_mfma_f32_16x16x32_bf16 v[112:115], a[196:199], a[180:183], v[112:115]
  v_mfma_f32_16x16x32_bf16 v[112:115], a[200:203], a[184:187], v[112:115]
  v_exp_f32 v56, v56
  v_mfma_f32_16x16x32_bf16 v[112:115], a[204:207], a[188:191], v[112:115]
  v_cvt_pk_bf16_f32 v37, v42, v43
  s_waitcnt lgkmcnt(0)
  v_mfma_f32_16x16x32_bf16 v[68:71], a[208:211], a[128:131], v[128:131]
  v_exp_f32 v57, v57
  v_mfma_f32_16x16x32_bf16 v[68:71], a[212:215], a[132:135], v[68:71]
  ds_read_b128 a[192:195], v148 offset:40960
  ds_read_b128 a[196:199], v149 offset:40960
  v_mfma_f32_16x16x32_bf16 v[68:71], a[216:219], a[136:139], v[68:71]
  v_exp_f32 v58, v58
  v_mfma_f32_16x16x32_bf16 v[68:71], a[220:223], a[140:143], v[68:71]
  v_exp_f32 v59, v59
  v_mfma_f32_16x16x32_bf16 v[84:87], a[208:211], a[144:147], v[132:135]
  buffer_load_dwordx4 v165, s[20:23], s44 offen offset:1024 lds
  v_mfma_f32_16x16x32_bf16 v[84:87], a[212:215], a[148:151], v[84:87]
  ds_read_b128 a[200:203], v150 offset:40960
  ds_read_b128 a[204:207], v151 offset:40960
  v_mfma_f32_16x16x32_bf16 v[84:87], a[216:219], a[152:155], v[84:87]
  v_cvt_pk_bf16_f32 v52, v56, v57
  v_cvt_pk_bf16_f32 v53, v58, v59
  v_mfma_f32_16x16x32_bf16 v[84:87], a[220:223], a[156:159], v[84:87]
  v_exp_f32 v12, v12
  v_mfma_f32_16x16x32_bf16 v[100:103], a[208:211], a[160:163], v[136:139]
  v_mfma_f32_16x16x32_bf16 v[100:103], a[212:215], a[164:167], v[100:103]
  v_exp_f32 v13, v13
  v_mfma_f32_16x16x32_bf16 v[100:103], a[216:219], a[168:171], v[100:103]
  v_cvt_pk_bf16_f32 v6, v12, v13
  v_mfma_f32_16x16x32_bf16 v[100:103], a[220:223], a[172:175], v[100:103]
  v_exp_f32 v14, v14
  v_mfma_f32_16x16x32_bf16 v[116:119], a[208:211], a[176:179], v[140:143]
  v_mfma_f32_16x16x32_bf16 v[116:119], a[212:215], a[180:183], v[116:119]
  v_exp_f32 v15, v15
  v_mfma_f32_16x16x32_bf16 v[116:119], a[216:219], a[184:187], v[116:119]
  v_exp_f32 v28, v28
  v_mfma_f32_16x16x32_bf16 v[116:119], a[220:223], a[188:191], v[116:119]
  v_cvt_pk_bf16_f32 v7, v14, v15
  s_waitcnt lgkmcnt(0)
  v_mfma_f32_16x16x32_bf16 v[72:75], a[192:195], a[128:131], v[128:131]
  v_mfma_f32_16x16x32_bf16 v[72:75], a[196:199], a[132:135], v[72:75]
  v_exp_f32 v29, v29
  v_mfma_f32_16x16x32_bf16 v[72:75], a[200:203], a[136:139], v[72:75]
  ds_read_b128 a[208:211], v148 offset:45056
  ds_read_b128 a[212:215], v149 offset:45056
  v_mfma_f32_16x16x32_bf16 v[72:75], a[204:207], a[140:143], v[72:75]
  v_exp_f32 v30, v30
  v_mfma_f32_16x16x32_bf16 v[88:91], a[192:195], a[144:147], v[132:135]
  v_exp_f32 v31, v31
  v_mfma_f32_16x16x32_bf16 v[88:91], a[196:199], a[148:151], v[88:91]
  buffer_load_dwordx4 v164, s[20:23], s44 offen offset:2048 lds
  v_mfma_f32_16x16x32_bf16 v[88:91], a[200:203], a[152:155], v[88:91]
  ds_read_b128 a[216:219], v150 offset:45056
  ds_read_b128 a[220:223], v151 offset:45056
  v_mfma_f32_16x16x32_bf16 v[88:91], a[204:207], a[156:159], v[88:91]
  v_exp_f32 v44, v44
  v_mfma_f32_16x16x32_bf16 v[104:107], a[192:195], a[160:163], v[136:139]
  v_cvt_pk_bf16_f32 v22, v28, v29
  v_cvt_pk_bf16_f32 v23, v30, v31
  v_mfma_f32_16x16x32_bf16 v[104:107], a[196:199], a[164:167], v[104:107]
  v_exp_f32 v45, v45
  v_mfma_f32_16x16x32_bf16 v[104:107], a[200:203], a[168:171], v[104:107]
  v_cvt_pk_bf16_f32 v38, v44, v45
  v_mfma_f32_16x16x32_bf16 v[104:107], a[204:207], a[172:175], v[104:107]
  v_exp_f32 v46, v46
  v_mfma_f32_16x16x32_bf16 v[120:123], a[192:195], a[176:179], v[140:143]
  v_mfma_f32_16x16x32_bf16 v[120:123], a[196:199], a[180:183], v[120:123]
  v_exp_f32 v47, v47
  v_mfma_f32_16x16x32_bf16 v[120:123], a[200:203], a[184:187], v[120:123]
  v_exp_f32 v60, v60
  v_mfma_f32_16x16x32_bf16 v[120:123], a[204:207], a[188:191], v[120:123]
  v_cvt_pk_bf16_f32 v39, v46, v47
  s_waitcnt lgkmcnt(0)
  v_mfma_f32_16x16x32_bf16 v[76:79], a[208:211], a[128:131], v[128:131]
  v_mfma_f32_16x16x32_bf16 v[76:79], a[212:215], a[132:135], v[76:79]
  v_exp_f32 v61, v61
  v_mfma_f32_16x16x32_bf16 v[76:79], a[216:219], a[136:139], v[76:79]
  ds_read_b64_tr_b16 a[192:193], v152 offset:49152
  ds_read_b64_tr_b16 a[194:195], v152 offset:53248
  v_mfma_f32_16x16x32_bf16 v[76:79], a[220:223], a[140:143], v[76:79]
  v_exp_f32 v62, v62
  v_mfma_f32_16x16x32_bf16 v[92:95], a[208:211], a[144:147], v[132:135]
  v_exp_f32 v63, v63
  v_mfma_f32_16x16x32_bf16 v[92:95], a[212:215], a[148:151], v[92:95]
  buffer_load_dwordx4 v165, s[20:23], s44 offen offset:3072 lds
  v_mfma_f32_16x16x32_bf16 v[92:95], a[216:219], a[152:155], v[92:95]
  s_add_u32 s44, s44, 16384
  ds_read_b64_tr_b16 a[196:197], v152 offset:57344
  v_mfma_f32_16x16x32_bf16 v[92:95], a[220:223], a[156:159], v[92:95]
  ds_read_b64_tr_b16 a[198:199], v152 offset:61440
  v_cvt_pk_bf16_f32 v54, v60, v61
  v_mfma_f32_16x16x32_bf16 v[108:111], a[208:211], a[160:163], v[136:139]
  v_exp_f32 v64, v64
  v_mfma_f32_16x16x32_bf16 v[108:111], a[212:215], a[164:167], v[108:111]
  ds_read_b64_tr_b16 a[200:201], v153 offset:49152
  ds_read_b64_tr_b16 a[202:203], v153 offset:53248
  v_mfma_f32_16x16x32_bf16 v[108:111], a[216:219], a[168:171], v[108:111]
  v_exp_f32 v65, v65
  v_mfma_f32_16x16x32_bf16 v[108:111], a[220:223], a[172:175], v[108:111]
  ds_read_b64_tr_b16 a[204:205], v153 offset:57344
  ds_read_b64_tr_b16 a[206:207], v153 offset:61440
  v_mfma_f32_16x16x32_bf16 v[124:127], a[208:211], a[176:179], v[140:143]
  v_exp_f32 v66, v66
  v_mfma_f32_16x16x32_bf16 v[124:127], a[212:215], a[180:183], v[124:127]
  v_cvt_pk_bf16_f32 v55, v62, v63
  v_cvt_pk_bf16_f32 v64, v64, v65
  v_mfma_f32_16x16x32_bf16 v[124:127], a[216:219], a[184:187], v[124:127]
  v_exp_f32 v67, v67
  v_mfma_f32_16x16x32_bf16 v[124:127], a[220:223], a[188:191], v[124:127]
  v_cvt_pk_bf16_f32 v65, v66, v67
  s_waitcnt lgkmcnt(4)
  v_mfma_f32_16x16x32_bf16 a[0:3], a[192:195], v[0:3], a[0:3]
  v_exp_f32 v80, v80
  v_mfma_f32_16x16x32_bf16 a[0:3], a[196:199], v[4:7], a[0:3]
  v_mfma_f32_16x16x32_bf16 a[4:7], a[192:195], v[16:19], a[4:7]
  v_exp_f32 v81, v81
  v_mfma_f32_16x16x32_bf16 a[4:7], a[196:199], v[20:23], a[4:7]
  v_cvt_pk_bf16_f32 v80, v80, v81
  v_mfma_f32_16x16x32_bf16 a[8:11], a[192:195], v[32:35], a[8:11]
  v_exp_f32 v82, v82
  v_mfma_f32_16x16x32_bf16 a[8:11], a[196:199], v[36:39], a[8:11]
  s_add_u32 m0, s45, 114688
  ds_read_b64_tr_b16 a[208:209], v154 offset:49152
  v_mfma_f32_16x16x32_bf16 a[12:15], a[192:195], v[48:51], a[12:15]
  buffer_load_dwordx4 v160, s[16:19], s43 offen offset:0 lds
  v_mfma_f32_16x16x32_bf16 a[12:15], a[196:199], v[52:55], a[12:15]
  ds_read_b64_tr_b16 a[210:211], v154 offset:53248
  s_waitcnt lgkmcnt(2)
  v_mfma_f32_16x16x32_bf16 a[16:19], a[200:203], v[0:3], a[16:19]
  v_exp_f32 v83, v83
  v_mfma_f32_16x16x32_bf16 a[16:19], a[204:207], v[4:7], a[16:19]
  v_exp_f32 v96, v96
  v_mfma_f32_16x16x32_bf16 a[20:23], a[200:203], v[16:19], a[20:23]
  v_exp_f32 v97, v97
  v_mfma_f32_16x16x32_bf16 a[20:23], a[204:207], v[20:23], a[20:23]
  ds_read_b64_tr_b16 a[212:213], v154 offset:57344
  ds_read_b64_tr_b16 a[214:215], v154 offset:61440
  v_mfma_f32_16x16x32_bf16 a[24:27], a[200:203], v[32:35], a[24:27]
  v_exp_f32 v98, v98
  v_mfma_f32_16x16x32_bf16 a[24:27], a[204:207], v[36:39], a[24:27]
  ds_read_b64_tr_b16 a[216:217], v155 offset:49152
  ds_read_b64_tr_b16 a[218:219], v155 offset:53248
  v_mfma_f32_16x16x32_bf16 a[28:31], a[200:203], v[48:51], a[28:31]
  v_exp_f32 v99, v99
  v_mfma_f32_16x16x32_bf16 a[28:31], a[204:207], v[52:55], a[28:31]
  v_exp_f32 v112, v112
  v_smfmac_f32_16x16x64_bf16 v[176:179], v[144:147], v[0:7], v236
  ds_read_b64_tr_b16 a[220:221], v155 offset:57344
  s_waitcnt lgkmcnt(3)
  v_mfma_f32_16x16x32_bf16 a[32:35], a[208:211], v[0:3], a[32:35]
  ds_read_b64_tr_b16 a[222:223], v155 offset:61440
  v_cvt_pk_bf16_f32 v81, v82, v83
  v_mfma_f32_16x16x32_bf16 a[32:35], a[212:215], v[4:7], a[32:35]
  v_exp_f32 v113, v113
  v_mfma_f32_16x16x32_bf16 a[36:39], a[208:211], v[16:19], a[36:39]
  ds_read_b64_tr_b16 a[192:193], v156 offset:49152
  ds_read_b64_tr_b16 a[194:195], v156 offset:53248
  v_mfma_f32_16x16x32_bf16 a[36:39], a[212:215], v[20:23], a[36:39]
  v_exp_f32 v114, v114
  v_mfma_f32_16x16x32_bf16 a[40:43], a[208:211], v[32:35], a[40:43]
  v_exp_f32 v115, v115
  v_mfma_f32_16x16x32_bf16 a[40:43], a[212:215], v[36:39], a[40:43]
  buffer_load_dwordx4 v161, s[16:19], s43 offen offset:1024 lds
  v_mfma_f32_16x16x32_bf16 a[44:47], a[208:211], v[48:51], a[44:47]
  ds_read_b64_tr_b16 a[196:197], v156 offset:57344
  ds_read_b64_tr_b16 a[198:199], v156 offset:61440
  v_mfma_f32_16x16x32_bf16 a[44:47], a[212:215], v[52:55], a[44:47]
  v_cvt_pk_bf16_f32 v96, v96, v97
  s_waitcnt lgkmcnt(4)
  v_mfma_f32_16x16x32_bf16 a[48:51], a[216:219], v[0:3], a[48:51]
  v_exp_f32 v68, v68
  v_mfma_f32_16x16x32_bf16 a[48:51], a[220:223], v[4:7], a[48:51]
  v_cvt_pk_bf16_f32 v97, v98, v99
  v_cvt_pk_bf16_f32 v112, v112, v113
  v_mfma_f32_16x16x32_bf16 a[52:55], a[216:219], v[16:19], a[52:55]
  v_exp_f32 v69, v69
  v_mfma_f32_16x16x32_bf16 a[52:55], a[220:223], v[20:23], a[52:55]
  ds_read_b64_tr_b16 a[200:201], v157 offset:49152
  ds_read_b64_tr_b16 a[202:203], v157 offset:53248
  v_mfma_f32_16x16x32_bf16 a[56:59], a[216:219], v[32:35], a[56:59]
  v_exp_f32 v70, v70
  v_mfma_f32_16x16x32_bf16 a[56:59], a[220:223], v[36:39], a[56:59]
  ds_read_b64_tr_b16 a[204:205], v157 offset:57344
  ds_read_b64_tr_b16 a[206:207], v157 offset:61440
  v_mfma_f32_16x16x32_bf16 a[60:63], a[216:219], v[48:51], a[60:63]
  v_exp_f32 v71, v71
  v_mfma_f32_16x16x32_bf16 a[60:63], a[220:223], v[52:55], a[60:63]
  v_exp_f32 v84, v84
  v_smfmac_f32_16x16x64_bf16 v[180:183], v[144:147], v[16:23], v236
  v_cvt_pk_bf16_f32 v113, v114, v115
  s_waitcnt lgkmcnt(4)
  v_mfma_f32_16x16x32_bf16 a[64:67], a[192:195], v[0:3], a[64:67]
  ds_read_b64_tr_b16 a[208:209], v158 offset:49152
  ds_read_b64_tr_b16 a[210:211], v158 offset:53248
  v_mfma_f32_16x16x32_bf16 a[64:67], a[196:199], v[4:7], a[64:67]
  v_exp_f32 v85, v85
  v_mfma_f32_16x16x32_bf16 a[68:71], a[192:195], v[16:19], a[68:71]
  v_exp_f32 v86, v86
  v_mfma_f32_16x16x32_bf16 a[68:71], a[196:199], v[20:23], a[68:71]
  s_waitcnt vmcnt(11)
  s_barrier
  v_mfma_f32_16x16x32_bf16 a[72:75], a[192:195], v[32:35], a[72:75]
  v_exp_f32 v87, v87
  v_mfma_f32_16x16x32_bf16 a[72:75], a[196:199], v[36:39], a[72:75]
  buffer_load_dwordx4 v162, s[16:19], s43 offen offset:2048 lds
  v_mfma_f32_16x16x32_bf16 a[76:79], a[192:195], v[48:51], a[76:79]
  v_exp_f32 v100, v100
  v_mfma_f32_16x16x32_bf16 a[76:79], a[196:199], v[52:55], a[76:79]
  ds_read_b64_tr_b16 a[212:213], v158 offset:57344
  s_waitcnt lgkmcnt(3)
  v_mfma_f32_16x16x32_bf16 a[80:83], a[200:203], v[0:3], a[80:83]
  ds_read_b64_tr_b16 a[214:215], v158 offset:61440
  v_cvt_pk_bf16_f32 v66, v68, v69
  v_mfma_f32_16x16x32_bf16 a[80:83], a[204:207], v[4:7], a[80:83]
  v_exp_f32 v101, v101
  v_mfma_f32_16x16x32_bf16 a[84:87], a[200:203], v[16:19], a[84:87]
  ds_read_b64_tr_b16 a[216:217], v159 offset:49152
  ds_read_b64_tr_b16 a[218:219], v159 offset:53248
  v_mfma_f32_16x16x32_bf16 a[84:87], a[204:207], v[20:23], a[84:87]
  v_exp_f32 v102, v102
  v_mfma_f32_16x16x32_bf16 a[88:91], a[200:203], v[32:35], a[88:91]
  ds_read_b64_tr_b16 a[220:221], v159 offset:57344
  ds_read_b64_tr_b16 a[222:223], v159 offset:61440
  v_mfma_f32_16x16x32_bf16 a[88:91], a[204:207], v[36:39], a[88:91]
  v_exp_f32 v103, v103
  v_mfma_f32_16x16x32_bf16 a[92:95], a[200:203], v[48:51], a[92:95]
  v_cvt_pk_bf16_f32 v67, v70, v71
  v_cvt_pk_bf16_f32 v82, v84, v85
  v_mfma_f32_16x16x32_bf16 a[92:95], a[204:207], v[52:55], a[92:95]
  v_exp_f32 v116, v116
  v_smfmac_f32_16x16x64_bf16 v[184:187], v[144:147], v[32:39], v236
  v_cvt_pk_bf16_f32 v83, v86, v87
  s_waitcnt lgkmcnt(4)
  v_mfma_f32_16x16x32_bf16 a[96:99], a[208:211], v[0:3], a[96:99]
  v_exp_f32 v117, v117
  v_mfma_f32_16x16x32_bf16 a[96:99], a[212:215], v[4:7], a[96:99]
  v_cvt_pk_bf16_f32 v98, v100, v101
  v_cvt_pk_bf16_f32 v99, v102, v103
  v_mfma_f32_16x16x32_bf16 a[100:103], a[208:211], v[16:19], a[100:103]
  v_exp_f32 v118, v118
  v_mfma_f32_16x16x32_bf16 a[100:103], a[212:215], v[20:23], a[100:103]
  v_exp_f32 v119, v119
  v_mfma_f32_16x16x32_bf16 a[104:107], a[208:211], v[32:35], a[104:107]
  buffer_load_dwordx4 v163, s[16:19], s43 offen offset:3072 lds
  v_mfma_f32_16x16x32_bf16 a[104:107], a[212:215], v[36:39], a[104:107]
  s_add_u32 s43, s43, 16384
  ds_read_b128 a[192:195], v148 offset:49152
  v_mfma_f32_16x16x32_bf16 a[108:111], a[208:211], v[48:51], a[108:111]
  v_exp_f32 v72, v72
  v_mfma_f32_16x16x32_bf16 a[108:111], a[212:215], v[52:55], a[108:111]
  ds_read_b128 a[196:199], v149 offset:49152
  s_waitcnt lgkmcnt(2)
  v_mfma_f32_16x16x32_bf16 a[112:115], a[216:219], v[0:3], a[112:115]
  ds_read_b128 a[200:203], v150 offset:49152
  ds_read_b128 a[204:207], v151 offset:49152
  v_mfma_f32_16x16x32_bf16 a[112:115], a[220:223], v[4:7], a[112:115]
  v_exp_f32 v73, v73
  v_mfma_f32_16x16x32_bf16 a[116:119], a[216:219], v[16:19], a[116:119]
  v_exp_f32 v74, v74
  v_mfma_f32_16x16x32_bf16 a[116:119], a[220:223], v[20:23], a[116:119]
  v_mfma_f32_16x16x32_bf16 a[120:123], a[216:219], v[32:35], a[120:123]
  v_cvt_pk_bf16_f32 v114, v116, v117
  v_mfma_f32_16x16x32_bf16 a[120:123], a[220:223], v[36:39], a[120:123]
  v_exp_f32 v75, v75
  v_mfma_f32_16x16x32_bf16 a[124:127], a[216:219], v[48:51], a[124:127]
  v_cvt_pk_bf16_f32 v115, v118, v119
  v_cvt_pk_bf16_f32 v68, v72, v73
  v_mfma_f32_16x16x32_bf16 a[124:127], a[220:223], v[52:55], a[124:127]
  v_exp_f32 v88, v88
  v_smfmac_f32_16x16x64_bf16 v[188:191], v[144:147], v[48:55], v236
  v_cvt_pk_bf16_f32 v69, v74, v75
  s_waitcnt lgkmcnt(0)
  s_sub_u32 s42, s42, 1
  s_cmp_eq_u32 s42, 0
  s_cbranch_scc1 L_att_tail
  s_cmp_eq_u32 s42, s95
  s_cbranch_scc1 L_hook
L_chback:
  v_mfma_f32_16x16x32_bf16 v[0:3], a[192:195], a[128:131], v[128:131]
  v_exp_f32 v89, v89
  v_mfma_f32_16x16x32_bf16 v[0:3], a[196:199], a[132:135], v[0:3]
  v_cvt_pk_bf16_f32 v84, v88, v89
  v_mfma_f32_16x16x32_bf16 v[0:3], a[200:203], a[136:139], v[0:3]
  v_exp_f32 v90, v90
  v_mfma_f32_16x16x32_bf16 v[0:3], a[204:207], a[140:143], v[0:3]
  s_add_u32 m0, s45, 65536
  ds_read_b128 a[208:211], v148 offset:53248
  v_mfma_f32_16x16x32_bf16 v[16:19], a[192:195], a[144:147], v[132:135]
  buffer_load_dwordx4 v164, s[20:23], s44 offen offset:0 lds
  v_mfma_f32_16x16x32_bf16 v[16:19], a[196:199], a[148:151], v[16:19]
  v_exp_f32 v91, v91
  v_mfma_f32_16x16x32_bf16 v[16:19], a[200:203], a[152:155], v[16:19]
  v_exp_f32 v104, v104
  v_mfma_f32_16x16x32_bf16 v[16:19], a[204:207], a[156:159], v[16:19]
  ds_read_b128 a[212:215], v149 offset:53248
  ds_read_b128 a[216:219], v150 offset:53248
  v_mfma_f32_16x16x32_bf16 v[32:35], a[192:195], a[160:163], v[136:139]
  v_exp_f32 v105, v105
  v_mfma_f32_16x16x32_bf16 v[32:35], a[196:199], a[164:167], v[32:35]
  ds_read_b128 a[220:223], v151 offset:53248
  v_cvt_pk_bf16_f32 v85, v90, v91
  v_mfma_f32_16x16x32_bf16 v[32:35], a[200:203], a[168:171], v[32:35]
  v_exp_f32 v106, v106
  v_mfma_f32_16x16x32_bf16 v[32:35], a[204:207], a[172:175], v[32:35]
  v_cvt_pk_bf16_f32 v100, v104, v105
  v_mfma_f32_16x16x32_bf16 v[48:51], a[192:195], a[176:179], v[140:143]
  v_exp_f32 v107, v107
  v_mfma_f32_16x16x32_bf16 v[48:51], a[196:199], a[180:183], v[48:51]
  v_mfma_f32_16x16x32_bf16 v[48:51], a[200:203], a[184:187], v[48:51]
  v_exp_f32 v120, v120
  v_mfma_f32_16x16x32_bf16 v[48:51], a[204:207], a[188:191], v[48:51]
  v_cvt_pk_bf16_f32 v101, v106, v107
  s_waitcnt lgkmcnt(0)
  v_mfma_f32_16x16x32_bf16 v[4:7], a[208:211], a[128:131], v[128:131]
  v_exp_f32 v121, v121
  v_mfma_f32_16x16x32_bf16 v[4:7], a[212:215], a[132:135], v[4:7]
  ds_read_b128 a[192:195], v148 offset:57344
  ds_read_b128 a[196:199], v149 offset:57344
  v_mfma_f32_16x16x32_bf16 v[4:7], a[216:219], a[136:139], v[4:7]
  v_exp_f32 v122, v122
  v_mfma_f32_16x16x32_bf16 v[4:7], a[220:223], a[140:143], v[4:7]
  v_exp_f32 v123, v123
  v_mfma_f32_16x16x32_bf16 v[20:23], a[208:211], a[144:147], v[132:135]
  buffer_load_dwordx4 v165, s[20:23], s44 offen offset:1024 lds
  v_mfma_f32_16x16x32_bf16 v[20:23], a[212:215], a[148:151], v[20:23]
  ds_read_b128 a[200:203], v150 offset:57344
  ds_read_b128 a[204:207], v151 offset:57344
  v_mfma_f32_16x16x32_bf16 v[20:23], a[216:219], a[152:155], v[20:23]
  v_cvt_pk_bf16_f32 v116, v120, v121
  v_cvt_pk_bf16_f32 v117, v122, v123
  v_mfma_f32_16x16x32_bf16 v[20:23], a[220:223], a[156:159], v[20:23]
  v_exp_f32 v76, v76
  v_mfma_f32_16x16x32_bf16 v[36:39], a[208:211], a[160:163], v[136:139]
  v_mfma_f32_16x16x32_bf16 v[36:39], a[212:215], a[164:167], v[36:39]
  v_exp_f32 v77, v77
  v_mfma_f32_16x16x32_bf16 v[36:39], a[216:219], a[168:171], v[36:39]
  v_cvt_pk_bf16_f32 v70, v76, v77
  v_mfma_f32_16x16x32_bf16 v[36:39], a[220:223], a[172:175], v[36:39]
  v_exp_f32 v78, v78
  v_mfma_f32_16x16x32_bf16 v[52:55], a[208:211], a[176:179], v[140:143]
  v_mfma_f32_16x16x32_bf16 v[52:55], a[212:215], a[180:183], v[52:55]
  v_exp_f32 v79, v79
  v_mfma_f32_16x16x32_bf16 v[52:55], a[216:219], a[184:187], v[52:55]
  v_exp_f32 v92, v92
  v_mfma_f32_16x16x32_bf16 v[52:55], a[220:223], a[188:191], v[52:55]
  v_cvt_pk_bf16_f32 v71, v78, v79
  s_waitcnt lgkmcnt(0)
  v_mfma_f32_16x16x32_bf16 v[8:11], a[192:195], a[128:131], v[128:131]
  v_mfma_f32_16x16x32_bf16 v[8:11], a[196:199], a[132:135], v[8:11]
  v_exp_f32 v93, v93
  v_mfma_f32_16x16x32_bf16 v[8:11], a[200:203], a[136:139], v[8:11]
  ds_read_b128 a[208:211], v148 offset:61440
  ds_read_b128 a[212:215], v149 offset:61440
  v_mfma_f32_16x16x32_bf16 v[8:11], a[204:207], a[140:143], v[8:11]
  v_exp_f32 v94, v94
  v_mfma_f32_16x16x32_bf16 v[24:27], a[192:195], a[144:147], v[132:135]
  v_exp_f32 v95, v95
  v_mfma_f32_16x16x32_bf16 v[24:27], a[196:199], a[148:151], v[24:27]
  buffer_load_dwordx4 v164, s[20:23], s44 offen offset:2048 lds
  v_mfma_f32_16x16x32_bf16 v[24:27], a[200:203], a[152:155], v[24:27]
  ds_read_b128 a[216:219], v150 offset:61440
  ds_read_b128 a[220:223], v151 offset:61440
  v_mfma_f32_16x16x32_bf16 v[24:27], a[204:207], a[156:159], v[24:27]
  v_exp_f32 v108, v108
  v_mfma_f32_16x16x32_bf16 v[40:43], a[192:195], a[160:163], v[136:139]
  v_cvt_pk_bf16_f32 v86, v92, v93
  v_cvt_pk_bf16_f32 v87, v94, v95
  v_mfma_f32_16x16x32_bf16 v[40:43], a[196:199], a[164:167], v[40:43]
  v_exp_f32 v109, v109
  v_mfma_f32_16x16x32_bf16 v[40:43], a[200:203], a[168:171], v[40:43]
  v_cvt_pk_bf16_f32 v102, v108, v109
  v_mfma_f32_16x16x32_bf16 v[40:43], a[204:207], a[172:175], v[40:43]
  v_exp_f32 v110, v110
  v_mfma_f32_16x16x32_bf16 v[56:59], a[192:195], a[176:179], v[140:143]
  v_mfma_f32_16x16x32_bf16 v[56:59], a[196:199], a[180:183], v[56:59]
  v_exp_f32 v111, v111
  v_mfma_f32_16x16x32_bf16 v[56:59], a[200:203], a[184:187], v[56:59]
  v_exp_f32 v124, v124
  v_mfma_f32_16x16x32_bf16 v[56:59], a[204:207], a[188:191], v[56:59]
  v_cvt_pk_bf16_f32 v103, v110, v111
  s_waitcnt lgkmcnt(0)
  v_mfma_f32_16x16x32_bf16 v[12:15], a[208:211], a[128:131], v[128:131]
  v_mfma_f32_16x16x32_bf16 v[12:15], a[212:215], a[132:135], v[12:15]
  v_exp_f32 v125, v125
  v_mfma_f32_16x16x32_bf16 v[12:15], a[216:219], a[136:139], v[12:15]
  ds_read_b64_tr_b16 a[192:193], v152 offset:0
  ds_read_b64_tr_b16 a[194:195], v152 offset:4096
  v_mfma_f32_16x16x32_bf16 v[12:15], a[220:223], a[140:143], v[12:15]
  v_exp_f32 v126, v126
  v_mfma_f32_16x16x32_bf16 v[28:31], a[208:211], a[144:147], v[132:135]
  v_exp_f32 v127, v127
  v_mfma_f32_16x16x32_bf16 v[28:31], a[212:215], a[148:151], v[28:31]
  buffer_load_dwordx4 v165, s[20:23], s44 offen offset:3072 lds
  v_mfma_f32_16x16x32_bf16 v[28:31], a[216:219], a[152:155], v[28:31]
  s_add_u32 s44, s44, 16384
  ds_read_b64_tr_b16 a[196:197], v152 offset:8192
  v_mfma_f32_16x16x32_bf16 v[28:31], a[220:223], a[156:159], v[28:31]
  ds_read_b64_tr_b16 a[198:199], v152 offset:12288
  v_cvt_pk_bf16_f32 v118, v124, v125
  v_mfma_f32_16x16x32_bf16 v[44:47], a[208:211], a[160:163], v[136:139]
  v_exp_f32 v0, v0
  v_mfma_f32_16x16x32_bf16 v[44:47], a[212:215], a[164:167], v[44:47]
  ds_read_b64_tr_b16 a[200:201], v153 offset:0
  ds_read_b64_tr_b16 a[202:203], v153 offset:4096
  v_mfma_f32_16x16x32_bf16 v[44:47], a[216:219], a[168:171], v[44:47]
  v_exp_f32 v1, v1
  v_mfma_f32_16x16x32_bf16 v[44:47], a[220:223], a[172:175], v[44:47]
  ds_read_b64_tr_b16 a[204:205], v153 offset:8192
  ds_read_b64_tr_b16 a[206:207], v153 offset:12288
  v_mfma_f32_16x16x32_bf16 v[60:63], a[208:211], a[176:179], v[140:143]
  v_exp_f32 v2, v2
  v_mfma_f32_16x16x32_bf16 v[60:63], a[212:215], a[180:183], v[60:63]
  v_cvt_pk_bf16_f32 v119, v126, v127
  v_cvt_pk_bf16_f32 v0, v0, v1
  v_mfma_f32_16x16x32_bf16 v[60:63], a[216:219], a[184:187], v[60:63]
  v_exp_f32 v3, v3
  v_mfma_f32_16x16x32_bf16 v[60:63], a[220:223], a[188:191], v[60:63]
  v_cvt_pk_bf16_f32 v1, v2, v3
  s_waitcnt lgkmcnt(4)
  v_mfma_f32_16x16x32_bf16 a[0:3], a[192:195], v[64:67], a[0:3]
  v_exp_f32 v16, v16
  v_mfma_f32_16x16x32_bf16 a[0:3], a[196:199], v[68:71], a[0:3]
  v_mfma_f32_16x16x32_bf16 a[4:7], a[192:195], v[80:83], a[4:7]
  v_exp_f32 v17, v17
  v_mfma_f32_16x16x32_bf16 a[4:7], a[196:199], v[84:87], a[4:7]
  v_cvt_pk_bf16_f32 v16, v16, v17
  v_mfma_f32_16x16x32_bf16 a[8:11], a[192:195], v[96:99], a[8:11]
  v_exp_f32 v18, v18
  v_mfma_f32_16x16x32_bf16 a[8:11], a[196:199], v[100:103], a[8:11]
  s_add_u32 m0, s45, 131072
  ds_read_b64_tr_b16 a[208:209], v154 offset:0
  v_mfma_f32_16x16x32_bf16 a[12:15], a[192:195], v[112:115], a[12:15]
  buffer_load_dwordx4 v160, s[16:19], s43 offen offset:0 lds
  v_mfma_f32_16x16x32_bf16 a[12:15], a[196:199], v[116:119], a[12:15]
  ds_read_b64_tr_b16 a[210:211], v154 offset:4096
  s_waitcnt lgkmcnt(2)
  v_mfma_f32_16x16x32_bf16 a[16:19], a[200:203], v[64:67], a[16:19]
  v_exp_f32 v19, v19
  v_mfma_f32_16x16x32_bf16 a[16:19], a[204:207], v[68:71], a[16:19]
  v_exp_f32 v32, v32
  v_mfma_f32_16x16x32_bf16 a[20:23], a[200:203], v[80:83], a[20:23]
  v_exp_f32 v33, v33
  v_mfma_f32_16x16x32_bf16 a[20:23], a[204:207], v[84:87], a[20:23]
  ds_read_b64_tr_b16 a[212:213], v154 offset:8192
  ds_read_b64_tr_b16 a[214:215], v154 offset:12288
  v_mfma_f32_16x16x32_bf16 a[24:27], a[200:203], v[96:99], a[24:27]
  v_exp_f32 v34, v34
  v_mfma_f32_16x16x32_bf16 a[24:27], a[204:207], v[100:103], a[24:27]
  ds_read_b64_tr_b16 a[216:217], v155 offset:0
  ds_read_b64_tr_b16 a[218:219], v155 offset:4096
  v_mfma_f32_16x16x32_bf16 a[28:31], a[200:203], v[112:115], a[28:31]
  v_exp_f32 v35, v35
  v_mfma_f32_16x16x32_bf16 a[28:31], a[204:207], v[116:119], a[28:31]
  v_exp_f32 v48, v48
  v_smfmac_f32_16x16x64_bf16 v[176:179], v[144:147], v[64:71], v236
  ds_read_b64_tr_b16 a[220:221], v155 offset:8192
  s_waitcnt lgkmcnt(3)
  v_mfma_f32_16x16x32_bf16 a[32:35], a[208:211], v[64:67], a[32:35]
  ds_read_b64_tr_b16 a[222:223], v155 offset:12288
  v_cvt_pk_bf16_f32 v17, v18, v19
  v_mfma_f32_16x16x32_bf16 a[32:35], a[212:215], v[68:71], a[32:35]
  v_exp_f32 v49, v49
  v_mfma_f32_16x16x32_bf16 a[36:39], a[208:211], v[80:83], a[36:39]
  ds_read_b64_tr_b16 a[192:193], v156 offset:0
  ds_read_b64_tr_b16 a[194:195], v156 offset:4096
  v_mfma_f32_16x16x32_bf16 a[36:39], a[212:215], v[84:87], a[36:39]
  v_exp_f32 v50, v50
  v_mfma_f32_16x16x32_bf16 a[40:43], a[208:211], v[96:99], a[40:43]
  v_exp_f32 v51, v51
  v_mfma_f32_16x16x32_bf16 a[40:43], a[212:215], v[100:103], a[40:43]
  buffer_load_dwordx4 v161, s[16:19], s43 offen offset:1024 lds
  v_mfma_f32_16x16x32_bf16 a[44:47], a[208:211], v[112:115], a[44:47]
  ds_read_b64_tr_b16 a[196:197], v156 offset:8192
  ds_read_b64_tr_b16 a[198:199], v156 offset:12288
  v_mfma_f32_16x16x32_bf16 a[44:47], a[212:215], v[116:119], a[44:47]
  v_cvt_pk_bf16_f32 v32, v32, v33
  s_waitcnt lgkmcnt(4)
  v_mfma_f32_16x16x32_bf16 a[48:51], a[216:219], v[64:67], a[48:51]
  v_exp_f32 v4, v4
  v_mfma_f32_16x16x32_bf16 a[48:51], a[220:223], v[68:71], a[48:51]
  v_cvt_pk_bf16_f32 v33, v34, v35
  v_cvt_pk_bf16_f32 v48, v48, v49
  v_mfma_f32_16x16x32_bf16 a[52:55], a[216:219], v[80:83], a[52:55]
  v_exp_f32 v5, v5
  v_mfma_f32_16x16x32_bf16 a[52:55], a[220:223], v[84:87], a[52:55]
  ds_read_b64_tr_b16 a[200:201], v157 offset:0
  ds_read_b64_tr_b16 a[202:203], v157 offset:4096
  v_mfma_f32_16x16x32_bf16 a[56:59], a[216:219], v[96:99], a[56:59]
  v_exp_f32 v6, v6
  v_mfma_f32_16x16x32_bf16 a[56:59], a[220:223], v[100:103], a[56:59]
  ds_read_b64_tr_b16 a[204:205], v157 offset:8192
  ds_read_b64_tr_b16 a[206:207], v157 offset:12288
  v_mfma_f32_16x16x32_bf16 a[60:63], a[216:219], v[112:115], a[60:63]
  v_exp_f32 v7, v7
  v_mfma_f32_16x16x32_bf16 a[60:63], a[220:223], v[116:119], a[60:63]
  v_exp_f32 v20, v20
  v_smfmac_f32_16x16x64_bf16 v[180:183], v[144:147], v[80:87], v236
  v_cvt_pk_bf16_f32 v49, v50, v51
  s_waitcnt lgkmcnt(4)
  v_mfma_f32_16x16x32_bf16 a[64:67], a[192:195], v[64:67], a[64:67]
  ds_read_b64_tr_b16 a[208:209], v158 offset:0
  ds_read_b64_tr_b16 a[210:211], v158 offset:4096
  v_mfma_f32_16x16x32_bf16 a[64:67], a[196:199], v[68:71], a[64:67]
  v_exp_f32 v21, v21
  v_mfma_f32_16x16x32_bf16 a[68:71], a[192:195], v[80:83], a[68:71]
  v_exp_f32 v22, v22
  v_mfma_f32_16x16x32_bf16 a[68:71], a[196:199], v[84:87], a[68:71]
  s_waitcnt vmcnt(10)
  s_barrier
  v_mfma_f32_16x16x32_bf16 a[72:75], a[192:195], v[96:99], a[72:75]
  v_exp_f32 v23, v23
  v_mfma_f32_16x16x32_bf16 a[72:75], a[196:199], v[100:103], a[72:75]
  buffer_load_dwordx4 v162, s[16:19], s43 offen offset:2048 lds
  v_mfma_f32_16x16x32_bf16 a[76:79], a[192:195], v[112:115], a[76:79]
  v_exp_f32 v36, v36
  v_mfma_f32_16x16x32_bf16 a[76:79], a[196:199], v[116:119], a[76:79]
  ds_read_b64_tr_b16 a[212:213], v158 offset:8192
  s_waitcnt lgkmcnt(3)
  v_mfma_f32_16x16x32_bf16 a[80:83], a[200:203], v[64:67], a[80:83]
  ds_read_b64_tr_b16 a[214:215], v158 offset:12288
  v_cvt_pk_bf16_f32 v2, v4, v5
  v_mfma_f32_16x16x32_bf16 a[80:83], a[204:207], v[68:71], a[80:83]
  v_exp_f32 v37, v37
  v_mfma_f32_16x16x32_bf16 a[84:87], a[200:203], v[80:83], a[84:87]
  ds_read_b64_tr_b16 a[216:217], v159 offset:0
  ds_read_b64_tr_b16 a[218:219], v159 offset:4096
  v_mfma_f32_16x16x32_bf16 a[84:87], a[204:207], v[84:87], a[84:87]
  v_exp_f32 v38, v38
  v_mfma_f32_16x16x32_bf16 a[88:91], a[200:203], v[96:99], a[88:91]
  ds_read_b64_tr_b16 a[220:221], v159 offset:8192
  ds_read_b64_tr_b16 a[222:223], v159 offset:12288
  v_mfma_f32_16x16x32_bf16 a[88:91], a[204:207], v[100:103], a[88:91]
  v_exp_f32 v39, v39
  v_mfma_f32_16x16x32_bf16 a[92:95], a[200:203], v[112:115], a[92:95]
  v_cvt_pk_bf16_f32 v3, v6, v7
  v_cvt_pk_bf16_f32 v18, v20, v21
  v_mfma_f32_16x16x32_bf16 a[92:95], a[204:207], v[116:119], a[92:95]
  v_exp_f32 v52, v52
  v_smfmac_f32_16x16x64_bf16 v[184:187], v[144:147], v[96:103], v236
  v_cvt_pk_bf16_f32 v19, v22, v23
  s_waitcnt lgkmcnt(4)
  v_mfma_f32_16x16x32_bf16 a[96:99], a[208:211], v[64:67], a[96:99]
  v_exp_f32 v53, v53
  v_mfma_f32_16x16x32_bf16 a[96:99], a[212:215], v[68:71], a[96:99]
  v_cvt_pk_bf16_f32 v34, v36, v37
  v_cvt_pk_bf16_f32 v35, v38, v39
  v_mfma_f32_16x16x32_bf16 a[100:103], a[208:211], v[80:83], a[100:103]
  v_exp_f32 v54, v54
  v_mfma_f32_16x16x32_bf16 a[100:103], a[212:215], v[84:87], a[100:103]
  v_exp_f32 v55, v55
  v_mfma_f32_16x16x32_bf16 a[104:107], a[208:211], v[96:99], a[104:107]
  buffer_load_dwordx4 v163, s[16:19], s43 offen offset:3072 lds
  v_mfma_f32_16x16x32_bf16 a[104:107], a[212:215], v[100:103], a[104:107]
  s_add_u32 s43, s43, 16384
  ds_read_b128 a[192:195], v148 offset:0
  v_mfma_f32_16x16x32_bf16 a[108:111], a[208:211], v[112:115], a[108:111]
  v_exp_f32 v8, v8
  v_mfma_f32_16x16x32_bf16 a[108:111], a[212:215], v[116:119], a[108:111]
  ds_read_b128 a[196:199], v149 offset:0
  s_waitcnt lgkmcnt(2)
  v_mfma_f32_16x16x32_bf16 a[112:115], a[216:219], v[64:67], a[112:115]
  ds_read_b128 a[200:203], v150 offset:0
  ds_read_b128 a[204:207], v151 offset:0
  v_mfma_f32_16x16x32_bf16 a[112:115], a[220:223], v[68:71], a[112:115]
  v_exp_f32 v9, v9
  v_mfma_f32_16x16x32_bf16 a[116:119], a[216:219], v[80:83], a[116:119]
  v_exp_f32 v10, v10
  v_mfma_f32_16x16x32_bf16 a[116:119], a[220:223], v[84:87], a[116:119]
  v_mfma_f32_16x16x32_bf16 a[120:123], a[216:219], v[96:99], a[120:123]
  v_cvt_pk_bf16_f32 v50, v52, v53
  v_mfma_f32_16x16x32_bf16 a[120:123], a[220:223], v[100:103], a[120:123]
  v_exp_f32 v11, v11
  v_mfma_f32_16x16x32_bf16 a[124:127], a[216:219], v[112:115], a[124:127]
  v_cvt_pk_bf16_f32 v51, v54, v55
  v_cvt_pk_bf16_f32 v4, v8, v9
  v_mfma_f32_16x16x32_bf16 a[124:127], a[220:223], v[116:119], a[124:127]
  v_exp_f32 v24, v24
  v_smfmac_f32_16x16x64_bf16 v[188:191], v[144:147], v[112:119], v236
  v_cvt_pk_bf16_f32 v5, v10, v11
  s_waitcnt lgkmcnt(0)
  s_branch L_att
L_att_tail:
  ds_read_b64_tr_b16 a[208:209], v156 offset:0
  ds_read_b64_tr_b16 a[210:211], v156 offset:4096
  ds_read_b64_tr_b16 a[212:213], v157 offset:0
  ds_read_b64_tr_b16 a[214:215], v157 offset:4096
  ds_read_b64_tr_b16 a[216:217], v158 offset:0
  ds_read_b64_tr_b16 a[218:219], v158 offset:4096
  ds_read_b64_tr_b16 a[220:221], v159 offset:0
  ds_read_b64_tr_b16 a[222:223], v159 offset:4096
  s_mov_b32 s34, s2
  s_and_b32 s48, s2, 4
  v_mov_b32 v208, s48
  v_lshrrev_b32 v209, 2, v166
  ds_read_b32 v208, v208 offset:256
  ds_read_b32 v209, v209 offset:272
  v_exp_f32 v89, v89
  s_nop 0
  v_cvt_pk_bf16_f32 v84, v88, v89
  v_exp_f32 v90, v90
  v_exp_f32 v91, v91
  v_exp_f32 v104, v104
  v_exp_f32 v105, v105
  ds_read_b64_tr_b16 a[192:193], v152 offset:0
  ds_read_b64_tr_b16 a[194:195], v152 offset:4096
  ds_read_b64_tr_b16 a[196:197], v153 offset:0
  ds_read_b64_tr_b16 a[198:199], v153 offset:4096
  ds_read_b64_tr_b16 a[200:201], v154 offset:0
  ds_read_b64_tr_b16 a[202:203], v154 offset:4096
  ds_read_b64_tr_b16 a[204:205], v155 offset:0
  ds_read_b64_tr_b16 a[206:207], v155 offset:4096
  v_cvt_pk_bf16_f32 v85, v90, v91
  v_exp_f32 v106, v106
  v_cvt_pk_bf16_f32 v100, v104, v105
  v_exp_f32 v107, v107
  v_exp_f32 v120, v120
  v_cvt_pk_bf16_f32 v101, v106, v107
  s_waitcnt lgkmcnt(15)
  v_mfma_f32_16x16x32_bf16 a[64:67], a[208:211], v[64:67], a[64:67]
  v_exp_f32 v121, v121
  v_exp_f32 v122, v122
  v_exp_f32 v123, v123
  v_mfma_f32_16x16x32_bf16 a[68:71], a[208:211], v[80:83], a[68:71]
  v_cvt_pk_bf16_f32 v116, v120, v121
  v_cvt_pk_bf16_f32 v117, v122, v123
  v_mfma_f32_16x16x32_bf16 a[72:75], a[208:211], v[96:99], a[72:75]
  v_exp_f32 v76, v76
  v_exp_f32 v77, v77
  s_nop 0
  v_cvt_pk_bf16_f32 v70, v76, v77
  v_mfma_f32_16x16x32_bf16 a[76:79], a[208:211], v[112:115], a[76:79]
  v_exp_f32 v78, v78
  v_exp_f32 v79, v79
  s_waitcnt lgkmcnt(9)
  v_readfirstlane_b32 s46, v208
  s_waitcnt lgkmcnt(8)
  v_cmp_gt_u32 vcc, 4, v209
  v_mfma_f32_16x16x32_bf16 a[80:83], a[212:215], v[64:67], a[80:83]
  v_exp_f32 v92, v92
  v_cvt_pk_bf16_f32 v71, v78, v79
  v_exp_f32 v93, v93
  s_and_b32 s48, s34, 3
  ds_read_b64_tr_b16 a[208:209], v156 offset:8192
  ds_read_b64_tr_b16 a[210:211], v156 offset:12288
  v_mfma_f32_16x16x32_bf16 a[84:87], a[212:215], v[80:83], a[84:87]
  v_exp_f32 v94, v94
  v_exp_f32 v95, v95
  s_lshl_b32 s48, s48, 2
  s_add_u32 s48, s48, 16
  v_mfma_f32_16x16x32_bf16 a[88:91], a[212:215], v[96:99], a[88:91]
  v_exp_f32 v108, v108
  v_cvt_pk_bf16_f32 v86, v92, v93
  s_lshr_b32 s47, s46, s48
  s_and_b32 s95, vcc_lo, 0xff
  v_mfma_f32_16x16x32_bf16 a[92:95], a[212:215], v[112:115], a[92:95]
  v_cvt_pk_bf16_f32 v87, v94, v95
  v_exp_f32 v109, v109
  s_nop 0
  v_cvt_pk_bf16_f32 v102, v108, v109
  v_mfma_f32_16x16x32_bf16 a[96:99], a[216:219], v[64:67], a[96:99]
  v_exp_f32 v110, v110
  v_exp_f32 v111, v111
  ds_read_b64_tr_b16 a[212:213], v157 offset:8192
  ds_read_b64_tr_b16 a[214:215], v157 offset:12288
  v_mfma_f32_16x16x32_bf16 a[100:103], a[216:219], v[80:83], a[100:103]
  v_exp_f32 v124, v124
  v_cvt_pk_bf16_f32 v103, v110, v111
  v_exp_f32 v125, v125
  v_mfma_f32_16x16x32_bf16 a[104:107], a[216:219], v[96:99], a[104:107]
  v_exp_f32 v126, v126
  v_exp_f32 v127, v127
  v_mfma_f32_16x16x32_bf16 a[108:111], a[216:219], v[112:115], a[108:111]
  v_cvt_pk_bf16_f32 v118, v124, v125
  v_cvt_pk_bf16_f32 v119, v126, v127
  v_mfma_f32_16x16x32_bf16 a[112:115], a[220:223], v[64:67], a[112:115]
  ds_read_b64_tr_b16 a[216:217], v158 offset:8192
  ds_read_b64_tr_b16 a[218:219], v158 offset:12288
  v_mfma_f32_16x16x32_bf16 a[116:119], a[220:223], v[80:83], a[116:119]
  v_smfmac_f32_16x16x64_bf16 v[176:179], v[144:147], v[64:71], v236
  v_smfmac_f32_16x16x64_bf16 v[180:183], v[144:147], v[80:87], v236
  v_mfma_f32_16x16x32_bf16 a[120:123], a[220:223], v[96:99], a[120:123]
  v_smfmac_f32_16x16x64_bf16 v[184:187], v[144:147], v[96:103], v236
  v_smfmac_f32_16x16x64_bf16 v[188:191], v[144:147], v[112:119], v236
  v_mfma_f32_16x16x32_bf16 a[124:127], a[220:223], v[112:115], a[124:127]
  s_bfe_u32 s35, s47, 0x10001
  s_bfe_u32 s56, s34, 0x10002
  s_and_b32 s48, s47, 1
  s_cmp_eq_u32 s35, 0
  s_cselect_b32 s39, s56, s48
  s_cselect_b32 s40, s48, s56
  s_cselect_b32 s58, s56, 0
  s_waitcnt lgkmcnt(4)
  v_mfma_f32_16x16x32_bf16 a[64:67], a[208:211], v[68:71], a[64:67]
  s_lshl_b32 s40, s40, 2
  s_bfe_u32 s48, s34, 0x20003
  s_add_u32 s48, s40, s48
  s_lshr_b32 s56, s34, 5
  ds_read_b64_tr_b16 a[220:221], v159 offset:8192
  ds_read_b64_tr_b16 a[222:223], v159 offset:12288
  v_add_f32 v204, v176, v177
  v_add_f32 v205, v180, v181
  v_add_f32 v206, v184, v185
  v_add_f32 v207, v188, v189
  v_mfma_f32_16x16x32_bf16 a[68:71], a[208:211], v[84:87], a[68:71]
  s_cmp_eq_u32 s35, 0
  s_cselect_b32 s40, s48, s56
  s_cselect_b32 s56, s56, s48
  s_lshl_b32 s41, s56, 3
  s_lshl_b32 s48, s3, 1
  s_add_u32 s41, s41, s48
  v_add_f32 v212, v204, v205
  v_add_f32 v213, v206, v207
  v_add_f32 v213, v212, v213
  v_mfma_f32_16x16x32_bf16 a[72:75], a[208:211], v[100:103], a[72:75]
  s_lshl_b32 s38, s56, 13
  s_lshl_b32 s48, s58, 7
  s_add_u32 s38, s38, s48
  s_lshl_b32 s48, s35, 8
  s_add_u32 s38, s38, s48
  s_mov_b32 s100, 0x4e800000
  v_cmp_nle_f32 vcc, v213, s100
  v_rcp_f32 v228, v204
  v_rcp_f32 v229, v204
  s_cmp_lg_u64 vcc, 0
  s_cselect_b32 s100, 1, 0
  s_andn2_b32 s100, s100, s64
  s_or_b32 s101, s59, s3
  s_cselect_b32 s101, 0, 2
  s_or_b32 s100, s100, s101
  v_mfma_f32_16x16x32_bf16 a[76:79], a[208:211], v[116:119], a[76:79]
  s_add_u32 s38, s38, 128
  s_bfe_u32 s56, s47, 0x10002
  s_sub_u32 s56, s56, 1
  s_cmp_eq_u32 s35, 0
  s_cselect_b32 s8, s96, s98
  s_cselect_b32 s9, s97, s99
  s_mov_b32 s10, 0x400000
  s_mov_b32 s47, 0x40000
  s_mov_b32 s57, 20971520
  s_cselect_b32 s10, s10, 0x3c0000
  s_cselect_b32 s47, s47, 0x38000
  s_cselect_b32 s57, s57, 4194304
  v_mov_b32 v214, s100
  s_lshl_b32 s101, s3, 2
  v_mov_b32 v215, s101
  ds_write_b32 v215, v214
  s_waitcnt lgkmcnt(5)
  v_mfma_f32_16x16x32_bf16 a[80:83], a[212:215], v[68:71], a[80:83]
  ds_read_b64_tr_b16 a[208:209], v152 offset:8192
  ds_read_b64_tr_b16 a[210:211], v152 offset:12288
  v_mfma_f32_16x16x32_bf16 a[84:87], a[212:215], v[84:87], a[84:87]
  s_mul_i32 s37, s10, s39
  s_lshl_b32 s36, s40, 8
  s_add_u32 s48, s37, s36
  s_add_u32 s8, s8, s48
  s_addc_u32 s9, s9, 0
  s_waitcnt lgkmcnt(2)
  s_barrier
  v_mov_b32 v215, 0
  ds_read_b128 v[216:219], v215
  v_mfma_f32_16x16x32_bf16 a[88:91], a[212:215], v[100:103], a[88:91]
  s_and_b32 s58, s35, s39
  s_lshl_b32 s48, s58, 19
  s_add_u32 s36, s36, s48
  s_sub_u32 s10, s10, s36
  s_mov_b32 s11, 0x20000
  v_rcp_f32 v230, v205
  v_mfma_f32_16x16x32_bf16 a[92:95], a[212:215], v[116:119], a[92:95]
  s_mul_i32 s48, s41, s47
  s_add_u32 s48, s48, s57
  s_lshr_b32 s36, s37, 5
  s_lshl_b32 s14, s47, 1
  s_sub_u32 s14, s14, s36
  s_add_u32 s48, s48, s36
  v_rcp_f32 v231, v205
  v_mfma_f32_16x16x32_bf16 a[96:99], a[216:219], v[68:71], a[96:99]
  s_add_u32 s12, s60, s48
  s_addc_u32 s13, s61, 0
  s_mov_b32 s15, 0x20000
  s_mul_i32 s36, s47, s39
  s_sub_u32 s37, s47, s36
  ds_read_b64_tr_b16 a[212:213], v153 offset:8192
  ds_read_b64_tr_b16 a[214:215], v153 offset:12288
  v_rcp_f32 v240, v206
  v_mfma_f32_16x16x32_bf16 a[100:103], a[216:219], v[84:87], a[100:103]
  s_add_u32 s41, s41, s39
  s_lshr_b32 s48, s46, 4
  s_xor_b32 s48, s48, s46
  s_or_b32 s49, s34, 4
  s_and_b32 s49, s49, 7
  s_mul_i32 s49, s49, 0x11
  v_rcp_f32 v241, v206
  v_mfma_f32_16x16x32_bf16 a[104:107], a[216:219], v[100:103], a[104:107]
  s_and_b32 s48, s48, 3
  s_xor_b32 s49, s49, s48
  s_and_b32 s48, s46, 0xff00
  s_or_b32 s49, s49, s48
  s_and_b32 s48, s46, 0x4444
  v_rcp_f32 v242, v207
  v_mfma_f32_16x16x32_bf16 a[108:111], a[216:219], v[116:119], a[108:111]
  s_lshl_b32 s47, s35, 16
  s_or_b32 s48, s48, s47
  s_cmp_eq_u32 s48, 17476
  s_cselect_b32 s46, s49, 0x7654
  s_cselect_b32 s49, -1, 0
  v_bfe_u32 v238, s46, v237, 2
  s_mul_i32 s57, s58, 393216
  s_sub_u32 s57, 3407872, s57
  s_sub_u32 s58, 6, s58
  s_lshl_b32 s48, s35, 4
  v_and_b32 v209, s48, v166
  s_mov_b32 s39, 0
  v_lshl_add_u32 v238, v238, 2, s38
  v_lshl_add_u32 v238, v209, 3, v238
  s_and_b32 s38, s32, 15
  s_lshl1_add_u32 s38, s38, 1
  s_lshl_b32 s38, s38, 17
  s_and_b32 s38, s38, s49
  s_or_b32 s95, s95, s56
  s_xor_b32 s48, s35, 1
  s_or_b32 s95, s95, s48
  s_cselect_b32 s95, 99, 0
  v_rcp_f32 v243, v207
  v_mfma_f32_16x16x32_bf16 a[112:115], a[220:223], v[68:71], a[112:115]
  ds_read_b64_tr_b16 a[216:217], v154 offset:8192
  ds_read_b64_tr_b16 a[218:219], v154 offset:12288
  v_mfma_f32_16x16x32_bf16 a[116:119], a[220:223], v[84:87], a[116:119]
  s_waitcnt lgkmcnt(4)
  v_or_b32 v216, v216, v217
  v_or_b32 v218, v218, v219
  v_mfma_f32_16x16x32_bf16 a[120:123], a[220:223], v[100:103], a[120:123]
  v_or_b32 v216, v216, v218
  v_mfma_f32_16x16x32_bf16 a[124:127], a[220:223], v[116:119], a[124:127]
  s_add_u32 s95, s95, s49
  s_cmp_lg_u32 s95, 0
  s_cbranch_scc1 L3_npf
  buffer_load_dwordx4 v[128:131], v166, s[12:15], s36 offen offset:0 sc1
  buffer_load_dwordx4 v[132:135], v166, s[12:15], s36 offen offset:1024 sc1
  buffer_load_dwordx4 v[136:139], v166, s[12:15], s36 offen offset:2048 sc1
  buffer_load_dwordx4 v[140:143], v166, s[12:15], s36 offen offset:3072 sc1
  s_add_u32 s36, s36, 4096
  buffer_load_dwordx4 a[240:243], v166, s[12:15], s37 offen offset:0 sc1
  buffer_load_dwordx4 a[244:247], v166, s[12:15], s37 offen offset:1024 sc1
  buffer_load_dwordx4 a[248:251], v166, s[12:15], s37 offen offset:2048 sc1
  buffer_load_dwordx4 a[252:255], v166, s[12:15], s37 offen offset:3072 sc1
  s_add_u32 s37, s37, 4096
L3_npf:
  v_readfirstlane_b32 s48, v216
  s_nop 1
  s_bitcmp1_b32 s48, 0
  s_cbranch_scc1 L_fallback
  s_lshr_b32 s48, s48, 1
  s_sub_u32 s48, 0, s48
  s_or_b32 s56, s56, s48
  s_lshl_b32 s50, s50, 18
  s_lshl_b32 s51, s51, 18
  s_lshl_b32 s48, s32, 13
  s_add_u32 s50, s50, s48
  s_add_u32 s51, s51, s48
  s_add_u32 s66, s50, 4096
  s_add_u32 s67, s51, 4096
  s_sub_u32 s48, s95, 98
  s_or_b32 s48, s48, s56
  s_cbranch_scc0 L3_oh
  v_mfma_f32_16x16x32_bf16 a[0:3], a[192:195], v[64:67], a[0:3]
  ds_read_b64_tr_b16 a[220:221], v155 offset:8192
  ds_read_b64_tr_b16 a[222:223], v155 offset:12288
  s_add_u32 m0, s45, 98304
  s_nop 0
  buffer_load_dwordx4 v224, s[8:11], s38 offen offset:0 lds
  v_mfma_f32_16x16x32_bf16 a[4:7], a[192:195], v[80:83], a[4:7]
  buffer_load_dwordx4 v225, s[8:11], s38 offen offset:1024 lds
  v_mfma_f32_16x16x32_bf16 a[8:11], a[192:195], v[96:99], a[8:11]
  buffer_load_dwordx4 v226, s[8:11], s38 offen offset:2048 lds
  v_mfma_f32_16x16x32_bf16 a[12:15], a[192:195], v[112:115], a[12:15]
  buffer_load_dwordx4 v227, s[8:11], s38 offen offset:3072 lds
  s_xor_b32 s38, s38, 0x20000
  v_mfma_f32_16x16x32_bf16 a[16:19], a[196:199], v[64:67], a[16:19]
  s_add_u32 m0, s45, 114688
  s_nop 0
  buffer_load_dwordx4 v224, s[8:11], s38 offen offset:0 lds
  v_mfma_f32_16x16x32_bf16 a[20:23], a[196:199], v[80:83], a[20:23]
  buffer_load_dwordx4 v225, s[8:11], s38 offen offset:1024 lds
  v_mfma_f32_16x16x32_bf16 a[24:27], a[196:199], v[96:99], a[24:27]
  buffer_load_dwordx4 v226, s[8:11], s38 offen offset:2048 lds
  v_mfma_f32_16x16x32_bf16 a[28:31], a[196:199], v[112:115], a[28:31]
  buffer_load_dwordx4 v227, s[8:11], s38 offen offset:3072 lds
  s_add_u32 s38, s38, 0x20000
  v_mfma_f32_16x16x32_bf16 a[32:35], a[200:203], v[64:67], a[32:35]
  v_mfma_f32_16x16x32_bf16 a[36:39], a[200:203], v[80:83], a[36:39]
  v_mfma_f32_16x16x32_bf16 a[40:43], a[200:203], v[96:99], a[40:43]
  v_mfma_f32_16x16x32_bf16 a[44:47], a[200:203], v[112:115], a[44:47]
  v_mfma_f32_16x16x32_bf16 a[48:51], a[204:207], v[64:67], a[48:51]
  v_mfma_f32_16x16x32_bf16 a[52:55], a[204:207], v[80:83], a[52:55]
  v_mfma_f32_16x16x32_bf16 a[56:59], a[204:207], v[96:99], a[56:59]
  v_mfma_f32_16x16x32_bf16 a[60:63], a[204:207], v[112:115], a[60:63]
  v_mfma_f32_16x16x32_bf16 a[0:3], a[208:211], v[68:71], a[0:3]
  v_mfma_f32_16x16x32_bf16 a[4:7], a[208:211], v[84:87], a[4:7]
  v_mfma_f32_16x16x32_bf16 a[8:11], a[208:211], v[100:103], a[8:11]
  v_mfma_f32_16x16x32_bf16 a[12:15], a[208:211], v[116:119], a[12:15]
  s_waitcnt lgkmcnt(4)
  v_mfma_f32_16x16x32_bf16 a[16:19], a[212:215], v[68:71], a[16:19]
  v_mfma_f32_16x16x32_bf16 a[20:23], a[212:215], v[84:87], a[20:23]
  v_mfma_f32_16x16x32_bf16 a[24:27], a[212:215], v[100:103], a[24:27]
  v_mfma_f32_16x16x32_bf16 a[28:31], a[212:215], v[116:119], a[28:31]
  s_waitcnt lgkmcnt(2)
  v_mfma_f32_16x16x32_bf16 a[32:35], a[216:219], v[68:71], a[32:35]
  v_mfma_f32_16x16x32_bf16 a[36:39], a[216:219], v[84:87], a[36:39]
  v_mfma_f32_16x16x32_bf16 a[40:43], a[216:219], v[100:103], a[40:43]
  v_mfma_f32_16x16x32_bf16 a[44:47], a[216:219], v[116:119], a[44:47]
  s_waitcnt lgkmcnt(0)
  v_mfma_f32_16x16x32_bf16 a[48:51], a[220:223], v[68:71], a[48:51]
  v_mfma_f32_16x16x32_bf16 a[52:55], a[220:223], v[84:87], a[52:55]
  v_mfma_f32_16x16x32_bf16 a[56:59], a[220:223], v[100:103], a[56:59]
  v_mfma_f32_16x16x32_bf16 a[60:63], a[220:223], v[116:119], a[60:63]
  s_cmp_eq_u32 s95, 0
  s_cbranch_scc1 L3_wv
  s_nop 4
  v_accvgpr_read_b32 v0, a0
  v_accvgpr_read_b32 v1, a1
  v_accvgpr_read_b32 v2, a2
  v_accvgpr_read_b32 v3, a3
  v_accvgpr_read_b32 v4, a16
  v_accvgpr_read_b32 v5, a17
  v_accvgpr_read_b32 v6, a18
  v_accvgpr_read_b32 v7, a19
  v_pk_mul_f32 v[0:1], v[0:1], v[228:229]
  v_pk_mul_f32 v[2:3], v[2:3], v[228:229]
  v_pk_mul_f32 v[4:5], v[4:5], v[228:229]
  v_pk_mul_f32 v[6:7], v[6:7], v[228:229]
  v_cvt_pk_bf16_f32 v0, v0, v1
  v_cvt_pk_bf16_f32 v1, v2, v3
  v_cvt_pk_bf16_f32 v2, v4, v5
  v_cvt_pk_bf16_f32 v3, v6, v7
  buffer_store_dwordx4 v[0:3], v166, s[28:31], s50 offen offset:0 sc1
  v_accvgpr_read_b32 v8, a32
  v_accvgpr_read_b32 v9, a33
  v_accvgpr_read_b32 v10, a34
  v_accvgpr_read_b32 v11, a35
  v_accvgpr_read_b32 v12, a48
  v_accvgpr_read_b32 v13, a49
  v_accvgpr_read_b32 v14, a50
  v_accvgpr_read_b32 v15, a51
  v_pk_mul_f32 v[8:9], v[8:9], v[228:229]
  v_pk_mul_f32 v[10:11], v[10:11], v[228:229]
  v_pk_mul_f32 v[12:13], v[12:13], v[228:229]
  v_pk_mul_f32 v[14:15], v[14:15], v[228:229]
  v_cvt_pk_bf16_f32 v8, v8, v9
  v_cvt_pk_bf16_f32 v9, v10, v11
  v_cvt_pk_bf16_f32 v10, v12, v13
  v_cvt_pk_bf16_f32 v11, v14, v15
  buffer_store_dwordx4 v[8:11], v166, s[28:31], s50 offen offset:2048 sc1
  v_accvgpr_read_b32 v16, a64
  v_accvgpr_read_b32 v17, a65
  v_accvgpr_read_b32 v18, a66
  v_accvgpr_read_b32 v19, a67
  v_accvgpr_read_b32 v20, a80
  v_accvgpr_read_b32 v21, a81
  v_accvgpr_read_b32 v22, a82
  v_accvgpr_read_b32 v23, a83
  v_pk_mul_f32 v[16:17], v[16:17], v[228:229]
  v_pk_mul_f32 v[18:19], v[18:19], v[228:229]
  v_pk_mul_f32 v[20:21], v[20:21], v[228:229]
  v_pk_mul_f32 v[22:23], v[22:23], v[228:229]
  v_cvt_pk_bf16_f32 v16, v16, v17
  v_cvt_pk_bf16_f32 v17, v18, v19
  v_cvt_pk_bf16_f32 v18, v20, v21
  v_cvt_pk_bf16_f32 v19, v22, v23
  buffer_store_dwordx4 v[16:19], v166, s[28:31], s66 offen offset:0 sc1
  v_accvgpr_read_b32 v24, a96
  v_accvgpr_read_b32 v25, a97
  v_accvgpr_read_b32 v26, a98
  v_accvgpr_read_b32 v27, a99
  v_accvgpr_read_b32 v28, a112
  v_accvgpr_read_b32 v29, a113
  v_accvgpr_read_b32 v30, a114
  v_accvgpr_read_b32 v31, a115
  v_pk_mul_f32 v[24:25], v[24:25], v[228:229]
  v_pk_mul_f32 v[26:27], v[26:27], v[228:229]
  v_pk_mul_f32 v[28:29], v[28:29], v[228:229]
  v_pk_mul_f32 v[30:31], v[30:31], v[228:229]
  v_cvt_pk_bf16_f32 v24, v24, v25
  v_cvt_pk_bf16_f32 v25, v26, v27
  v_cvt_pk_bf16_f32 v26, v28, v29
  v_cvt_pk_bf16_f32 v27, v30, v31
  buffer_store_dwordx4 v[24:27], v166, s[28:31], s66 offen offset:2048 sc1
  v_accvgpr_read_b32 v0, a4
  v_accvgpr_read_b32 v1, a5
  v_accvgpr_read_b32 v2, a6
  v_accvgpr_read_b32 v3, a7
  v_accvgpr_read_b32 v4, a20
  v_accvgpr_read_b32 v5, a21
  v_accvgpr_read_b32 v6, a22
  v_accvgpr_read_b32 v7, a23
  v_pk_mul_f32 v[0:1], v[0:1], v[230:231]
  v_pk_mul_f32 v[2:3], v[2:3], v[230:231]
  v_pk_mul_f32 v[4:5], v[4:5], v[230:231]
  v_pk_mul_f32 v[6:7], v[6:7], v[230:231]
  v_cvt_pk_bf16_f32 v0, v0, v1
  v_cvt_pk_bf16_f32 v1, v2, v3
  v_cvt_pk_bf16_f32 v2, v4, v5
  v_cvt_pk_bf16_f32 v3, v6, v7
  buffer_store_dwordx4 v[0:3], v166, s[28:31], s50 offen offset:1024 sc1
  v_accvgpr_read_b32 v8, a36
  v_accvgpr_read_b32 v9, a37
  v_accvgpr_read_b32 v10, a38
  v_accvgpr_read_b32 v11, a39
  v_accvgpr_read_b32 v12, a52
  v_accvgpr_read_b32 v13, a53
  v_accvgpr_read_b32 v14, a54
  v_accvgpr_read_b32 v15, a55
  v_pk_mul_f32 v[8:9], v[8:9], v[230:231]
  v_pk_mul_f32 v[10:11], v[10:11], v[230:231]
  v_pk_mul_f32 v[12:13], v[12:13], v[230:231]
  v_pk_mul_f32 v[14:15], v[14:15], v[230:231]
  v_cvt_pk_bf16_f32 v8, v8, v9
  v_cvt_pk_bf16_f32 v9, v10, v11
  v_cvt_pk_bf16_f32 v10, v12, v13
  v_cvt_pk_bf16_f32 v11, v14, v15
  buffer_store_dwordx4 v[8:11], v166, s[28:31], s50 offen offset:3072 sc1
  v_accvgpr_read_b32 v16, a68
  v_accvgpr_read_b32 v17, a69
  v_accvgpr_read_b32 v18, a70
  v_accvgpr_read_b32 v19, a71
  v_accvgpr_read_b32 v20, a84
  v_accvgpr_read_b32 v21, a85
  v_accvgpr_read_b32 v22, a86
  v_accvgpr_read_b32 v23, a87
  v_pk_mul_f32 v[16:17], v[16:17], v[230:231]
  v_pk_mul_f32 v[18:19], v[18:19], v[230:231]
  v_pk_mul_f32 v[20:21], v[20:21], v[230:231]
  v_pk_mul_f32 v[22:23], v[22:23], v[230:231]
  v_cvt_pk_bf16_f32 v16, v16, v17
  v_cvt_pk_bf16_f32 v17, v18, v19
  v_cvt_pk_bf16_f32 v18, v20, v21
  v_cvt_pk_bf16_f32 v19, v22, v23
  buffer_store_dwordx4 v[16:19], v166, s[28:31], s66 offen offset:1024 sc1
  v_accvgpr_read_b32 v24, a100
  v_accvgpr_read_b32 v25, a101
  v_accvgpr_read_b32 v26, a102
  v_accvgpr_read_b32 v27, a103
  v_accvgpr_read_b32 v28, a116
  v_accvgpr_read_b32 v29, a117
  v_accvgpr_read_b32 v30, a118
  v_accvgpr_read_b32 v31, a119
  v_pk_mul_f32 v[24:25], v[24:25], v[230:231]
  v_pk_mul_f32 v[26:27], v[26:27], v[230:231]
  v_pk_mul_f32 v[28:29], v[28:29], v[230:231]
  v_pk_mul_f32 v[30:31], v[30:31], v[230:231]
  v_cvt_pk_bf16_f32 v24, v24, v25
  v_cvt_pk_bf16_f32 v25, v26, v27
  v_cvt_pk_bf16_f32 v26, v28, v29
  v_cvt_pk_bf16_f32 v27, v30, v31
  buffer_store_dwordx4 v[24:27], v166, s[28:31], s66 offen offset:3072 sc1
  buffer_load_dword v245, v238, s[4:7], 0 offen sc0 sc1
  v_accvgpr_read_b32 v0, a8
  v_accvgpr_read_b32 v1, a9
  v_accvgpr_read_b32 v2, a10
  v_accvgpr_read_b32 v3, a11
  v_accvgpr_read_b32 v4, a24
  v_accvgpr_read_b32 v5, a25
  v_accvgpr_read_b32 v6, a26
  v_accvgpr_read_b32 v7, a27
  v_pk_mul_f32 v[0:1], v[0:1], v[240:241]
  v_pk_mul_f32 v[2:3], v[2:3], v[240:241]
  v_pk_mul_f32 v[4:5], v[4:5], v[240:241]
  v_pk_mul_f32 v[6:7], v[6:7], v[240:241]
  v_cvt_pk_bf16_f32 v0, v0, v1
  v_cvt_pk_bf16_f32 v1, v2, v3
  v_cvt_pk_bf16_f32 v2, v4, v5
  v_cvt_pk_bf16_f32 v3, v6, v7
  buffer_store_dwordx4 v[0:3], v166, s[28:31], s51 offen offset:0 sc1
  v_accvgpr_read_b32 v8, a40
  v_accvgpr_read_b32 v9, a41
  v_accvgpr_read_b32 v10, a42
  v_accvgpr_read_b32 v11, a43
  v_accvgpr_read_b32 v12, a56
  v_accvgpr_read_b32 v13, a57
  v_accvgpr_read_b32 v14, a58
  v_accvgpr_read_b32 v15, a59
  v_pk_mul_f32 v[8:9], v[8:9], v[240:241]
  v_pk_mul_f32 v[10:11], v[10:11], v[240:241]
  v_pk_mul_f32 v[12:13], v[12:13], v[240:241]
  v_pk_mul_f32 v[14:15], v[14:15], v[240:241]
  v_cvt_pk_bf16_f32 v8, v8, v9
  v_cvt_pk_bf16_f32 v9, v10, v11
  v_cvt_pk_bf16_f32 v10, v12, v13
  v_cvt_pk_bf16_f32 v11, v14, v15
  buffer_store_dwordx4 v[8:11], v166, s[28:31], s51 offen offset:2048 sc1
  v_accvgpr_read_b32 v16, a72
  v_accvgpr_read_b32 v17, a73
  v_accvgpr_read_b32 v18, a74
  v_accvgpr_read_b32 v19, a75
  v_accvgpr_read_b32 v20, a88
  v_accvgpr_read_b32 v21, a89
  v_accvgpr_read_b32 v22, a90
  v_accvgpr_read_b32 v23, a91
  v_pk_mul_f32 v[16:17], v[16:17], v[240:241]
  v_pk_mul_f32 v[18:19], v[18:19], v[240:241]
  v_pk_mul_f32 v[20:21], v[20:21], v[240:241]
  v_pk_mul_f32 v[22:23], v[22:23], v[240:241]
  v_cvt_pk_bf16_f32 v16, v16, v17
  v_cvt_pk_bf16_f32 v17, v18, v19
  v_cvt_pk_bf16_f32 v18, v20, v21
  v_cvt_pk_bf16_f32 v19, v22, v23
  buffer_store_dwordx4 v[16:19], v166, s[28:31], s67 offen offset:0 sc1
  v_accvgpr_read_b32 v24, a104
  v_accvgpr_read_b32 v25, a105
  v_accvgpr_read_b32 v26, a106
  v_accvgpr_read_b32 v27, a107
  v_accvgpr_read_b32 v28, a120
  v_accvgpr_read_b32 v29, a121
  v_accvgpr_read_b32 v30, a122
  v_accvgpr_read_b32 v31, a123
  v_pk_mul_f32 v[24:25], v[24:25], v[240:241]
  v_pk_mul_f32 v[26:27], v[26:27], v[240:241]
  v_pk_mul_f32 v[28:29], v[28:29], v[240:241]
  v_pk_mul_f32 v[30:31], v[30:31], v[240:241]
  v_cvt_pk_bf16_f32 v24, v24, v25
  v_cvt_pk_bf16_f32 v25, v26, v27
  v_cvt_pk_bf16_f32 v26, v28, v29
  v_cvt_pk_bf16_f32 v27, v30, v31
  buffer_store_dwordx4 v[24:27], v166, s[28:31], s67 offen offset:2048 sc1
  v_accvgpr_read_b32 v0, a12
  v_accvgpr_read_b32 v1, a13
  v_accvgpr_read_b32 v2, a14
  v_accvgpr_read_b32 v3, a15
  v_accvgpr_read_b32 v4, a28
  v_accvgpr_read_b32 v5, a29
  v_accvgpr_read_b32 v6, a30
  v_accvgpr_read_b32 v7, a31
  v_pk_mul_f32 v[0:1], v[0:1], v[242:243]
  v_pk_mul_f32 v[2:3], v[2:3], v[242:243]
  v_pk_mul_f32 v[4:5], v[4:5], v[242:243]
  v_pk_mul_f32 v[6:7], v[6:7], v[242:243]
  v_cvt_pk_bf16_f32 v0, v0, v1
  v_cvt_pk_bf16_f32 v1, v2, v3
  v_cvt_pk_bf16_f32 v2, v4, v5
  v_cvt_pk_bf16_f32 v3, v6, v7
  buffer_store_dwordx4 v[0:3], v166, s[28:31], s51 offen offset:1024 sc1
  v_accvgpr_read_b32 v8, a44
  v_accvgpr_read_b32 v9, a45
  v_accvgpr_read_b32 v10, a46
  v_accvgpr_read_b32 v11, a47
  v_accvgpr_read_b32 v12, a60
  v_accvgpr_read_b32 v13, a61
  v_accvgpr_read_b32 v14, a62
  v_accvgpr_read_b32 v15, a63
  v_pk_mul_f32 v[8:9], v[8:9], v[242:243]
  v_pk_mul_f32 v[10:11], v[10:11], v[242:243]
  v_pk_mul_f32 v[12:13], v[12:13], v[242:243]
  v_pk_mul_f32 v[14:15], v[14:15], v[242:243]
  v_cvt_pk_bf16_f32 v8, v8, v9
  v_cvt_pk_bf16_f32 v9, v10, v11
  v_cvt_pk_bf16_f32 v10, v12, v13
  v_cvt_pk_bf16_f32 v11, v14, v15
  buffer_store_dwordx4 v[8:11], v166, s[28:31], s51 offen offset:3072 sc1
  v_accvgpr_read_b32 v16, a76
  v_accvgpr_read_b32 v17, a77
  v_accvgpr_read_b32 v18, a78
  v_accvgpr_read_b32 v19, a79
  v_accvgpr_read_b32 v20, a92
  v_accvgpr_read_b32 v21, a93
  v_accvgpr_read_b32 v22, a94
  v_accvgpr_read_b32 v23, a95
  v_pk_mul_f32 v[16:17], v[16:17], v[242:243]
  v_pk_mul_f32 v[18:19], v[18:19], v[242:243]
  v_pk_mul_f32 v[20:21], v[20:21], v[242:243]
  v_pk_mul_f32 v[22:23], v[22:23], v[242:243]
  v_cvt_pk_bf16_f32 v16, v16, v17
  v_cvt_pk_bf16_f32 v17, v18, v19
  v_cvt_pk_bf16_f32 v18, v20, v21
  v_cvt_pk_bf16_f32 v19, v22, v23
  buffer_store_dwordx4 v[16:19], v166, s[28:31], s67 offen offset:1024 sc1
  v_accvgpr_read_b32 v24, a108
  v_accvgpr_read_b32 v25, a109
  v_accvgpr_read_b32 v26, a110
  v_accvgpr_read_b32 v27, a111
  v_accvgpr_read_b32 v28, a124
  v_accvgpr_read_b32 v29, a125
  v_accvgpr_read_b32 v30, a126
  v_accvgpr_read_b32 v31, a127
  v_pk_mul_f32 v[24:25], v[24:25], v[242:243]
  v_pk_mul_f32 v[26:27], v[26:27], v[242:243]
  v_pk_mul_f32 v[28:29], v[28:29], v[242:243]
  v_pk_mul_f32 v[30:31], v[30:31], v[242:243]
  v_cvt_pk_bf16_f32 v24, v24, v25
  v_cvt_pk_bf16_f32 v25, v26, v27
  v_cvt_pk_bf16_f32 v26, v28, v29
  v_cvt_pk_bf16_f32 v27, v30, v31
  buffer_store_dwordx4 v[24:27], v166, s[28:31], s67 offen offset:3072 sc1
L3_setup:
  v_and_b32 v172, 0x3c0, v166
  v_and_b32 v173, 0xf0, v166
  v_lshl_add_u32 v172, v172, 2, v173
  v_add_u32 v176, 32768, v172
  v_add_u32 v172, 98304, v172
  v_xor_b32 v173, 64, v172
  v_xor_b32 v174, 128, v172
  v_xor_b32 v175, 192, v172
  v_xor_b32 v177, 64, v176
  v_xor_b32 v178, 128, v176
  v_xor_b32 v179, 192, v176
  v_lshrrev_b32 v164, 2, v166
  s_mov_b32 s47, 0xff
  s_mov_b32 s95, 0
  s_cmp_eq_u32 s59, 2
  s_cbranch_scc1 L3_e1
  s_waitcnt vmcnt(8)
  v_cmp_gt_u32 vcc, 4, v245
  s_nop 1
  s_or_b32 s95, vcc_lo, s56
  s_and_b32 s48, s95, s47
  s_cbranch_scc1 L3_l1
L3_e1:
  buffer_load_dwordx4 a[0:3], v166, s[12:15], s36 offen offset:0 sc1
  buffer_load_dwordx4 a[4:7], v166, s[12:15], s36 offen offset:1024 sc1
  buffer_load_dwordx4 a[8:11], v166, s[12:15], s36 offen offset:2048 sc1
  buffer_load_dwordx4 a[12:15], v166, s[12:15], s36 offen offset:3072 sc1
  s_add_u32 s36, s36, 4096
  buffer_load_dwordx4 a[16:19], v166, s[12:15], s37 offen offset:0 sc1
  buffer_load_dwordx4 a[20:23], v166, s[12:15], s37 offen offset:1024 sc1
  buffer_load_dwordx4 a[24:27], v166, s[12:15], s37 offen offset:2048 sc1
  buffer_load_dwordx4 a[28:31], v166, s[12:15], s37 offen offset:3072 sc1
  s_add_u32 s37, s37, 4096
  buffer_load_dwordx4 a[48:51], v166, s[12:15], s37 offen offset:0 sc1
  buffer_load_dwordx4 a[52:55], v166, s[12:15], s37 offen offset:1024 sc1
  buffer_load_dwordx4 a[56:59], v166, s[12:15], s37 offen offset:2048 sc1
  buffer_load_dwordx4 a[60:63], v166, s[12:15], s37 offen offset:3072 sc1
  s_add_u32 s37, s37, 4096
  buffer_load_dwordx4 a[32:35], v166, s[12:15], s36 offen offset:0 sc1
  buffer_load_dwordx4 a[36:39], v166, s[12:15], s36 offen offset:1024 sc1
  buffer_load_dwordx4 a[40:43], v166, s[12:15], s36 offen offset:2048 sc1
  buffer_load_dwordx4 a[44:47], v166, s[12:15], s36 offen offset:3072 sc1
  s_add_u32 s36, s36, 4096
  buffer_load_dwordx4 a[80:83], v166, s[12:15], s37 offen offset:0 sc1
  buffer_load_dwordx4 a[84:87], v166, s[12:15], s37 offen offset:1024 sc1
  buffer_load_dwordx4 a[88:91], v166, s[12:15], s37 offen offset:2048 sc1
  buffer_load_dwordx4 a[92:95], v166, s[12:15], s37 offen offset:3072 sc1
  s_add_u32 s37, s37, 4096
  s_add_u32 m0, s45, 131072
  s_nop 0
  buffer_load_dwordx4 v224, s[8:11], s38 offen offset:0 lds
  buffer_load_dwordx4 v225, s[8:11], s38 offen offset:1024 lds
  buffer_load_dwordx4 v226, s[8:11], s38 offen offset:2048 lds
  buffer_load_dwordx4 v227, s[8:11], s38 offen offset:3072 lds
  s_add_u32 s38, s38, 0x20000
  s_lshl_b32 s62, s41, 9
  s_add_u32 s62, s62, 98304
  v_and_b32 v185, 0xf0, v166
  buffer_load_dwordx2 v[220:221], v185, s[4:7], s62 offen offset:0 sc1
  buffer_load_dwordx2 v[222:223], v185, s[4:7], s62 offen offset:256 sc1
  v_lshlrev_b32 v184, 3, v166
  buffer_load_dword v248, v184, s[12:15], s36 offen sc1
L3_l1:
  v_bfe_u32 v183, v166, 4, 4
  v_lshrrev_b32 v182, 8, v166
  v_lshlrev_b32 v180, 11, v183
  s_mov_b32 s46, 32768
  v_lshl_add_u32 v180, v182, 4, v180
  s_lshl_b32 s48, s41, 16
  s_lshl_b32 s63, s40, 8
  s_add_u32 s48, s48, s63
  s_add_u32 s24, s52, s48
  s_addc_u32 s25, s53, 0
  s_mov_b32 s26, 65536
  s_mov_b32 s27, 0x20000
  s_sub_u32 s26, s26, s63
  buffer_load_dwordx4 v[188:191], v180, s[24:27], 0 offen offset:0
  buffer_load_dwordx4 v[192:195], v180, s[24:27], s46 offen offset:0
  buffer_load_dwordx4 v[196:199], v180, s[24:27], 0 offen offset:64
  buffer_load_dwordx4 v[200:203], v180, s[24:27], s46 offen offset:64
  buffer_load_dwordx4 v[204:207], v180, s[24:27], 0 offen offset:128
  buffer_load_dwordx4 v[208:211], v180, s[24:27], s46 offen offset:128
  buffer_load_dwordx4 v[212:215], v180, s[24:27], 0 offen offset:192
  buffer_load_dwordx4 v[216:219], v180, s[24:27], s46 offen offset:192
  v_mov_b32 v181, 0
  s_mov_b32 s42, 4096
  s_mov_b32 s43, 8192
  s_mov_b32 s44, 12288
  s_lshl_b32 s62, s41, 3
  s_add_u32 s62, s62, s40
  s_lshl_b32 s48, s62, 14
  s_lshl_b32 s63, s35, 23
  s_add_u32 s48, s48, s63
  s_add_u32 s48, s48, 67108864
  s_add_u32 s20, s60, s48
  s_addc_u32 s21, s61, 0
  s_mov_b32 s22, 16384
  s_mov_b32 s23, 0x20000
  s_lshl_b32 s48, s62, 13
  s_cmp_eq_u32 s35, 0
  s_mov_b32 s63, 41943040
  s_mov_b32 s50, 37748736
  s_cselect_b32 s63, s63, 37748736
  s_cselect_b32 s50, s50, 41943040
  s_add_u32 s63, s63, s48
  s_add_u32 s50, s50, s48
  s_add_u32 s68, s60, s63
  s_addc_u32 s69, s61, 0
  s_mov_b32 s70, 8192
  s_mov_b32 s71, 0x20000
  s_add_u32 s64, s60, s50
  s_addc_u32 s65, s61, 0
  s_mov_b32 s66, 8192
  s_mov_b32 s67, 0x20000
  s_lshl_b32 s48, s41, 16
  s_lshl_b32 s63, s40, 8
  s_add_u32 s48, s48, s63
  s_add_u32 s28, s54, s48
  s_addc_u32 s29, s55, 0
  s_mov_b32 s30, 65536
  s_mov_b32 s31, 0x20000
  s_sub_u32 s30, s30, s63
  s_lshr_b32 s50, s62, 6
  s_lshl_b32 s50, s50, 13
  s_and_b32 s48, s62, 63
  s_lshl_b32 s48, s48, 6
  s_add_u32 s50, s50, s48
  s_add_u32 s50, s50, 4096
  s_xor_b32 s48, s62, 8
  s_lshl_b32 s48, s48, 14
  s_lshl_b32 s63, s35, 23
  s_add_u32 s48, s48, s63
  s_add_u32 s48, s48, 67108864
  s_add_u32 s16, s60, s48
  s_addc_u32 s17, s61, 0
  s_mov_b32 s18, 16384
  s_mov_b32 s19, 0x20000
  s_xor_b32 s51, s50, 512
  s_lshl_b32 s48, s35, 2
  s_add_u32 s51, s51, s48
  v_mov_b32 v244, 1
  v_mov_b32 v32, 0
  v_mov_b32 v33, 0
  v_mov_b32 v34, 0
  v_mov_b32 v35, 0
  v_mov_b32 v36, 0
  v_mov_b32 v37, 0
  v_mov_b32 v38, 0
  v_mov_b32 v39, 0
  v_mov_b32 v40, 0
  v_mov_b32 v41, 0
  v_mov_b32 v42, 0
  v_mov_b32 v43, 0
  v_mov_b32 v44, 0
  v_mov_b32 v45, 0
  v_mov_b32 v46, 0
  v_mov_b32 v47, 0
  v_mov_b32 v48, 0
  v_mov_b32 v49, 0
  v_mov_b32 v50, 0
  v_mov_b32 v51, 0
  v_mov_b32 v52, 0
  v_mov_b32 v53, 0
  v_mov_b32 v54, 0
  v_mov_b32 v55, 0
  v_mov_b32 v56, 0
  v_mov_b32 v57, 0
  v_mov_b32 v58, 0
  v_mov_b32 v59, 0
  v_mov_b32 v60, 0
  v_mov_b32 v61, 0
  v_mov_b32 v62, 0
  v_mov_b32 v63, 0
  v_mov_b32 v64, 0
  v_mov_b32 v65, 0
  v_mov_b32 v66, 0
  v_mov_b32 v67, 0
  v_mov_b32 v68, 0
  v_mov_b32 v69, 0
  v_mov_b32 v70, 0
  v_mov_b32 v71, 0
  v_mov_b32 v72, 0
  v_mov_b32 v73, 0
  v_mov_b32 v74, 0
  v_mov_b32 v75, 0
  v_mov_b32 v76, 0
  v_mov_b32 v77, 0
  v_mov_b32 v78, 0
  v_mov_b32 v79, 0
  v_mov_b32 v80, 0
  v_mov_b32 v81, 0
  v_mov_b32 v82, 0
  v_mov_b32 v83, 0
  v_mov_b32 v84, 0
  v_mov_b32 v85, 0
  v_mov_b32 v86, 0
  v_mov_b32 v87, 0
  v_mov_b32 v88, 0
  v_mov_b32 v89, 0
  v_mov_b32 v90, 0
  v_mov_b32 v91, 0
  v_mov_b32 v92, 0
  v_mov_b32 v93, 0
  v_mov_b32 v94, 0
  v_mov_b32 v95, 0
  v_mov_b32 v96, 0
  v_mov_b32 v97, 0
  v_mov_b32 v98, 0
  v_mov_b32 v99, 0
  v_mov_b32 v100, 0
  v_mov_b32 v101, 0
  v_mov_b32 v102, 0
  v_mov_b32 v103, 0
  v_mov_b32 v104, 0
  v_mov_b32 v105, 0
  v_mov_b32 v106, 0
  v_mov_b32 v107, 0
  v_mov_b32 v108, 0
  v_mov_b32 v109, 0
  v_mov_b32 v110, 0
  v_mov_b32 v111, 0
  v_mov_b32 v112, 0
  v_mov_b32 v113, 0
  v_mov_b32 v114, 0
  v_mov_b32 v115, 0
  v_mov_b32 v116, 0
  v_mov_b32 v117, 0
  v_mov_b32 v118, 0
  v_mov_b32 v119, 0
  v_mov_b32 v120, 0
  v_mov_b32 v121, 0
  v_mov_b32 v122, 0
  v_mov_b32 v123, 0
  v_mov_b32 v124, 0
  v_mov_b32 v125, 0
  v_mov_b32 v126, 0
  v_mov_b32 v127, 0
  v_mov_b32 v0, 0
  v_mov_b32 v1, 0
  v_mov_b32 v2, 0
  v_mov_b32 v3, 0
  v_mov_b32 v4, 0
  v_mov_b32 v5, 0
  v_mov_b32 v6, 0
  v_mov_b32 v7, 0
  v_mov_b32 v8, 0
  v_mov_b32 v9, 0
  v_mov_b32 v10, 0
  v_mov_b32 v11, 0
  v_mov_b32 v12, 0
  v_mov_b32 v13, 0
  v_mov_b32 v14, 0
  v_mov_b32 v15, 0
  v_mov_b32 v16, 0
  v_mov_b32 v17, 0
  v_mov_b32 v18, 0
  v_mov_b32 v19, 0
  v_mov_b32 v20, 0
  v_mov_b32 v21, 0
  v_mov_b32 v22, 0
  v_mov_b32 v23, 0
  v_mov_b32 v24, 0
  v_mov_b32 v25, 0
  v_mov_b32 v26, 0
  v_mov_b32 v27, 0
  v_mov_b32 v28, 0
  v_mov_b32 v29, 0
  v_mov_b32 v30, 0
  v_mov_b32 v31, 0
  s_waitcnt vmcnt(35)
  s_and_b32 s48, s95, s47
  s_cbranch_scc0 L3_l2
  s_waitcnt vmcnt(8)
L3_l2:
  s_barrier
  s_lshr_b32 s48, s59, 1
  s_or_b32 s48, s48, s3
  s_cbranch_scc1 L3_s2
  s_lshl_b32 s48, s33, 13
  s_and_b32 s63, s32, 16
  s_lshl_b32 s63, s63, 3
  s_add_u32 s48, s48, s63
  s_and_b32 s63, s32, 12
  s_add_u32 s48, s48, s63
  s_mov_b64 exec, 1
  s_cmp_eq_u32 s59, 0
  s_cbranch_scc1 L3_noco
  buffer_atomic_add v233, v232, s[4:7], s48 offen offset:128 sc1
L3_noco:
  buffer_atomic_add v235, v232, s[72:75], 0 offen offset:32 sc0 sc1
  s_mov_b64 exec, -1
L3_s2:
  s_and_b32 s48, s95, s47
  s_cbranch_scc0 L3_sh
  s_cmp_lg_u32 s56, 0
  s_cbranch_scc1 L3_sh
  s_mov_b32 s49, 1024
L3_poll:
  buffer_load_dword v245, v238, s[4:7], 0 offen sc0 sc1
  s_sub_u32 s49, s49, 1
  s_waitcnt vmcnt(0)
  v_cmp_gt_u32 vcc, 4, v245
  s_nop 1
  s_and_b32 s48, vcc_lo, s47
  s_cbranch_scc0 L3_polled
  s_cmp_lg_u32 s49, 0
  s_cbranch_scc1 L3_poll
L3_polled:
  s_mov_b32 s95, vcc_lo
  s_and_b32 s48, s95, s47
  s_cbranch_scc1 L3_sh
  buffer_load_dwordx4 a[0:3], v166, s[12:15], s36 offen offset:0 sc1
  buffer_load_dwordx4 a[4:7], v166, s[12:15], s36 offen offset:1024 sc1
  buffer_load_dwordx4 a[8:11], v166, s[12:15], s36 offen offset:2048 sc1
  buffer_load_dwordx4 a[12:15], v166, s[12:15], s36 offen offset:3072 sc1
  s_add_u32 s36, s36, 4096
  buffer_load_dwordx4 a[16:19], v166, s[12:15], s37 offen offset:0 sc1
  buffer_load_dwordx4 a[20:23], v166, s[12:15], s37 offen offset:1024 sc1
  buffer_load_dwordx4 a[24:27], v166, s[12:15], s37 offen offset:2048 sc1
  buffer_load_dwordx4 a[28:31], v166, s[12:15], s37 offen offset:3072 sc1
  s_add_u32 s37, s37, 4096
  buffer_load_dwordx4 a[48:51], v166, s[12:15], s37 offen offset:0 sc1
  buffer_load_dwordx4 a[52:55], v166, s[12:15], s37 offen offset:1024 sc1
  buffer_load_dwordx4 a[56:59], v166, s[12:15], s37 offen offset:2048 sc1
  buffer_load_dwordx4 a[60:63], v166, s[12:15], s37 offen offset:3072 sc1
  s_add_u32 s37, s37, 4096
  buffer_load_dwordx4 a[32:35], v166, s[12:15], s36 offen offset:0 sc1
  buffer_load_dwordx4 a[36:39], v166, s[12:15], s36 offen offset:1024 sc1
  buffer_load_dwordx4 a[40:43], v166, s[12:15], s36 offen offset:2048 sc1
  buffer_load_dwordx4 a[44:47], v166, s[12:15], s36 offen offset:3072 sc1
  s_add_u32 s36, s36, 4096
  buffer_load_dwordx4 a[80:83], v166, s[12:15], s37 offen offset:0 sc1
  buffer_load_dwordx4 a[84:87], v166, s[12:15], s37 offen offset:1024 sc1
  buffer_load_dwordx4 a[88:91], v166, s[12:15], s37 offen offset:2048 sc1
  buffer_load_dwordx4 a[92:95], v166, s[12:15], s37 offen offset:3072 sc1
  s_add_u32 s37, s37, 4096
  s_add_u32 m0, s45, 131072
  s_nop 0
  buffer_load_dwordx4 v224, s[8:11], s38 offen offset:0 lds
  buffer_load_dwordx4 v225, s[8:11], s38 offen offset:1024 lds
  buffer_load_dwordx4 v226, s[8:11], s38 offen offset:2048 lds
  buffer_load_dwordx4 v227, s[8:11], s38 offen offset:3072 lds
  s_add_u32 s38, s38, 0x20000
  s_lshl_b32 s62, s41, 9
  s_add_u32 s62, s62, 98304
  v_and_b32 v185, 0xf0, v166
  buffer_load_dwordx2 v[220:221], v185, s[4:7], s62 offen offset:0 sc1
  buffer_load_dwordx2 v[222:223], v185, s[4:7], s62 offen offset:256 sc1
  v_lshlrev_b32 v184, 3, v166
  buffer_load_dword v248, v184, s[12:15], s36 offen sc1
L3_sh:
  s_mov_b32 s59, 2
  s_lshl_b32 s48, s3, 2
  v_mov_b32 v182, s95
  v_mov_b32 v183, s48
  ds_write_b32 v183, v182 offset:64
  s_waitcnt lgkmcnt(0)
  s_barrier
  ds_read_b128 v[182:185], v181 offset:64
  s_waitcnt lgkmcnt(0)
  v_or_b32 v182, v182, v183
  v_or3_b32 v182, v182, v184, v185
  s_nop 0
  v_readfirstlane_b32 s95, v182
  s_nop 1
  s_and_b32 s95, s95, s47
  s_cbranch_scc1 L3_giveup
  ds_read_b64_tr_b16 a[128:129], v172 offset:0
  ds_read_b64_tr_b16 a[130:131], v172 offset:4096
  ds_read_b64_tr_b16 a[132:133], v172 offset:8192
  ds_read_b64_tr_b16 a[134:135], v172 offset:12288
  ds_read_b64_tr_b16 a[136:137], v172 offset:8
  ds_read_b64_tr_b16 a[138:139], v172 offset:4104
  ds_read_b64_tr_b16 a[140:141], v172 offset:8200
  ds_read_b64_tr_b16 a[142:143], v172 offset:12296
  ds_read_b64_tr_b16 a[144:145], v173 offset:0
  ds_read_b64_tr_b16 a[146:147], v173 offset:4096
  ds_read_b64_tr_b16 a[148:149], v173 offset:8192
  ds_read_b64_tr_b16 a[150:151], v173 offset:12288
  s_waitcnt lgkmcnt(8)
  s_waitcnt vmcnt(19)
L3_loop:
  v_mfma_f32_16x16x32_bf16 v[0:3], a[128:131], a[0:3], v[0:3]
  v_mfma_f32_16x16x32_bf16 v[0:3], a[132:135], a[8:11], v[0:3]
  buffer_load_dwordx4 a[64:67], v166, s[12:15], s36 offen offset:0 sc1
  v_mfma_f32_16x16x32_bf16 v[8:11], a[128:131], a[4:7], v[8:11]
  s_lshl_b32 s56, s58, 14
  ds_read_b64_tr_b16 a[152:153], v173 offset:8
  v_mfma_f32_16x16x32_bf16 v[8:11], a[132:135], a[12:15], v[8:11]
  s_sub_u32 s56, 98304, s56
  ds_read_b64_tr_b16 a[154:155], v173 offset:4104
  v_mfma_f32_16x16x32_bf16 v[64:67], a[128:131], a[16:19], v[64:67]
  s_max_u32 s56, s56, 0x4000
  v_mfma_f32_16x16x32_bf16 v[64:67], a[132:135], a[24:27], v[64:67]
  buffer_load_dwordx4 a[68:71], v166, s[12:15], s36 offen offset:1024 sc1
  v_mfma_f32_16x16x32_bf16 v[72:75], a[128:131], a[20:23], v[72:75]
  ds_read_b64_tr_b16 a[156:157], v173 offset:8200
  v_mfma_f32_16x16x32_bf16 v[72:75], a[132:135], a[28:31], v[72:75]
  s_waitcnt lgkmcnt(7)
  v_mfma_f32_16x16x32_bf16 v[4:7], a[136:139], a[0:3], v[4:7]
  ds_read_b64_tr_b16 a[158:159], v173 offset:12296
  v_mfma_f32_16x16x32_bf16 v[4:7], a[140:143], a[8:11], v[4:7]
  buffer_load_dwordx4 a[72:75], v166, s[12:15], s36 offen offset:2048 sc1
  v_mfma_f32_16x16x32_bf16 v[12:15], a[136:139], a[4:7], v[12:15]
  ds_read_b64_tr_b16 a[160:161], v174 offset:0
  v_mfma_f32_16x16x32_bf16 v[12:15], a[140:143], a[12:15], v[12:15]
  ds_read_b64_tr_b16 a[162:163], v174 offset:4096
  v_mfma_f32_16x16x32_bf16 v[68:71], a[136:139], a[16:19], v[68:71]
  ds_read_b64_tr_b16 a[164:165], v174 offset:8192
  ds_read_b64_tr_b16 a[166:167], v174 offset:12288
  v_mfma_f32_16x16x32_bf16 v[68:71], a[140:143], a[24:27], v[68:71]
  v_mfma_f32_16x16x32_bf16 v[76:79], a[136:139], a[20:23], v[76:79]
  buffer_load_dwordx4 a[76:79], v166, s[12:15], s36 offen offset:3072 sc1
  v_mfma_f32_16x16x32_bf16 v[76:79], a[140:143], a[28:31], v[76:79]
  s_add_u32 s36, s36, 4096
  s_waitcnt lgkmcnt(8)
  v_mfma_f32_16x16x32_bf16 v[16:19], a[144:147], a[0:3], v[16:19]
  v_mfma_f32_16x16x32_bf16 v[16:19], a[148:151], a[8:11], v[16:19]
  s_add_u32 m0, s45, s56
  ds_read_b64_tr_b16 a[168:169], v174 offset:8
  v_mfma_f32_16x16x32_bf16 v[24:27], a[144:147], a[4:7], v[24:27]
  buffer_load_dwordx4 v224, s[8:11], s57 offen offset:0 lds
  v_mfma_f32_16x16x32_bf16 v[24:27], a[148:151], a[12:15], v[24:27]
  ds_read_b64_tr_b16 a[170:171], v174 offset:4104
  v_mfma_f32_16x16x32_bf16 v[80:83], a[144:147], a[16:19], v[80:83]
  ds_read_b64_tr_b16 a[172:173], v174 offset:8200
  ds_read_b64_tr_b16 a[174:175], v174 offset:12296
  v_mfma_f32_16x16x32_bf16 v[80:83], a[148:151], a[24:27], v[80:83]
  v_mfma_f32_16x16x32_bf16 v[88:91], a[144:147], a[20:23], v[88:91]
  v_mfma_f32_16x16x32_bf16 v[88:91], a[148:151], a[28:31], v[88:91]
  s_waitcnt lgkmcnt(8)
  v_mfma_f32_16x16x32_bf16 v[20:23], a[152:155], a[0:3], v[20:23]
  buffer_load_dwordx4 a[112:115], v166, s[12:15], s37 offen offset:0 sc1
  v_mfma_f32_16x16x32_bf16 v[20:23], a[156:159], a[8:11], v[20:23]
  v_mfma_f32_16x16x32_bf16 v[28:31], a[152:155], a[4:7], v[28:31]
  ds_read_b64_tr_b16 a[176:177], v175 offset:0
  ds_read_b64_tr_b16 a[178:179], v175 offset:4096
  v_mfma_f32_16x16x32_bf16 v[28:31], a[156:159], a[12:15], v[28:31]
  buffer_load_dwordx4 a[116:119], v166, s[12:15], s37 offen offset:1024 sc1
  v_mfma_f32_16x16x32_bf16 v[84:87], a[152:155], a[16:19], v[84:87]
  ds_read_b64_tr_b16 a[180:181], v175 offset:8192
  ds_read_b64_tr_b16 a[182:183], v175 offset:12288
  v_mfma_f32_16x16x32_bf16 v[84:87], a[156:159], a[24:27], v[84:87]
  v_mfma_f32_16x16x32_bf16 v[92:95], a[152:155], a[20:23], v[92:95]
  v_mfma_f32_16x16x32_bf16 v[92:95], a[156:159], a[28:31], v[92:95]
  s_waitcnt lgkmcnt(8)
  v_mfma_f32_16x16x32_bf16 v[32:35], a[160:163], a[0:3], v[32:35]
  buffer_load_dwordx4 a[120:123], v166, s[12:15], s37 offen offset:2048 sc1
  v_mfma_f32_16x16x32_bf16 v[32:35], a[164:167], a[8:11], v[32:35]
  v_mfma_f32_16x16x32_bf16 v[40:43], a[160:163], a[4:7], v[40:43]
  ds_read_b64_tr_b16 a[184:185], v175 offset:8
  ds_read_b64_tr_b16 a[186:187], v175 offset:4104
  v_mfma_f32_16x16x32_bf16 v[40:43], a[164:167], a[12:15], v[40:43]
  ds_read_b64_tr_b16 a[188:189], v175 offset:8200
  ds_read_b64_tr_b16 a[190:191], v175 offset:12296
  v_mfma_f32_16x16x32_bf16 v[96:99], a[160:163], a[16:19], v[96:99]
  buffer_load_dwordx4 a[124:127], v166, s[12:15], s37 offen offset:3072 sc1
  v_mfma_f32_16x16x32_bf16 v[96:99], a[164:167], a[24:27], v[96:99]
  s_add_u32 s37, s37, 4096
  v_mfma_f32_16x16x32_bf16 v[104:107], a[160:163], a[20:23], v[104:107]
  v_mfma_f32_16x16x32_bf16 v[104:107], a[164:167], a[28:31], v[104:107]
  s_waitcnt lgkmcnt(8)
  v_mfma_f32_16x16x32_bf16 v[36:39], a[168:171], a[0:3], v[36:39]
  v_mfma_f32_16x16x32_bf16 v[36:39], a[172:175], a[8:11], v[36:39]
  v_mfma_f32_16x16x32_bf16 v[44:47], a[168:171], a[4:7], v[44:47]
  v_mfma_f32_16x16x32_bf16 v[44:47], a[172:175], a[12:15], v[44:47]
  v_mfma_f32_16x16x32_bf16 v[100:103], a[168:171], a[16:19], v[100:103]
  v_mfma_f32_16x16x32_bf16 v[100:103], a[172:175], a[24:27], v[100:103]
  v_mfma_f32_16x16x32_bf16 v[108:111], a[168:171], a[20:23], v[108:111]
  s_waitcnt vmcnt(22)
  s_barrier
  v_mfma_f32_16x16x32_bf16 v[108:111], a[172:175], a[28:31], v[108:111]
  s_add_u32 m0, s45, 147456
  s_waitcnt lgkmcnt(4)
  v_mfma_f32_16x16x32_bf16 v[48:51], a[176:179], a[0:3], v[48:51]
  buffer_load_dwordx4 v224, s[8:11], s38 offen offset:0 lds
  v_mfma_f32_16x16x32_bf16 v[48:51], a[180:183], a[8:11], v[48:51]
  ds_read_b32 v165, v164 offset:512
  v_mfma_f32_16x16x32_bf16 v[56:59], a[176:179], a[4:7], v[56:59]
  ds_read_b64_tr_b16 a[128:129], v172 offset:16384
  ds_read_b64_tr_b16 a[130:131], v172 offset:20480
  v_mfma_f32_16x16x32_bf16 v[56:59], a[180:183], a[12:15], v[56:59]
  ds_read_b64_tr_b16 a[132:133], v172 offset:24576
  ds_read_b64_tr_b16 a[134:135], v172 offset:28672
  v_mfma_f32_16x16x32_bf16 v[112:115], a[176:179], a[16:19], v[112:115]
  buffer_load_dwordx4 v225, s[8:11], s38 offen offset:1024 lds
  v_mfma_f32_16x16x32_bf16 v[112:115], a[180:183], a[24:27], v[112:115]
  ds_read_b64_tr_b16 a[136:137], v172 offset:16392
  ds_read_b64_tr_b16 a[138:139], v172 offset:20488
  v_mfma_f32_16x16x32_bf16 v[120:123], a[176:179], a[20:23], v[120:123]
  v_mfma_f32_16x16x32_bf16 v[120:123], a[180:183], a[28:31], v[120:123]
  ds_read_b64_tr_b16 a[140:141], v172 offset:24584
  s_waitcnt lgkmcnt(8)
  v_mfma_f32_16x16x32_bf16 v[52:55], a[184:187], a[0:3], v[52:55]
  buffer_load_dwordx4 v226, s[8:11], s38 offen offset:2048 lds
  v_mfma_f32_16x16x32_bf16 v[52:55], a[188:191], a[8:11], v[52:55]
  ds_read_b64_tr_b16 a[142:143], v172 offset:28680
  ds_read_b64_tr_b16 a[144:145], v173 offset:16384
  v_mfma_f32_16x16x32_bf16 v[60:63], a[184:187], a[4:7], v[60:63]
  v_mfma_f32_16x16x32_bf16 v[60:63], a[188:191], a[12:15], v[60:63]
  s_waitcnt lgkmcnt(9)
  v_cmp_gt_u32 vcc, 4, v165
  ds_read_b64_tr_b16 a[146:147], v173 offset:20480
  v_mfma_f32_16x16x32_bf16 v[116:119], a[184:187], a[16:19], v[116:119]
  buffer_load_dwordx4 v227, s[8:11], s38 offen offset:3072 lds
  v_mfma_f32_16x16x32_bf16 v[116:119], a[188:191], a[24:27], v[116:119]
  s_add_u32 s38, s38, 0x20000
  s_and_b32 s95, s95, vcc_lo
  v_mfma_f32_16x16x32_bf16 v[124:127], a[184:187], a[20:23], v[124:127]
  ds_read_b64_tr_b16 a[148:149], v173 offset:24576
  s_waitcnt vmcnt(22)
  v_mfma_f32_16x16x32_bf16 v[124:127], a[188:191], a[28:31], v[124:127]
  ds_read_b64_tr_b16 a[150:151], v173 offset:28672
  s_waitcnt lgkmcnt(8)
  v_mfma_f32_16x16x32_bf16 v[0:3], a[128:131], a[32:35], v[0:3]
  s_bitcmp1_b32 s95, s58
  s_cbranch_scc1 L3_chk
L3_chkb:
  v_mfma_f32_16x16x32_bf16 v[0:3], a[132:135], a[40:43], v[0:3]
  buffer_load_dwordx4 a[96:99], v166, s[12:15], s36 offen offset:0 sc1
  v_mfma_f32_16x16x32_bf16 v[8:11], a[128:131], a[36:39], v[8:11]
  ds_read_b64_tr_b16 a[152:153], v173 offset:16392
  v_mfma_f32_16x16x32_bf16 v[8:11], a[132:135], a[44:47], v[8:11]
  ds_read_b64_tr_b16 a[154:155], v173 offset:20488
  v_mfma_f32_16x16x32_bf16 v[64:67], a[128:131], a[48:51], v[64:67]
  s_bfe_i32 s47, s39, 0x60000
  v_mfma_f32_16x16x32_bf16 v[64:67], a[132:135], a[56:59], v[64:67]
  buffer_load_dwordx4 a[100:103], v166, s[12:15], s36 offen offset:1024 sc1
  v_mfma_f32_16x16x32_bf16 v[72:75], a[128:131], a[52:55], v[72:75]
  s_lshl_b32 s49, s47, 18
  ds_read_b64_tr_b16 a[156:157], v173 offset:24584
  v_mfma_f32_16x16x32_bf16 v[72:75], a[132:135], a[60:63], v[72:75]
  s_add_u32 s38, s38, s49
  s_waitcnt lgkmcnt(7)
  v_mfma_f32_16x16x32_bf16 v[4:7], a[136:139], a[32:35], v[4:7]
  s_lshr_b32 s39, s39, 6
  ds_read_b64_tr_b16 a[158:159], v173 offset:28680
  v_mfma_f32_16x16x32_bf16 v[4:7], a[140:143], a[40:43], v[4:7]
  buffer_load_dwordx4 a[104:107], v166, s[12:15], s36 offen offset:2048 sc1
  v_mfma_f32_16x16x32_bf16 v[12:15], a[136:139], a[36:39], v[12:15]
  s_lshl_b32 s49, s47, 13
  ds_read_b64_tr_b16 a[160:161], v174 offset:16384
  v_mfma_f32_16x16x32_bf16 v[12:15], a[140:143], a[44:47], v[12:15]
  s_add_u32 s37, s37, s49
  ds_read_b64_tr_b16 a[162:163], v174 offset:20480
  v_mfma_f32_16x16x32_bf16 v[68:71], a[136:139], a[48:51], v[68:71]
  ds_read_b64_tr_b16 a[164:165], v174 offset:24576
  ds_read_b64_tr_b16 a[166:167], v174 offset:28672
  v_mfma_f32_16x16x32_bf16 v[68:71], a[140:143], a[56:59], v[68:71]
  v_mfma_f32_16x16x32_bf16 v[76:79], a[136:139], a[52:55], v[76:79]
  buffer_load_dwordx4 a[108:111], v166, s[12:15], s36 offen offset:3072 sc1
  v_mfma_f32_16x16x32_bf16 v[76:79], a[140:143], a[60:63], v[76:79]
  s_add_u32 s36, s36, 4096
  s_waitcnt lgkmcnt(8)
  v_mfma_f32_16x16x32_bf16 v[16:19], a[144:147], a[32:35], v[16:19]
  v_mfma_f32_16x16x32_bf16 v[16:19], a[148:151], a[40:43], v[16:19]
  s_add_u32 m0, s45, s56
  ds_read_b64_tr_b16 a[168:169], v174 offset:16392
  v_mfma_f32_16x16x32_bf16 v[24:27], a[144:147], a[36:39], v[24:27]
  buffer_load_dwordx4 v225, s[8:11], s57 offen offset:1024 lds
  v_mfma_f32_16x16x32_bf16 v[24:27], a[148:151], a[44:47], v[24:27]
  ds_read_b64_tr_b16 a[170:171], v174 offset:20488
  v_mfma_f32_16x16x32_bf16 v[80:83], a[144:147], a[48:51], v[80:83]
  ds_read_b64_tr_b16 a[172:173], v174 offset:24584
  ds_read_b64_tr_b16 a[174:175], v174 offset:28680
  v_mfma_f32_16x16x32_bf16 v[80:83], a[148:151], a[56:59], v[80:83]
  v_mfma_f32_16x16x32_bf16 v[88:91], a[144:147], a[52:55], v[88:91]
  v_mfma_f32_16x16x32_bf16 v[88:91], a[148:151], a[60:63], v[88:91]
  s_waitcnt lgkmcnt(8)
  v_mfma_f32_16x16x32_bf16 v[20:23], a[152:155], a[32:35], v[20:23]
  buffer_load_dwordx4 a[16:19], v166, s[12:15], s37 offen offset:0 sc1
  v_mfma_f32_16x16x32_bf16 v[20:23], a[156:159], a[40:43], v[20:23]
  v_mfma_f32_16x16x32_bf16 v[28:31], a[152:155], a[36:39], v[28:31]
  ds_read_b64_tr_b16 a[176:177], v175 offset:16384
  ds_read_b64_tr_b16 a[178:179], v175 offset:20480
  v_mfma_f32_16x16x32_bf16 v[28:31], a[156:159], a[44:47], v[28:31]
  buffer_load_dwordx4 a[20:23], v166, s[12:15], s37 offen offset:1024 sc1
  v_mfma_f32_16x16x32_bf16 v[84:87], a[152:155], a[48:51], v[84:87]
  ds_read_b64_tr_b16 a[180:181], v175 offset:24576
  ds_read_b64_tr_b16 a[182:183], v175 offset:28672
  v_mfma_f32_16x16x32_bf16 v[84:87], a[156:159], a[56:59], v[84:87]
  v_mfma_f32_16x16x32_bf16 v[92:95], a[152:155], a[52:55], v[92:95]
  v_mfma_f32_16x16x32_bf16 v[92:95], a[156:159], a[60:63], v[92:95]
  s_waitcnt lgkmcnt(8)
  v_mfma_f32_16x16x32_bf16 v[32:35], a[160:163], a[32:35], v[32:35]
  buffer_load_dwordx4 a[24:27], v166, s[12:15], s37 offen offset:2048 sc1
  v_mfma_f32_16x16x32_bf16 v[32:35], a[164:167], a[40:43], v[32:35]
  v_mfma_f32_16x16x32_bf16 v[40:43], a[160:163], a[36:39], v[40:43]
  ds_read_b64_tr_b16 a[184:185], v175 offset:16392
  ds_read_b64_tr_b16 a[186:187], v175 offset:20488
  v_mfma_f32_16x16x32_bf16 v[40:43], a[164:167], a[44:47], v[40:43]
  ds_read_b64_tr_b16 a[188:189], v175 offset:24584
  ds_read_b64_tr_b16 a[190:191], v175 offset:28680
  v_mfma_f32_16x16x32_bf16 v[96:99], a[160:163], a[48:51], v[96:99]
  buffer_load_dwordx4 a[28:31], v166, s[12:15], s37 offen offset:3072 sc1
  v_mfma_f32_16x16x32_bf16 v[96:99], a[164:167], a[56:59], v[96:99]
  s_add_u32 s37, s37, 4096
  v_mfma_f32_16x16x32_bf16 v[104:107], a[160:163], a[52:55], v[104:107]
  v_mfma_f32_16x16x32_bf16 v[104:107], a[164:167], a[60:63], v[104:107]
  s_waitcnt lgkmcnt(8)
  v_mfma_f32_16x16x32_bf16 v[36:39], a[168:171], a[32:35], v[36:39]
  v_mfma_f32_16x16x32_bf16 v[36:39], a[172:175], a[40:43], v[36:39]
  v_mfma_f32_16x16x32_bf16 v[44:47], a[168:171], a[36:39], v[44:47]
  v_mfma_f32_16x16x32_bf16 v[44:47], a[172:175], a[44:47], v[44:47]
  v_mfma_f32_16x16x32_bf16 v[100:103], a[168:171], a[48:51], v[100:103]
  v_mfma_f32_16x16x32_bf16 v[100:103], a[172:175], a[56:59], v[100:103]
  v_mfma_f32_16x16x32_bf16 v[108:111], a[168:171], a[52:55], v[108:111]
  s_waitcnt vmcnt(22)
  s_barrier
  v_mfma_f32_16x16x32_bf16 v[108:111], a[172:175], a[60:63], v[108:111]
  s_add_u32 m0, s45, 98304
  s_waitcnt lgkmcnt(4)
  v_mfma_f32_16x16x32_bf16 v[48:51], a[176:179], a[32:35], v[48:51]
  buffer_load_dwordx4 v224, s[8:11], s38 offen offset:0 lds
  v_mfma_f32_16x16x32_bf16 v[48:51], a[180:183], a[40:43], v[48:51]
  s_add_u32 s36, s36, s49
  v_mfma_f32_16x16x32_bf16 v[56:59], a[176:179], a[36:39], v[56:59]
  ds_read_b64_tr_b16 a[128:129], v172 offset:32768
  ds_read_b64_tr_b16 a[130:131], v172 offset:36864
  v_mfma_f32_16x16x32_bf16 v[56:59], a[180:183], a[44:47], v[56:59]
  ds_read_b64_tr_b16 a[132:133], v172 offset:40960
  ds_read_b64_tr_b16 a[134:135], v172 offset:45056
  v_mfma_f32_16x16x32_bf16 v[112:115], a[176:179], a[48:51], v[112:115]
  buffer_load_dwordx4 v225, s[8:11], s38 offen offset:1024 lds
  v_mfma_f32_16x16x32_bf16 v[112:115], a[180:183], a[56:59], v[112:115]
  ds_read_b64_tr_b16 a[136:137], v172 offset:32776
  ds_read_b64_tr_b16 a[138:139], v172 offset:36872
  v_mfma_f32_16x16x32_bf16 v[120:123], a[176:179], a[52:55], v[120:123]
  v_mfma_f32_16x16x32_bf16 v[120:123], a[180:183], a[60:63], v[120:123]
  ds_read_b64_tr_b16 a[140:141], v172 offset:40968
  s_waitcnt lgkmcnt(7)
  v_mfma_f32_16x16x32_bf16 v[52:55], a[184:187], a[32:35], v[52:55]
  buffer_load_dwordx4 v226, s[8:11], s38 offen offset:2048 lds
  v_mfma_f32_16x16x32_bf16 v[52:55], a[188:191], a[40:43], v[52:55]
  ds_read_b64_tr_b16 a[142:143], v172 offset:45064
  ds_read_b64_tr_b16 a[144:145], v173 offset:32768
  v_mfma_f32_16x16x32_bf16 v[60:63], a[184:187], a[36:39], v[60:63]
  v_mfma_f32_16x16x32_bf16 v[60:63], a[188:191], a[44:47], v[60:63]
  ds_read_b64_tr_b16 a[146:147], v173 offset:36864
  v_mfma_f32_16x16x32_bf16 v[116:119], a[184:187], a[48:51], v[116:119]
  buffer_load_dwordx4 v227, s[8:11], s38 offen offset:3072 lds
  v_mfma_f32_16x16x32_bf16 v[116:119], a[188:191], a[56:59], v[116:119]
  s_add_u32 s38, s38, 0x20000
  v_mfma_f32_16x16x32_bf16 v[124:127], a[184:187], a[52:55], v[124:127]
  ds_read_b64_tr_b16 a[148:149], v173 offset:40960
  s_waitcnt vmcnt(22)
  v_mfma_f32_16x16x32_bf16 v[124:127], a[188:191], a[60:63], v[124:127]
  ds_read_b64_tr_b16 a[150:151], v173 offset:45056
  s_waitcnt lgkmcnt(8)
  v_mfma_f32_16x16x32_bf16 v[0:3], a[128:131], a[64:67], v[0:3]
  v_mfma_f32_16x16x32_bf16 v[0:3], a[132:135], a[72:75], v[0:3]
  buffer_load_dwordx4 a[0:3], v166, s[12:15], s36 offen offset:0 sc1
  v_mfma_f32_16x16x32_bf16 v[8:11], a[128:131], a[68:71], v[8:11]
  ds_read_b64_tr_b16 a[152:153], v173 offset:32776
  v_mfma_f32_16x16x32_bf16 v[8:11], a[132:135], a[76:79], v[8:11]
  ds_read_b64_tr_b16 a[154:155], v173 offset:36872
  v_mfma_f32_16x16x32_bf16 v[64:67], a[128:131], a[80:83], v[64:67]
  v_mfma_f32_16x16x32_bf16 v[64:67], a[132:135], a[88:91], v[64:67]
  buffer_load_dwordx4 a[4:7], v166, s[12:15], s36 offen offset:1024 sc1
  v_mfma_f32_16x16x32_bf16 v[72:75], a[128:131], a[84:87], v[72:75]
  ds_read_b64_tr_b16 a[156:157], v173 offset:40968
  v_mfma_f32_16x16x32_bf16 v[72:75], a[132:135], a[92:95], v[72:75]
  s_waitcnt lgkmcnt(7)
  v_mfma_f32_16x16x32_bf16 v[4:7], a[136:139], a[64:67], v[4:7]
  ds_read_b64_tr_b16 a[158:159], v173 offset:45064
  v_mfma_f32_16x16x32_bf16 v[4:7], a[140:143], a[72:75], v[4:7]
  buffer_load_dwordx4 a[8:11], v166, s[12:15], s36 offen offset:2048 sc1
  v_mfma_f32_16x16x32_bf16 v[12:15], a[136:139], a[68:71], v[12:15]
  ds_read_b64_tr_b16 a[160:161], v174 offset:32768
  v_mfma_f32_16x16x32_bf16 v[12:15], a[140:143], a[76:79], v[12:15]
  ds_read_b64_tr_b16 a[162:163], v174 offset:36864
  v_mfma_f32_16x16x32_bf16 v[68:71], a[136:139], a[80:83], v[68:71]
  ds_read_b64_tr_b16 a[164:165], v174 offset:40960
  ds_read_b64_tr_b16 a[166:167], v174 offset:45056
  v_mfma_f32_16x16x32_bf16 v[68:71], a[140:143], a[88:91], v[68:71]
  v_mfma_f32_16x16x32_bf16 v[76:79], a[136:139], a[84:87], v[76:79]
  buffer_load_dwordx4 a[12:15], v166, s[12:15], s36 offen offset:3072 sc1
  v_mfma_f32_16x16x32_bf16 v[76:79], a[140:143], a[92:95], v[76:79]
  s_add_u32 s36, s36, 4096
  s_waitcnt lgkmcnt(8)
  v_mfma_f32_16x16x32_bf16 v[16:19], a[144:147], a[64:67], v[16:19]
  v_mfma_f32_16x16x32_bf16 v[16:19], a[148:151], a[72:75], v[16:19]
  s_add_u32 m0, s45, s56
  ds_read_b64_tr_b16 a[168:169], v174 offset:32776
  v_mfma_f32_16x16x32_bf16 v[24:27], a[144:147], a[68:71], v[24:27]
  buffer_load_dwordx4 v226, s[8:11], s57 offen offset:2048 lds
  v_mfma_f32_16x16x32_bf16 v[24:27], a[148:151], a[76:79], v[24:27]
  ds_read_b64_tr_b16 a[170:171], v174 offset:36872
  v_mfma_f32_16x16x32_bf16 v[80:83], a[144:147], a[80:83], v[80:83]
  ds_read_b64_tr_b16 a[172:173], v174 offset:40968
  ds_read_b64_tr_b16 a[174:175], v174 offset:45064
  v_mfma_f32_16x16x32_bf16 v[80:83], a[148:151], a[88:91], v[80:83]
  v_mfma_f32_16x16x32_bf16 v[88:91], a[144:147], a[84:87], v[88:91]
  v_mfma_f32_16x16x32_bf16 v[88:91], a[148:151], a[92:95], v[88:91]
  s_waitcnt lgkmcnt(8)
  v_mfma_f32_16x16x32_bf16 v[20:23], a[152:155], a[64:67], v[20:23]
  buffer_load_dwordx4 a[48:51], v166, s[12:15], s37 offen offset:0 sc1
  v_mfma_f32_16x16x32_bf16 v[20:23], a[156:159], a[72:75], v[20:23]
  v_mfma_f32_16x16x32_bf16 v[28:31], a[152:155], a[68:71], v[28:31]
  ds_read_b64_tr_b16 a[176:177], v175 offset:32768
  ds_read_b64_tr_b16 a[178:179], v175 offset:36864
  v_mfma_f32_16x16x32_bf16 v[28:31], a[156:159], a[76:79], v[28:31]
  buffer_load_dwordx4 a[52:55], v166, s[12:15], s37 offen offset:1024 sc1
  v_mfma_f32_16x16x32_bf16 v[84:87], a[152:155], a[80:83], v[84:87]
  ds_read_b64_tr_b16 a[180:181], v175 offset:40960
  ds_read_b64_tr_b16 a[182:183], v175 offset:45056
  v_mfma_f32_16x16x32_bf16 v[84:87], a[156:159], a[88:91], v[84:87]
  v_mfma_f32_16x16x32_bf16 v[92:95], a[152:155], a[84:87], v[92:95]
  v_mfma_f32_16x16x32_bf16 v[92:95], a[156:159], a[92:95], v[92:95]
  s_waitcnt lgkmcnt(8)
  v_mfma_f32_16x16x32_bf16 v[32:35], a[160:163], a[64:67], v[32:35]
  buffer_load_dwordx4 a[56:59], v166, s[12:15], s37 offen offset:2048 sc1
  v_mfma_f32_16x16x32_bf16 v[32:35], a[164:167], a[72:75], v[32:35]
  v_mfma_f32_16x16x32_bf16 v[40:43], a[160:163], a[68:71], v[40:43]
  ds_read_b64_tr_b16 a[184:185], v175 offset:32776
  ds_read_b64_tr_b16 a[186:187], v175 offset:36872
  v_mfma_f32_16x16x32_bf16 v[40:43], a[164:167], a[76:79], v[40:43]
  ds_read_b64_tr_b16 a[188:189], v175 offset:40968
  ds_read_b64_tr_b16 a[190:191], v175 offset:45064
  v_mfma_f32_16x16x32_bf16 v[96:99], a[160:163], a[80:83], v[96:99]
  buffer_load_dwordx4 a[60:63], v166, s[12:15], s37 offen offset:3072 sc1
  v_mfma_f32_16x16x32_bf16 v[96:99], a[164:167], a[88:91], v[96:99]
  s_add_u32 s37, s37, 4096
  v_mfma_f32_16x16x32_bf16 v[104:107], a[160:163], a[84:87], v[104:107]
  v_mfma_f32_16x16x32_bf16 v[104:107], a[164:167], a[92:95], v[104:107]
  s_add_u32 m0, s45, 512
  s_waitcnt lgkmcnt(8)
  v_mfma_f32_16x16x32_bf16 v[36:39], a[168:171], a[64:67], v[36:39]
  buffer_load_dword v238, s[4:7], 0 offen sc0 sc1 lds
  v_mfma_f32_16x16x32_bf16 v[36:39], a[172:175], a[72:75], v[36:39]
  v_mfma_f32_16x16x32_bf16 v[44:47], a[168:171], a[68:71], v[44:47]
  v_mfma_f32_16x16x32_bf16 v[44:47], a[172:175], a[76:79], v[44:47]
  v_mfma_f32_16x16x32_bf16 v[100:103], a[168:171], a[80:83], v[100:103]
  v_mfma_f32_16x16x32_bf16 v[100:103], a[172:175], a[88:91], v[100:103]
  v_mfma_f32_16x16x32_bf16 v[108:111], a[168:171], a[84:87], v[108:111]
  s_waitcnt vmcnt(23)
  s_barrier
  v_mfma_f32_16x16x32_bf16 v[108:111], a[172:175], a[92:95], v[108:111]
  s_add_u32 m0, s45, 114688
  s_waitcnt lgkmcnt(4)
  v_mfma_f32_16x16x32_bf16 v[48:51], a[176:179], a[64:67], v[48:51]
  buffer_load_dwordx4 v224, s[8:11], s38 offen offset:0 lds
  v_mfma_f32_16x16x32_bf16 v[48:51], a[180:183], a[72:75], v[48:51]
  v_mfma_f32_16x16x32_bf16 v[56:59], a[176:179], a[68:71], v[56:59]
  ds_read_b64_tr_b16 a[128:129], v172 offset:49152
  ds_read_b64_tr_b16 a[130:131], v172 offset:53248
  v_mfma_f32_16x16x32_bf16 v[56:59], a[180:183], a[76:79], v[56:59]
  ds_read_b64_tr_b16 a[132:133], v172 offset:57344
  ds_read_b64_tr_b16 a[134:135], v172 offset:61440
  v_mfma_f32_16x16x32_bf16 v[112:115], a[176:179], a[80:83], v[112:115]
  buffer_load_dwordx4 v225, s[8:11], s38 offen offset:1024 lds
  v_mfma_f32_16x16x32_bf16 v[112:115], a[180:183], a[88:91], v[112:115]
  ds_read_b64_tr_b16 a[136:137], v172 offset:49160
  ds_read_b64_tr_b16 a[138:139], v172 offset:53256
  v_mfma_f32_16x16x32_bf16 v[120:123], a[176:179], a[84:87], v[120:123]
  v_mfma_f32_16x16x32_bf16 v[120:123], a[180:183], a[92:95], v[120:123]
  ds_read_b64_tr_b16 a[140:141], v172 offset:57352
  s_waitcnt lgkmcnt(7)
  v_mfma_f32_16x16x32_bf16 v[52:55], a[184:187], a[64:67], v[52:55]
  buffer_load_dwordx4 v226, s[8:11], s38 offen offset:2048 lds
  v_mfma_f32_16x16x32_bf16 v[52:55], a[188:191], a[72:75], v[52:55]
  ds_read_b64_tr_b16 a[142:143], v172 offset:61448
  ds_read_b64_tr_b16 a[144:145], v173 offset:49152
  v_mfma_f32_16x16x32_bf16 v[60:63], a[184:187], a[68:71], v[60:63]
  v_mfma_f32_16x16x32_bf16 v[60:63], a[188:191], a[76:79], v[60:63]
  ds_read_b64_tr_b16 a[146:147], v173 offset:53248
  v_mfma_f32_16x16x32_bf16 v[116:119], a[184:187], a[80:83], v[116:119]
  buffer_load_dwordx4 v227, s[8:11], s38 offen offset:3072 lds
  v_mfma_f32_16x16x32_bf16 v[116:119], a[188:191], a[88:91], v[116:119]
  s_add_u32 s38, s38, 0x20000
  v_mfma_f32_16x16x32_bf16 v[124:127], a[184:187], a[84:87], v[124:127]
  ds_read_b64_tr_b16 a[148:149], v173 offset:57344
  s_waitcnt vmcnt(23)
  v_mfma_f32_16x16x32_bf16 v[124:127], a[188:191], a[92:95], v[124:127]
  ds_read_b64_tr_b16 a[150:151], v173 offset:61440
  s_waitcnt lgkmcnt(8)
  v_mfma_f32_16x16x32_bf16 v[0:3], a[128:131], a[96:99], v[0:3]
  v_mfma_f32_16x16x32_bf16 v[0:3], a[132:135], a[104:107], v[0:3]
  buffer_load_dwordx4 a[32:35], v166, s[12:15], s36 offen offset:0 sc1
  v_mfma_f32_16x16x32_bf16 v[8:11], a[128:131], a[100:103], v[8:11]
  ds_read_b64_tr_b16 a[152:153], v173 offset:49160
  v_mfma_f32_16x16x32_bf16 v[8:11], a[132:135], a[108:111], v[8:11]
  ds_read_b64_tr_b16 a[154:155], v173 offset:53256
  v_mfma_f32_16x16x32_bf16 v[64:67], a[128:131], a[112:115], v[64:67]
  v_mfma_f32_16x16x32_bf16 v[64:67], a[132:135], a[120:123], v[64:67]
  buffer_load_dwordx4 a[36:39], v166, s[12:15], s36 offen offset:1024 sc1
  v_mfma_f32_16x16x32_bf16 v[72:75], a[128:131], a[116:119], v[72:75]
  ds_read_b64_tr_b16 a[156:157], v173 offset:57352
  v_mfma_f32_16x16x32_bf16 v[72:75], a[132:135], a[124:127], v[72:75]
  s_waitcnt lgkmcnt(7)
  v_mfma_f32_16x16x32_bf16 v[4:7], a[136:139], a[96:99], v[4:7]
  ds_read_b64_tr_b16 a[158:159], v173 offset:61448
  v_mfma_f32_16x16x32_bf16 v[4:7], a[140:143], a[104:107], v[4:7]
  buffer_load_dwordx4 a[40:43], v166, s[12:15], s36 offen offset:2048 sc1
  v_mfma_f32_16x16x32_bf16 v[12:15], a[136:139], a[100:103], v[12:15]
  ds_read_b64_tr_b16 a[160:161], v174 offset:49152
  v_mfma_f32_16x16x32_bf16 v[12:15], a[140:143], a[108:111], v[12:15]
  ds_read_b64_tr_b16 a[162:163], v174 offset:53248
  v_mfma_f32_16x16x32_bf16 v[68:71], a[136:139], a[112:115], v[68:71]
  ds_read_b64_tr_b16 a[164:165], v174 offset:57344
  ds_read_b64_tr_b16 a[166:167], v174 offset:61440
  v_mfma_f32_16x16x32_bf16 v[68:71], a[140:143], a[120:123], v[68:71]
  v_mfma_f32_16x16x32_bf16 v[76:79], a[136:139], a[116:119], v[76:79]
  buffer_load_dwordx4 a[44:47], v166, s[12:15], s36 offen offset:3072 sc1
  v_mfma_f32_16x16x32_bf16 v[76:79], a[140:143], a[124:127], v[76:79]
  s_add_u32 s36, s36, 4096
  s_waitcnt lgkmcnt(8)
  v_mfma_f32_16x16x32_bf16 v[16:19], a[144:147], a[96:99], v[16:19]
  v_mfma_f32_16x16x32_bf16 v[16:19], a[148:151], a[104:107], v[16:19]
  s_add_u32 m0, s45, s56
  ds_read_b64_tr_b16 a[168:169], v174 offset:49160
  v_mfma_f32_16x16x32_bf16 v[24:27], a[144:147], a[100:103], v[24:27]
  buffer_load_dwordx4 v227, s[8:11], s57 offen offset:3072 lds
  v_mfma_f32_16x16x32_bf16 v[24:27], a[148:151], a[108:111], v[24:27]
  s_add_u32 s57, s57, 0x20000
  ds_read_b64_tr_b16 a[170:171], v174 offset:53256
  v_mfma_f32_16x16x32_bf16 v[80:83], a[144:147], a[112:115], v[80:83]
  ds_read_b64_tr_b16 a[172:173], v174 offset:57352
  ds_read_b64_tr_b16 a[174:175], v174 offset:61448
  v_mfma_f32_16x16x32_bf16 v[80:83], a[148:151], a[120:123], v[80:83]
  v_mfma_f32_16x16x32_bf16 v[88:91], a[144:147], a[116:119], v[88:91]
  v_mfma_f32_16x16x32_bf16 v[88:91], a[148:151], a[124:127], v[88:91]
  s_waitcnt lgkmcnt(8)
  v_mfma_f32_16x16x32_bf16 v[20:23], a[152:155], a[96:99], v[20:23]
  buffer_load_dwordx4 a[80:83], v166, s[12:15], s37 offen offset:0 sc1
  v_mfma_f32_16x16x32_bf16 v[20:23], a[156:159], a[104:107], v[20:23]
  v_mfma_f32_16x16x32_bf16 v[28:31], a[152:155], a[100:103], v[28:31]
  ds_read_b64_tr_b16 a[176:177], v175 offset:49152
  ds_read_b64_tr_b16 a[178:179], v175 offset:53248
  v_mfma_f32_16x16x32_bf16 v[28:31], a[156:159], a[108:111], v[28:31]
  buffer_load_dwordx4 a[84:87], v166, s[12:15], s37 offen offset:1024 sc1
  v_mfma_f32_16x16x32_bf16 v[84:87], a[152:155], a[112:115], v[84:87]
  ds_read_b64_tr_b16 a[180:181], v175 offset:57344
  ds_read_b64_tr_b16 a[182:183], v175 offset:61440
  v_mfma_f32_16x16x32_bf16 v[84:87], a[156:159], a[120:123], v[84:87]
  v_mfma_f32_16x16x32_bf16 v[92:95], a[152:155], a[116:119], v[92:95]
  v_mfma_f32_16x16x32_bf16 v[92:95], a[156:159], a[124:127], v[92:95]
  s_waitcnt lgkmcnt(8)
  v_mfma_f32_16x16x32_bf16 v[32:35], a[160:163], a[96:99], v[32:35]
  buffer_load_dwordx4 a[88:91], v166, s[12:15], s37 offen offset:2048 sc1
  v_mfma_f32_16x16x32_bf16 v[32:35], a[164:167], a[104:107], v[32:35]
  v_mfma_f32_16x16x32_bf16 v[40:43], a[160:163], a[100:103], v[40:43]
  ds_read_b64_tr_b16 a[184:185], v175 offset:49160
  ds_read_b64_tr_b16 a[186:187], v175 offset:53256
  v_mfma_f32_16x16x32_bf16 v[40:43], a[164:167], a[108:111], v[40:43]
  ds_read_b64_tr_b16 a[188:189], v175 offset:57352
  ds_read_b64_tr_b16 a[190:191], v175 offset:61448
  v_mfma_f32_16x16x32_bf16 v[96:99], a[160:163], a[112:115], v[96:99]
  buffer_load_dwordx4 a[92:95], v166, s[12:15], s37 offen offset:3072 sc1
  v_mfma_f32_16x16x32_bf16 v[96:99], a[164:167], a[120:123], v[96:99]
  s_add_u32 s37, s37, 4096
  v_mfma_f32_16x16x32_bf16 v[104:107], a[160:163], a[116:119], v[104:107]
  v_mfma_f32_16x16x32_bf16 v[104:107], a[164:167], a[124:127], v[104:107]
  s_waitcnt lgkmcnt(8)
  v_mfma_f32_16x16x32_bf16 v[36:39], a[168:171], a[96:99], v[36:39]
  v_mfma_f32_16x16x32_bf16 v[36:39], a[172:175], a[104:107], v[36:39]
  v_mfma_f32_16x16x32_bf16 v[44:47], a[168:171], a[100:103], v[44:47]
  v_mfma_f32_16x16x32_bf16 v[44:47], a[172:175], a[108:111], v[44:47]
  v_mfma_f32_16x16x32_bf16 v[100:103], a[168:171], a[112:115], v[100:103]
  v_mfma_f32_16x16x32_bf16 v[100:103], a[172:175], a[120:123], v[100:103]
  v_mfma_f32_16x16x32_bf16 v[108:111], a[168:171], a[116:119], v[108:111]
  s_waitcnt vmcnt(23)
  s_barrier
  v_mfma_f32_16x16x32_bf16 v[108:111], a[172:175], a[124:127], v[108:111]
  s_add_u32 m0, s45, 131072
  s_waitcnt lgkmcnt(4)
  v_mfma_f32_16x16x32_bf16 v[48:51], a[176:179], a[96:99], v[48:51]
  buffer_load_dwordx4 v224, s[8:11], s38 offen offset:0 lds
  v_mfma_f32_16x16x32_bf16 v[48:51], a[180:183], a[104:107], v[48:51]
  v_mfma_f32_16x16x32_bf16 v[56:59], a[176:179], a[100:103], v[56:59]
  ds_read_b64_tr_b16 a[128:129], v172 offset:0
  ds_read_b64_tr_b16 a[130:131], v172 offset:4096
  v_mfma_f32_16x16x32_bf16 v[56:59], a[180:183], a[108:111], v[56:59]
  ds_read_b64_tr_b16 a[132:133], v172 offset:8192
  ds_read_b64_tr_b16 a[134:135], v172 offset:12288
  v_mfma_f32_16x16x32_bf16 v[112:115], a[176:179], a[112:115], v[112:115]
  buffer_load_dwordx4 v225, s[8:11], s38 offen offset:1024 lds
  v_mfma_f32_16x16x32_bf16 v[112:115], a[180:183], a[120:123], v[112:115]
  ds_read_b64_tr_b16 a[136:137], v172 offset:8
  ds_read_b64_tr_b16 a[138:139], v172 offset:4104
  v_mfma_f32_16x16x32_bf16 v[120:123], a[176:179], a[116:119], v[120:123]
  v_mfma_f32_16x16x32_bf16 v[120:123], a[180:183], a[124:127], v[120:123]
  ds_read_b64_tr_b16 a[140:141], v172 offset:8200
  s_waitcnt lgkmcnt(7)
  v_mfma_f32_16x16x32_bf16 v[52:55], a[184:187], a[96:99], v[52:55]
  buffer_load_dwordx4 v226, s[8:11], s38 offen offset:2048 lds
  v_mfma_f32_16x16x32_bf16 v[52:55], a[188:191], a[104:107], v[52:55]
  ds_read_b64_tr_b16 a[142:143], v172 offset:12296
  ds_read_b64_tr_b16 a[144:145], v173 offset:0
  v_mfma_f32_16x16x32_bf16 v[60:63], a[184:187], a[100:103], v[60:63]
  v_mfma_f32_16x16x32_bf16 v[60:63], a[188:191], a[108:111], v[60:63]
  ds_read_b64_tr_b16 a[146:147], v173 offset:4096
  v_mfma_f32_16x16x32_bf16 v[116:119], a[184:187], a[112:115], v[116:119]
  buffer_load_dwordx4 v227, s[8:11], s38 offen offset:3072 lds
  v_mfma_f32_16x16x32_bf16 v[116:119], a[188:191], a[120:123], v[116:119]
  s_add_u32 s38, s38, 0x20000
  v_mfma_f32_16x16x32_bf16 v[124:127], a[184:187], a[116:119], v[124:127]
  ds_read_b64_tr_b16 a[148:149], v173 offset:8192
  s_waitcnt vmcnt(23)
  v_mfma_f32_16x16x32_bf16 v[124:127], a[188:191], a[124:127], v[124:127]
  ds_read_b64_tr_b16 a[150:151], v173 offset:12288
  s_waitcnt lgkmcnt(8)
  s_sub_u32 s58, s58, 1
  s_cmp_lg_u32 s58, 0
  s_cbranch_scc1 L3_loop
  v_mfma_f32_16x16x32_bf16 v[64:67], a[128:131], a[16:19], v[64:67]
  ds_read_b64_tr_b16 a[152:153], v173 offset:8
  ds_read_b64_tr_b16 a[154:155], v173 offset:4104
  v_mfma_f32_16x16x32_bf16 v[64:67], a[132:135], a[24:27], v[64:67]
  buffer_load_dwordx4 a[112:115], v166, s[12:15], s37 offen offset:0 sc1
  v_mfma_f32_16x16x32_bf16 v[72:75], a[128:131], a[20:23], v[72:75]
  ds_read_b64_tr_b16 a[156:157], v173 offset:8200
  ds_read_b64_tr_b16 a[158:159], v173 offset:12296
  v_mfma_f32_16x16x32_bf16 v[72:75], a[132:135], a[28:31], v[72:75]
  ds_read_b64_tr_b16 a[160:161], v174 offset:0
  s_waitcnt lgkmcnt(9)
  v_mfma_f32_16x16x32_bf16 v[68:71], a[136:139], a[16:19], v[68:71]
  buffer_load_dwordx4 a[116:119], v166, s[12:15], s37 offen offset:1024 sc1
  v_mfma_f32_16x16x32_bf16 v[68:71], a[140:143], a[24:27], v[68:71]
  buffer_load_dwordx4 a[120:123], v166, s[12:15], s37 offen offset:2048 sc1
  v_mfma_f32_16x16x32_bf16 v[76:79], a[136:139], a[20:23], v[76:79]
  ds_read_b64_tr_b16 a[162:163], v174 offset:4096
  ds_read_b64_tr_b16 a[164:165], v174 offset:8192
  v_mfma_f32_16x16x32_bf16 v[76:79], a[140:143], a[28:31], v[76:79]
  ds_read_b64_tr_b16 a[166:167], v174 offset:12288
  s_waitcnt lgkmcnt(8)
  v_mfma_f32_16x16x32_bf16 v[80:83], a[144:147], a[16:19], v[80:83]
  buffer_load_dwordx4 a[124:127], v166, s[12:15], s37 offen offset:3072 sc1
  v_mfma_f32_16x16x32_bf16 v[80:83], a[148:151], a[24:27], v[80:83]
  s_add_u32 s37, s37, 4096
  ds_read_b64_tr_b16 a[168:169], v174 offset:8
  v_mfma_f32_16x16x32_bf16 v[88:91], a[144:147], a[20:23], v[88:91]
  s_waitcnt vmcnt(17)
  s_barrier
  v_mfma_f32_16x16x32_bf16 v[88:91], a[148:151], a[28:31], v[88:91]
  s_add_u32 m0, s45, 147456
  s_waitcnt lgkmcnt(5)
  v_mfma_f32_16x16x32_bf16 v[84:87], a[152:155], a[16:19], v[84:87]
  buffer_load_dwordx4 v224, s[8:11], s38 offen offset:0 lds
  v_mfma_f32_16x16x32_bf16 v[84:87], a[156:159], a[24:27], v[84:87]
  ds_read_b64_tr_b16 a[170:171], v174 offset:4104
  ds_read_b64_tr_b16 a[172:173], v174 offset:8200
  v_mfma_f32_16x16x32_bf16 v[92:95], a[152:155], a[20:23], v[92:95]
  ds_read_b64_tr_b16 a[174:175], v174 offset:12296
  ds_read_b64_tr_b16 a[176:177], v175 offset:0
  v_mfma_f32_16x16x32_bf16 v[92:95], a[156:159], a[28:31], v[92:95]
  ds_read_b64_tr_b16 a[178:179], v175 offset:4096
  s_waitcnt lgkmcnt(6)
  v_mfma_f32_16x16x32_bf16 v[96:99], a[160:163], a[16:19], v[96:99]
  buffer_load_dwordx4 v225, s[8:11], s38 offen offset:1024 lds
  v_mfma_f32_16x16x32_bf16 v[96:99], a[164:167], a[24:27], v[96:99]
  ds_read_b64_tr_b16 a[180:181], v175 offset:8192
  ds_read_b64_tr_b16 a[182:183], v175 offset:12288
  v_mfma_f32_16x16x32_bf16 v[104:107], a[160:163], a[20:23], v[104:107]
  ds_read_b64_tr_b16 a[184:185], v175 offset:8
  ds_read_b64_tr_b16 a[186:187], v175 offset:4104
  v_mfma_f32_16x16x32_bf16 v[104:107], a[164:167], a[28:31], v[104:107]
  ds_read_b64_tr_b16 a[188:189], v175 offset:8200
  s_waitcnt lgkmcnt(7)
  v_mfma_f32_16x16x32_bf16 v[100:103], a[168:171], a[16:19], v[100:103]
  buffer_load_dwordx4 v226, s[8:11], s38 offen offset:2048 lds
  v_mfma_f32_16x16x32_bf16 v[100:103], a[172:175], a[24:27], v[100:103]
  ds_read_b64_tr_b16 a[190:191], v175 offset:12296
  ds_read_b64_tr_b16 a[128:129], v172 offset:16384
  v_mfma_f32_16x16x32_bf16 v[108:111], a[168:171], a[20:23], v[108:111]
  buffer_load_dwordx4 v227, s[8:11], s38 offen offset:3072 lds
  v_mfma_f32_16x16x32_bf16 v[108:111], a[172:175], a[28:31], v[108:111]
  s_add_u32 s38, s38, 0x20000
  s_waitcnt lgkmcnt(5)
  v_mfma_f32_16x16x32_bf16 v[112:115], a[176:179], a[16:19], v[112:115]
  ds_read_b64_tr_b16 a[130:131], v172 offset:20480
  ds_read_b64_tr_b16 a[132:133], v172 offset:24576
  v_mfma_f32_16x16x32_bf16 v[112:115], a[180:183], a[24:27], v[112:115]
  ds_read_b64_tr_b16 a[134:135], v172 offset:28672
  ds_read_b64_tr_b16 a[136:137], v172 offset:16392
  v_mfma_f32_16x16x32_bf16 v[120:123], a[176:179], a[20:23], v[120:123]
  buffer_load_dwordx4 a[64:67], v166, s[12:15], s37 offen offset:0 sc1
  v_mfma_f32_16x16x32_bf16 v[120:123], a[180:183], a[28:31], v[120:123]
  ds_read_b64_tr_b16 a[138:139], v172 offset:20488
  s_waitcnt lgkmcnt(6)
  v_mfma_f32_16x16x32_bf16 v[116:119], a[184:187], a[16:19], v[116:119]
  ds_read_b64_tr_b16 a[140:141], v172 offset:24584
  ds_read_b64_tr_b16 a[142:143], v172 offset:28680
  v_mfma_f32_16x16x32_bf16 v[116:119], a[188:191], a[24:27], v[116:119]
  buffer_load_dwordx4 a[68:71], v166, s[12:15], s37 offen offset:1024 sc1
  v_mfma_f32_16x16x32_bf16 v[124:127], a[184:187], a[20:23], v[124:127]
  ds_read_b64_tr_b16 a[144:145], v173 offset:16384
  v_mfma_f32_16x16x32_bf16 v[124:127], a[188:191], a[28:31], v[124:127]
  ds_read_b64_tr_b16 a[146:147], v173 offset:20480
  s_waitcnt lgkmcnt(6)
  v_mfma_f32_16x16x32_bf16 v[64:67], a[128:131], a[48:51], v[64:67]
  ds_read_b64_tr_b16 a[148:149], v173 offset:24576
  ds_read_b64_tr_b16 a[150:151], v173 offset:28672
  v_mfma_f32_16x16x32_bf16 v[64:67], a[132:135], a[56:59], v[64:67]
  buffer_load_dwordx4 a[72:75], v166, s[12:15], s37 offen offset:2048 sc1
  v_mfma_f32_16x16x32_bf16 v[72:75], a[128:131], a[52:55], v[72:75]
  ds_read_b64_tr_b16 a[152:153], v173 offset:16392
  ds_read_b64_tr_b16 a[154:155], v173 offset:20488
  v_mfma_f32_16x16x32_bf16 v[72:75], a[132:135], a[60:63], v[72:75]
  ds_read_b64_tr_b16 a[156:157], v173 offset:24584
  s_waitcnt lgkmcnt(7)
  v_mfma_f32_16x16x32_bf16 v[68:71], a[136:139], a[48:51], v[68:71]
  buffer_load_dwordx4 a[76:79], v166, s[12:15], s37 offen offset:3072 sc1
  v_mfma_f32_16x16x32_bf16 v[68:71], a[140:143], a[56:59], v[68:71]
  s_add_u32 s37, s37, 4096
  ds_read_b64_tr_b16 a[158:159], v173 offset:28680
  v_mfma_f32_16x16x32_bf16 v[76:79], a[136:139], a[52:55], v[76:79]
  ds_read_b64_tr_b16 a[160:161], v174 offset:16384
  ds_read_b64_tr_b16 a[162:163], v174 offset:20480
  v_mfma_f32_16x16x32_bf16 v[76:79], a[140:143], a[60:63], v[76:79]
  ds_read_b64_tr_b16 a[164:165], v174 offset:24576
  s_waitcnt lgkmcnt(7)
  v_mfma_f32_16x16x32_bf16 v[80:83], a[144:147], a[48:51], v[80:83]
  buffer_load_dwordx4 a[96:99], v166, s[12:15], s37 offen offset:0 sc1
  v_mfma_f32_16x16x32_bf16 v[80:83], a[148:151], a[56:59], v[80:83]
  ds_read_b64_tr_b16 a[166:167], v174 offset:28672
  ds_read_b64_tr_b16 a[168:169], v174 offset:16392
  v_mfma_f32_16x16x32_bf16 v[88:91], a[144:147], a[52:55], v[88:91]
  ds_read_b64_tr_b16 a[170:171], v174 offset:20488
  ds_read_b64_tr_b16 a[172:173], v174 offset:24584
  v_mfma_f32_16x16x32_bf16 v[88:91], a[148:151], a[60:63], v[88:91]
  ds_read_b64_tr_b16 a[174:175], v174 offset:28680
  s_waitcnt lgkmcnt(8)
  v_mfma_f32_16x16x32_bf16 v[84:87], a[152:155], a[48:51], v[84:87]
  buffer_load_dwordx4 a[100:103], v166, s[12:15], s37 offen offset:1024 sc1
  v_mfma_f32_16x16x32_bf16 v[84:87], a[156:159], a[56:59], v[84:87]
  ds_read_b64_tr_b16 a[176:177], v175 offset:16384
  ds_read_b64_tr_b16 a[178:179], v175 offset:20480
  v_mfma_f32_16x16x32_bf16 v[92:95], a[152:155], a[52:55], v[92:95]
  s_waitcnt vmcnt(14)
  s_barrier
  v_mfma_f32_16x16x32_bf16 v[92:95], a[156:159], a[60:63], v[92:95]
  ds_read_b64_tr_b16 a[180:181], v175 offset:24576
  s_waitcnt lgkmcnt(7)
  v_mfma_f32_16x16x32_bf16 v[96:99], a[160:163], a[48:51], v[96:99]
  buffer_load_dwordx4 a[104:107], v166, s[12:15], s37 offen offset:2048 sc1
  v_mfma_f32_16x16x32_bf16 v[96:99], a[164:167], a[56:59], v[96:99]
  ds_read_b64_tr_b16 a[182:183], v175 offset:28672
  ds_read_b64_tr_b16 a[184:185], v175 offset:16392
  v_mfma_f32_16x16x32_bf16 v[104:107], a[160:163], a[52:55], v[104:107]
  buffer_load_dwordx4 a[108:111], v166, s[12:15], s37 offen offset:3072 sc1
  v_mfma_f32_16x16x32_bf16 v[104:107], a[164:167], a[60:63], v[104:107]
  s_add_u32 s37, s37, 4096
  s_waitcnt lgkmcnt(5)
  v_mfma_f32_16x16x32_bf16 v[100:103], a[168:171], a[48:51], v[100:103]
  ds_read_b64_tr_b16 a[186:187], v175 offset:20488
  ds_read_b64_tr_b16 a[188:189], v175 offset:24584
  v_mfma_f32_16x16x32_bf16 v[100:103], a[172:175], a[56:59], v[100:103]
  ds_read_b64_tr_b16 a[190:191], v175 offset:28680
  ds_read_b64_tr_b16 a[128:129], v172 offset:32768
  v_mfma_f32_16x16x32_bf16 v[108:111], a[168:171], a[52:55], v[108:111]
  buffer_load_dwordx4 a[192:195], v166, s[12:15], s37 offen offset:0 sc1
  v_mfma_f32_16x16x32_bf16 v[108:111], a[172:175], a[60:63], v[108:111]
  ds_read_b64_tr_b16 a[130:131], v172 offset:36864
  s_waitcnt lgkmcnt(6)
  v_mfma_f32_16x16x32_bf16 v[112:115], a[176:179], a[48:51], v[112:115]
  ds_read_b64_tr_b16 a[132:133], v172 offset:40960
  ds_read_b64_tr_b16 a[134:135], v172 offset:45056
  v_mfma_f32_16x16x32_bf16 v[112:115], a[180:183], a[56:59], v[112:115]
  buffer_load_dwordx4 a[196:199], v166, s[12:15], s37 offen offset:1024 sc1
  v_mfma_f32_16x16x32_bf16 v[120:123], a[176:179], a[52:55], v[120:123]
  ds_read_b64_tr_b16 a[136:137], v172 offset:32776
  ds_read_b64_tr_b16 a[138:139], v172 offset:36872
  v_mfma_f32_16x16x32_bf16 v[120:123], a[180:183], a[60:63], v[120:123]
  ds_read_b64_tr_b16 a[140:141], v172 offset:40968
  s_waitcnt lgkmcnt(7)
  v_mfma_f32_16x16x32_bf16 v[116:119], a[184:187], a[48:51], v[116:119]
  ds_read_b64_tr_b16 a[142:143], v172 offset:45064
  ds_read_b64_tr_b16 a[144:145], v173 offset:32768
  v_mfma_f32_16x16x32_bf16 v[116:119], a[188:191], a[56:59], v[116:119]
  buffer_load_dwordx4 a[200:203], v166, s[12:15], s37 offen offset:2048 sc1
  v_mfma_f32_16x16x32_bf16 v[124:127], a[184:187], a[52:55], v[124:127]
  ds_read_b64_tr_b16 a[146:147], v173 offset:36864
  v_mfma_f32_16x16x32_bf16 v[124:127], a[188:191], a[60:63], v[124:127]
  ds_read_b64_tr_b16 a[148:149], v173 offset:40960
  s_waitcnt lgkmcnt(7)
  v_mfma_f32_16x16x32_bf16 v[64:67], a[128:131], a[80:83], v[64:67]
  buffer_load_dwordx4 a[204:207], v166, s[12:15], s37 offen offset:3072 sc1
  v_mfma_f32_16x16x32_bf16 v[64:67], a[132:135], a[88:91], v[64:67]
  s_add_u32 s37, s37, 4096
  ds_read_b64_tr_b16 a[150:151], v173 offset:45056
  v_mfma_f32_16x16x32_bf16 v[72:75], a[128:131], a[84:87], v[72:75]
  ds_read_b64_tr_b16 a[152:153], v173 offset:32776
  ds_read_b64_tr_b16 a[154:155], v173 offset:36872
  v_mfma_f32_16x16x32_bf16 v[72:75], a[132:135], a[92:95], v[72:75]
  ds_read_b64_tr_b16 a[156:157], v173 offset:40968
  s_waitcnt lgkmcnt(7)
  v_mfma_f32_16x16x32_bf16 v[68:71], a[136:139], a[80:83], v[68:71]
  buffer_load_dwordx4 a[208:211], v166, s[12:15], s37 offen offset:0 sc1
  v_mfma_f32_16x16x32_bf16 v[68:71], a[140:143], a[88:91], v[68:71]
  ds_read_b64_tr_b16 a[158:159], v173 offset:45064
  ds_read_b64_tr_b16 a[160:161], v174 offset:32768
  v_mfma_f32_16x16x32_bf16 v[76:79], a[136:139], a[84:87], v[76:79]
  ds_read_b64_tr_b16 a[162:163], v174 offset:36864
  ds_read_b64_tr_b16 a[164:165], v174 offset:40960
  v_mfma_f32_16x16x32_bf16 v[76:79], a[140:143], a[92:95], v[76:79]
  ds_read_b64_tr_b16 a[166:167], v174 offset:45056
  s_waitcnt lgkmcnt(8)
  v_mfma_f32_16x16x32_bf16 v[80:83], a[144:147], a[80:83], v[80:83]
  buffer_load_dwordx4 a[212:215], v166, s[12:15], s37 offen offset:1024 sc1
  v_mfma_f32_16x16x32_bf16 v[80:83], a[148:151], a[88:91], v[80:83]
  ds_read_b64_tr_b16 a[168:169], v174 offset:32776
  ds_read_b64_tr_b16 a[170:171], v174 offset:36872
  v_mfma_f32_16x16x32_bf16 v[88:91], a[144:147], a[84:87], v[88:91]
  ds_read_b64_tr_b16 a[172:173], v174 offset:40968
  ds_read_b64_tr_b16 a[174:175], v174 offset:45064
  v_mfma_f32_16x16x32_bf16 v[88:91], a[148:151], a[92:95], v[88:91]
  ds_read_b64_tr_b16 a[176:177], v175 offset:32768
  s_waitcnt lgkmcnt(9)
  v_mfma_f32_16x16x32_bf16 v[84:87], a[152:155], a[80:83], v[84:87]
  buffer_load_dwordx4 a[216:219], v166, s[12:15], s37 offen offset:2048 sc1
  v_mfma_f32_16x16x32_bf16 v[84:87], a[156:159], a[88:91], v[84:87]
  ds_read_b64_tr_b16 a[178:179], v175 offset:36864
  ds_read_b64_tr_b16 a[180:181], v175 offset:40960
  v_mfma_f32_16x16x32_bf16 v[92:95], a[152:155], a[84:87], v[92:95]
  s_waitcnt vmcnt(15)
  s_barrier
  v_mfma_f32_16x16x32_bf16 v[92:95], a[156:159], a[92:95], v[92:95]
  ds_read_b64_tr_b16 a[182:183], v175 offset:45056
  s_waitcnt lgkmcnt(8)
  v_mfma_f32_16x16x32_bf16 v[96:99], a[160:163], a[80:83], v[96:99]
  buffer_load_dwordx4 a[220:223], v166, s[12:15], s37 offen offset:3072 sc1
  v_mfma_f32_16x16x32_bf16 v[96:99], a[164:167], a[88:91], v[96:99]
  s_add_u32 s37, s37, 4096
  ds_read_b64_tr_b16 a[184:185], v175 offset:32776
  v_mfma_f32_16x16x32_bf16 v[104:107], a[160:163], a[84:87], v[104:107]
  ds_read_b64_tr_b16 a[186:187], v175 offset:36872
  ds_read_b64_tr_b16 a[188:189], v175 offset:40968
  v_mfma_f32_16x16x32_bf16 v[104:107], a[164:167], a[92:95], v[104:107]
  ds_read_b64_tr_b16 a[190:191], v175 offset:45064
  s_waitcnt lgkmcnt(8)
  v_mfma_f32_16x16x32_bf16 v[100:103], a[168:171], a[80:83], v[100:103]
  ds_read_b64_tr_b16 a[128:129], v172 offset:49152
  ds_read_b64_tr_b16 a[130:131], v172 offset:53248
  v_mfma_f32_16x16x32_bf16 v[100:103], a[172:175], a[88:91], v[100:103]
  ds_read_b64_tr_b16 a[132:133], v172 offset:57344
  ds_read_b64_tr_b16 a[134:135], v172 offset:61440
  v_mfma_f32_16x16x32_bf16 v[108:111], a[168:171], a[84:87], v[108:111]
  ds_read_b64_tr_b16 a[136:137], v172 offset:49160
  ds_read_b64_tr_b16 a[138:139], v172 offset:53256
  v_mfma_f32_16x16x32_bf16 v[108:111], a[172:175], a[92:95], v[108:111]
  ds_read_b64_tr_b16 a[140:141], v172 offset:57352
  s_waitcnt lgkmcnt(11)
  v_mfma_f32_16x16x32_bf16 v[112:115], a[176:179], a[80:83], v[112:115]
  ds_read_b64_tr_b16 a[142:143], v172 offset:61448
  v_mfma_f32_16x16x32_bf16 v[112:115], a[180:183], a[88:91], v[112:115]
  v_mfma_f32_16x16x32_bf16 v[120:123], a[176:179], a[84:87], v[120:123]
  ds_read_b64_tr_b16 a[144:145], v173 offset:49152
  ds_read_b64_tr_b16 a[146:147], v173 offset:53248
  v_mfma_f32_16x16x32_bf16 v[120:123], a[180:183], a[92:95], v[120:123]
  ds_read_b64_tr_b16 a[148:149], v173 offset:57344
  s_waitcnt lgkmcnt(11)
  v_mfma_f32_16x16x32_bf16 v[116:119], a[184:187], a[80:83], v[116:119]
  ds_read_b64_tr_b16 a[150:151], v173 offset:61440
  v_mfma_f32_16x16x32_bf16 v[116:119], a[188:191], a[88:91], v[116:119]
  v_mfma_f32_16x16x32_bf16 v[124:127], a[184:187], a[84:87], v[124:127]
  ds_read_b64_tr_b16 a[152:153], v173 offset:49160
  v_mfma_f32_16x16x32_bf16 v[124:127], a[188:191], a[92:95], v[124:127]
  ds_read_b64_tr_b16 a[154:155], v173 offset:53256
  s_waitcnt lgkmcnt(10)
  v_mfma_f32_16x16x32_bf16 v[64:67], a[128:131], a[112:115], v[64:67]
  ds_read_b64_tr_b16 a[156:157], v173 offset:57352
  ds_read_b64_tr_b16 a[158:159], v173 offset:61448
  v_mfma_f32_16x16x32_bf16 v[64:67], a[132:135], a[120:123], v[64:67]
  v_mfma_f32_16x16x32_bf16 v[72:75], a[128:131], a[116:119], v[72:75]
  ds_read_b64_tr_b16 a[160:161], v174 offset:49152
  ds_read_b64_tr_b16 a[162:163], v174 offset:53248
  v_mfma_f32_16x16x32_bf16 v[72:75], a[132:135], a[124:127], v[72:75]
  ds_read_b64_tr_b16 a[164:165], v174 offset:57344
  s_waitcnt lgkmcnt(11)
  v_mfma_f32_16x16x32_bf16 v[68:71], a[136:139], a[112:115], v[68:71]
  ds_read_b64_tr_b16 a[166:167], v174 offset:61440
  v_mfma_f32_16x16x32_bf16 v[68:71], a[140:143], a[120:123], v[68:71]
  v_mfma_f32_16x16x32_bf16 v[76:79], a[136:139], a[116:119], v[76:79]
  ds_read_b64_tr_b16 a[168:169], v174 offset:49160
  ds_read_b64_tr_b16 a[170:171], v174 offset:53256
  v_mfma_f32_16x16x32_bf16 v[76:79], a[140:143], a[124:127], v[76:79]
  ds_read_b64_tr_b16 a[172:173], v174 offset:57352
  s_waitcnt lgkmcnt(11)
  v_mfma_f32_16x16x32_bf16 v[80:83], a[144:147], a[112:115], v[80:83]
  ds_read_b64_tr_b16 a[174:175], v174 offset:61448
  v_mfma_f32_16x16x32_bf16 v[80:83], a[148:151], a[120:123], v[80:83]
  v_mfma_f32_16x16x32_bf16 v[88:91], a[144:147], a[116:119], v[88:91]
  ds_read_b64_tr_b16 a[176:177], v175 offset:49152
  ds_read_b64_tr_b16 a[178:179], v175 offset:53248
  v_mfma_f32_16x16x32_bf16 v[88:91], a[148:151], a[124:127], v[88:91]
  ds_read_b64_tr_b16 a[180:181], v175 offset:57344
  s_waitcnt lgkmcnt(11)
  v_mfma_f32_16x16x32_bf16 v[84:87], a[152:155], a[112:115], v[84:87]
  ds_read_b64_tr_b16 a[182:183], v175 offset:61440
  v_mfma_f32_16x16x32_bf16 v[84:87], a[156:159], a[120:123], v[84:87]
  v_mfma_f32_16x16x32_bf16 v[92:95], a[152:155], a[116:119], v[92:95]
  ds_read_b64_tr_b16 a[184:185], v175 offset:49160
  ds_read_b64_tr_b16 a[186:187], v175 offset:53256
  v_mfma_f32_16x16x32_bf16 v[92:95], a[156:159], a[124:127], v[92:95]
  ds_read_b64_tr_b16 a[188:189], v175 offset:57352
  s_waitcnt lgkmcnt(11)
  v_mfma_f32_16x16x32_bf16 v[96:99], a[160:163], a[112:115], v[96:99]
  ds_read_b64_tr_b16 a[190:191], v175 offset:61448
  v_mfma_f32_16x16x32_bf16 v[96:99], a[164:167], a[120:123], v[96:99]
  v_mfma_f32_16x16x32_bf16 v[104:107], a[160:163], a[116:119], v[104:107]
  ds_read_b64_tr_b16 a[128:129], v176 offset:0
  ds_read_b64_tr_b16 a[130:131], v176 offset:4096
  v_mfma_f32_16x16x32_bf16 v[104:107], a[164:167], a[124:127], v[104:107]
  ds_read_b64_tr_b16 a[132:133], v176 offset:8192
  s_waitcnt lgkmcnt(11)
  v_mfma_f32_16x16x32_bf16 v[100:103], a[168:171], a[112:115], v[100:103]
  ds_read_b64_tr_b16 a[134:135], v176 offset:12288
  v_mfma_f32_16x16x32_bf16 v[100:103], a[172:175], a[120:123], v[100:103]
  v_mfma_f32_16x16x32_bf16 v[108:111], a[168:171], a[116:119], v[108:111]
  ds_read_b64_tr_b16 a[136:137], v176 offset:16384
  ds_read_b64_tr_b16 a[138:139], v176 offset:20480
  v_mfma_f32_16x16x32_bf16 v[108:111], a[172:175], a[124:127], v[108:111]
  ds_read_b64_tr_b16 a[140:141], v176 offset:24576
  s_waitcnt lgkmcnt(11)
  v_mfma_f32_16x16x32_bf16 v[112:115], a[176:179], a[112:115], v[112:115]
  ds_read_b64_tr_b16 a[142:143], v176 offset:28672
  v_mfma_f32_16x16x32_bf16 v[112:115], a[180:183], a[120:123], v[112:115]
  v_mfma_f32_16x16x32_bf16 v[120:123], a[176:179], a[116:119], v[120:123]
  ds_read_b64_tr_b16 a[144:145], v176 offset:32768
  ds_read_b64_tr_b16 a[146:147], v176 offset:36864
  v_mfma_f32_16x16x32_bf16 v[120:123], a[180:183], a[124:127], v[120:123]
  ds_read_b64_tr_b16 a[148:149], v176 offset:40960
  s_waitcnt lgkmcnt(11)
  v_mfma_f32_16x16x32_bf16 v[116:119], a[184:187], a[112:115], v[116:119]
  ds_read_b64_tr_b16 a[150:151], v176 offset:45056
  v_mfma_f32_16x16x32_bf16 v[116:119], a[188:191], a[120:123], v[116:119]
  v_mfma_f32_16x16x32_bf16 v[124:127], a[184:187], a[116:119], v[124:127]
  ds_read_b64_tr_b16 a[152:153], v176 offset:49152
  s_waitcnt vmcnt(12)
  v_mfma_f32_16x16x32_bf16 v[124:127], a[188:191], a[124:127], v[124:127]
  ds_read_b64_tr_b16 a[154:155], v176 offset:53248
  s_waitcnt lgkmcnt(10)
  v_mfma_f32_16x16x32_bf16 v[64:67], a[128:131], a[64:67], v[64:67]
  ds_read_b64_tr_b16 a[156:157], v176 offset:57344
  ds_read_b64_tr_b16 a[158:159], v176 offset:61440
  v_mfma_f32_16x16x32_bf16 v[64:67], a[132:135], a[72:75], v[64:67]
  v_mfma_f32_16x16x32_bf16 v[72:75], a[128:131], a[68:71], v[72:75]
  ds_read_b64_tr_b16 a[160:161], v176 offset:8
  s_waitcnt vmcnt(8)
  v_mfma_f32_16x16x32_bf16 v[72:75], a[132:135], a[76:79], v[72:75]
  ds_read_b64_tr_b16 a[162:163], v176 offset:4104
  s_waitcnt lgkmcnt(10)
  v_mfma_f32_16x16x32_bf16 v[64:67], a[136:139], a[96:99], v[64:67]
  buffer_load_dwordx4 a[224:227], v166, s[12:15], s36 offen offset:0 sc1
  v_mfma_f32_16x16x32_bf16 v[64:67], a[140:143], a[104:107], v[64:67]
  ds_read_b64_tr_b16 a[164:165], v176 offset:8200
  ds_read_b64_tr_b16 a[166:167], v176 offset:12296
  v_mfma_f32_16x16x32_bf16 v[72:75], a[136:139], a[100:103], v[72:75]
  ds_read_b64_tr_b16 a[168:169], v176 offset:16392
  s_waitcnt vmcnt(5)
  v_mfma_f32_16x16x32_bf16 v[72:75], a[140:143], a[108:111], v[72:75]
  ds_read_b64_tr_b16 a[170:171], v176 offset:20488
  s_waitcnt lgkmcnt(10)
  v_mfma_f32_16x16x32_bf16 v[64:67], a[144:147], a[192:195], v[64:67]
  ds_read_b64_tr_b16 a[172:173], v176 offset:24584
  ds_read_b64_tr_b16 a[174:175], v176 offset:28680
  v_mfma_f32_16x16x32_bf16 v[64:67], a[148:151], a[200:203], v[64:67]
  v_mfma_f32_16x16x32_bf16 v[72:75], a[144:147], a[196:199], v[72:75]
  ds_read_b64_tr_b16 a[176:177], v176 offset:32776
  s_waitcnt vmcnt(1)
  v_mfma_f32_16x16x32_bf16 v[72:75], a[148:151], a[204:207], v[72:75]
  ds_read_b64_tr_b16 a[178:179], v176 offset:36872
  s_waitcnt lgkmcnt(10)
  v_mfma_f32_16x16x32_bf16 v[64:67], a[152:155], a[208:211], v[64:67]
  buffer_load_dwordx4 a[228:231], v166, s[12:15], s36 offen offset:1024 sc1
  v_mfma_f32_16x16x32_bf16 v[64:67], a[156:159], a[216:219], v[64:67]
  ds_read_b64_tr_b16 a[180:181], v176 offset:40968
  ds_read_b64_tr_b16 a[182:183], v176 offset:45064
  v_mfma_f32_16x16x32_bf16 v[72:75], a[152:155], a[212:215], v[72:75]
  ds_read_b64_tr_b16 a[184:185], v176 offset:49160
  ds_read_b64_tr_b16 a[186:187], v176 offset:53256
  v_mfma_f32_16x16x32_bf16 v[72:75], a[156:159], a[220:223], v[72:75]
  ds_read_b64_tr_b16 a[188:189], v176 offset:57352
  s_waitcnt lgkmcnt(11)
  v_mfma_f32_16x16x32_bf16 v[68:71], a[160:163], a[64:67], v[68:71]
  ds_read_b64_tr_b16 a[190:191], v176 offset:61448
  v_mfma_f32_16x16x32_bf16 v[68:71], a[164:167], a[72:75], v[68:71]
  buffer_load_dwordx4 a[232:235], v166, s[12:15], s36 offen offset:2048 sc1
  v_mfma_f32_16x16x32_bf16 v[76:79], a[160:163], a[68:71], v[76:79]
  ds_read_b64_tr_b16 a[128:129], v177 offset:0
  ds_read_b64_tr_b16 a[130:131], v177 offset:4096
  v_mfma_f32_16x16x32_bf16 v[76:79], a[164:167], a[76:79], v[76:79]
  ds_read_b64_tr_b16 a[132:133], v177 offset:8192
  s_waitcnt lgkmcnt(11)
  v_mfma_f32_16x16x32_bf16 v[68:71], a[168:171], a[96:99], v[68:71]
  ds_read_b64_tr_b16 a[134:135], v177 offset:12288
  v_mfma_f32_16x16x32_bf16 v[68:71], a[172:175], a[104:107], v[68:71]
  v_mfma_f32_16x16x32_bf16 v[76:79], a[168:171], a[100:103], v[76:79]
  ds_read_b64_tr_b16 a[136:137], v177 offset:16384
  ds_read_b64_tr_b16 a[138:139], v177 offset:20480
  v_mfma_f32_16x16x32_bf16 v[76:79], a[172:175], a[108:111], v[76:79]
  ds_read_b64_tr_b16 a[140:141], v177 offset:24576
  s_waitcnt lgkmcnt(11)
  v_mfma_f32_16x16x32_bf16 v[68:71], a[176:179], a[192:195], v[68:71]
  buffer_load_dwordx4 a[236:239], v166, s[12:15], s36 offen offset:3072 sc1
  v_mfma_f32_16x16x32_bf16 v[68:71], a[180:183], a[200:203], v[68:71]
  s_add_u32 s36, s36, 4096
  ds_read_b64_tr_b16 a[142:143], v177 offset:28672
  v_mfma_f32_16x16x32_bf16 v[76:79], a[176:179], a[196:199], v[76:79]
  ds_read_b64_tr_b16 a[144:145], v177 offset:32768
  ds_read_b64_tr_b16 a[146:147], v177 offset:36864
  v_mfma_f32_16x16x32_bf16 v[76:79], a[180:183], a[204:207], v[76:79]
  ds_read_b64_tr_b16 a[148:149], v177 offset:40960
  s_waitcnt lgkmcnt(11)
  v_mfma_f32_16x16x32_bf16 v[68:71], a[184:187], a[208:211], v[68:71]
  ds_read_b64_tr_b16 a[150:151], v177 offset:45056
  v_mfma_f32_16x16x32_bf16 v[68:71], a[188:191], a[216:219], v[68:71]
  ds_read_b64_tr_b16 a[152:153], v177 offset:49152
  ds_read_b64_tr_b16 a[154:155], v177 offset:53248
  v_mfma_f32_16x16x32_bf16 v[76:79], a[184:187], a[212:215], v[76:79]
  buffer_load_dwordx4 a[240:243], v166, s[12:15], s36 offen offset:0 sc1
  v_mfma_f32_16x16x32_bf16 v[76:79], a[188:191], a[220:223], v[76:79]
  ds_read_b64_tr_b16 a[156:157], v177 offset:57344
  s_waitcnt lgkmcnt(11)
  v_mfma_f32_16x16x32_bf16 v[80:83], a[128:131], a[64:67], v[80:83]
  ds_read_b64_tr_b16 a[158:159], v177 offset:61440
  ds_read_b64_tr_b16 a[160:161], v177 offset:8
  v_mfma_f32_16x16x32_bf16 v[80:83], a[132:135], a[72:75], v[80:83]
  v_cvt_pk_bf16_f32 v64, v64, v65
  v_cvt_pk_bf16_f32 v65, v66, v67
  v_mfma_f32_16x16x32_bf16 v[88:91], a[128:131], a[68:71], v[88:91]
  v_cvt_pk_bf16_f32 v66, v68, v69
  v_cvt_pk_bf16_f32 v67, v70, v71
  v_mfma_f32_16x16x32_bf16 v[88:91], a[132:135], a[76:79], v[88:91]
  v_cvt_pk_bf16_f32 v72, v72, v73
  s_waitcnt lgkmcnt(9)
  v_mfma_f32_16x16x32_bf16 v[80:83], a[136:139], a[96:99], v[80:83]
  v_cvt_pk_bf16_f32 v73, v74, v75
  v_cvt_pk_bf16_f32 v74, v76, v77
  v_mfma_f32_16x16x32_bf16 v[80:83], a[140:143], a[104:107], v[80:83]
  v_cvt_pk_bf16_f32 v75, v78, v79
  ds_read_b64_tr_b16 a[162:163], v177 offset:4104
  v_mfma_f32_16x16x32_bf16 v[88:91], a[136:139], a[100:103], v[88:91]
  buffer_store_dwordx4 v[64:67], v166, s[16:19], 0 offen offset:0 sc1
  v_mfma_f32_16x16x32_bf16 v[88:91], a[140:143], a[108:111], v[88:91]
  ds_read_b64_tr_b16 a[164:165], v177 offset:8200
  s_waitcnt lgkmcnt(7)
  v_mfma_f32_16x16x32_bf16 v[80:83], a[144:147], a[192:195], v[80:83]
  buffer_load_dwordx4 a[244:247], v166, s[12:15], s36 offen offset:1024 sc1
  v_mfma_f32_16x16x32_bf16 v[80:83], a[148:151], a[200:203], v[80:83]
  buffer_store_dwordx4 v[72:75], v166, s[16:19], 0 offen offset:1024 sc1
  v_mfma_f32_16x16x32_bf16 v[88:91], a[144:147], a[196:199], v[88:91]
  ds_read_b64_tr_b16 a[166:167], v177 offset:12296
  ds_read_b64_tr_b16 a[168:169], v177 offset:16392
  v_mfma_f32_16x16x32_bf16 v[88:91], a[148:151], a[204:207], v[88:91]
  ds_read_b64_tr_b16 a[170:171], v177 offset:20488
  s_waitcnt lgkmcnt(6)
  v_mfma_f32_16x16x32_bf16 v[80:83], a[152:155], a[208:211], v[80:83]
  buffer_load_dwordx4 a[248:251], v166, s[12:15], s36 offen offset:2048 sc1
  v_mfma_f32_16x16x32_bf16 v[80:83], a[156:159], a[216:219], v[80:83]
  ds_read_b64_tr_b16 a[172:173], v177 offset:24584
  ds_read_b64_tr_b16 a[174:175], v177 offset:28680
  v_mfma_f32_16x16x32_bf16 v[88:91], a[152:155], a[212:215], v[88:91]
  ds_read_b64_tr_b16 a[176:177], v177 offset:32776
  ds_read_b64_tr_b16 a[178:179], v177 offset:36872
  v_mfma_f32_16x16x32_bf16 v[88:91], a[156:159], a[220:223], v[88:91]
  ds_read_b64_tr_b16 a[180:181], v177 offset:40968
  s_waitcnt lgkmcnt(7)
  v_mfma_f32_16x16x32_bf16 v[84:87], a[160:163], a[64:67], v[84:87]
  ds_read_b64_tr_b16 a[182:183], v177 offset:45064
  ds_read_b64_tr_b16 a[184:185], v177 offset:49160
  v_mfma_f32_16x16x32_bf16 v[84:87], a[164:167], a[72:75], v[84:87]
  buffer_load_dwordx4 a[252:255], v166, s[12:15], s36 offen offset:3072 sc1
  v_mfma_f32_16x16x32_bf16 v[92:95], a[160:163], a[68:71], v[92:95]
  s_add_u32 s36, s36, 4096
  ds_read_b64_tr_b16 a[186:187], v177 offset:53256
  v_mfma_f32_16x16x32_bf16 v[92:95], a[164:167], a[76:79], v[92:95]
  ds_read_b64_tr_b16 a[188:189], v177 offset:57352
  s_waitcnt lgkmcnt(7)
  v_mfma_f32_16x16x32_bf16 v[84:87], a[168:171], a[96:99], v[84:87]
  ds_read_b64_tr_b16 a[190:191], v177 offset:61448
  ds_read_b64_tr_b16 a[128:129], v178 offset:0
  v_mfma_f32_16x16x32_bf16 v[84:87], a[172:175], a[104:107], v[84:87]
  ds_read_b64_tr_b16 a[130:131], v178 offset:4096
  ds_read_b64_tr_b16 a[132:133], v178 offset:8192
  v_mfma_f32_16x16x32_bf16 v[92:95], a[168:171], a[100:103], v[92:95]
  ds_read_b64_tr_b16 a[134:135], v178 offset:12288
  ds_read_b64_tr_b16 a[136:137], v178 offset:16384
  v_mfma_f32_16x16x32_bf16 v[92:95], a[172:175], a[108:111], v[92:95]
  ds_read_b64_tr_b16 a[138:139], v178 offset:20480
  s_waitcnt lgkmcnt(10)
  v_mfma_f32_16x16x32_bf16 v[84:87], a[176:179], a[192:195], v[84:87]
  buffer_load_dwordx4 a[16:19], v166, s[12:15], s36 offen offset:0 sc1
  v_mfma_f32_16x16x32_bf16 v[84:87], a[180:183], a[200:203], v[84:87]
  ds_read_b64_tr_b16 a[140:141], v178 offset:24576
  ds_read_b64_tr_b16 a[142:143], v178 offset:28672
  v_mfma_f32_16x16x32_bf16 v[92:95], a[176:179], a[196:199], v[92:95]
  ds_read_b64_tr_b16 a[144:145], v178 offset:32768
  ds_read_b64_tr_b16 a[146:147], v178 offset:36864
  v_mfma_f32_16x16x32_bf16 v[92:95], a[180:183], a[204:207], v[92:95]
  ds_read_b64_tr_b16 a[148:149], v178 offset:40960
  s_waitcnt lgkmcnt(11)
  v_mfma_f32_16x16x32_bf16 v[84:87], a[184:187], a[208:211], v[84:87]
  ds_read_b64_tr_b16 a[150:151], v178 offset:45056
  v_mfma_f32_16x16x32_bf16 v[84:87], a[188:191], a[216:219], v[84:87]
  ds_read_b64_tr_b16 a[152:153], v178 offset:49152
  ds_read_b64_tr_b16 a[154:155], v178 offset:53248
  v_mfma_f32_16x16x32_bf16 v[92:95], a[184:187], a[212:215], v[92:95]
  buffer_load_dwordx4 a[20:23], v166, s[12:15], s36 offen offset:1024 sc1
  v_mfma_f32_16x16x32_bf16 v[92:95], a[188:191], a[220:223], v[92:95]
  ds_read_b64_tr_b16 a[156:157], v178 offset:57344
  s_waitcnt lgkmcnt(11)
  v_mfma_f32_16x16x32_bf16 v[96:99], a[128:131], a[64:67], v[96:99]
  ds_read_b64_tr_b16 a[158:159], v178 offset:61440
  ds_read_b64_tr_b16 a[160:161], v178 offset:8
  v_mfma_f32_16x16x32_bf16 v[96:99], a[132:135], a[72:75], v[96:99]
  v_cvt_pk_bf16_f32 v80, v80, v81
  v_cvt_pk_bf16_f32 v81, v82, v83
  v_mfma_f32_16x16x32_bf16 v[104:107], a[128:131], a[68:71], v[104:107]
  v_cvt_pk_bf16_f32 v82, v84, v85
  v_cvt_pk_bf16_f32 v83, v86, v87
  v_mfma_f32_16x16x32_bf16 v[104:107], a[132:135], a[76:79], v[104:107]
  v_cvt_pk_bf16_f32 v88, v88, v89
  s_waitcnt lgkmcnt(9)
  v_mfma_f32_16x16x32_bf16 v[96:99], a[136:139], a[96:99], v[96:99]
  v_cvt_pk_bf16_f32 v89, v90, v91
  v_cvt_pk_bf16_f32 v90, v92, v93
  v_mfma_f32_16x16x32_bf16 v[96:99], a[140:143], a[104:107], v[96:99]
  v_cvt_pk_bf16_f32 v91, v94, v95
  ds_read_b64_tr_b16 a[162:163], v178 offset:4104
  v_mfma_f32_16x16x32_bf16 v[104:107], a[136:139], a[100:103], v[104:107]
  buffer_store_dwordx4 v[80:83], v166, s[16:19], 0 offen offset:2048 sc1
  v_mfma_f32_16x16x32_bf16 v[104:107], a[140:143], a[108:111], v[104:107]
  ds_read_b64_tr_b16 a[164:165], v178 offset:8200
  s_waitcnt lgkmcnt(7)
  v_mfma_f32_16x16x32_bf16 v[96:99], a[144:147], a[192:195], v[96:99]
  buffer_load_dwordx4 a[24:27], v166, s[12:15], s36 offen offset:2048 sc1
  v_mfma_f32_16x16x32_bf16 v[96:99], a[148:151], a[200:203], v[96:99]
  buffer_store_dwordx4 v[88:91], v166, s[16:19], 0 offen offset:3072 sc1
  v_mfma_f32_16x16x32_bf16 v[104:107], a[144:147], a[196:199], v[104:107]
  ds_read_b64_tr_b16 a[166:167], v178 offset:12296
  ds_read_b64_tr_b16 a[168:169], v178 offset:16392
  v_mfma_f32_16x16x32_bf16 v[104:107], a[148:151], a[204:207], v[104:107]
  ds_read_b64_tr_b16 a[170:171], v178 offset:20488
  s_waitcnt lgkmcnt(6)
  v_mfma_f32_16x16x32_bf16 v[96:99], a[152:155], a[208:211], v[96:99]
  buffer_load_dwordx4 a[28:31], v166, s[12:15], s36 offen offset:3072 sc1
  v_mfma_f32_16x16x32_bf16 v[96:99], a[156:159], a[216:219], v[96:99]
  s_add_u32 s36, s36, 4096
  ds_read_b64_tr_b16 a[172:173], v178 offset:24584
  v_mfma_f32_16x16x32_bf16 v[104:107], a[152:155], a[212:215], v[104:107]
  ds_read_b64_tr_b16 a[174:175], v178 offset:28680
  ds_read_b64_tr_b16 a[176:177], v178 offset:32776
  v_mfma_f32_16x16x32_bf16 v[104:107], a[156:159], a[220:223], v[104:107]
  ds_read_b64_tr_b16 a[178:179], v178 offset:36872
  s_waitcnt lgkmcnt(6)
  v_mfma_f32_16x16x32_bf16 v[100:103], a[160:163], a[64:67], v[100:103]
  ds_read_b64_tr_b16 a[180:181], v178 offset:40968
  ds_read_b64_tr_b16 a[182:183], v178 offset:45064
  v_mfma_f32_16x16x32_bf16 v[100:103], a[164:167], a[72:75], v[100:103]
  ds_read_b64_tr_b16 a[184:185], v178 offset:49160
  ds_read_b64_tr_b16 a[186:187], v178 offset:53256
  v_mfma_f32_16x16x32_bf16 v[108:111], a[160:163], a[68:71], v[108:111]
  buffer_load_dwordx4 a[48:51], v166, s[12:15], s36 offen offset:0 sc1
  v_mfma_f32_16x16x32_bf16 v[108:111], a[164:167], a[76:79], v[108:111]
  ds_read_b64_tr_b16 a[188:189], v178 offset:57352
  s_waitcnt lgkmcnt(7)
  v_mfma_f32_16x16x32_bf16 v[100:103], a[168:171], a[96:99], v[100:103]
  ds_read_b64_tr_b16 a[190:191], v178 offset:61448
  ds_read_b64_tr_b16 a[128:129], v179 offset:0
  v_mfma_f32_16x16x32_bf16 v[100:103], a[172:175], a[104:107], v[100:103]
  ds_read_b64_tr_b16 a[130:131], v179 offset:4096
  ds_read_b64_tr_b16 a[132:133], v179 offset:8192
  v_mfma_f32_16x16x32_bf16 v[108:111], a[168:171], a[100:103], v[108:111]
  ds_read_b64_tr_b16 a[134:135], v179 offset:12288
  ds_read_b64_tr_b16 a[136:137], v179 offset:16384
  v_mfma_f32_16x16x32_bf16 v[108:111], a[172:175], a[108:111], v[108:111]
  ds_read_b64_tr_b16 a[138:139], v179 offset:20480
  s_waitcnt lgkmcnt(10)
  v_mfma_f32_16x16x32_bf16 v[100:103], a[176:179], a[192:195], v[100:103]
  buffer_load_dwordx4 a[52:55], v166, s[12:15], s36 offen offset:1024 sc1
  v_mfma_f32_16x16x32_bf16 v[100:103], a[180:183], a[200:203], v[100:103]
  ds_read_b64_tr_b16 a[140:141], v179 offset:24576
  ds_read_b64_tr_b16 a[142:143], v179 offset:28672
  v_mfma_f32_16x16x32_bf16 v[108:111], a[176:179], a[196:199], v[108:111]
  ds_read_b64_tr_b16 a[144:145], v179 offset:32768
  ds_read_b64_tr_b16 a[146:147], v179 offset:36864
  v_mfma_f32_16x16x32_bf16 v[108:111], a[180:183], a[204:207], v[108:111]
  ds_read_b64_tr_b16 a[148:149], v179 offset:40960
  s_waitcnt lgkmcnt(11)
  v_mfma_f32_16x16x32_bf16 v[100:103], a[184:187], a[208:211], v[100:103]
  ds_read_b64_tr_b16 a[150:151], v179 offset:45056
  v_mfma_f32_16x16x32_bf16 v[100:103], a[188:191], a[216:219], v[100:103]
  v_mfma_f32_16x16x32_bf16 v[108:111], a[184:187], a[212:215], v[108:111]
  ds_read_b64_tr_b16 a[152:153], v179 offset:49152
  ds_read_b64_tr_b16 a[154:155], v179 offset:53248
  v_mfma_f32_16x16x32_bf16 v[108:111], a[188:191], a[220:223], v[108:111]
  ds_read_b64_tr_b16 a[156:157], v179 offset:57344
  s_waitcnt lgkmcnt(11)
  v_mfma_f32_16x16x32_bf16 v[112:115], a[128:131], a[64:67], v[112:115]
  buffer_load_dwordx4 a[56:59], v166, s[12:15], s36 offen offset:2048 sc1
  v_mfma_f32_16x16x32_bf16 v[112:115], a[132:135], a[72:75], v[112:115]
  v_cvt_pk_bf16_f32 v96, v96, v97
  v_cvt_pk_bf16_f32 v97, v98, v99
  v_mfma_f32_16x16x32_bf16 v[120:123], a[128:131], a[68:71], v[120:123]
  v_cvt_pk_bf16_f32 v98, v100, v101
  v_cvt_pk_bf16_f32 v99, v102, v103
  v_mfma_f32_16x16x32_bf16 v[120:123], a[132:135], a[76:79], v[120:123]
  v_cvt_pk_bf16_f32 v104, v104, v105
  s_waitcnt lgkmcnt(7)
  v_mfma_f32_16x16x32_bf16 v[112:115], a[136:139], a[96:99], v[112:115]
  v_cvt_pk_bf16_f32 v105, v106, v107
  v_cvt_pk_bf16_f32 v106, v108, v109
  v_mfma_f32_16x16x32_bf16 v[112:115], a[140:143], a[104:107], v[112:115]
  v_cvt_pk_bf16_f32 v107, v110, v111
  ds_read_b64_tr_b16 a[158:159], v179 offset:61440
  v_mfma_f32_16x16x32_bf16 v[120:123], a[136:139], a[100:103], v[120:123]
  buffer_store_dwordx4 v[96:99], v166, s[16:19], s42 offen offset:0 sc1
  v_mfma_f32_16x16x32_bf16 v[120:123], a[140:143], a[108:111], v[120:123]
  ds_read_b64_tr_b16 a[160:161], v179 offset:8
  s_waitcnt lgkmcnt(5)
  v_mfma_f32_16x16x32_bf16 v[112:115], a[144:147], a[192:195], v[112:115]
  buffer_load_dwordx4 a[60:63], v166, s[12:15], s36 offen offset:3072 sc1
  v_mfma_f32_16x16x32_bf16 v[112:115], a[148:151], a[200:203], v[112:115]
  s_add_u32 s36, s36, 4096
  ds_read_b64_tr_b16 a[162:163], v179 offset:4104
  v_mfma_f32_16x16x32_bf16 v[120:123], a[144:147], a[196:199], v[120:123]
  buffer_store_dwordx4 v[104:107], v166, s[16:19], s42 offen offset:1024 sc1
  v_mfma_f32_16x16x32_bf16 v[120:123], a[148:151], a[204:207], v[120:123]
  ds_read_b64_tr_b16 a[164:165], v179 offset:8200
  ds_read_b64_tr_b16 a[166:167], v179 offset:12296
  s_waitcnt lgkmcnt(4)
  v_mfma_f32_16x16x32_bf16 v[112:115], a[152:155], a[208:211], v[112:115]
  buffer_load_dwordx4 a[80:83], v166, s[12:15], s36 offen offset:0 sc1
  v_mfma_f32_16x16x32_bf16 v[112:115], a[156:159], a[216:219], v[112:115]
  ds_read_b64_tr_b16 a[168:169], v179 offset:16392
  ds_read_b64_tr_b16 a[170:171], v179 offset:20488
  v_mfma_f32_16x16x32_bf16 v[120:123], a[152:155], a[212:215], v[120:123]
  ds_read_b64_tr_b16 a[172:173], v179 offset:24584
  ds_read_b64_tr_b16 a[174:175], v179 offset:28680
  v_mfma_f32_16x16x32_bf16 v[120:123], a[156:159], a[220:223], v[120:123]
  ds_read_b64_tr_b16 a[176:177], v179 offset:32776
  s_waitcnt lgkmcnt(5)
  v_mfma_f32_16x16x32_bf16 v[116:119], a[160:163], a[64:67], v[116:119]
  ds_read_b64_tr_b16 a[178:179], v179 offset:36872
  ds_read_b64_tr_b16 a[180:181], v179 offset:40968
  v_mfma_f32_16x16x32_bf16 v[116:119], a[164:167], a[72:75], v[116:119]
  ds_read_b64_tr_b16 a[182:183], v179 offset:45064
  ds_read_b64_tr_b16 a[184:185], v179 offset:49160
  v_mfma_f32_16x16x32_bf16 v[124:127], a[160:163], a[68:71], v[124:127]
  buffer_load_dwordx4 a[84:87], v166, s[12:15], s36 offen offset:1024 sc1
  v_mfma_f32_16x16x32_bf16 v[124:127], a[164:167], a[76:79], v[124:127]
  ds_read_b64_tr_b16 a[186:187], v179 offset:53256
  s_waitcnt lgkmcnt(6)
  v_mfma_f32_16x16x32_bf16 v[116:119], a[168:171], a[96:99], v[116:119]
  ds_read_b64_tr_b16 a[188:189], v179 offset:57352
  ds_read_b64_tr_b16 a[190:191], v179 offset:61448
  v_mfma_f32_16x16x32_bf16 v[116:119], a[172:175], a[104:107], v[116:119]
  ds_read_b64_tr_b16 a[128:129], v172 offset:0
  ds_read_b64_tr_b16 a[130:131], v172 offset:4096
  v_mfma_f32_16x16x32_bf16 v[124:127], a[168:171], a[100:103], v[124:127]
  ds_read_b64_tr_b16 a[132:133], v172 offset:8192
  ds_read_b64_tr_b16 a[134:135], v172 offset:12288
  v_mfma_f32_16x16x32_bf16 v[124:127], a[172:175], a[108:111], v[124:127]
  ds_read_b64_tr_b16 a[136:137], v172 offset:8
  s_waitcnt lgkmcnt(9)
  v_mfma_f32_16x16x32_bf16 v[116:119], a[176:179], a[192:195], v[116:119]
  ds_read_b64_tr_b16 a[138:139], v172 offset:4104
  ds_read_b64_tr_b16 a[140:141], v172 offset:8200
  v_mfma_f32_16x16x32_bf16 v[116:119], a[180:183], a[200:203], v[116:119]
  buffer_load_dwordx4 a[88:91], v166, s[12:15], s36 offen offset:2048 sc1
  v_mfma_f32_16x16x32_bf16 v[124:127], a[176:179], a[196:199], v[124:127]
  ds_read_b64_tr_b16 a[142:143], v172 offset:12296
  ds_read_b64_tr_b16 a[144:145], v173 offset:0
  v_mfma_f32_16x16x32_bf16 v[124:127], a[180:183], a[204:207], v[124:127]
  ds_read_b64_tr_b16 a[146:147], v173 offset:4096
  s_waitcnt lgkmcnt(10)
  v_mfma_f32_16x16x32_bf16 v[116:119], a[184:187], a[208:211], v[116:119]
  ds_read_b64_tr_b16 a[148:149], v173 offset:8192
  ds_read_b64_tr_b16 a[150:151], v173 offset:12288
  v_mfma_f32_16x16x32_bf16 v[116:119], a[188:191], a[216:219], v[116:119]
  v_mfma_f32_16x16x32_bf16 v[124:127], a[184:187], a[212:215], v[124:127]
  ds_read_b64_tr_b16 a[152:153], v173 offset:8
  v_mfma_f32_16x16x32_bf16 v[124:127], a[188:191], a[220:223], v[124:127]
  ds_read_b64_tr_b16 a[154:155], v173 offset:4104
  s_waitcnt lgkmcnt(10)
  v_mfma_f32_16x16x32_bf16 v[0:3], a[128:131], a[0:3], v[0:3]
  buffer_load_dwordx4 a[92:95], v166, s[12:15], s36 offen offset:3072 sc1
  v_mfma_f32_16x16x32_bf16 v[0:3], a[132:135], a[8:11], v[0:3]
  v_cvt_pk_bf16_f32 v112, v112, v113
  v_cvt_pk_bf16_f32 v113, v114, v115
  v_mfma_f32_16x16x32_bf16 v[8:11], a[128:131], a[4:7], v[8:11]
  v_cvt_pk_bf16_f32 v114, v116, v117
  v_cvt_pk_bf16_f32 v115, v118, v119
  v_mfma_f32_16x16x32_bf16 v[8:11], a[132:135], a[12:15], v[8:11]
  v_cvt_pk_bf16_f32 v120, v120, v121
  s_waitcnt lgkmcnt(6)
  v_mfma_f32_16x16x32_bf16 v[4:7], a[136:139], a[0:3], v[4:7]
  v_cvt_pk_bf16_f32 v121, v122, v123
  v_cvt_pk_bf16_f32 v122, v124, v125
  v_mfma_f32_16x16x32_bf16 v[4:7], a[140:143], a[8:11], v[4:7]
  v_cvt_pk_bf16_f32 v123, v126, v127
  s_add_u32 s36, s36, 4096
  v_mfma_f32_16x16x32_bf16 v[12:15], a[136:139], a[4:7], v[12:15]
  buffer_store_dwordx4 v[112:115], v166, s[16:19], s42 offen offset:2048 sc1
  v_mfma_f32_16x16x32_bf16 v[12:15], a[140:143], a[12:15], v[12:15]
  ds_read_b64_tr_b16 a[156:157], v173 offset:8200
  ds_read_b64_tr_b16 a[158:159], v173 offset:12296
  s_waitcnt lgkmcnt(4)
  v_mfma_f32_16x16x32_bf16 v[16:19], a[144:147], a[0:3], v[16:19]
  buffer_store_dwordx4 v[120:123], v166, s[16:19], s42 offen offset:3072 sc1
  v_mfma_f32_16x16x32_bf16 v[16:19], a[148:151], a[8:11], v[16:19]
  buffer_load_dwordx4 a[112:115], v166, s[12:15], s36 offen offset:0 sc1
  v_mfma_f32_16x16x32_bf16 v[24:27], a[144:147], a[4:7], v[24:27]
  ds_read_b64_tr_b16 a[160:161], v174 offset:0
  ds_read_b64_tr_b16 a[162:163], v174 offset:4096
  v_mfma_f32_16x16x32_bf16 v[24:27], a[148:151], a[12:15], v[24:27]
  ds_read_b64_tr_b16 a[164:165], v174 offset:8192
  ds_read_b64_tr_b16 a[166:167], v174 offset:12288
  s_waitcnt lgkmcnt(4)
  v_mfma_f32_16x16x32_bf16 v[20:23], a[152:155], a[0:3], v[20:23]
  buffer_load_dwordx4 a[116:119], v166, s[12:15], s36 offen offset:1024 sc1
  v_mfma_f32_16x16x32_bf16 v[20:23], a[156:159], a[8:11], v[20:23]
  ds_read_b64_tr_b16 a[168:169], v174 offset:8
  ds_read_b64_tr_b16 a[170:171], v174 offset:4104
  v_mfma_f32_16x16x32_bf16 v[28:31], a[152:155], a[4:7], v[28:31]
  ds_read_b64_tr_b16 a[172:173], v174 offset:8200
  ds_read_b64_tr_b16 a[174:175], v174 offset:12296
  v_mfma_f32_16x16x32_bf16 v[28:31], a[156:159], a[12:15], v[28:31]
  ds_read_b64_tr_b16 a[176:177], v175 offset:0
  s_waitcnt lgkmcnt(5)
  v_mfma_f32_16x16x32_bf16 v[32:35], a[160:163], a[0:3], v[32:35]
  ds_read_b64_tr_b16 a[178:179], v175 offset:4096
  ds_read_b64_tr_b16 a[180:181], v175 offset:8192
  v_mfma_f32_16x16x32_bf16 v[32:35], a[164:167], a[8:11], v[32:35]
  ds_read_b64_tr_b16 a[182:183], v175 offset:12288
  ds_read_b64_tr_b16 a[184:185], v175 offset:8
  v_mfma_f32_16x16x32_bf16 v[40:43], a[160:163], a[4:7], v[40:43]
  ds_read_b64_tr_b16 a[186:187], v175 offset:4104
  ds_read_b64_tr_b16 a[188:189], v175 offset:8200
  v_mfma_f32_16x16x32_bf16 v[40:43], a[164:167], a[12:15], v[40:43]
  ds_read_b64_tr_b16 a[190:191], v175 offset:12296
  s_waitcnt lgkmcnt(8)
  v_mfma_f32_16x16x32_bf16 v[36:39], a[168:171], a[0:3], v[36:39]
  buffer_load_dwordx4 a[120:123], v166, s[12:15], s36 offen offset:2048 sc1
  v_mfma_f32_16x16x32_bf16 v[36:39], a[172:175], a[8:11], v[36:39]
  ds_read_b64_tr_b16 a[128:129], v172 offset:16384
  ds_read_b64_tr_b16 a[130:131], v172 offset:20480
  v_mfma_f32_16x16x32_bf16 v[44:47], a[168:171], a[4:7], v[44:47]
  ds_read_b64_tr_b16 a[132:133], v172 offset:24576
  ds_read_b64_tr_b16 a[134:135], v172 offset:28672
  v_mfma_f32_16x16x32_bf16 v[44:47], a[172:175], a[12:15], v[44:47]
  ds_read_b64_tr_b16 a[136:137], v172 offset:16392
  s_waitcnt lgkmcnt(9)
  v_mfma_f32_16x16x32_bf16 v[48:51], a[176:179], a[0:3], v[48:51]
  ds_read_b64_tr_b16 a[138:139], v172 offset:20488
  ds_read_b64_tr_b16 a[140:141], v172 offset:24584
  v_mfma_f32_16x16x32_bf16 v[48:51], a[180:183], a[8:11], v[48:51]
  buffer_load_dwordx4 a[124:127], v166, s[12:15], s36 offen offset:3072 sc1
  v_mfma_f32_16x16x32_bf16 v[56:59], a[176:179], a[4:7], v[56:59]
  s_add_u32 s36, s36, 4096
  ds_read_b64_tr_b16 a[142:143], v172 offset:28680
  v_mfma_f32_16x16x32_bf16 v[56:59], a[180:183], a[12:15], v[56:59]
  ds_read_b64_tr_b16 a[144:145], v173 offset:16384
  s_waitcnt lgkmcnt(9)
  v_mfma_f32_16x16x32_bf16 v[52:55], a[184:187], a[0:3], v[52:55]
  ds_read_b64_tr_b16 a[146:147], v173 offset:20480
  ds_read_b64_tr_b16 a[148:149], v173 offset:24576
  v_mfma_f32_16x16x32_bf16 v[52:55], a[188:191], a[8:11], v[52:55]
  ds_read_b64_tr_b16 a[150:151], v173 offset:28672
  v_mfma_f32_16x16x32_bf16 v[60:63], a[184:187], a[4:7], v[60:63]
  ds_read_b64_tr_b16 a[152:153], v173 offset:16392
  v_mfma_f32_16x16x32_bf16 v[60:63], a[188:191], a[12:15], v[60:63]
  ds_read_b64_tr_b16 a[154:155], v173 offset:20488
  s_waitcnt lgkmcnt(10)
  v_mfma_f32_16x16x32_bf16 v[0:3], a[128:131], a[32:35], v[0:3]
  ds_read_b64_tr_b16 a[156:157], v173 offset:24584
  ds_read_b64_tr_b16 a[158:159], v173 offset:28680
  v_mfma_f32_16x16x32_bf16 v[0:3], a[132:135], a[40:43], v[0:3]
  v_mfma_f32_16x16x32_bf16 v[8:11], a[128:131], a[36:39], v[8:11]
  ds_read_b64_tr_b16 a[160:161], v174 offset:16384
  ds_read_b64_tr_b16 a[162:163], v174 offset:20480
  v_mfma_f32_16x16x32_bf16 v[8:11], a[132:135], a[44:47], v[8:11]
  ds_read_b64_tr_b16 a[164:165], v174 offset:24576
  s_waitcnt lgkmcnt(11)
  v_mfma_f32_16x16x32_bf16 v[4:7], a[136:139], a[32:35], v[4:7]
  v_bfe_u32 v250, v166, 6, 2
  ds_read_b64_tr_b16 a[166:167], v174 offset:28672
  v_mfma_f32_16x16x32_bf16 v[4:7], a[140:143], a[40:43], v[4:7]
  v_mfma_f32_16x16x32_bf16 v[12:15], a[136:139], a[36:39], v[12:15]
  v_lshrrev_b32 v251, 8, v166
  ds_read_b64_tr_b16 a[168:169], v174 offset:16392
  v_mfma_f32_16x16x32_bf16 v[12:15], a[140:143], a[44:47], v[12:15]
  ds_read_b64_tr_b16 a[170:171], v174 offset:20488
  s_waitcnt lgkmcnt(10)
  v_mfma_f32_16x16x32_bf16 v[16:19], a[144:147], a[32:35], v[16:19]
  s_mov_b32 s48, 0x3f80
  ds_read_b64_tr_b16 a[172:173], v174 offset:24584
  v_mfma_f32_16x16x32_bf16 v[16:19], a[148:151], a[40:43], v[16:19]
  ds_read_b64_tr_b16 a[174:175], v174 offset:28680
  v_mfma_f32_16x16x32_bf16 v[24:27], a[144:147], a[36:39], v[24:27]
  v_cmp_eq_u32 vcc, v250, v251
  ds_read_b64_tr_b16 a[176:177], v175 offset:16384
  v_mfma_f32_16x16x32_bf16 v[24:27], a[148:151], a[44:47], v[24:27]
  ds_read_b64_tr_b16 a[178:179], v175 offset:20480
  s_waitcnt lgkmcnt(10)
  v_mfma_f32_16x16x32_bf16 v[20:23], a[152:155], a[32:35], v[20:23]
  v_and_b32 v250, 16, v166
  ds_read_b64_tr_b16 a[180:181], v175 offset:24576
  v_mfma_f32_16x16x32_bf16 v[20:23], a[156:159], a[40:43], v[20:23]
  ds_read_b64_tr_b16 a[182:183], v175 offset:28672
  v_mfma_f32_16x16x32_bf16 v[28:31], a[152:155], a[36:39], v[28:31]
  v_lshlrev_b32 v250, v250, s48
  ds_read_b64_tr_b16 a[184:185], v175 offset:16392
  v_mfma_f32_16x16x32_bf16 v[28:31], a[156:159], a[44:47], v[28:31]
  ds_read_b64_tr_b16 a[186:187], v175 offset:20488
  s_waitcnt lgkmcnt(10)
  v_mfma_f32_16x16x32_bf16 v[32:35], a[160:163], a[32:35], v[32:35]
  v_cndmask_b32 v253, 0, v250, vcc
  ds_read_b64_tr_b16 a[188:189], v175 offset:24584
  v_mfma_f32_16x16x32_bf16 v[32:35], a[164:167], a[40:43], v[32:35]
  ds_read_b64_tr_b16 a[190:191], v175 offset:28680
  v_mfma_f32_16x16x32_bf16 v[40:43], a[160:163], a[36:39], v[40:43]
  v_and_b32 v251, 32, v166
  ds_read_b64_tr_b16 a[128:129], v172 offset:32768
  v_mfma_f32_16x16x32_bf16 v[40:43], a[164:167], a[44:47], v[40:43]
  ds_read_b64_tr_b16 a[130:131], v172 offset:36864
  s_waitcnt lgkmcnt(10)
  v_mfma_f32_16x16x32_bf16 v[36:39], a[168:171], a[32:35], v[36:39]
  v_cmp_eq_u32 vcc, 0, v251
  ds_read_b64_tr_b16 a[132:133], v172 offset:40960
  v_mfma_f32_16x16x32_bf16 v[36:39], a[172:175], a[40:43], v[36:39]
  ds_read_b64_tr_b16 a[134:135], v172 offset:45056
  v_mfma_f32_16x16x32_bf16 v[44:47], a[168:171], a[36:39], v[44:47]
  v_mov_b64 v[250:251], 0
  ds_read_b64_tr_b16 a[136:137], v172 offset:32776
  v_mfma_f32_16x16x32_bf16 v[44:47], a[172:175], a[44:47], v[44:47]
  ds_read_b64_tr_b16 a[138:139], v172 offset:36872
  s_waitcnt lgkmcnt(10)
  v_mfma_f32_16x16x32_bf16 v[48:51], a[176:179], a[32:35], v[48:51]
  v_mov_b64 v[254:255], 0
  ds_read_b64_tr_b16 a[140:141], v172 offset:40968
  v_mfma_f32_16x16x32_bf16 v[48:51], a[180:183], a[40:43], v[48:51]
  ds_read_b64_tr_b16 a[142:143], v172 offset:45064
  v_mfma_f32_16x16x32_bf16 v[56:59], a[176:179], a[36:39], v[56:59]
  v_cndmask_b32 v252, 0, v253, vcc
  ds_read_b64_tr_b16 a[144:145], v173 offset:32768
  v_mfma_f32_16x16x32_bf16 v[56:59], a[180:183], a[44:47], v[56:59]
  ds_read_b64_tr_b16 a[146:147], v173 offset:36864
  s_waitcnt lgkmcnt(10)
  v_mfma_f32_16x16x32_bf16 v[52:55], a[184:187], a[32:35], v[52:55]
  v_xor_b32 v253, v253, v252
  ds_read_b64_tr_b16 a[148:149], v173 offset:40960
  v_mfma_f32_16x16x32_bf16 v[52:55], a[188:191], a[40:43], v[52:55]
  ds_read_b64_tr_b16 a[150:151], v173 offset:45056
  v_mfma_f32_16x16x32_bf16 v[60:63], a[184:187], a[36:39], v[60:63]
  ds_read_b64_tr_b16 a[152:153], v173 offset:32776
  s_waitcnt vmcnt(28)
  v_mfma_f32_16x16x32_bf16 v[60:63], a[188:191], a[44:47], v[60:63]
  ds_read_b64_tr_b16 a[154:155], v173 offset:36872
  s_waitcnt lgkmcnt(10)
  v_mfma_f32_16x16x32_bf16 v[0:3], a[128:131], a[224:227], v[0:3]
  ds_read_b64_tr_b16 a[156:157], v173 offset:40968
  ds_read_b64_tr_b16 a[158:159], v173 offset:45064
  v_mfma_f32_16x16x32_bf16 v[0:3], a[132:135], a[232:235], v[0:3]
  v_mfma_f32_16x16x32_bf16 v[8:11], a[128:131], a[228:231], v[8:11]
  ds_read_b64_tr_b16 a[160:161], v174 offset:32768
  ds_read_b64_tr_b16 a[162:163], v174 offset:36864
  v_mfma_f32_16x16x32_bf16 v[8:11], a[132:135], a[236:239], v[8:11]
  ds_read_b64_tr_b16 a[164:165], v174 offset:40960
  s_waitcnt lgkmcnt(11)
  v_mfma_f32_16x16x32_bf16 v[4:7], a[136:139], a[224:227], v[4:7]
  ds_read_b64_tr_b16 a[166:167], v174 offset:45056
  v_mfma_f32_16x16x32_bf16 v[4:7], a[140:143], a[232:235], v[4:7]
  v_mfma_f32_16x16x32_bf16 v[12:15], a[136:139], a[228:231], v[12:15]
  ds_read_b64_tr_b16 a[168:169], v174 offset:32776
  ds_read_b64_tr_b16 a[170:171], v174 offset:36872
  v_mfma_f32_16x16x32_bf16 v[12:15], a[140:143], a[236:239], v[12:15]
  ds_read_b64_tr_b16 a[172:173], v174 offset:40968
  s_waitcnt lgkmcnt(11)
  v_mfma_f32_16x16x32_bf16 v[16:19], a[144:147], a[224:227], v[16:19]
  ds_read_b64_tr_b16 a[174:175], v174 offset:45064
  v_mfma_f32_16x16x32_bf16 v[16:19], a[148:151], a[232:235], v[16:19]
  v_mfma_f32_16x16x32_bf16 v[24:27], a[144:147], a[228:231], v[24:27]
  ds_read_b64_tr_b16 a[176:177], v175 offset:32768
  ds_read_b64_tr_b16 a[178:179], v175 offset:36864
  v_mfma_f32_16x16x32_bf16 v[24:27], a[148:151], a[236:239], v[24:27]
  ds_read_b64_tr_b16 a[180:181], v175 offset:40960
  s_waitcnt lgkmcnt(11)
  v_mfma_f32_16x16x32_bf16 v[20:23], a[152:155], a[224:227], v[20:23]
  ds_read_b64_tr_b16 a[182:183], v175 offset:45056
  v_mfma_f32_16x16x32_bf16 v[20:23], a[156:159], a[232:235], v[20:23]
  v_mfma_f32_16x16x32_bf16 v[28:31], a[152:155], a[228:231], v[28:31]
  ds_read_b64_tr_b16 a[184:185], v175 offset:32776
  ds_read_b64_tr_b16 a[186:187], v175 offset:36872
  v_mfma_f32_16x16x32_bf16 v[28:31], a[156:159], a[236:239], v[28:31]
  s_waitcnt vmcnt(4)
  s_mov_b64 exec, 1
  buffer_atomic_add v244, v232, s[4:7], s51 offen sc0 sc1
  s_mov_b64 exec, -1
  s_waitcnt lgkmcnt(10)
  v_mfma_f32_16x16x32_bf16 v[32:35], a[160:163], a[224:227], v[32:35]
  ds_read_b64_tr_b16 a[188:189], v175 offset:40968
  ds_read_b64_tr_b16 a[190:191], v175 offset:45064
  v_mfma_f32_16x16x32_bf16 v[32:35], a[164:167], a[232:235], v[32:35]
  v_mfma_f32_16x16x32_bf16 v[40:43], a[160:163], a[228:231], v[40:43]
  ds_read_b64_tr_b16 a[128:129], v172 offset:49152
  ds_read_b64_tr_b16 a[130:131], v172 offset:53248
  v_mfma_f32_16x16x32_bf16 v[40:43], a[164:167], a[236:239], v[40:43]
  ds_read_b64_tr_b16 a[132:133], v172 offset:57344
  s_waitcnt lgkmcnt(11)
  v_mfma_f32_16x16x32_bf16 v[36:39], a[168:171], a[224:227], v[36:39]
  ds_read_b64_tr_b16 a[134:135], v172 offset:61440
  v_mfma_f32_16x16x32_bf16 v[36:39], a[172:175], a[232:235], v[36:39]
  v_mfma_f32_16x16x32_bf16 v[44:47], a[168:171], a[228:231], v[44:47]
  ds_read_b64_tr_b16 a[136:137], v172 offset:49160
  ds_read_b64_tr_b16 a[138:139], v172 offset:53256
  v_mfma_f32_16x16x32_bf16 v[44:47], a[172:175], a[236:239], v[44:47]
  ds_read_b64_tr_b16 a[140:141], v172 offset:57352
  s_waitcnt lgkmcnt(11)
  v_mfma_f32_16x16x32_bf16 v[48:51], a[176:179], a[224:227], v[48:51]
  ds_read_b64_tr_b16 a[142:143], v172 offset:61448
  v_mfma_f32_16x16x32_bf16 v[48:51], a[180:183], a[232:235], v[48:51]
  v_mfma_f32_16x16x32_bf16 v[56:59], a[176:179], a[228:231], v[56:59]
  ds_read_b64_tr_b16 a[144:145], v173 offset:49152
  ds_read_b64_tr_b16 a[146:147], v173 offset:53248
  v_mfma_f32_16x16x32_bf16 v[56:59], a[180:183], a[236:239], v[56:59]
  ds_read_b64_tr_b16 a[148:149], v173 offset:57344
  s_waitcnt lgkmcnt(11)
  v_mfma_f32_16x16x32_bf16 v[52:55], a[184:187], a[224:227], v[52:55]
  ds_read_b64_tr_b16 a[150:151], v173 offset:61440
  v_mfma_f32_16x16x32_bf16 v[52:55], a[188:191], a[232:235], v[52:55]
  v_mfma_f32_16x16x32_bf16 v[60:63], a[184:187], a[228:231], v[60:63]
  ds_read_b64_tr_b16 a[152:153], v173 offset:49160
  v_mfma_f32_16x16x32_bf16 v[60:63], a[188:191], a[236:239], v[60:63]
  ds_read_b64_tr_b16 a[154:155], v173 offset:53256
  s_waitcnt lgkmcnt(10)
  v_mfma_f32_16x16x32_bf16 v[0:3], a[128:131], a[240:243], v[0:3]
  ds_read_b64_tr_b16 a[156:157], v173 offset:57352
  ds_read_b64_tr_b16 a[158:159], v173 offset:61448
  v_mfma_f32_16x16x32_bf16 v[0:3], a[132:135], a[248:251], v[0:3]
  v_mfma_f32_16x16x32_bf16 v[8:11], a[128:131], a[244:247], v[8:11]
  ds_read_b64_tr_b16 a[160:161], v174 offset:49152
  ds_read_b64_tr_b16 a[162:163], v174 offset:53248
  v_mfma_f32_16x16x32_bf16 v[8:11], a[132:135], a[252:255], v[8:11]
  ds_read_b64_tr_b16 a[164:165], v174 offset:57344
  s_waitcnt lgkmcnt(11)
  v_mfma_f32_16x16x32_bf16 v[4:7], a[136:139], a[240:243], v[4:7]
  ds_read_b64_tr_b16 a[166:167], v174 offset:61440
  v_mfma_f32_16x16x32_bf16 v[4:7], a[140:143], a[248:251], v[4:7]
  v_mfma_f32_16x16x32_bf16 v[12:15], a[136:139], a[244:247], v[12:15]
  ds_read_b64_tr_b16 a[168:169], v174 offset:49160
  ds_read_b64_tr_b16 a[170:171], v174 offset:53256
  v_mfma_f32_16x16x32_bf16 v[12:15], a[140:143], a[252:255], v[12:15]
  ds_read_b64_tr_b16 a[172:173], v174 offset:57352
  s_waitcnt lgkmcnt(11)
  v_mfma_f32_16x16x32_bf16 v[16:19], a[144:147], a[240:243], v[16:19]
  ds_read_b64_tr_b16 a[174:175], v174 offset:61448
  v_mfma_f32_16x16x32_bf16 v[16:19], a[148:151], a[248:251], v[16:19]
  v_mfma_f32_16x16x32_bf16 v[24:27], a[144:147], a[244:247], v[24:27]
  ds_read_b64_tr_b16 a[176:177], v175 offset:49152
  ds_read_b64_tr_b16 a[178:179], v175 offset:53248
  v_mfma_f32_16x16x32_bf16 v[24:27], a[148:151], a[252:255], v[24:27]
  ds_read_b64_tr_b16 a[180:181], v175 offset:57344
  s_waitcnt lgkmcnt(11)
  v_mfma_f32_16x16x32_bf16 v[20:23], a[152:155], a[240:243], v[20:23]
  ds_read_b64_tr_b16 a[182:183], v175 offset:61440
  v_mfma_f32_16x16x32_bf16 v[20:23], a[156:159], a[248:251], v[20:23]
  v_mfma_f32_16x16x32_bf16 v[28:31], a[152:155], a[244:247], v[28:31]
  ds_read_b64_tr_b16 a[184:185], v175 offset:49160
  ds_read_b64_tr_b16 a[186:187], v175 offset:53256
  v_mfma_f32_16x16x32_bf16 v[28:31], a[156:159], a[252:255], v[28:31]
  ds_read_b64_tr_b16 a[188:189], v175 offset:57352
  s_waitcnt lgkmcnt(11)
  v_mfma_f32_16x16x32_bf16 v[32:35], a[160:163], a[240:243], v[32:35]
  ds_read_b64_tr_b16 a[190:191], v175 offset:61448
  v_mfma_f32_16x16x32_bf16 v[32:35], a[164:167], a[248:251], v[32:35]
  v_mfma_f32_16x16x32_bf16 v[40:43], a[160:163], a[244:247], v[40:43]
  ds_read_b64_tr_b16 a[128:129], v176 offset:0
  ds_read_b64_tr_b16 a[130:131], v176 offset:4096
  v_mfma_f32_16x16x32_bf16 v[40:43], a[164:167], a[252:255], v[40:43]
  ds_read_b64_tr_b16 a[132:133], v176 offset:8192
  s_waitcnt lgkmcnt(11)
  v_mfma_f32_16x16x32_bf16 v[36:39], a[168:171], a[240:243], v[36:39]
  ds_read_b64_tr_b16 a[134:135], v176 offset:12288
  v_mfma_f32_16x16x32_bf16 v[36:39], a[172:175], a[248:251], v[36:39]
  v_mfma_f32_16x16x32_bf16 v[44:47], a[168:171], a[244:247], v[44:47]
  ds_read_b64_tr_b16 a[136:137], v176 offset:8
  ds_read_b64_tr_b16 a[138:139], v176 offset:4104
  v_mfma_f32_16x16x32_bf16 v[44:47], a[172:175], a[252:255], v[44:47]
  ds_read_b64_tr_b16 a[140:141], v176 offset:8200
  s_waitcnt lgkmcnt(11)
  v_mfma_f32_16x16x32_bf16 v[48:51], a[176:179], a[240:243], v[48:51]
  ds_read_b64_tr_b16 a[142:143], v176 offset:12296
  v_mfma_f32_16x16x32_bf16 v[48:51], a[180:183], a[248:251], v[48:51]
  v_mfma_f32_16x16x32_bf16 v[56:59], a[176:179], a[244:247], v[56:59]
  ds_read_b64_tr_b16 a[144:145], v177 offset:0
  ds_read_b64_tr_b16 a[146:147], v177 offset:4096
  v_mfma_f32_16x16x32_bf16 v[56:59], a[180:183], a[252:255], v[56:59]
  ds_read_b64_tr_b16 a[148:149], v177 offset:8192
  s_waitcnt lgkmcnt(11)
  v_mfma_f32_16x16x32_bf16 v[52:55], a[184:187], a[240:243], v[52:55]
  ds_read_b64_tr_b16 a[150:151], v177 offset:12288
  v_mfma_f32_16x16x32_bf16 v[52:55], a[188:191], a[248:251], v[52:55]
  v_mfma_f32_16x16x32_bf16 v[60:63], a[184:187], a[244:247], v[60:63]
  ds_read_b64_tr_b16 a[152:153], v177 offset:8
  v_mfma_f32_16x16x32_bf16 v[60:63], a[188:191], a[252:255], v[60:63]
  ds_read_b64_tr_b16 a[154:155], v177 offset:4104
  s_waitcnt lgkmcnt(10)
  v_mfma_f32_16x16x32_bf16 v[0:3], a[128:131], a[16:19], v[0:3]
  ds_read_b64_tr_b16 a[156:157], v177 offset:8200
  ds_read_b64_tr_b16 a[158:159], v177 offset:12296
  v_mfma_f32_16x16x32_bf16 v[0:3], a[132:135], a[24:27], v[0:3]
  v_mfma_f32_16x16x32_bf16 v[8:11], a[128:131], a[20:23], v[8:11]
  ds_read_b64_tr_b16 a[160:161], v178 offset:0
  ds_read_b64_tr_b16 a[162:163], v178 offset:4096
  v_mfma_f32_16x16x32_bf16 v[8:11], a[132:135], a[28:31], v[8:11]
  ds_read_b64_tr_b16 a[164:165], v178 offset:8192
  s_waitcnt lgkmcnt(11)
  v_mfma_f32_16x16x32_bf16 v[4:7], a[136:139], a[16:19], v[4:7]
  ds_read_b64_tr_b16 a[166:167], v178 offset:12288
  v_mfma_f32_16x16x32_bf16 v[4:7], a[140:143], a[24:27], v[4:7]
  v_mfma_f32_16x16x32_bf16 v[12:15], a[136:139], a[20:23], v[12:15]
  ds_read_b64_tr_b16 a[168:169], v178 offset:8
  ds_read_b64_tr_b16 a[170:171], v178 offset:4104
  v_mfma_f32_16x16x32_bf16 v[12:15], a[140:143], a[28:31], v[12:15]
  ds_read_b64_tr_b16 a[172:173], v178 offset:8200
  s_waitcnt lgkmcnt(11)
  v_mfma_f32_16x16x32_bf16 v[16:19], a[144:147], a[16:19], v[16:19]
  ds_read_b64_tr_b16 a[174:175], v178 offset:12296
  v_mfma_f32_16x16x32_bf16 v[16:19], a[148:151], a[24:27], v[16:19]
  v_mfma_f32_16x16x32_bf16 v[24:27], a[144:147], a[20:23], v[24:27]
  ds_read_b64_tr_b16 a[176:177], v179 offset:0
  ds_read_b64_tr_b16 a[178:179], v179 offset:4096
  v_mfma_f32_16x16x32_bf16 v[24:27], a[148:151], a[28:31], v[24:27]
  ds_read_b64_tr_b16 a[180:181], v179 offset:8192
  s_waitcnt lgkmcnt(11)
  v_mfma_f32_16x16x32_bf16 v[20:23], a[152:155], a[16:19], v[20:23]
  ds_read_b64_tr_b16 a[182:183], v179 offset:12288
  v_mfma_f32_16x16x32_bf16 v[20:23], a[156:159], a[24:27], v[20:23]
  v_mfma_f32_16x16x32_bf16 v[28:31], a[152:155], a[20:23], v[28:31]
  ds_read_b64_tr_b16 a[184:185], v179 offset:8
  ds_read_b64_tr_b16 a[186:187], v179 offset:4104
  v_mfma_f32_16x16x32_bf16 v[28:31], a[156:159], a[28:31], v[28:31]
  ds_read_b64_tr_b16 a[188:189], v179 offset:8200
  s_waitcnt lgkmcnt(11)
  v_mfma_f32_16x16x32_bf16 v[32:35], a[160:163], a[16:19], v[32:35]
  buffer_load_dwordx4 v[240:243], v181, s[4:7], s50 offen sc0 sc1
  v_mfma_f32_16x16x32_bf16 v[32:35], a[164:167], a[24:27], v[32:35]
  ds_read_b64_tr_b16 a[190:191], v179 offset:12296
  v_mfma_f32_16x16x32_bf16 v[40:43], a[160:163], a[20:23], v[40:43]
  ds_read_b64_tr_b16 a[128:129], v176 offset:16384
  ds_read_b64_tr_b16 a[130:131], v176 offset:20480
  v_mfma_f32_16x16x32_bf16 v[40:43], a[164:167], a[28:31], v[40:43]
  ds_read_b64_tr_b16 a[132:133], v176 offset:24576
  s_waitcnt lgkmcnt(11)
  v_mfma_f32_16x16x32_bf16 v[36:39], a[168:171], a[16:19], v[36:39]
  ds_read_b64_tr_b16 a[134:135], v176 offset:28672
  v_mfma_f32_16x16x32_bf16 v[36:39], a[172:175], a[24:27], v[36:39]
  v_mfma_f32_16x16x32_bf16 v[44:47], a[168:171], a[20:23], v[44:47]
  ds_read_b64_tr_b16 a[136:137], v176 offset:16392
  ds_read_b64_tr_b16 a[138:139], v176 offset:20488
  v_mfma_f32_16x16x32_bf16 v[44:47], a[172:175], a[28:31], v[44:47]
  ds_read_b64_tr_b16 a[140:141], v176 offset:24584
  s_waitcnt lgkmcnt(11)
  v_mfma_f32_16x16x32_bf16 v[48:51], a[176:179], a[16:19], v[48:51]
  ds_read_b64_tr_b16 a[142:143], v176 offset:28680
  v_mfma_f32_16x16x32_bf16 v[48:51], a[180:183], a[24:27], v[48:51]
  v_mfma_f32_16x16x32_bf16 v[56:59], a[176:179], a[20:23], v[56:59]
  ds_read_b64_tr_b16 a[144:145], v177 offset:16384
  ds_read_b64_tr_b16 a[146:147], v177 offset:20480
  v_mfma_f32_16x16x32_bf16 v[56:59], a[180:183], a[28:31], v[56:59]
  ds_read_b64_tr_b16 a[148:149], v177 offset:24576
  s_waitcnt lgkmcnt(11)
  v_mfma_f32_16x16x32_bf16 v[52:55], a[184:187], a[16:19], v[52:55]
  ds_read_b64_tr_b16 a[150:151], v177 offset:28672
  v_mfma_f32_16x16x32_bf16 v[52:55], a[188:191], a[24:27], v[52:55]
  v_mfma_f32_16x16x32_bf16 v[60:63], a[184:187], a[20:23], v[60:63]
  ds_read_b64_tr_b16 a[152:153], v177 offset:16392
  v_mfma_f32_16x16x32_bf16 v[60:63], a[188:191], a[28:31], v[60:63]
  ds_read_b64_tr_b16 a[154:155], v177 offset:20488
  s_waitcnt lgkmcnt(10)
  v_mfma_f32_16x16x32_bf16 v[0:3], a[128:131], a[48:51], v[0:3]
  ds_read_b64_tr_b16 a[156:157], v177 offset:24584
  ds_read_b64_tr_b16 a[158:159], v177 offset:28680
  v_mfma_f32_16x16x32_bf16 v[0:3], a[132:135], a[56:59], v[0:3]
  v_mfma_f32_16x16x32_bf16 v[8:11], a[128:131], a[52:55], v[8:11]
  ds_read_b64_tr_b16 a[160:161], v178 offset:16384
  ds_read_b64_tr_b16 a[162:163], v178 offset:20480
  v_mfma_f32_16x16x32_bf16 v[8:11], a[132:135], a[60:63], v[8:11]
  ds_read_b64_tr_b16 a[164:165], v178 offset:24576
  s_waitcnt lgkmcnt(11)
  v_mfma_f32_16x16x32_bf16 v[4:7], a[136:139], a[48:51], v[4:7]
  ds_read_b64_tr_b16 a[166:167], v178 offset:28672
  v_mfma_f32_16x16x32_bf16 v[4:7], a[140:143], a[56:59], v[4:7]
  v_mfma_f32_16x16x32_bf16 v[12:15], a[136:139], a[52:55], v[12:15]
  ds_read_b64_tr_b16 a[168:169], v178 offset:16392
  ds_read_b64_tr_b16 a[170:171], v178 offset:20488
  v_mfma_f32_16x16x32_bf16 v[12:15], a[140:143], a[60:63], v[12:15]
  ds_read_b64_tr_b16 a[172:173], v178 offset:24584
  s_waitcnt lgkmcnt(11)
  v_mfma_f32_16x16x32_bf16 v[16:19], a[144:147], a[48:51], v[16:19]
  ds_read_b64_tr_b16 a[174:175], v178 offset:28680
  v_mfma_f32_16x16x32_bf16 v[16:19], a[148:151], a[56:59], v[16:19]
  v_mfma_f32_16x16x32_bf16 v[24:27], a[144:147], a[52:55], v[24:27]
  ds_read_b64_tr_b16 a[176:177], v179 offset:16384
  ds_read_b64_tr_b16 a[178:179], v179 offset:20480
  v_mfma_f32_16x16x32_bf16 v[24:27], a[148:151], a[60:63], v[24:27]
  ds_read_b64_tr_b16 a[180:181], v179 offset:24576
  s_waitcnt lgkmcnt(11)
  v_mfma_f32_16x16x32_bf16 v[20:23], a[152:155], a[48:51], v[20:23]
  ds_read_b64_tr_b16 a[182:183], v179 offset:28672
  v_mfma_f32_16x16x32_bf16 v[20:23], a[156:159], a[56:59], v[20:23]
  v_mfma_f32_16x16x32_bf16 v[28:31], a[152:155], a[52:55], v[28:31]
  ds_read_b64_tr_b16 a[184:185], v179 offset:16392
  ds_read_b64_tr_b16 a[186:187], v179 offset:20488
  v_mfma_f32_16x16x32_bf16 v[28:31], a[156:159], a[60:63], v[28:31]
  ds_read_b64_tr_b16 a[188:189], v179 offset:24584
  s_waitcnt lgkmcnt(11)
  v_mfma_f32_16x16x32_bf16 v[32:35], a[160:163], a[48:51], v[32:35]
  ds_read_b64_tr_b16 a[190:191], v179 offset:28680
  v_mfma_f32_16x16x32_bf16 v[32:35], a[164:167], a[56:59], v[32:35]
  v_mfma_f32_16x16x32_bf16 v[40:43], a[160:163], a[52:55], v[40:43]
  ds_read_b64_tr_b16 a[128:129], v176 offset:32768
  ds_read_b64_tr_b16 a[130:131], v176 offset:36864
  v_mfma_f32_16x16x32_bf16 v[40:43], a[164:167], a[60:63], v[40:43]
  ds_read_b64_tr_b16 a[132:133], v176 offset:40960
  s_waitcnt lgkmcnt(11)
  v_mfma_f32_16x16x32_bf16 v[36:39], a[168:171], a[48:51], v[36:39]
  ds_read_b64_tr_b16 a[134:135], v176 offset:45056
  v_mfma_f32_16x16x32_bf16 v[36:39], a[172:175], a[56:59], v[36:39]
  v_mfma_f32_16x16x32_bf16 v[44:47], a[168:171], a[52:55], v[44:47]
  ds_read_b64_tr_b16 a[136:137], v176 offset:32776
  ds_read_b64_tr_b16 a[138:139], v176 offset:36872
  v_mfma_f32_16x16x32_bf16 v[44:47], a[172:175], a[60:63], v[44:47]
  ds_read_b64_tr_b16 a[140:141], v176 offset:40968
  s_waitcnt lgkmcnt(11)
  v_mfma_f32_16x16x32_bf16 v[48:51], a[176:179], a[48:51], v[48:51]
  s_waitcnt vmcnt(0)
  v_readfirstlane_b32 s47, v240
  v_readfirstlane_b32 s48, v241
  v_mfma_f32_16x16x32_bf16 v[48:51], a[180:183], a[56:59], v[48:51]
  s_cmp_eq_u32 s35, 0
  s_cselect_b32 s47, s47, s48
  s_cselect_b32 s66, s43, 0
  v_mfma_f32_16x16x32_bf16 v[56:59], a[176:179], a[52:55], v[56:59]
  ds_read_b64_tr_b16 a[142:143], v176 offset:45064
  ds_read_b64_tr_b16 a[144:145], v177 offset:32768
  v_mfma_f32_16x16x32_bf16 v[56:59], a[180:183], a[60:63], v[56:59]
  s_cmp_lg_u32 s47, 0
  s_cselect_b32 s22, 0x4000, 0
  s_waitcnt lgkmcnt(9)
  v_mfma_f32_16x16x32_bf16 v[52:55], a[184:187], a[48:51], v[52:55]
  buffer_load_dwordx4 v[68:71], v166, s[20:23], 0 offen offset:0 sc1
  v_mfma_f32_16x16x32_bf16 v[52:55], a[188:191], a[56:59], v[52:55]
  ds_read_b64_tr_b16 a[146:147], v177 offset:36864
  ds_read_b64_tr_b16 a[148:149], v177 offset:40960
  v_mfma_f32_16x16x32_bf16 v[60:63], a[184:187], a[52:55], v[60:63]
  ds_read_b64_tr_b16 a[150:151], v177 offset:45056
  v_mfma_f32_16x16x32_bf16 v[60:63], a[188:191], a[60:63], v[60:63]
  ds_read_b64_tr_b16 a[152:153], v177 offset:32776
  s_waitcnt lgkmcnt(9)
  v_mfma_f32_16x16x32_bf16 v[0:3], a[128:131], a[80:83], v[0:3]
  buffer_load_dwordx4 v[128:131], v166, s[64:67], 0 offen offset:0 sc0 sc1
  v_mfma_f32_16x16x32_bf16 v[0:3], a[132:135], a[88:91], v[0:3]
  buffer_load_dwordx4 v[76:79], v166, s[20:23], 0 offen offset:1024 sc1
  v_mfma_f32_16x16x32_bf16 v[8:11], a[128:131], a[84:87], v[8:11]
  buffer_load_dwordx4 v[132:135], v166, s[64:67], 0 offen offset:1024 sc0 sc1
  v_mfma_f32_16x16x32_bf16 v[8:11], a[132:135], a[92:95], v[8:11]
  ds_read_b64_tr_b16 a[154:155], v177 offset:36872
  s_waitcnt lgkmcnt(6)
  v_mfma_f32_16x16x32_bf16 v[4:7], a[136:139], a[80:83], v[4:7]
  ds_read_b64_tr_b16 a[156:157], v177 offset:40968
  ds_read_b64_tr_b16 a[158:159], v177 offset:45064
  v_mfma_f32_16x16x32_bf16 v[4:7], a[140:143], a[88:91], v[4:7]
  buffer_load_dwordx4 v[84:87], v166, s[20:23], 0 offen offset:2048 sc1
  v_mfma_f32_16x16x32_bf16 v[12:15], a[136:139], a[84:87], v[12:15]
  ds_read_b64_tr_b16 a[160:161], v178 offset:32768
  ds_read_b64_tr_b16 a[162:163], v178 offset:36864
  v_mfma_f32_16x16x32_bf16 v[12:15], a[140:143], a[92:95], v[12:15]
  ds_read_b64_tr_b16 a[164:165], v178 offset:40960
  s_waitcnt lgkmcnt(7)
  v_mfma_f32_16x16x32_bf16 v[16:19], a[144:147], a[80:83], v[16:19]
  buffer_load_dwordx4 v[136:139], v166, s[64:67], 0 offen offset:2048 sc0 sc1
  v_mfma_f32_16x16x32_bf16 v[16:19], a[148:151], a[88:91], v[16:19]
  buffer_load_dwordx4 v[92:95], v166, s[20:23], 0 offen offset:3072 sc1
  v_mfma_f32_16x16x32_bf16 v[24:27], a[144:147], a[84:87], v[24:27]
  ds_read_b64_tr_b16 a[166:167], v178 offset:45056
  ds_read_b64_tr_b16 a[168:169], v178 offset:32776
  v_mfma_f32_16x16x32_bf16 v[24:27], a[148:151], a[92:95], v[24:27]
  ds_read_b64_tr_b16 a[170:171], v178 offset:36872
  s_waitcnt lgkmcnt(6)
  v_mfma_f32_16x16x32_bf16 v[20:23], a[152:155], a[80:83], v[20:23]
  buffer_load_dwordx4 v[140:143], v166, s[64:67], 0 offen offset:3072 sc0 sc1
  v_mfma_f32_16x16x32_bf16 v[20:23], a[156:159], a[88:91], v[20:23]
  ds_read_b64_tr_b16 a[172:173], v178 offset:40968
  ds_read_b64_tr_b16 a[174:175], v178 offset:45064
  v_mfma_f32_16x16x32_bf16 v[28:31], a[152:155], a[84:87], v[28:31]
  buffer_load_dwordx4 v[100:103], v166, s[20:23], s42 offen offset:0 sc1
  v_mfma_f32_16x16x32_bf16 v[28:31], a[156:159], a[92:95], v[28:31]
  ds_read_b64_tr_b16 a[176:177], v179 offset:32768
  s_waitcnt lgkmcnt(5)
  v_mfma_f32_16x16x32_bf16 v[32:35], a[160:163], a[80:83], v[32:35]
  buffer_load_dwordx4 v[144:147], v166, s[64:67], s42 offen offset:0 sc0 sc1
  v_mfma_f32_16x16x32_bf16 v[32:35], a[164:167], a[88:91], v[32:35]
  ds_read_b64_tr_b16 a[178:179], v179 offset:36864
  ds_read_b64_tr_b16 a[180:181], v179 offset:40960
  v_mfma_f32_16x16x32_bf16 v[40:43], a[160:163], a[84:87], v[40:43]
  buffer_load_dwordx4 v[108:111], v166, s[20:23], s42 offen offset:1024 sc1
  v_mfma_f32_16x16x32_bf16 v[40:43], a[164:167], a[92:95], v[40:43]
  ds_read_b64_tr_b16 a[182:183], v179 offset:45056
  s_waitcnt lgkmcnt(4)
  v_mfma_f32_16x16x32_bf16 v[36:39], a[168:171], a[80:83], v[36:39]
  buffer_load_dwordx4 v[148:151], v166, s[64:67], s42 offen offset:1024 sc0 sc1
  v_mfma_f32_16x16x32_bf16 v[36:39], a[172:175], a[88:91], v[36:39]
  ds_read_b64_tr_b16 a[184:185], v179 offset:32776
  ds_read_b64_tr_b16 a[186:187], v179 offset:36872
  v_mfma_f32_16x16x32_bf16 v[44:47], a[168:171], a[84:87], v[44:47]
  ds_read_b64_tr_b16 a[188:189], v179 offset:40968
  ds_read_b64_tr_b16 a[190:191], v179 offset:45064
  v_mfma_f32_16x16x32_bf16 v[44:47], a[172:175], a[92:95], v[44:47]
  ds_read_b64_tr_b16 a[128:129], v176 offset:49152
  s_waitcnt lgkmcnt(5)
  v_mfma_f32_16x16x32_bf16 v[48:51], a[176:179], a[80:83], v[48:51]
  buffer_load_dwordx4 v[116:119], v166, s[20:23], s42 offen offset:2048 sc1
  v_mfma_f32_16x16x32_bf16 v[48:51], a[180:183], a[88:91], v[48:51]
  buffer_load_dwordx4 v[160:163], v166, s[64:67], s42 offen offset:2048 sc0 sc1
  v_mfma_f32_16x16x32_bf16 v[56:59], a[176:179], a[84:87], v[56:59]
  ds_read_b64_tr_b16 a[130:131], v176 offset:53248
  ds_read_b64_tr_b16 a[132:133], v176 offset:57344
  v_mfma_f32_16x16x32_bf16 v[56:59], a[180:183], a[92:95], v[56:59]
  ds_read_b64_tr_b16 a[134:135], v176 offset:61440
  s_waitcnt lgkmcnt(4)
  v_mfma_f32_16x16x32_bf16 v[52:55], a[184:187], a[80:83], v[52:55]
  buffer_load_dwordx4 v[124:127], v166, s[20:23], s42 offen offset:3072 sc1
  v_mfma_f32_16x16x32_bf16 v[52:55], a[188:191], a[88:91], v[52:55]
  buffer_load_dwordx4 v[168:171], v166, s[64:67], s42 offen offset:3072 sc0 sc1
  v_mfma_f32_16x16x32_bf16 v[60:63], a[184:187], a[84:87], v[60:63]
  ds_read_b64_tr_b16 a[136:137], v176 offset:49160
  v_mfma_f32_16x16x32_bf16 v[60:63], a[188:191], a[92:95], v[60:63]
  ds_read_b64_tr_b16 a[138:139], v176 offset:53256
  ds_read_b64_tr_b16 a[140:141], v176 offset:57352
  ds_read_b64_tr_b16 a[142:143], v176 offset:61448
  s_waitcnt lgkmcnt(4)
  v_mfma_f32_16x16x32_bf16 v[0:3], a[128:131], a[112:115], v[0:3]
  ds_read_b64_tr_b16 a[144:145], v177 offset:49152
  ds_read_b64_tr_b16 a[146:147], v177 offset:53248
  v_mfma_f32_16x16x32_bf16 v[0:3], a[132:135], a[120:123], v[0:3]
  ds_read_b64_tr_b16 a[148:149], v177 offset:57344
  ds_read_b64_tr_b16 a[150:151], v177 offset:61440
  v_mfma_f32_16x16x32_bf16 v[8:11], a[128:131], a[116:119], v[8:11]
  ds_read_b64_tr_b16 a[152:153], v177 offset:49160
  ds_read_b64_tr_b16 a[154:155], v177 offset:53256
  v_mfma_f32_16x16x32_bf16 v[8:11], a[132:135], a[124:127], v[8:11]
  ds_read_b64_tr_b16 a[156:157], v177 offset:57352
  s_waitcnt lgkmcnt(7)
  v_mfma_f32_16x16x32_bf16 v[4:7], a[136:139], a[112:115], v[4:7]
  buffer_load_dwordx4 v[240:243], v181, s[4:7], s50 offen sc0 sc1
  v_mfma_f32_16x16x32_bf16 v[4:7], a[140:143], a[120:123], v[4:7]
  ds_read_b64_tr_b16 a[158:159], v177 offset:61448
  ds_read_b64_tr_b16 a[160:161], v178 offset:49152
  v_mfma_f32_16x16x32_bf16 v[12:15], a[136:139], a[116:119], v[12:15]
  ds_read_b64_tr_b16 a[162:163], v178 offset:53248
  ds_read_b64_tr_b16 a[164:165], v178 offset:57344
  v_mfma_f32_16x16x32_bf16 v[12:15], a[140:143], a[124:127], v[12:15]
  ds_read_b64_tr_b16 a[166:167], v178 offset:61440
  s_waitcnt lgkmcnt(8)
  v_mfma_f32_16x16x32_bf16 v[16:19], a[144:147], a[112:115], v[16:19]
  ds_read_b64_tr_b16 a[168:169], v178 offset:49160
  ds_read_b64_tr_b16 a[170:171], v178 offset:53256
  v_mfma_f32_16x16x32_bf16 v[16:19], a[148:151], a[120:123], v[16:19]
  ds_read_b64_tr_b16 a[172:173], v178 offset:57352
  ds_read_b64_tr_b16 a[174:175], v178 offset:61448
  v_mfma_f32_16x16x32_bf16 v[24:27], a[144:147], a[116:119], v[24:27]
  ds_read_b64_tr_b16 a[176:177], v179 offset:49152
  ds_read_b64_tr_b16 a[178:179], v179 offset:53248
  v_mfma_f32_16x16x32_bf16 v[24:27], a[148:151], a[124:127], v[24:27]
  ds_read_b64_tr_b16 a[180:181], v179 offset:57344
  s_waitcnt lgkmcnt(11)
  v_mfma_f32_16x16x32_bf16 v[20:23], a[152:155], a[112:115], v[20:23]
  ds_read_b64_tr_b16 a[182:183], v179 offset:61440
  v_mfma_f32_16x16x32_bf16 v[20:23], a[156:159], a[120:123], v[20:23]
  v_mfma_f32_16x16x32_bf16 v[28:31], a[152:155], a[116:119], v[28:31]
  ds_read_b64_tr_b16 a[184:185], v179 offset:49160
  ds_read_b64_tr_b16 a[186:187], v179 offset:53256
  v_mfma_f32_16x16x32_bf16 v[28:31], a[156:159], a[124:127], v[28:31]
  ds_read_b64_tr_b16 a[188:189], v179 offset:57352
  s_waitcnt lgkmcnt(11)
  v_mfma_f32_16x16x32_bf16 v[32:35], a[160:163], a[112:115], v[32:35]
  ds_read_b64_tr_b16 a[190:191], v179 offset:61448
  v_mfma_f32_16x16x32_bf16 v[32:35], a[164:167], a[120:123], v[32:35]
  v_mfma_f32_16x16x32_bf16 v[40:43], a[160:163], a[116:119], v[40:43]
  v_mfma_f32_16x16x32_bf16 v[40:43], a[164:167], a[124:127], v[40:43]
  s_waitcnt lgkmcnt(8)
  v_mfma_f32_16x16x32_bf16 v[36:39], a[168:171], a[112:115], v[36:39]
  v_mfma_f32_16x16x32_bf16 v[36:39], a[172:175], a[120:123], v[36:39]
  v_mfma_f32_16x16x32_bf16 v[44:47], a[168:171], a[116:119], v[44:47]
  v_mfma_f32_16x16x32_bf16 v[44:47], a[172:175], a[124:127], v[44:47]
  s_waitcnt lgkmcnt(4)
  v_mfma_f32_16x16x32_bf16 v[48:51], a[176:179], a[112:115], v[48:51]
  v_mfma_f32_16x16x32_bf16 v[48:51], a[180:183], a[120:123], v[48:51]
  v_mfma_f32_16x16x32_bf16 v[56:59], a[176:179], a[116:119], v[56:59]
  v_mfma_f32_16x16x32_bf16 v[56:59], a[180:183], a[124:127], v[56:59]
  s_waitcnt lgkmcnt(0)
  v_mfma_f32_16x16x32_bf16 v[52:55], a[184:187], a[112:115], v[52:55]
  v_mfma_f32_16x16x32_bf16 v[52:55], a[188:191], a[120:123], v[52:55]
  v_mfma_f32_16x16x32_bf16 v[60:63], a[184:187], a[116:119], v[60:63]
  v_mfma_f32_16x16x32_bf16 v[60:63], a[188:191], a[124:127], v[60:63]
L3_epi:
  s_waitcnt lgkmcnt(0)
  s_cmp_lg_u32 s47, 0
  s_cbranch_scc1 L3_add
  s_mov_b32 s22, 0x4000
  s_cmp_eq_u32 s94, 0
  s_cselect_b32 s49, 1024, 4
  s_branch L3_q1w
L3_q1:
  buffer_load_dwordx4 v[240:243], v181, s[4:7], s50 offen sc0 sc1
L3_q1w:
  s_waitcnt vmcnt(0)
  v_readfirstlane_b32 s48, v240
  v_readfirstlane_b32 s47, v241
  v_readfirstlane_b32 s56, v242
  s_cmp_eq_u32 s35, 0
  s_cselect_b32 s48, s48, s47
  s_cselect_b32 s56, s56, 0
  s_cmp_lg_u32 s48, 0
  s_cbranch_scc1 L3_got
  s_sub_u32 s49, s49, 1
  s_cmp_lg_u32 s49, 0
  s_cbranch_scc1 L3_q1
  s_add_u32 s16, s20, 33554432
  s_addc_u32 s17, s21, 0
  buffer_store_dwordx4 v[0:3], v166, s[16:19], 0 offen offset:0 sc1
  buffer_store_dwordx4 v[4:7], v166, s[16:19], 0 offen offset:1024 sc1
  buffer_store_dwordx4 v[8:11], v166, s[16:19], 0 offen offset:2048 sc1
  buffer_store_dwordx4 v[12:15], v166, s[16:19], 0 offen offset:3072 sc1
  buffer_store_dwordx4 v[16:19], v166, s[16:19], s42 offen offset:0 sc1
  buffer_store_dwordx4 v[20:23], v166, s[16:19], s42 offen offset:1024 sc1
  buffer_store_dwordx4 v[24:27], v166, s[16:19], s42 offen offset:2048 sc1
  buffer_store_dwordx4 v[28:31], v166, s[16:19], s42 offen offset:3072 sc1
  buffer_store_dwordx4 v[32:35], v166, s[16:19], s43 offen offset:0 sc1
  buffer_store_dwordx4 v[36:39], v166, s[16:19], s43 offen offset:1024 sc1
  buffer_store_dwordx4 v[40:43], v166, s[16:19], s43 offen offset:2048 sc1
  buffer_store_dwordx4 v[44:47], v166, s[16:19], s43 offen offset:3072 sc1
  buffer_store_dwordx4 v[48:51], v166, s[16:19], s44 offen offset:0 sc1
  buffer_store_dwordx4 v[52:55], v166, s[16:19], s44 offen offset:1024 sc1
  buffer_store_dwordx4 v[56:59], v166, s[16:19], s44 offen offset:2048 sc1
  buffer_store_dwordx4 v[60:63], v166, s[16:19], s44 offen offset:3072 sc1
  s_lshl_b32 s48, s35, 2
  s_add_u32 s48, s48, s50
  v_mov_b32 v182, 1
  s_waitcnt vmcnt(0)
  s_mov_b64 exec, 1
  buffer_atomic_add v182, v232, s[4:7], s48 offen sc0 sc1
  s_mov_b64 exec, -1
  s_waitcnt vmcnt(0)
  v_readfirstlane_b32 s48, v182
  s_mov_b32 s56, 0
  s_cmp_eq_u32 s48, 0
  s_cbranch_scc1 L3_next
L3_got:
  buffer_load_dwordx4 v[68:71], v166, s[20:23], 0 offen offset:0 sc1
  buffer_load_dwordx4 v[128:131], v166, s[64:67], 0 offen offset:0 sc0 sc1
  buffer_load_dwordx4 v[76:79], v166, s[20:23], 0 offen offset:1024 sc1
  buffer_load_dwordx4 v[132:135], v166, s[64:67], 0 offen offset:1024 sc0 sc1
  buffer_load_dwordx4 v[84:87], v166, s[20:23], 0 offen offset:2048 sc1
  buffer_load_dwordx4 v[136:139], v166, s[64:67], 0 offen offset:2048 sc0 sc1
  buffer_load_dwordx4 v[92:95], v166, s[20:23], 0 offen offset:3072 sc1
  buffer_load_dwordx4 v[140:143], v166, s[64:67], 0 offen offset:3072 sc0 sc1
  buffer_load_dwordx4 v[100:103], v166, s[20:23], s42 offen offset:0 sc1
  buffer_load_dwordx4 v[144:147], v166, s[64:67], s42 offen offset:0 sc0 sc1
  buffer_load_dwordx4 v[108:111], v166, s[20:23], s42 offen offset:1024 sc1
  buffer_load_dwordx4 v[148:151], v166, s[64:67], s42 offen offset:1024 sc0 sc1
  buffer_load_dwordx4 v[116:119], v166, s[20:23], s42 offen offset:2048 sc1
  buffer_load_dwordx4 v[160:163], v166, s[64:67], s42 offen offset:2048 sc0 sc1
  buffer_load_dwordx4 v[124:127], v166, s[20:23], s42 offen offset:3072 sc1
  buffer_load_dwordx4 v[168:171], v166, s[64:67], s42 offen offset:3072 sc0 sc1
  buffer_load_dword v182, v181, s[4:7], s50 offen offset:8 sc0 sc1
L3_add:
  s_mov_b32 s56, -2
  s_cmp_eq_u32 s94, 0
  s_cselect_b32 s57, 64, 2
  s_cmp_eq_u32 s35, 0
  s_cbranch_scc1 L3_finish
  s_branch L3_silu
L3_x0:
  s_waitcnt vmcnt(0)
  buffer_load_dwordx4 v[128:131], v166, s[64:67], 0 offen offset:0 sc0 sc1
  buffer_load_dwordx4 v[132:135], v166, s[64:67], 0 offen offset:1024 sc0 sc1
  buffer_load_dwordx4 v[136:139], v166, s[64:67], 0 offen offset:2048 sc0 sc1
  buffer_load_dwordx4 v[140:143], v166, s[64:67], 0 offen offset:3072 sc0 sc1
  buffer_load_dwordx4 v[144:147], v166, s[64:67], s42 offen offset:0 sc0 sc1
  buffer_load_dwordx4 v[148:151], v166, s[64:67], s42 offen offset:1024 sc0 sc1
  buffer_load_dwordx4 v[160:163], v166, s[64:67], s42 offen offset:2048 sc0 sc1
  buffer_load_dwordx4 v[168:171], v166, s[64:67], s42 offen offset:3072 sc0 sc1
  v_mfma_f32_16x16x32_bf16 v[8:11], v[252:255], v[76:79], v[8:11]
  v_mfma_f32_16x16x32_bf16 v[12:15], v[250:253], v[76:79], v[12:15]
  v_mfma_f32_16x16x32_bf16 v[16:19], v[252:255], v[84:87], v[16:19]
  v_mfma_f32_16x16x32_bf16 v[20:23], v[250:253], v[84:87], v[20:23]
  v_mfma_f32_16x16x32_bf16 v[24:27], v[252:255], v[92:95], v[24:27]
  v_mfma_f32_16x16x32_bf16 v[28:31], v[250:253], v[92:95], v[28:31]
  v_mfma_f32_16x16x32_bf16 v[32:35], v[252:255], v[100:103], v[32:35]
  v_mfma_f32_16x16x32_bf16 v[36:39], v[250:253], v[100:103], v[36:39]
  v_mfma_f32_16x16x32_bf16 v[40:43], v[252:255], v[108:111], v[40:43]
  v_mfma_f32_16x16x32_bf16 v[44:47], v[250:253], v[108:111], v[44:47]
  v_mfma_f32_16x16x32_bf16 v[48:51], v[252:255], v[116:119], v[48:51]
  v_mfma_f32_16x16x32_bf16 v[52:55], v[250:253], v[116:119], v[52:55]
  v_mfma_f32_16x16x32_bf16 v[56:59], v[252:255], v[124:127], v[56:59]
  v_mfma_f32_16x16x32_bf16 v[60:63], v[250:253], v[124:127], v[60:63]
  s_branch L3_f0
L3_r0:
  s_sub_u32 s57, s57, 1
  s_cbranch_scc1 L3_slow
  s_waitcnt vmcnt(0)
  buffer_load_dwordx4 v[128:131], v166, s[64:67], 0 offen offset:0 sc0 sc1
  buffer_load_dwordx4 v[132:135], v166, s[64:67], 0 offen offset:1024 sc0 sc1
  buffer_load_dwordx4 v[136:139], v166, s[64:67], 0 offen offset:2048 sc0 sc1
  buffer_load_dwordx4 v[140:143], v166, s[64:67], 0 offen offset:3072 sc0 sc1
  buffer_load_dwordx4 v[144:147], v166, s[64:67], s42 offen offset:0 sc0 sc1
  buffer_load_dwordx4 v[148:151], v166, s[64:67], s42 offen offset:1024 sc0 sc1
  buffer_load_dwordx4 v[160:163], v166, s[64:67], s42 offen offset:2048 sc0 sc1
  buffer_load_dwordx4 v[168:171], v166, s[64:67], s42 offen offset:3072 sc0 sc1
  s_branch L3_f0
L3_x1:
  s_waitcnt vmcnt(1)
  buffer_load_dwordx4 v[132:135], v166, s[64:67], 0 offen offset:1024 sc0 sc1
  buffer_load_dwordx4 v[136:139], v166, s[64:67], 0 offen offset:2048 sc0 sc1
  buffer_load_dwordx4 v[140:143], v166, s[64:67], 0 offen offset:3072 sc0 sc1
  buffer_load_dwordx4 v[144:147], v166, s[64:67], s42 offen offset:0 sc0 sc1
  buffer_load_dwordx4 v[148:151], v166, s[64:67], s42 offen offset:1024 sc0 sc1
  buffer_load_dwordx4 v[160:163], v166, s[64:67], s42 offen offset:2048 sc0 sc1
  buffer_load_dwordx4 v[168:171], v166, s[64:67], s42 offen offset:3072 sc0 sc1
  buffer_load_dword v182, v181, s[4:7], s50 offen offset:8 sc0 sc1
  v_mfma_f32_16x16x32_bf16 v[16:19], v[252:255], v[84:87], v[16:19]
  v_mfma_f32_16x16x32_bf16 v[20:23], v[250:253], v[84:87], v[20:23]
  v_mfma_f32_16x16x32_bf16 v[24:27], v[252:255], v[92:95], v[24:27]
  v_mfma_f32_16x16x32_bf16 v[28:31], v[250:253], v[92:95], v[28:31]
  v_mfma_f32_16x16x32_bf16 v[32:35], v[252:255], v[100:103], v[32:35]
  v_mfma_f32_16x16x32_bf16 v[36:39], v[250:253], v[100:103], v[36:39]
  v_mfma_f32_16x16x32_bf16 v[40:43], v[252:255], v[108:111], v[40:43]
  v_mfma_f32_16x16x32_bf16 v[44:47], v[250:253], v[108:111], v[44:47]
  v_mfma_f32_16x16x32_bf16 v[48:51], v[252:255], v[116:119], v[48:51]
  v_mfma_f32_16x16x32_bf16 v[52:55], v[250:253], v[116:119], v[52:55]
  v_mfma_f32_16x16x32_bf16 v[56:59], v[252:255], v[124:127], v[56:59]
  v_mfma_f32_16x16x32_bf16 v[60:63], v[250:253], v[124:127], v[60:63]
  s_branch L3_f1
L3_r1:
  s_sub_u32 s57, s57, 1
  s_cbranch_scc1 L3_slow
  s_waitcnt vmcnt(1)
  buffer_load_dwordx4 v[132:135], v166, s[64:67], 0 offen offset:1024 sc0 sc1
  buffer_load_dwordx4 v[136:139], v166, s[64:67], 0 offen offset:2048 sc0 sc1
  buffer_load_dwordx4 v[140:143], v166, s[64:67], 0 offen offset:3072 sc0 sc1
  buffer_load_dwordx4 v[144:147], v166, s[64:67], s42 offen offset:0 sc0 sc1
  buffer_load_dwordx4 v[148:151], v166, s[64:67], s42 offen offset:1024 sc0 sc1
  buffer_load_dwordx4 v[160:163], v166, s[64:67], s42 offen offset:2048 sc0 sc1
  buffer_load_dwordx4 v[168:171], v166, s[64:67], s42 offen offset:3072 sc0 sc1
  buffer_load_dword v182, v181, s[4:7], s50 offen offset:8 sc0 sc1
  s_branch L3_f1
L3_x2:
  s_waitcnt vmcnt(2)
  buffer_load_dwordx4 v[136:139], v166, s[64:67], 0 offen offset:2048 sc0 sc1
  buffer_load_dwordx4 v[140:143], v166, s[64:67], 0 offen offset:3072 sc0 sc1
  buffer_load_dwordx4 v[144:147], v166, s[64:67], s42 offen offset:0 sc0 sc1
  buffer_load_dwordx4 v[148:151], v166, s[64:67], s42 offen offset:1024 sc0 sc1
  buffer_load_dwordx4 v[160:163], v166, s[64:67], s42 offen offset:2048 sc0 sc1
  buffer_load_dwordx4 v[168:171], v166, s[64:67], s42 offen offset:3072 sc0 sc1
  buffer_load_dword v182, v181, s[4:7], s50 offen offset:8 sc0 sc1
  buffer_load_dword v182, v181, s[4:7], s50 offen offset:8 sc0 sc1
  v_mfma_f32_16x16x32_bf16 v[24:27], v[252:255], v[92:95], v[24:27]
  v_mfma_f32_16x16x32_bf16 v[28:31], v[250:253], v[92:95], v[28:31]
  v_mfma_f32_16x16x32_bf16 v[32:35], v[252:255], v[100:103], v[32:35]
  v_mfma_f32_16x16x32_bf16 v[36:39], v[250:253], v[100:103], v[36:39]
  v_mfma_f32_16x16x32_bf16 v[40:43], v[252:255], v[108:111], v[40:43]
  v_mfma_f32_16x16x32_bf16 v[44:47], v[250:253], v[108:111], v[44:47]
  v_mfma_f32_16x16x32_bf16 v[48:51], v[252:255], v[116:119], v[48:51]
  v_mfma_f32_16x16x32_bf16 v[52:55], v[250:253], v[116:119], v[52:55]
  v_mfma_f32_16x16x32_bf16 v[56:59], v[252:255], v[124:127], v[56:59]
  v_mfma_f32_16x16x32_bf16 v[60:63], v[250:253], v[124:127], v[60:63]
  s_branch L3_f2
L3_r2:
  s_sub_u32 s57, s57, 1
  s_cbranch_scc1 L3_slow
  s_waitcnt vmcnt(2)
  buffer_load_dwordx4 v[136:139], v166, s[64:67], 0 offen offset:2048 sc0 sc1
  buffer_load_dwordx4 v[140:143], v166, s[64:67], 0 offen offset:3072 sc0 sc1
  buffer_load_dwordx4 v[144:147], v166, s[64:67], s42 offen offset:0 sc0 sc1
  buffer_load_dwordx4 v[148:151], v166, s[64:67], s42 offen offset:1024 sc0 sc1
  buffer_load_dwordx4 v[160:163], v166, s[64:67], s42 offen offset:2048 sc0 sc1
  buffer_load_dwordx4 v[168:171], v166, s[64:67], s42 offen offset:3072 sc0 sc1
  buffer_load_dword v182, v181, s[4:7], s50 offen offset:8 sc0 sc1
  buffer_load_dword v182, v181, s[4:7], s50 offen offset:8 sc0 sc1
  s_branch L3_f2
L3_x3:
  s_waitcnt vmcnt(3)
  buffer_load_dwordx4 v[140:143], v166, s[64:67], 0 offen offset:3072 sc0 sc1
  buffer_load_dwordx4 v[144:147], v166, s[64:67], s42 offen offset:0 sc0 sc1
  buffer_load_dwordx4 v[148:151], v166, s[64:67], s42 offen offset:1024 sc0 sc1
  buffer_load_dwordx4 v[160:163], v166, s[64:67], s42 offen offset:2048 sc0 sc1
  buffer_load_dwordx4 v[168:171], v166, s[64:67], s42 offen offset:3072 sc0 sc1
  buffer_load_dword v182, v181, s[4:7], s50 offen offset:8 sc0 sc1
  buffer_load_dword v182, v181, s[4:7], s50 offen offset:8 sc0 sc1
  buffer_load_dword v182, v181, s[4:7], s50 offen offset:8 sc0 sc1
  v_mfma_f32_16x16x32_bf16 v[32:35], v[252:255], v[100:103], v[32:35]
  v_mfma_f32_16x16x32_bf16 v[36:39], v[250:253], v[100:103], v[36:39]
  v_mfma_f32_16x16x32_bf16 v[40:43], v[252:255], v[108:111], v[40:43]
  v_mfma_f32_16x16x32_bf16 v[44:47], v[250:253], v[108:111], v[44:47]
  v_mfma_f32_16x16x32_bf16 v[48:51], v[252:255], v[116:119], v[48:51]
  v_mfma_f32_16x16x32_bf16 v[52:55], v[250:253], v[116:119], v[52:55]
  v_mfma_f32_16x16x32_bf16 v[56:59], v[252:255], v[124:127], v[56:59]
  v_mfma_f32_16x16x32_bf16 v[60:63], v[250:253], v[124:127], v[60:63]
  s_branch L3_f3
L3_r3:
  s_sub_u32 s57, s57, 1
  s_cbranch_scc1 L3_slow
  s_waitcnt vmcnt(3)
  buffer_load_dwordx4 v[140:143], v166, s[64:67], 0 offen offset:3072 sc0 sc1
  buffer_load_dwordx4 v[144:147], v166, s[64:67], s42 offen offset:0 sc0 sc1
  buffer_load_dwordx4 v[148:151], v166, s[64:67], s42 offen offset:1024 sc0 sc1
  buffer_load_dwordx4 v[160:163], v166, s[64:67], s42 offen offset:2048 sc0 sc1
  buffer_load_dwordx4 v[168:171], v166, s[64:67], s42 offen offset:3072 sc0 sc1
  buffer_load_dword v182, v181, s[4:7], s50 offen offset:8 sc0 sc1
  buffer_load_dword v182, v181, s[4:7], s50 offen offset:8 sc0 sc1
  buffer_load_dword v182, v181, s[4:7], s50 offen offset:8 sc0 sc1
  s_branch L3_f3
L3_x4:
  s_waitcnt vmcnt(4)
  buffer_load_dwordx4 v[144:147], v166, s[64:67], s42 offen offset:0 sc0 sc1
  buffer_load_dwordx4 v[148:151], v166, s[64:67], s42 offen offset:1024 sc0 sc1
  buffer_load_dwordx4 v[160:163], v166, s[64:67], s42 offen offset:2048 sc0 sc1
  buffer_load_dwordx4 v[168:171], v166, s[64:67], s42 offen offset:3072 sc0 sc1
  buffer_load_dword v182, v181, s[4:7], s50 offen offset:8 sc0 sc1
  buffer_load_dword v182, v181, s[4:7], s50 offen offset:8 sc0 sc1
  buffer_load_dword v182, v181, s[4:7], s50 offen offset:8 sc0 sc1
  buffer_load_dword v182, v181, s[4:7], s50 offen offset:8 sc0 sc1
  v_mfma_f32_16x16x32_bf16 v[40:43], v[252:255], v[108:111], v[40:43]
  v_mfma_f32_16x16x32_bf16 v[44:47], v[250:253], v[108:111], v[44:47]
  v_mfma_f32_16x16x32_bf16 v[48:51], v[252:255], v[116:119], v[48:51]
  v_mfma_f32_16x16x32_bf16 v[52:55], v[250:253], v[116:119], v[52:55]
  v_mfma_f32_16x16x32_bf16 v[56:59], v[252:255], v[124:127], v[56:59]
  v_mfma_f32_16x16x32_bf16 v[60:63], v[250:253], v[124:127], v[60:63]
  s_branch L3_f4
L3_r4:
  s_sub_u32 s57, s57, 1
  s_cbranch_scc1 L3_slow
  s_waitcnt vmcnt(4)
  buffer_load_dwordx4 v[144:147], v166, s[64:67], s42 offen offset:0 sc0 sc1
  buffer_load_dwordx4 v[148:151], v166, s[64:67], s42 offen offset:1024 sc0 sc1
  buffer_load_dwordx4 v[160:163], v166, s[64:67], s42 offen offset:2048 sc0 sc1
  buffer_load_dwordx4 v[168:171], v166, s[64:67], s42 offen offset:3072 sc0 sc1
  buffer_load_dword v182, v181, s[4:7], s50 offen offset:8 sc0 sc1
  buffer_load_dword v182, v181, s[4:7], s50 offen offset:8 sc0 sc1
  buffer_load_dword v182, v181, s[4:7], s50 offen offset:8 sc0 sc1
  buffer_load_dword v182, v181, s[4:7], s50 offen offset:8 sc0 sc1
  s_branch L3_f4
L3_x5:
  s_waitcnt vmcnt(5)
  buffer_load_dwordx4 v[148:151], v166, s[64:67], s42 offen offset:1024 sc0 sc1
  buffer_load_dwordx4 v[160:163], v166, s[64:67], s42 offen offset:2048 sc0 sc1
  buffer_load_dwordx4 v[168:171], v166, s[64:67], s42 offen offset:3072 sc0 sc1
  buffer_load_dword v182, v181, s[4:7], s50 offen offset:8 sc0 sc1
  buffer_load_dword v182, v181, s[4:7], s50 offen offset:8 sc0 sc1
  buffer_load_dword v182, v181, s[4:7], s50 offen offset:8 sc0 sc1
  buffer_load_dword v182, v181, s[4:7], s50 offen offset:8 sc0 sc1
  buffer_load_dword v182, v181, s[4:7], s50 offen offset:8 sc0 sc1
  v_mfma_f32_16x16x32_bf16 v[48:51], v[252:255], v[116:119], v[48:51]
  v_mfma_f32_16x16x32_bf16 v[52:55], v[250:253], v[116:119], v[52:55]
  v_mfma_f32_16x16x32_bf16 v[56:59], v[252:255], v[124:127], v[56:59]
  v_mfma_f32_16x16x32_bf16 v[60:63], v[250:253], v[124:127], v[60:63]
  s_branch L3_f5
L3_r5:
  s_sub_u32 s57, s57, 1
  s_cbranch_scc1 L3_slow
  s_waitcnt vmcnt(5)
  buffer_load_dwordx4 v[148:151], v166, s[64:67], s42 offen offset:1024 sc0 sc1
  buffer_load_dwordx4 v[160:163], v166, s[64:67], s42 offen offset:2048 sc0 sc1
  buffer_load_dwordx4 v[168:171], v166, s[64:67], s42 offen offset:3072 sc0 sc1
  buffer_load_dword v182, v181, s[4:7], s50 offen offset:8 sc0 sc1
  buffer_load_dword v182, v181, s[4:7], s50 offen offset:8 sc0 sc1
  buffer_load_dword v182, v181, s[4:7], s50 offen offset:8 sc0 sc1
  buffer_load_dword v182, v181, s[4:7], s50 offen offset:8 sc0 sc1
  buffer_load_dword v182, v181, s[4:7], s50 offen offset:8 sc0 sc1
  s_branch L3_f5
L3_x6:
  s_waitcnt vmcnt(6)
  buffer_load_dwordx4 v[160:163], v166, s[64:67], s42 offen offset:2048 sc0 sc1
  buffer_load_dwordx4 v[168:171], v166, s[64:67], s42 offen offset:3072 sc0 sc1
  buffer_load_dword v182, v181, s[4:7], s50 offen offset:8 sc0 sc1
  buffer_load_dword v182, v181, s[4:7], s50 offen offset:8 sc0 sc1
  buffer_load_dword v182, v181, s[4:7], s50 offen offset:8 sc0 sc1
  buffer_load_dword v182, v181, s[4:7], s50 offen offset:8 sc0 sc1
  buffer_load_dword v182, v181, s[4:7], s50 offen offset:8 sc0 sc1
  buffer_load_dword v182, v181, s[4:7], s50 offen offset:8 sc0 sc1
  v_mfma_f32_16x16x32_bf16 v[56:59], v[252:255], v[124:127], v[56:59]
  v_mfma_f32_16x16x32_bf16 v[60:63], v[250:253], v[124:127], v[60:63]
  s_branch L3_f6
L3_r6:
  s_sub_u32 s57, s57, 1
  s_cbranch_scc1 L3_slow
  s_waitcnt vmcnt(6)
  buffer_load_dwordx4 v[160:163], v166, s[64:67], s42 offen offset:2048 sc0 sc1
  buffer_load_dwordx4 v[168:171], v166, s[64:67], s42 offen offset:3072 sc0 sc1
  buffer_load_dword v182, v181, s[4:7], s50 offen offset:8 sc0 sc1
  buffer_load_dword v182, v181, s[4:7], s50 offen offset:8 sc0 sc1
  buffer_load_dword v182, v181, s[4:7], s50 offen offset:8 sc0 sc1
  buffer_load_dword v182, v181, s[4:7], s50 offen offset:8 sc0 sc1
  buffer_load_dword v182, v181, s[4:7], s50 offen offset:8 sc0 sc1
  buffer_load_dword v182, v181, s[4:7], s50 offen offset:8 sc0 sc1
  s_branch L3_f6
L3_x7:
  buffer_load_dwordx4 v[168:171], v166, s[64:67], s42 offen offset:3072 sc0 sc1
  buffer_load_dword v182, v181, s[4:7], s50 offen offset:8 sc0 sc1
  buffer_load_dword v182, v181, s[4:7], s50 offen offset:8 sc0 sc1
  buffer_load_dword v182, v181, s[4:7], s50 offen offset:8 sc0 sc1
  buffer_load_dword v182, v181, s[4:7], s50 offen offset:8 sc0 sc1
  buffer_load_dword v182, v181, s[4:7], s50 offen offset:8 sc0 sc1
  buffer_load_dword v182, v181, s[4:7], s50 offen offset:8 sc0 sc1
  buffer_load_dword v182, v181, s[4:7], s50 offen offset:8 sc0 sc1
  s_branch L3_f7
L3_r7:
  s_sub_u32 s57, s57, 1
  s_cbranch_scc1 L3_slow
  s_waitcnt vmcnt(7)
  buffer_load_dwordx4 v[168:171], v166, s[64:67], s42 offen offset:3072 sc0 sc1
  buffer_load_dword v182, v181, s[4:7], s50 offen offset:8 sc0 sc1
  buffer_load_dword v182, v181, s[4:7], s50 offen offset:8 sc0 sc1
  buffer_load_dword v182, v181, s[4:7], s50 offen offset:8 sc0 sc1
  buffer_load_dword v182, v181, s[4:7], s50 offen offset:8 sc0 sc1
  buffer_load_dword v182, v181, s[4:7], s50 offen offset:8 sc0 sc1
  buffer_load_dword v182, v181, s[4:7], s50 offen offset:8 sc0 sc1
  buffer_load_dword v182, v181, s[4:7], s50 offen offset:8 sc0 sc1
  s_branch L3_f7
L3_slow:
  s_waitcnt vmcnt(0)
  s_cmp_eq_u32 s94, 0
  s_cselect_b32 s49, 1024, 4
L3_q2:
  buffer_load_dword v182, v181, s[4:7], s50 offen offset:8 sc0 sc1
  s_waitcnt vmcnt(0)
  v_readfirstlane_b32 s48, v182
  s_nop 1
  s_cmp_lg_u32 s48, 0
  s_cbranch_scc1 L3_fin0
  s_sub_u32 s49, s49, 1
  s_cmp_lg_u32 s49, 0
  s_cbranch_scc1 L3_q2
  v_cvt_pk_bf16_f32 v64, v0, v1
  v_cvt_pk_bf16_f32 v65, v2, v3
  v_cvt_pk_bf16_f32 v66, v4, v5
  v_cvt_pk_bf16_f32 v67, v6, v7
  buffer_store_dwordx4 v[64:67], v166, s[68:71], 0 offen offset:0 sc1
  v_cvt_pk_bf16_f32 v72, v8, v9
  v_cvt_pk_bf16_f32 v73, v10, v11
  v_cvt_pk_bf16_f32 v74, v12, v13
  v_cvt_pk_bf16_f32 v75, v14, v15
  buffer_store_dwordx4 v[72:75], v166, s[68:71], 0 offen offset:1024 sc1
  v_cvt_pk_bf16_f32 v80, v16, v17
  v_cvt_pk_bf16_f32 v81, v18, v19
  v_cvt_pk_bf16_f32 v82, v20, v21
  v_cvt_pk_bf16_f32 v83, v22, v23
  buffer_store_dwordx4 v[80:83], v166, s[68:71], 0 offen offset:2048 sc1
  v_cvt_pk_bf16_f32 v88, v24, v25
  v_cvt_pk_bf16_f32 v89, v26, v27
  v_cvt_pk_bf16_f32 v90, v28, v29
  v_cvt_pk_bf16_f32 v91, v30, v31
  buffer_store_dwordx4 v[88:91], v166, s[68:71], 0 offen offset:3072 sc1
  v_cvt_pk_bf16_f32 v96, v32, v33
  v_cvt_pk_bf16_f32 v97, v34, v35
  v_cvt_pk_bf16_f32 v98, v36, v37
  v_cvt_pk_bf16_f32 v99, v38, v39
  buffer_store_dwordx4 v[96:99], v166, s[68:71], s42 offen offset:0 sc1
  v_cvt_pk_bf16_f32 v104, v40, v41
  v_cvt_pk_bf16_f32 v105, v42, v43
  v_cvt_pk_bf16_f32 v106, v44, v45
  v_cvt_pk_bf16_f32 v107, v46, v47
  buffer_store_dwordx4 v[104:107], v166, s[68:71], s42 offen offset:1024 sc1
  v_cvt_pk_bf16_f32 v112, v48, v49
  v_cvt_pk_bf16_f32 v113, v50, v51
  v_cvt_pk_bf16_f32 v114, v52, v53
  v_cvt_pk_bf16_f32 v115, v54, v55
  buffer_store_dwordx4 v[112:115], v166, s[68:71], s42 offen offset:2048 sc1
  v_cvt_pk_bf16_f32 v120, v56, v57
  v_cvt_pk_bf16_f32 v121, v58, v59
  v_cvt_pk_bf16_f32 v122, v60, v61
  v_cvt_pk_bf16_f32 v123, v62, v63
  buffer_store_dwordx4 v[120:123], v166, s[68:71], s42 offen offset:3072 sc1
  s_branch L3_pub
L3_silu:
  v_mov_b32 v152, v220
  v_mov_b32 v153, v222
  v_rcp_f32 v221, v220
  v_rcp_f32 v223, v222
  v_mul_f32 v220, 0xbfb8aa3b, v220
  v_mul_f32 v222, 0xbfb8aa3b, v222
  s_waitcnt vmcnt(16)
  v_mfma_f32_16x16x32_bf16 v[0:3], v[252:255], v[68:71], v[0:3]
  v_mfma_f32_16x16x32_bf16 v[4:7], v[250:253], v[68:71], v[4:7]
  s_waitcnt vmcnt(14)
  v_mfma_f32_16x16x32_bf16 v[8:11], v[252:255], v[76:79], v[8:11]
  v_mfma_f32_16x16x32_bf16 v[12:15], v[250:253], v[76:79], v[12:15]
  s_nop 4
  v_pk_mul_f32 v[64:65], v[0:1], v[220:221] op_sel_hi:[1,0]
  v_pk_mul_f32 v[66:67], v[2:3], v[220:221] op_sel_hi:[1,0]
  v_pk_mul_f32 v[68:69], v[4:5], v[220:221] op_sel_hi:[1,0]
  v_pk_mul_f32 v[70:71], v[6:7], v[220:221] op_sel_hi:[1,0]
  v_exp_f32 v64, v64
  v_exp_f32 v65, v65
  v_exp_f32 v66, v66
  v_exp_f32 v67, v67
  v_exp_f32 v68, v68
  v_exp_f32 v69, v69
  v_exp_f32 v70, v70
  v_exp_f32 v71, v71
  v_pk_fma_f32 v[64:65], v[64:65], v[220:221], v[220:221] op_sel:[0,1,1]
  v_pk_fma_f32 v[66:67], v[66:67], v[220:221], v[220:221] op_sel:[0,1,1]
  v_pk_fma_f32 v[68:69], v[68:69], v[220:221], v[220:221] op_sel:[0,1,1]
  v_pk_fma_f32 v[70:71], v[70:71], v[220:221], v[220:221] op_sel:[0,1,1]
  v_rcp_f32 v64, v64
  v_rcp_f32 v65, v65
  v_rcp_f32 v66, v66
  v_rcp_f32 v67, v67
  v_rcp_f32 v68, v68
  v_rcp_f32 v69, v69
  v_rcp_f32 v70, v70
  v_rcp_f32 v71, v71
  v_pk_mul_f32 v[0:1], v[0:1], v[64:65]
  v_pk_mul_f32 v[2:3], v[2:3], v[66:67]
  v_pk_mul_f32 v[4:5], v[4:5], v[68:69]
  v_pk_mul_f32 v[6:7], v[6:7], v[70:71]
  v_cvt_pk_bf16_f32 v64, v0, v1
  v_cvt_pk_bf16_f32 v65, v2, v3
  v_cvt_pk_bf16_f32 v66, v4, v5
  v_cvt_pk_bf16_f32 v67, v6, v7
  buffer_store_dwordx4 v[64:67], v166, s[68:71], 0 offen offset:0 sc1
  s_waitcnt vmcnt(13)
  v_mfma_f32_16x16x32_bf16 v[16:19], v[252:255], v[84:87], v[16:19]
  v_mfma_f32_16x16x32_bf16 v[20:23], v[250:253], v[84:87], v[20:23]
  v_pk_mul_f32 v[72:73], v[8:9], v[222:223] op_sel_hi:[1,0]
  v_pk_mul_f32 v[74:75], v[10:11], v[222:223] op_sel_hi:[1,0]
  v_pk_mul_f32 v[76:77], v[12:13], v[222:223] op_sel_hi:[1,0]
  v_pk_mul_f32 v[78:79], v[14:15], v[222:223] op_sel_hi:[1,0]
  v_exp_f32 v72, v72
  v_exp_f32 v73, v73
  v_exp_f32 v74, v74
  v_exp_f32 v75, v75
  v_exp_f32 v76, v76
  v_exp_f32 v77, v77
  v_exp_f32 v78, v78
  v_exp_f32 v79, v79
  v_pk_fma_f32 v[72:73], v[72:73], v[222:223], v[222:223] op_sel:[0,1,1]
  v_pk_fma_f32 v[74:75], v[74:75], v[222:223], v[222:223] op_sel:[0,1,1]
  v_pk_fma_f32 v[76:77], v[76:77], v[222:223], v[222:223] op_sel:[0,1,1]
  v_pk_fma_f32 v[78:79], v[78:79], v[222:223], v[222:223] op_sel:[0,1,1]
  v_rcp_f32 v72, v72
  v_rcp_f32 v73, v73
  v_rcp_f32 v74, v74
  v_rcp_f32 v75, v75
  v_rcp_f32 v76, v76
  v_rcp_f32 v77, v77
  v_rcp_f32 v78, v78
  v_rcp_f32 v79, v79
  v_pk_mul_f32 v[8:9], v[8:9], v[72:73]
  v_pk_mul_f32 v[10:11], v[10:11], v[74:75]
  v_pk_mul_f32 v[12:13], v[12:13], v[76:77]
  v_pk_mul_f32 v[14:15], v[14:15], v[78:79]
  v_cvt_pk_bf16_f32 v72, v8, v9
  v_cvt_pk_bf16_f32 v73, v10, v11
  v_cvt_pk_bf16_f32 v74, v12, v13
  v_cvt_pk_bf16_f32 v75, v14, v15
  buffer_store_dwordx4 v[72:75], v166, s[68:71], 0 offen offset:1024 sc1
  s_waitcnt vmcnt(12)
  v_mfma_f32_16x16x32_bf16 v[24:27], v[252:255], v[92:95], v[24:27]
  v_mfma_f32_16x16x32_bf16 v[28:31], v[250:253], v[92:95], v[28:31]
  v_pk_mul_f32 v[80:81], v[16:17], v[220:221] op_sel_hi:[1,0]
  v_pk_mul_f32 v[82:83], v[18:19], v[220:221] op_sel_hi:[1,0]
  v_pk_mul_f32 v[84:85], v[20:21], v[220:221] op_sel_hi:[1,0]
  v_pk_mul_f32 v[86:87], v[22:23], v[220:221] op_sel_hi:[1,0]
  v_exp_f32 v80, v80
  v_exp_f32 v81, v81
  v_exp_f32 v82, v82
  v_exp_f32 v83, v83
  v_exp_f32 v84, v84
  v_exp_f32 v85, v85
  v_exp_f32 v86, v86
  v_exp_f32 v87, v87
  v_pk_fma_f32 v[80:81], v[80:81], v[220:221], v[220:221] op_sel:[0,1,1]
  v_pk_fma_f32 v[82:83], v[82:83], v[220:221], v[220:221] op_sel:[0,1,1]
  v_pk_fma_f32 v[84:85], v[84:85], v[220:221], v[220:221] op_sel:[0,1,1]
  v_pk_fma_f32 v[86:87], v[86:87], v[220:221], v[220:221] op_sel:[0,1,1]
  v_rcp_f32 v80, v80
  v_rcp_f32 v81, v81
  v_rcp_f32 v82, v82
  v_rcp_f32 v83, v83
  v_rcp_f32 v84, v84
  v_rcp_f32 v85, v85
  v_rcp_f32 v86, v86
  v_rcp_f32 v87, v87
  v_pk_mul_f32 v[16:17], v[16:17], v[80:81]
  v_pk_mul_f32 v[18:19], v[18:19], v[82:83]
  v_pk_mul_f32 v[20:21], v[20:21], v[84:85]
  v_pk_mul_f32 v[22:23], v[22:23], v[86:87]
  v_cvt_pk_bf16_f32 v80, v16, v17
  v_cvt_pk_bf16_f32 v81, v18, v19
  v_cvt_pk_bf16_f32 v82, v20, v21
  v_cvt_pk_bf16_f32 v83, v22, v23
  buffer_store_dwordx4 v[80:83], v166, s[68:71], 0 offen offset:2048 sc1
  s_waitcnt vmcnt(11)
  v_mfma_f32_16x16x32_bf16 v[32:35], v[252:255], v[100:103], v[32:35]
  v_mfma_f32_16x16x32_bf16 v[36:39], v[250:253], v[100:103], v[36:39]
  v_pk_mul_f32 v[88:89], v[24:25], v[222:223] op_sel_hi:[1,0]
  v_pk_mul_f32 v[90:91], v[26:27], v[222:223] op_sel_hi:[1,0]
  v_pk_mul_f32 v[92:93], v[28:29], v[222:223] op_sel_hi:[1,0]
  v_pk_mul_f32 v[94:95], v[30:31], v[222:223] op_sel_hi:[1,0]
  v_exp_f32 v88, v88
  v_exp_f32 v89, v89
  v_exp_f32 v90, v90
  v_exp_f32 v91, v91
  v_exp_f32 v92, v92
  v_exp_f32 v93, v93
  v_exp_f32 v94, v94
  v_exp_f32 v95, v95
  v_pk_fma_f32 v[88:89], v[88:89], v[222:223], v[222:223] op_sel:[0,1,1]
  v_pk_fma_f32 v[90:91], v[90:91], v[222:223], v[222:223] op_sel:[0,1,1]
  v_pk_fma_f32 v[92:93], v[92:93], v[222:223], v[222:223] op_sel:[0,1,1]
  v_pk_fma_f32 v[94:95], v[94:95], v[222:223], v[222:223] op_sel:[0,1,1]
  v_rcp_f32 v88, v88
  v_rcp_f32 v89, v89
  v_rcp_f32 v90, v90
  v_rcp_f32 v91, v91
  v_rcp_f32 v92, v92
  v_rcp_f32 v93, v93
  v_rcp_f32 v94, v94
  v_rcp_f32 v95, v95
  v_pk_mul_f32 v[24:25], v[24:25], v[88:89]
  v_pk_mul_f32 v[26:27], v[26:27], v[90:91]
  v_pk_mul_f32 v[28:29], v[28:29], v[92:93]
  v_pk_mul_f32 v[30:31], v[30:31], v[94:95]
  v_cvt_pk_bf16_f32 v88, v24, v25
  v_cvt_pk_bf16_f32 v89, v26, v27
  v_cvt_pk_bf16_f32 v90, v28, v29
  v_cvt_pk_bf16_f32 v91, v30, v31
  buffer_store_dwordx4 v[88:91], v166, s[68:71], 0 offen offset:3072 sc1
  s_waitcnt vmcnt(10)
  v_mfma_f32_16x16x32_bf16 v[40:43], v[252:255], v[108:111], v[40:43]
  v_mfma_f32_16x16x32_bf16 v[44:47], v[250:253], v[108:111], v[44:47]
  v_pk_mul_f32 v[96:97], v[32:33], v[220:221] op_sel_hi:[1,0]
  v_pk_mul_f32 v[98:99], v[34:35], v[220:221] op_sel_hi:[1,0]
  v_pk_mul_f32 v[100:101], v[36:37], v[220:221] op_sel_hi:[1,0]
  v_pk_mul_f32 v[102:103], v[38:39], v[220:221] op_sel_hi:[1,0]
  v_exp_f32 v96, v96
  v_exp_f32 v97, v97
  v_exp_f32 v98, v98
  v_exp_f32 v99, v99
  v_exp_f32 v100, v100
  v_exp_f32 v101, v101
  v_exp_f32 v102, v102
  v_exp_f32 v103, v103
  v_pk_fma_f32 v[96:97], v[96:97], v[220:221], v[220:221] op_sel:[0,1,1]
  v_pk_fma_f32 v[98:99], v[98:99], v[220:221], v[220:221] op_sel:[0,1,1]
  v_pk_fma_f32 v[100:101], v[100:101], v[220:221], v[220:221] op_sel:[0,1,1]
  v_pk_fma_f32 v[102:103], v[102:103], v[220:221], v[220:221] op_sel:[0,1,1]
  v_rcp_f32 v96, v96
  v_rcp_f32 v97, v97
  v_rcp_f32 v98, v98
  v_rcp_f32 v99, v99
  v_rcp_f32 v100, v100
  v_rcp_f32 v101, v101
  v_rcp_f32 v102, v102
  v_rcp_f32 v103, v103
  v_pk_mul_f32 v[32:33], v[32:33], v[96:97]
  v_pk_mul_f32 v[34:35], v[34:35], v[98:99]
  v_pk_mul_f32 v[36:37], v[36:37], v[100:101]
  v_pk_mul_f32 v[38:39], v[38:39], v[102:103]
  v_cvt_pk_bf16_f32 v96, v32, v33
  v_cvt_pk_bf16_f32 v97, v34, v35
  v_cvt_pk_bf16_f32 v98, v36, v37
  v_cvt_pk_bf16_f32 v99, v38, v39
  buffer_store_dwordx4 v[96:99], v166, s[68:71], s42 offen offset:0 sc1
  s_waitcnt vmcnt(9)
  v_mfma_f32_16x16x32_bf16 v[48:51], v[252:255], v[116:119], v[48:51]
  v_mfma_f32_16x16x32_bf16 v[52:55], v[250:253], v[116:119], v[52:55]
  v_pk_mul_f32 v[104:105], v[40:41], v[222:223] op_sel_hi:[1,0]
  v_pk_mul_f32 v[106:107], v[42:43], v[222:223] op_sel_hi:[1,0]
  v_pk_mul_f32 v[108:109], v[44:45], v[222:223] op_sel_hi:[1,0]
  v_pk_mul_f32 v[110:111], v[46:47], v[222:223] op_sel_hi:[1,0]
  v_exp_f32 v104, v104
  v_exp_f32 v105, v105
  v_exp_f32 v106, v106
  v_exp_f32 v107, v107
  v_exp_f32 v108, v108
  v_exp_f32 v109, v109
  v_exp_f32 v110, v110
  v_exp_f32 v111, v111
  v_pk_fma_f32 v[104:105], v[104:105], v[222:223], v[222:223] op_sel:[0,1,1]
  v_pk_fma_f32 v[106:107], v[106:107], v[222:223], v[222:223] op_sel:[0,1,1]
  v_pk_fma_f32 v[108:109], v[108:109], v[222:223], v[222:223] op_sel:[0,1,1]
  v_pk_fma_f32 v[110:111], v[110:111], v[222:223], v[222:223] op_sel:[0,1,1]
  v_rcp_f32 v104, v104
  v_rcp_f32 v105, v105
  v_rcp_f32 v106, v106
  v_rcp_f32 v107, v107
  v_rcp_f32 v108, v108
  v_rcp_f32 v109, v109
  v_rcp_f32 v110, v110
  v_rcp_f32 v111, v111
  v_pk_mul_f32 v[40:41], v[40:41], v[104:105]
  v_pk_mul_f32 v[42:43], v[42:43], v[106:107]
  v_pk_mul_f32 v[44:45], v[44:45], v[108:109]
  v_pk_mul_f32 v[46:47], v[46:47], v[110:111]
  v_cvt_pk_bf16_f32 v104, v40, v41
  v_cvt_pk_bf16_f32 v105, v42, v43
  v_cvt_pk_bf16_f32 v106, v44, v45
  v_cvt_pk_bf16_f32 v107, v46, v47
  buffer_store_dwordx4 v[104:107], v166, s[68:71], s42 offen offset:1024 sc1
  s_waitcnt vmcnt(8)
  v_mfma_f32_16x16x32_bf16 v[56:59], v[252:255], v[124:127], v[56:59]
  v_mfma_f32_16x16x32_bf16 v[60:63], v[250:253], v[124:127], v[60:63]
  v_pk_mul_f32 v[112:113], v[48:49], v[220:221] op_sel_hi:[1,0]
  v_pk_mul_f32 v[114:115], v[50:51], v[220:221] op_sel_hi:[1,0]
  v_pk_mul_f32 v[116:117], v[52:53], v[220:221] op_sel_hi:[1,0]
  v_pk_mul_f32 v[118:119], v[54:55], v[220:221] op_sel_hi:[1,0]
  v_exp_f32 v112, v112
  v_exp_f32 v113, v113
  v_exp_f32 v114, v114
  v_exp_f32 v115, v115
  v_exp_f32 v116, v116
  v_exp_f32 v117, v117
  v_exp_f32 v118, v118
  v_exp_f32 v119, v119
  v_pk_fma_f32 v[112:113], v[112:113], v[220:221], v[220:221] op_sel:[0,1,1]
  v_pk_fma_f32 v[114:115], v[114:115], v[220:221], v[220:221] op_sel:[0,1,1]
  v_pk_fma_f32 v[116:117], v[116:117], v[220:221], v[220:221] op_sel:[0,1,1]
  v_pk_fma_f32 v[118:119], v[118:119], v[220:221], v[220:221] op_sel:[0,1,1]
  v_rcp_f32 v112, v112
  v_rcp_f32 v113, v113
  v_rcp_f32 v114, v114
  v_rcp_f32 v115, v115
  v_rcp_f32 v116, v116
  v_rcp_f32 v117, v117
  v_rcp_f32 v118, v118
  v_rcp_f32 v119, v119
  v_pk_mul_f32 v[48:49], v[48:49], v[112:113]
  v_pk_mul_f32 v[50:51], v[50:51], v[114:115]
  v_pk_mul_f32 v[52:53], v[52:53], v[116:117]
  v_pk_mul_f32 v[54:55], v[54:55], v[118:119]
  v_cvt_pk_bf16_f32 v112, v48, v49
  v_cvt_pk_bf16_f32 v113, v50, v51
  v_cvt_pk_bf16_f32 v114, v52, v53
  v_cvt_pk_bf16_f32 v115, v54, v55
  buffer_store_dwordx4 v[112:115], v166, s[68:71], s42 offen offset:2048 sc1
  v_pk_mul_f32 v[120:121], v[56:57], v[222:223] op_sel_hi:[1,0]
  v_pk_mul_f32 v[122:123], v[58:59], v[222:223] op_sel_hi:[1,0]
  v_pk_mul_f32 v[124:125], v[60:61], v[222:223] op_sel_hi:[1,0]
  v_pk_mul_f32 v[126:127], v[62:63], v[222:223] op_sel_hi:[1,0]
  v_exp_f32 v120, v120
  v_exp_f32 v121, v121
  v_exp_f32 v122, v122
  v_exp_f32 v123, v123
  v_exp_f32 v124, v124
  v_exp_f32 v125, v125
  v_exp_f32 v126, v126
  v_exp_f32 v127, v127
  v_pk_fma_f32 v[120:121], v[120:121], v[222:223], v[222:223] op_sel:[0,1,1]
  v_pk_fma_f32 v[122:123], v[122:123], v[222:223], v[222:223] op_sel:[0,1,1]
  v_pk_fma_f32 v[124:125], v[124:125], v[222:223], v[222:223] op_sel:[0,1,1]
  v_pk_fma_f32 v[126:127], v[126:127], v[222:223], v[222:223] op_sel:[0,1,1]
  v_rcp_f32 v120, v120
  v_rcp_f32 v121, v121
  v_rcp_f32 v122, v122
  v_rcp_f32 v123, v123
  v_rcp_f32 v124, v124
  v_rcp_f32 v125, v125
  v_rcp_f32 v126, v126
  v_rcp_f32 v127, v127
  v_pk_mul_f32 v[56:57], v[56:57], v[120:121]
  v_pk_mul_f32 v[58:59], v[58:59], v[122:123]
  v_pk_mul_f32 v[60:61], v[60:61], v[124:125]
  v_pk_mul_f32 v[62:63], v[62:63], v[126:127]
  v_cvt_pk_bf16_f32 v120, v56, v57
  v_cvt_pk_bf16_f32 v121, v58, v59
  v_cvt_pk_bf16_f32 v122, v60, v61
  v_cvt_pk_bf16_f32 v123, v62, v63
  buffer_store_dwordx4 v[120:123], v166, s[68:71], s42 offen offset:3072 sc1
L3_pub:
  v_mov_b32 v182, 1
  s_waitcnt vmcnt(0)
  s_mov_b64 exec, 1
  buffer_atomic_add v182, v232, s[4:7], s50 offen offset:8 sc0 sc1
  s_mov_b64 exec, -1
  s_waitcnt vmcnt(0)
  v_readfirstlane_b32 s48, v182
  s_nop 1
  s_cmp_eq_u32 s48, 0
  s_cbranch_scc1 L3_next
  v_bfe_u32 v183, v166, 4, 4
  v_lshrrev_b32 v182, 8, v166
  v_lshlrev_b32 v180, 11, v183
  s_mov_b32 s46, 32768
  v_lshl_add_u32 v180, v182, 4, v180
  s_lshl_b32 s48, s41, 16
  s_lshl_b32 s63, s40, 8
  s_add_u32 s48, s48, s63
  s_add_u32 s24, s52, s48
  s_addc_u32 s25, s53, 0
  s_mov_b32 s26, 65536
  s_mov_b32 s27, 0x20000
  s_sub_u32 s26, s26, s63
  buffer_load_dwordx4 v[188:191], v180, s[24:27], 0 offen offset:0
  buffer_load_dwordx4 v[192:195], v180, s[24:27], s46 offen offset:0
  buffer_load_dwordx4 v[196:199], v180, s[24:27], 0 offen offset:64
  buffer_load_dwordx4 v[200:203], v180, s[24:27], s46 offen offset:64
  buffer_load_dwordx4 v[204:207], v180, s[24:27], 0 offen offset:128
  buffer_load_dwordx4 v[208:211], v180, s[24:27], s46 offen offset:128
  buffer_load_dwordx4 v[212:215], v180, s[24:27], 0 offen offset:192
  buffer_load_dwordx4 v[216:219], v180, s[24:27], s46 offen offset:192
  s_mov_b32 s66, 8192
L3_fin0:
  s_mov_b32 s56, -1
  buffer_load_dwordx4 v[128:131], v166, s[64:67], 0 offen offset:0 sc0 sc1
  buffer_load_dwordx4 v[132:135], v166, s[64:67], 0 offen offset:1024 sc0 sc1
  buffer_load_dwordx4 v[136:139], v166, s[64:67], 0 offen offset:2048 sc0 sc1
  buffer_load_dwordx4 v[140:143], v166, s[64:67], 0 offen offset:3072 sc0 sc1
  buffer_load_dwordx4 v[144:147], v166, s[64:67], s42 offen offset:0 sc0 sc1
  buffer_load_dwordx4 v[148:151], v166, s[64:67], s42 offen offset:1024 sc0 sc1
  buffer_load_dwordx4 v[160:163], v166, s[64:67], s42 offen offset:2048 sc0 sc1
  buffer_load_dwordx4 v[168:171], v166, s[64:67], s42 offen offset:3072 sc0 sc1
L3_finish2:
L3_f0:
  s_waitcnt vmcnt(7)
  v_max_u32 v152, v128, v130
  v_cmp_lt_u32 vcc, s56, v152
  v_lshlrev_b32 v64, 16, v128
  v_and_b32 v65, 0xffff0000, v128
  v_lshlrev_b32 v66, 16, v129
  v_and_b32 v67, 0xffff0000, v129
  v_lshlrev_b32 v68, 16, v130
  v_and_b32 v69, 0xffff0000, v130
  v_lshlrev_b32 v70, 16, v131
  v_and_b32 v71, 0xffff0000, v131
  s_cbranch_vccnz L3_r0
  v_lshlrev_b32 v152, 16, v188
  v_and_b32 v153, 0xffff0000, v188
  v_lshlrev_b32 v154, 16, v189
  v_and_b32 v155, 0xffff0000, v189
  v_lshlrev_b32 v156, 16, v190
  v_and_b32 v157, 0xffff0000, v190
  v_lshlrev_b32 v158, 16, v191
  v_and_b32 v159, 0xffff0000, v191
  v_pk_fma_f32 v[64:65], v[0:1], v[64:65], v[152:153]
  v_pk_fma_f32 v[66:67], v[2:3], v[66:67], v[154:155]
  v_pk_fma_f32 v[68:69], v[4:5], v[68:69], v[156:157]
  v_pk_fma_f32 v[70:71], v[6:7], v[70:71], v[158:159]
  v_cvt_pk_bf16_f32 v128, v64, v65
  v_cvt_pk_bf16_f32 v129, v66, v67
  v_cvt_pk_bf16_f32 v130, v68, v69
  v_cvt_pk_bf16_f32 v131, v70, v71
  buffer_store_dwordx4 v[128:131], v180, s[28:31], 0 offen offset:0 sc0 sc1
L3_f1:
  s_waitcnt vmcnt(7)
  v_max_u32 v152, v132, v134
  v_cmp_lt_u32 vcc, s56, v152
  v_lshlrev_b32 v72, 16, v132
  v_and_b32 v73, 0xffff0000, v132
  v_lshlrev_b32 v74, 16, v133
  v_and_b32 v75, 0xffff0000, v133
  v_lshlrev_b32 v76, 16, v134
  v_and_b32 v77, 0xffff0000, v134
  v_lshlrev_b32 v78, 16, v135
  v_and_b32 v79, 0xffff0000, v135
  s_cbranch_vccnz L3_r1
  v_lshlrev_b32 v152, 16, v192
  v_and_b32 v153, 0xffff0000, v192
  v_lshlrev_b32 v154, 16, v193
  v_and_b32 v155, 0xffff0000, v193
  v_lshlrev_b32 v156, 16, v194
  v_and_b32 v157, 0xffff0000, v194
  v_lshlrev_b32 v158, 16, v195
  v_and_b32 v159, 0xffff0000, v195
  v_pk_fma_f32 v[72:73], v[8:9], v[72:73], v[152:153]
  v_pk_fma_f32 v[74:75], v[10:11], v[74:75], v[154:155]
  v_pk_fma_f32 v[76:77], v[12:13], v[76:77], v[156:157]
  v_pk_fma_f32 v[78:79], v[14:15], v[78:79], v[158:159]
  v_cvt_pk_bf16_f32 v132, v72, v73
  v_cvt_pk_bf16_f32 v133, v74, v75
  v_cvt_pk_bf16_f32 v134, v76, v77
  v_cvt_pk_bf16_f32 v135, v78, v79
  buffer_store_dwordx4 v[132:135], v180, s[28:31], s46 offen offset:0 sc0 sc1
L3_f2:
  s_waitcnt vmcnt(7)
  v_max_u32 v152, v136, v138
  v_cmp_lt_u32 vcc, s56, v152
  v_lshlrev_b32 v80, 16, v136
  v_and_b32 v81, 0xffff0000, v136
  v_lshlrev_b32 v82, 16, v137
  v_and_b32 v83, 0xffff0000, v137
  v_lshlrev_b32 v84, 16, v138
  v_and_b32 v85, 0xffff0000, v138
  v_lshlrev_b32 v86, 16, v139
  v_and_b32 v87, 0xffff0000, v139
  s_cbranch_vccnz L3_r2
  v_lshlrev_b32 v152, 16, v196
  v_and_b32 v153, 0xffff0000, v196
  v_lshlrev_b32 v154, 16, v197
  v_and_b32 v155, 0xffff0000, v197
  v_lshlrev_b32 v156, 16, v198
  v_and_b32 v157, 0xffff0000, v198
  v_lshlrev_b32 v158, 16, v199
  v_and_b32 v159, 0xffff0000, v199
  v_pk_fma_f32 v[80:81], v[16:17], v[80:81], v[152:153]
  v_pk_fma_f32 v[82:83], v[18:19], v[82:83], v[154:155]
  v_pk_fma_f32 v[84:85], v[20:21], v[84:85], v[156:157]
  v_pk_fma_f32 v[86:87], v[22:23], v[86:87], v[158:159]
  v_cvt_pk_bf16_f32 v136, v80, v81
  v_cvt_pk_bf16_f32 v137, v82, v83
  v_cvt_pk_bf16_f32 v138, v84, v85
  v_cvt_pk_bf16_f32 v139, v86, v87
  buffer_store_dwordx4 v[136:139], v180, s[28:31], 0 offen offset:64 sc0 sc1
L3_f3:
  s_waitcnt vmcnt(7)
  v_max_u32 v152, v140, v142
  v_cmp_lt_u32 vcc, s56, v152
  v_lshlrev_b32 v88, 16, v140
  v_and_b32 v89, 0xffff0000, v140
  v_lshlrev_b32 v90, 16, v141
  v_and_b32 v91, 0xffff0000, v141
  v_lshlrev_b32 v92, 16, v142
  v_and_b32 v93, 0xffff0000, v142
  v_lshlrev_b32 v94, 16, v143
  v_and_b32 v95, 0xffff0000, v143
  s_cbranch_vccnz L3_r3
  v_lshlrev_b32 v152, 16, v200
  v_and_b32 v153, 0xffff0000, v200
  v_lshlrev_b32 v154, 16, v201
  v_and_b32 v155, 0xffff0000, v201
  v_lshlrev_b32 v156, 16, v202
  v_and_b32 v157, 0xffff0000, v202
  v_lshlrev_b32 v158, 16, v203
  v_and_b32 v159, 0xffff0000, v203
  v_pk_fma_f32 v[88:89], v[24:25], v[88:89], v[152:153]
  v_pk_fma_f32 v[90:91], v[26:27], v[90:91], v[154:155]
  v_pk_fma_f32 v[92:93], v[28:29], v[92:93], v[156:157]
  v_pk_fma_f32 v[94:95], v[30:31], v[94:95], v[158:159]
  v_cvt_pk_bf16_f32 v140, v88, v89
  v_cvt_pk_bf16_f32 v141, v90, v91
  v_cvt_pk_bf16_f32 v142, v92, v93
  v_cvt_pk_bf16_f32 v143, v94, v95
  buffer_store_dwordx4 v[140:143], v180, s[28:31], s46 offen offset:64 sc0 sc1
L3_f4:
  s_waitcnt vmcnt(7)
  v_max_u32 v152, v144, v146
  v_cmp_lt_u32 vcc, s56, v152
  v_lshlrev_b32 v96, 16, v144
  v_and_b32 v97, 0xffff0000, v144
  v_lshlrev_b32 v98, 16, v145
  v_and_b32 v99, 0xffff0000, v145
  v_lshlrev_b32 v100, 16, v146
  v_and_b32 v101, 0xffff0000, v146
  v_lshlrev_b32 v102, 16, v147
  v_and_b32 v103, 0xffff0000, v147
  s_cbranch_vccnz L3_r4
  v_lshlrev_b32 v152, 16, v204
  v_and_b32 v153, 0xffff0000, v204
  v_lshlrev_b32 v154, 16, v205
  v_and_b32 v155, 0xffff0000, v205
  v_lshlrev_b32 v156, 16, v206
  v_and_b32 v157, 0xffff0000, v206
  v_lshlrev_b32 v158, 16, v207
  v_and_b32 v159, 0xffff0000, v207
  v_pk_fma_f32 v[96:97], v[32:33], v[96:97], v[152:153]
  v_pk_fma_f32 v[98:99], v[34:35], v[98:99], v[154:155]
  v_pk_fma_f32 v[100:101], v[36:37], v[100:101], v[156:157]
  v_pk_fma_f32 v[102:103], v[38:39], v[102:103], v[158:159]
  v_cvt_pk_bf16_f32 v144, v96, v97
  v_cvt_pk_bf16_f32 v145, v98, v99
  v_cvt_pk_bf16_f32 v146, v100, v101
  v_cvt_pk_bf16_f32 v147, v102, v103
  buffer_store_dwordx4 v[144:147], v180, s[28:31], 0 offen offset:128 sc0 sc1
L3_f5:
  s_waitcnt vmcnt(7)
  v_max_u32 v152, v148, v150
  v_cmp_lt_u32 vcc, s56, v152
  v_lshlrev_b32 v104, 16, v148
  v_and_b32 v105, 0xffff0000, v148
  v_lshlrev_b32 v106, 16, v149
  v_and_b32 v107, 0xffff0000, v149
  v_lshlrev_b32 v108, 16, v150
  v_and_b32 v109, 0xffff0000, v150
  v_lshlrev_b32 v110, 16, v151
  v_and_b32 v111, 0xffff0000, v151
  s_cbranch_vccnz L3_r5
  v_lshlrev_b32 v152, 16, v208
  v_and_b32 v153, 0xffff0000, v208
  v_lshlrev_b32 v154, 16, v209
  v_and_b32 v155, 0xffff0000, v209
  v_lshlrev_b32 v156, 16, v210
  v_and_b32 v157, 0xffff0000, v210
  v_lshlrev_b32 v158, 16, v211
  v_and_b32 v159, 0xffff0000, v211
  v_pk_fma_f32 v[104:105], v[40:41], v[104:105], v[152:153]
  v_pk_fma_f32 v[106:107], v[42:43], v[106:107], v[154:155]
  v_pk_fma_f32 v[108:109], v[44:45], v[108:109], v[156:157]
  v_pk_fma_f32 v[110:111], v[46:47], v[110:111], v[158:159]
  v_cvt_pk_bf16_f32 v148, v104, v105
  v_cvt_pk_bf16_f32 v149, v106, v107
  v_cvt_pk_bf16_f32 v150, v108, v109
  v_cvt_pk_bf16_f32 v151, v110, v111
  buffer_store_dwordx4 v[148:151], v180, s[28:31], s46 offen offset:128 sc0 sc1
L3_f6:
  s_waitcnt vmcnt(7)
  v_max_u32 v152, v160, v162
  v_cmp_lt_u32 vcc, s56, v152
  v_lshlrev_b32 v112, 16, v160
  v_and_b32 v113, 0xffff0000, v160
  v_lshlrev_b32 v114, 16, v161
  v_and_b32 v115, 0xffff0000, v161
  v_lshlrev_b32 v116, 16, v162
  v_and_b32 v117, 0xffff0000, v162
  v_lshlrev_b32 v118, 16, v163
  v_and_b32 v119, 0xffff0000, v163
  s_cbranch_vccnz L3_r6
  v_lshlrev_b32 v152, 16, v212
  v_and_b32 v153, 0xffff0000, v212
  v_lshlrev_b32 v154, 16, v213
  v_and_b32 v155, 0xffff0000, v213
  v_lshlrev_b32 v156, 16, v214
  v_and_b32 v157, 0xffff0000, v214
  v_lshlrev_b32 v158, 16, v215
  v_and_b32 v159, 0xffff0000, v215
  v_pk_fma_f32 v[112:113], v[48:49], v[112:113], v[152:153]
  v_pk_fma_f32 v[114:115], v[50:51], v[114:115], v[154:155]
  v_pk_fma_f32 v[116:117], v[52:53], v[116:117], v[156:157]
  v_pk_fma_f32 v[118:119], v[54:55], v[118:119], v[158:159]
  v_cvt_pk_bf16_f32 v160, v112, v113
  v_cvt_pk_bf16_f32 v161, v114, v115
  v_cvt_pk_bf16_f32 v162, v116, v117
  v_cvt_pk_bf16_f32 v163, v118, v119
  buffer_store_dwordx4 v[160:163], v180, s[28:31], 0 offen offset:192 sc0 sc1
L3_f7:
  s_waitcnt vmcnt(7)
  v_max_u32 v152, v168, v170
  v_cmp_lt_u32 vcc, s56, v152
  v_lshlrev_b32 v120, 16, v168
  v_and_b32 v121, 0xffff0000, v168
  v_lshlrev_b32 v122, 16, v169
  v_and_b32 v123, 0xffff0000, v169
  v_lshlrev_b32 v124, 16, v170
  v_and_b32 v125, 0xffff0000, v170
  v_lshlrev_b32 v126, 16, v171
  v_and_b32 v127, 0xffff0000, v171
  s_cbranch_vccnz L3_r7
  v_lshlrev_b32 v152, 16, v216
  v_and_b32 v153, 0xffff0000, v216
  v_lshlrev_b32 v154, 16, v217
  v_and_b32 v155, 0xffff0000, v217
  v_lshlrev_b32 v156, 16, v218
  v_and_b32 v157, 0xffff0000, v218
  v_lshlrev_b32 v158, 16, v219
  v_and_b32 v159, 0xffff0000, v219
  v_pk_fma_f32 v[120:121], v[56:57], v[120:121], v[152:153]
  v_pk_fma_f32 v[122:123], v[58:59], v[122:123], v[154:155]
  v_pk_fma_f32 v[124:125], v[60:61], v[124:125], v[156:157]
  v_pk_fma_f32 v[126:127], v[62:63], v[126:127], v[158:159]
  v_cvt_pk_bf16_f32 v168, v120, v121
  v_cvt_pk_bf16_f32 v169, v122, v123
  v_cvt_pk_bf16_f32 v170, v124, v125
  v_cvt_pk_bf16_f32 v171, v126, v127
  buffer_store_dwordx4 v[168:171], v180, s[28:31], s46 offen offset:192 sc0 sc1
  s_branch L3_next
L3_finish:
  s_waitcnt vmcnt(15)
  v_mfma_f32_16x16x32_bf16 v[0:3], v[252:255], v[68:71], v[0:3]
  v_mfma_f32_16x16x32_bf16 v[4:7], v[250:253], v[68:71], v[4:7]
  v_max_u32 v152, v128, v130
  v_cmp_lt_u32 vcc, s56, v152
  v_lshlrev_b32 v64, 16, v128
  v_and_b32 v65, 0xffff0000, v128
  v_lshlrev_b32 v66, 16, v129
  v_and_b32 v67, 0xffff0000, v129
  v_lshlrev_b32 v68, 16, v130
  v_and_b32 v69, 0xffff0000, v130
  v_lshlrev_b32 v70, 16, v131
  v_and_b32 v71, 0xffff0000, v131
  s_cbranch_vccnz L3_x0
  v_lshlrev_b32 v152, 16, v188
  v_and_b32 v153, 0xffff0000, v188
  v_lshlrev_b32 v154, 16, v189
  v_and_b32 v155, 0xffff0000, v189
  v_lshlrev_b32 v156, 16, v190
  v_and_b32 v157, 0xffff0000, v190
  v_lshlrev_b32 v158, 16, v191
  v_and_b32 v159, 0xffff0000, v191
  v_pk_fma_f32 v[64:65], v[0:1], v[64:65], v[152:153]
  v_pk_fma_f32 v[66:67], v[2:3], v[66:67], v[154:155]
  v_pk_fma_f32 v[68:69], v[4:5], v[68:69], v[156:157]
  v_pk_fma_f32 v[70:71], v[6:7], v[70:71], v[158:159]
  v_cvt_pk_bf16_f32 v128, v64, v65
  v_cvt_pk_bf16_f32 v129, v66, v67
  v_cvt_pk_bf16_f32 v130, v68, v69
  v_cvt_pk_bf16_f32 v131, v70, v71
  buffer_store_dwordx4 v[128:131], v180, s[28:31], 0 offen offset:0 sc0 sc1
  s_waitcnt vmcnt(14)
  v_mfma_f32_16x16x32_bf16 v[8:11], v[252:255], v[76:79], v[8:11]
  v_mfma_f32_16x16x32_bf16 v[12:15], v[250:253], v[76:79], v[12:15]
  v_max_u32 v152, v132, v134
  v_cmp_lt_u32 vcc, s56, v152
  v_lshlrev_b32 v72, 16, v132
  v_and_b32 v73, 0xffff0000, v132
  v_lshlrev_b32 v74, 16, v133
  v_and_b32 v75, 0xffff0000, v133
  v_lshlrev_b32 v76, 16, v134
  v_and_b32 v77, 0xffff0000, v134
  v_lshlrev_b32 v78, 16, v135
  v_and_b32 v79, 0xffff0000, v135
  s_cbranch_vccnz L3_x1
  v_lshlrev_b32 v152, 16, v192
  v_and_b32 v153, 0xffff0000, v192
  v_lshlrev_b32 v154, 16, v193
  v_and_b32 v155, 0xffff0000, v193
  v_lshlrev_b32 v156, 16, v194
  v_and_b32 v157, 0xffff0000, v194
  v_lshlrev_b32 v158, 16, v195
  v_and_b32 v159, 0xffff0000, v195
  v_pk_fma_f32 v[72:73], v[8:9], v[72:73], v[152:153]
  v_pk_fma_f32 v[74:75], v[10:11], v[74:75], v[154:155]
  v_pk_fma_f32 v[76:77], v[12:13], v[76:77], v[156:157]
  v_pk_fma_f32 v[78:79], v[14:15], v[78:79], v[158:159]
  v_cvt_pk_bf16_f32 v132, v72, v73
  v_cvt_pk_bf16_f32 v133, v74, v75
  v_cvt_pk_bf16_f32 v134, v76, v77
  v_cvt_pk_bf16_f32 v135, v78, v79
  buffer_store_dwordx4 v[132:135], v180, s[28:31], s46 offen offset:0 sc0 sc1
  s_waitcnt vmcnt(13)
  v_mfma_f32_16x16x32_bf16 v[16:19], v[252:255], v[84:87], v[16:19]
  v_mfma_f32_16x16x32_bf16 v[20:23], v[250:253], v[84:87], v[20:23]
  v_max_u32 v152, v136, v138
  v_cmp_lt_u32 vcc, s56, v152
  v_lshlrev_b32 v80, 16, v136
  v_and_b32 v81, 0xffff0000, v136
  v_lshlrev_b32 v82, 16, v137
  v_and_b32 v83, 0xffff0000, v137
  v_lshlrev_b32 v84, 16, v138
  v_and_b32 v85, 0xffff0000, v138
  v_lshlrev_b32 v86, 16, v139
  v_and_b32 v87, 0xffff0000, v139
  s_cbranch_vccnz L3_x2
  v_lshlrev_b32 v152, 16, v196
  v_and_b32 v153, 0xffff0000, v196
  v_lshlrev_b32 v154, 16, v197
  v_and_b32 v155, 0xffff0000, v197
  v_lshlrev_b32 v156, 16, v198
  v_and_b32 v157, 0xffff0000, v198
  v_lshlrev_b32 v158, 16, v199
  v_and_b32 v159, 0xffff0000, v199
  v_pk_fma_f32 v[80:81], v[16:17], v[80:81], v[152:153]
  v_pk_fma_f32 v[82:83], v[18:19], v[82:83], v[154:155]
  v_pk_fma_f32 v[84:85], v[20:21], v[84:85], v[156:157]
  v_pk_fma_f32 v[86:87], v[22:23], v[86:87], v[158:159]
  v_cvt_pk_bf16_f32 v136, v80, v81
  v_cvt_pk_bf16_f32 v137, v82, v83
  v_cvt_pk_bf16_f32 v138, v84, v85
  v_cvt_pk_bf16_f32 v139, v86, v87
  buffer_store_dwordx4 v[136:139], v180, s[28:31], 0 offen offset:64 sc0 sc1
  s_waitcnt vmcnt(12)
  v_mfma_f32_16x16x32_bf16 v[24:27], v[252:255], v[92:95], v[24:27]
  v_mfma_f32_16x16x32_bf16 v[28:31], v[250:253], v[92:95], v[28:31]
  v_max_u32 v152, v140, v142
  v_cmp_lt_u32 vcc, s56, v152
  v_lshlrev_b32 v88, 16, v140
  v_and_b32 v89, 0xffff0000, v140
  v_lshlrev_b32 v90, 16, v141
  v_and_b32 v91, 0xffff0000, v141
  v_lshlrev_b32 v92, 16, v142
  v_and_b32 v93, 0xffff0000, v142
  v_lshlrev_b32 v94, 16, v143
  v_and_b32 v95, 0xffff0000, v143
  s_cbranch_vccnz L3_x3
  v_lshlrev_b32 v152, 16, v200
  v_and_b32 v153, 0xffff0000, v200
  v_lshlrev_b32 v154, 16, v201
  v_and_b32 v155, 0xffff0000, v201
  v_lshlrev_b32 v156, 16, v202
  v_and_b32 v157, 0xffff0000, v202
  v_lshlrev_b32 v158, 16, v203
  v_and_b32 v159, 0xffff0000, v203
  v_pk_fma_f32 v[88:89], v[24:25], v[88:89], v[152:153]
  v_pk_fma_f32 v[90:91], v[26:27], v[90:91], v[154:155]
  v_pk_fma_f32 v[92:93], v[28:29], v[92:93], v[156:157]
  v_pk_fma_f32 v[94:95], v[30:31], v[94:95], v[158:159]
  v_cvt_pk_bf16_f32 v140, v88, v89
  v_cvt_pk_bf16_f32 v141, v90, v91
  v_cvt_pk_bf16_f32 v142, v92, v93
  v_cvt_pk_bf16_f32 v143, v94, v95
  buffer_store_dwordx4 v[140:143], v180, s[28:31], s46 offen offset:64 sc0 sc1
  s_waitcnt vmcnt(11)
  v_mfma_f32_16x16x32_bf16 v[32:35], v[252:255], v[100:103], v[32:35]
  v_mfma_f32_16x16x32_bf16 v[36:39], v[250:253], v[100:103], v[36:39]
  v_max_u32 v152, v144, v146
  v_cmp_lt_u32 vcc, s56, v152
  v_lshlrev_b32 v96, 16, v144
  v_and_b32 v97, 0xffff0000, v144
  v_lshlrev_b32 v98, 16, v145
  v_and_b32 v99, 0xffff0000, v145
  v_lshlrev_b32 v100, 16, v146
  v_and_b32 v101, 0xffff0000, v146
  v_lshlrev_b32 v102, 16, v147
  v_and_b32 v103, 0xffff0000, v147
  s_cbranch_vccnz L3_x4
  v_lshlrev_b32 v152, 16, v204
  v_and_b32 v153, 0xffff0000, v204
  v_lshlrev_b32 v154, 16, v205
  v_and_b32 v155, 0xffff0000, v205
  v_lshlrev_b32 v156, 16, v206
  v_and_b32 v157, 0xffff0000, v206
  v_lshlrev_b32 v158, 16, v207
  v_and_b32 v159, 0xffff0000, v207
  v_pk_fma_f32 v[96:97], v[32:33], v[96:97], v[152:153]
  v_pk_fma_f32 v[98:99], v[34:35], v[98:99], v[154:155]
  v_pk_fma_f32 v[100:101], v[36:37], v[100:101], v[156:157]
  v_pk_fma_f32 v[102:103], v[38:39], v[102:103], v[158:159]
  v_cvt_pk_bf16_f32 v144, v96, v97
  v_cvt_pk_bf16_f32 v145, v98, v99
  v_cvt_pk_bf16_f32 v146, v100, v101
  v_cvt_pk_bf16_f32 v147, v102, v103
  buffer_store_dwordx4 v[144:147], v180, s[28:31], 0 offen offset:128 sc0 sc1
  s_waitcnt vmcnt(10)
  v_mfma_f32_16x16x32_bf16 v[40:43], v[252:255], v[108:111], v[40:43]
  v_mfma_f32_16x16x32_bf16 v[44:47], v[250:253], v[108:111], v[44:47]
  v_max_u32 v152, v148, v150
  v_cmp_lt_u32 vcc, s56, v152
  v_lshlrev_b32 v104, 16, v148
  v_and_b32 v105, 0xffff0000, v148
  v_lshlrev_b32 v106, 16, v149
  v_and_b32 v107, 0xffff0000, v149
  v_lshlrev_b32 v108, 16, v150
  v_and_b32 v109, 0xffff0000, v150
  v_lshlrev_b32 v110, 16, v151
  v_and_b32 v111, 0xffff0000, v151
  s_cbranch_vccnz L3_x5
  v_lshlrev_b32 v152, 16, v208
  v_and_b32 v153, 0xffff0000, v208
  v_lshlrev_b32 v154, 16, v209
  v_and_b32 v155, 0xffff0000, v209
  v_lshlrev_b32 v156, 16, v210
  v_and_b32 v157, 0xffff0000, v210
  v_lshlrev_b32 v158, 16, v211
  v_and_b32 v159, 0xffff0000, v211
  v_pk_fma_f32 v[104:105], v[40:41], v[104:105], v[152:153]
  v_pk_fma_f32 v[106:107], v[42:43], v[106:107], v[154:155]
  v_pk_fma_f32 v[108:109], v[44:45], v[108:109], v[156:157]
  v_pk_fma_f32 v[110:111], v[46:47], v[110:111], v[158:159]
  v_cvt_pk_bf16_f32 v148, v104, v105
  v_cvt_pk_bf16_f32 v149, v106, v107
  v_cvt_pk_bf16_f32 v150, v108, v109
  v_cvt_pk_bf16_f32 v151, v110, v111
  buffer_store_dwordx4 v[148:151], v180, s[28:31], s46 offen offset:128 sc0 sc1
  s_waitcnt vmcnt(9)
  v_mfma_f32_16x16x32_bf16 v[48:51], v[252:255], v[116:119], v[48:51]
  v_mfma_f32_16x16x32_bf16 v[52:55], v[250:253], v[116:119], v[52:55]
  v_max_u32 v152, v160, v162
  v_cmp_lt_u32 vcc, s56, v152
  v_lshlrev_b32 v112, 16, v160
  v_and_b32 v113, 0xffff0000, v160
  v_lshlrev_b32 v114, 16, v161
  v_and_b32 v115, 0xffff0000, v161
  v_lshlrev_b32 v116, 16, v162
  v_and_b32 v117, 0xffff0000, v162
  v_lshlrev_b32 v118, 16, v163
  v_and_b32 v119, 0xffff0000, v163
  s_cbranch_vccnz L3_x6
  v_lshlrev_b32 v152, 16, v212
  v_and_b32 v153, 0xffff0000, v212
  v_lshlrev_b32 v154, 16, v213
  v_and_b32 v155, 0xffff0000, v213
  v_lshlrev_b32 v156, 16, v214
  v_and_b32 v157, 0xffff0000, v214
  v_lshlrev_b32 v158, 16, v215
  v_and_b32 v159, 0xffff0000, v215
  v_pk_fma_f32 v[112:113], v[48:49], v[112:113], v[152:153]
  v_pk_fma_f32 v[114:115], v[50:51], v[114:115], v[154:155]
  v_pk_fma_f32 v[116:117], v[52:53], v[116:117], v[156:157]
  v_pk_fma_f32 v[118:119], v[54:55], v[118:119], v[158:159]
  v_cvt_pk_bf16_f32 v160, v112, v113
  v_cvt_pk_bf16_f32 v161, v114, v115
  v_cvt_pk_bf16_f32 v162, v116, v117
  v_cvt_pk_bf16_f32 v163, v118, v119
  buffer_store_dwordx4 v[160:163], v180, s[28:31], 0 offen offset:192 sc0 sc1
  s_waitcnt vmcnt(8)
  v_mfma_f32_16x16x32_bf16 v[56:59], v[252:255], v[124:127], v[56:59]
  v_mfma_f32_16x16x32_bf16 v[60:63], v[250:253], v[124:127], v[60:63]
  v_max_u32 v152, v168, v170
  v_cmp_lt_u32 vcc, s56, v152
  v_lshlrev_b32 v120, 16, v168
  v_and_b32 v121, 0xffff0000, v168
  v_lshlrev_b32 v122, 16, v169
  v_and_b32 v123, 0xffff0000, v169
  v_lshlrev_b32 v124, 16, v170
  v_and_b32 v125, 0xffff0000, v170
  v_lshlrev_b32 v126, 16, v171
  v_and_b32 v127, 0xffff0000, v171
  s_cbranch_vccnz L3_x7
  v_lshlrev_b32 v152, 16, v216
  v_and_b32 v153, 0xffff0000, v216
  v_lshlrev_b32 v154, 16, v217
  v_and_b32 v155, 0xffff0000, v217
  v_lshlrev_b32 v156, 16, v218
  v_and_b32 v157, 0xffff0000, v218
  v_lshlrev_b32 v158, 16, v219
  v_and_b32 v159, 0xffff0000, v219
  v_pk_fma_f32 v[120:121], v[56:57], v[120:121], v[152:153]
  v_pk_fma_f32 v[122:123], v[58:59], v[122:123], v[154:155]
  v_pk_fma_f32 v[124:125], v[60:61], v[124:125], v[156:157]
  v_pk_fma_f32 v[126:127], v[62:63], v[126:127], v[158:159]
  v_cvt_pk_bf16_f32 v168, v120, v121
  v_cvt_pk_bf16_f32 v169, v122, v123
  v_cvt_pk_bf16_f32 v170, v124, v125
  v_cvt_pk_bf16_f32 v171, v126, v127
  buffer_store_dwordx4 v[168:171], v180, s[28:31], s46 offen offset:192 sc0 sc1
L3_next:
  v_readfirstlane_b32 s48, v244
  s_nop 1
  s_cmp_eq_u32 s48, 0
  s_cbranch_scc1 L3_end
  v_mov_b32 v244, 0
  v_mov_b32 v242, 0
  s_xor_b32 s41, s41, 1
  s_waitcnt vmcnt(0)
  s_lshl_b32 s62, s41, 3
  s_add_u32 s62, s62, s40
  s_lshl_b32 s48, s62, 14
  s_lshl_b32 s63, s35, 23
  s_add_u32 s48, s48, s63
  s_add_u32 s48, s48, 67108864
  s_add_u32 s20, s60, s48
  s_addc_u32 s21, s61, 0
  s_mov_b32 s22, 16384
  s_mov_b32 s23, 0x20000
  s_lshl_b32 s48, s62, 13
  s_cmp_eq_u32 s35, 0
  s_mov_b32 s63, 41943040
  s_mov_b32 s50, 37748736
  s_cselect_b32 s63, s63, 37748736
  s_cselect_b32 s50, s50, 41943040
  s_add_u32 s63, s63, s48
  s_add_u32 s50, s50, s48
  s_add_u32 s68, s60, s63
  s_addc_u32 s69, s61, 0
  s_mov_b32 s70, 8192
  s_mov_b32 s71, 0x20000
  s_add_u32 s64, s60, s50
  s_addc_u32 s65, s61, 0
  s_mov_b32 s66, 8192
  s_mov_b32 s67, 0x20000
  s_lshl_b32 s48, s41, 16
  s_lshl_b32 s63, s40, 8
  s_add_u32 s48, s48, s63
  s_add_u32 s28, s54, s48
  s_addc_u32 s29, s55, 0
  s_mov_b32 s30, 65536
  s_mov_b32 s31, 0x20000
  s_sub_u32 s30, s30, s63
  s_lshr_b32 s50, s62, 6
  s_lshl_b32 s50, s50, 13
  s_and_b32 s48, s62, 63
  s_lshl_b32 s48, s48, 6
  s_add_u32 s50, s50, s48
  s_add_u32 s50, s50, 4096
  s_lshl_b32 s62, s41, 9
  s_add_u32 s62, s62, 98304
  v_and_b32 v185, 0xf0, v166
  buffer_load_dwordx2 v[220:221], v185, s[4:7], s62 offen offset:0 sc1
  buffer_load_dwordx2 v[222:223], v185, s[4:7], s62 offen offset:256 sc1
  s_add_u32 s16, s20, 33554432
  s_addc_u32 s17, s21, 0
  buffer_load_dwordx4 v[0:3], v166, s[16:19], 0 offen offset:0 sc1
  buffer_load_dwordx4 v[4:7], v166, s[16:19], 0 offen offset:1024 sc1
  buffer_load_dwordx4 v[8:11], v166, s[16:19], 0 offen offset:2048 sc1
  buffer_load_dwordx4 v[12:15], v166, s[16:19], 0 offen offset:3072 sc1
  buffer_load_dwordx4 v[16:19], v166, s[16:19], s42 offen offset:0 sc1
  buffer_load_dwordx4 v[20:23], v166, s[16:19], s42 offen offset:1024 sc1
  buffer_load_dwordx4 v[24:27], v166, s[16:19], s42 offen offset:2048 sc1
  buffer_load_dwordx4 v[28:31], v166, s[16:19], s42 offen offset:3072 sc1
  buffer_load_dwordx4 v[32:35], v166, s[16:19], s43 offen offset:0 sc1
  buffer_load_dwordx4 v[36:39], v166, s[16:19], s43 offen offset:1024 sc1
  buffer_load_dwordx4 v[40:43], v166, s[16:19], s43 offen offset:2048 sc1
  buffer_load_dwordx4 v[44:47], v166, s[16:19], s43 offen offset:3072 sc1
  buffer_load_dwordx4 v[48:51], v166, s[16:19], s44 offen offset:0 sc1
  buffer_load_dwordx4 v[52:55], v166, s[16:19], s44 offen offset:1024 sc1
  buffer_load_dwordx4 v[56:59], v166, s[16:19], s44 offen offset:2048 sc1
  buffer_load_dwordx4 v[60:63], v166, s[16:19], s44 offen offset:3072 sc1
  v_bfe_u32 v183, v166, 4, 4
  v_lshrrev_b32 v182, 8, v166
  v_lshlrev_b32 v180, 11, v183
  s_mov_b32 s46, 32768
  v_lshl_add_u32 v180, v182, 4, v180
  s_lshl_b32 s48, s41, 16
  s_lshl_b32 s63, s40, 8
  s_add_u32 s48, s48, s63
  s_add_u32 s24, s52, s48
  s_addc_u32 s25, s53, 0
  s_mov_b32 s26, 65536
  s_mov_b32 s27, 0x20000
  s_sub_u32 s26, s26, s63
  buffer_load_dwordx4 v[188:191], v180, s[24:27], 0 offen offset:0
  buffer_load_dwordx4 v[192:195], v180, s[24:27], s46 offen offset:0
  buffer_load_dwordx4 v[196:199], v180, s[24:27], 0 offen offset:64
  buffer_load_dwordx4 v[200:203], v180, s[24:27], s46 offen offset:64
  buffer_load_dwordx4 v[204:207], v180, s[24:27], 0 offen offset:128
  buffer_load_dwordx4 v[208:211], v180, s[24:27], s46 offen offset:128
  buffer_load_dwordx4 v[212:215], v180, s[24:27], 0 offen offset:192
  buffer_load_dwordx4 v[216:219], v180, s[24:27], s46 offen offset:192
  s_add_u32 s20, s20, 0
  s_addc_u32 s21, s21, 0
  s_mov_b32 s57, 0
  s_mov_b32 s56, 0
  s_waitcnt vmcnt(0)
  s_branch L3_got
L3_end:
  s_cmp_lg_u32 s94, 0
  s_cbranch_scc1 L3_orph
  s_cmp_lg_u32 s3, 0
  s_cbranch_scc1 L3_fin1
  s_mov_b64 exec, 1
  ds_write_b32 v181, v235 offset:76
  s_mov_b64 exec, -1
  s_waitcnt lgkmcnt(0)
L3_fin1:
  s_barrier
  ds_read_b32 v182, v181 offset:76
  s_waitcnt lgkmcnt(0)
  v_readfirstlane_b32 s48, v182
  s_nop 1
  s_cmp_lg_u32 s48, 255
  s_cbranch_scc1 L3_exit
  v_lshrrev_b32 v183, 2, v166
  s_cmp_lg_u32 s3, 0
  s_cbranch_scc1 L3_fin2
  v_mov_b32 v236, 0xaaaaaaaa
  s_mov_b64 exec, 0xffff
  buffer_atomic_or v236, v183, s[72:75], 0 offen offset:64 sc0 sc1
  s_waitcnt vmcnt(0)
  ds_write_b32 v183, v236 offset:128
  s_mov_b64 exec, -1
  s_waitcnt lgkmcnt(0)
L3_fin2:
  s_barrier
  ds_read_b32 v236, v183 offset:128
  s_waitcnt lgkmcnt(0)
  v_and_b32 v182, 0x55555555, v236
  v_cmp_ne_u32 vcc, 0, v182
  s_nop 1
  s_and_b32 s48, vcc_lo, 0xffff
  s_cbranch_scc0 L3_exit
L3_orph:
  s_cmp_ge_u32 s94, 256
  s_cbranch_scc1 L3_exit
  s_xor_b32 s34, s94, 2
  s_add_u32 s94, s94, 1
  s_lshr_b32 s48, s34, 4
  s_and_b32 s49, s34, 15
  s_lshl_b32 s49, s49, 1
  s_nop 2
  v_readlane_b32 s48, v236, s48
  s_nop 1
  s_bitcmp1_b32 s48, s49
  s_cbranch_scc1 L3_take
  s_branch L3_orph
L3_take:
  s_waitcnt vmcnt(0) lgkmcnt(0)
  s_barrier
  s_and_b32 s48, s34, 4
  buffer_load_dword v182, v181, s[72:75], s48 offen offset:48 sc0 sc1
  s_waitcnt vmcnt(0)
  v_readfirstlane_b32 s46, v182
  s_nop 0
  s_and_b32 s48, s34, 3
  s_lshl_b32 s48, s48, 2
  s_add_u32 s48, s48, 16
  s_lshr_b32 s47, s46, s48
  s_bfe_u32 s35, s47, 0x10001
  s_bfe_u32 s56, s34, 0x10002
  s_and_b32 s48, s47, 1
  s_cmp_eq_u32 s35, 0
  s_cselect_b32 s39, s56, s48
  s_cselect_b32 s40, s48, s56
  s_cselect_b32 s58, s56, 0
  s_lshl_b32 s40, s40, 2
  s_bfe_u32 s48, s34, 0x20003
  s_add_u32 s48, s40, s48
  s_lshr_b32 s56, s34, 5
  s_cmp_eq_u32 s35, 0
  s_cselect_b32 s40, s48, s56
  s_cselect_b32 s56, s56, s48
  s_lshl_b32 s41, s56, 3
  s_lshl_b32 s48, s3, 1
  s_add_u32 s41, s41, s48
  s_lshl_b32 s38, s56, 13
  s_lshl_b32 s48, s58, 7
  s_add_u32 s38, s38, s48
  s_lshl_b32 s48, s35, 8
  s_add_u32 s38, s38, s48
  s_add_u32 s38, s38, 128
  s_bfe_u32 s56, s47, 0x10002
  s_sub_u32 s56, s56, 1
  s_cmp_eq_u32 s35, 0
  s_cselect_b32 s8, s96, s98
  s_cselect_b32 s9, s97, s99
  s_mov_b32 s10, 0x400000
  s_mov_b32 s47, 0x40000
  s_mov_b32 s57, 20971520
  s_cselect_b32 s10, s10, 0x3c0000
  s_cselect_b32 s47, s47, 0x38000
  s_cselect_b32 s57, s57, 4194304
  s_mul_i32 s37, s10, s39
  s_lshl_b32 s36, s40, 8
  s_add_u32 s48, s37, s36
  s_add_u32 s8, s8, s48
  s_addc_u32 s9, s9, 0
  s_and_b32 s58, s35, s39
  s_lshl_b32 s48, s58, 19
  s_add_u32 s36, s36, s48
  s_sub_u32 s10, s10, s36
  s_mov_b32 s11, 0x20000
  s_mul_i32 s48, s41, s47
  s_add_u32 s48, s48, s57
  s_lshr_b32 s36, s37, 5
  s_lshl_b32 s14, s47, 1
  s_sub_u32 s14, s14, s36
  s_add_u32 s48, s48, s36
  s_add_u32 s12, s60, s48
  s_addc_u32 s13, s61, 0
  s_mov_b32 s15, 0x20000
  s_mul_i32 s36, s47, s39
  s_sub_u32 s37, s47, s36
  s_add_u32 s41, s41, s39
  s_mov_b32 s46, 0x7654
  v_bfe_u32 v238, s46, v237, 2
  s_mul_i32 s57, s58, 393216
  s_sub_u32 s57, 3407872, s57
  s_sub_u32 s58, 6, s58
  s_lshl_b32 s48, s35, 4
  v_and_b32 v209, s48, v166
  s_mov_b32 s39, 0
  v_lshl_add_u32 v238, v238, 2, s38
  v_lshl_add_u32 v238, v209, 3, v238
  s_mov_b32 s38, 0
  s_add_u32 m0, s45, 98304
  s_nop 0
  buffer_load_dwordx4 v224, s[8:11], s38 offen offset:0 lds
  buffer_load_dwordx4 v225, s[8:11], s38 offen offset:1024 lds
  buffer_load_dwordx4 v226, s[8:11], s38 offen offset:2048 lds
  buffer_load_dwordx4 v227, s[8:11], s38 offen offset:3072 lds
  s_add_u32 s38, s38, 0x20000
  s_add_u32 m0, s45, 114688
  s_nop 0
  buffer_load_dwordx4 v224, s[8:11], s38 offen offset:0 lds
  buffer_load_dwordx4 v225, s[8:11], s38 offen offset:1024 lds
  buffer_load_dwordx4 v226, s[8:11], s38 offen offset:2048 lds
  buffer_load_dwordx4 v227, s[8:11], s38 offen offset:3072 lds
  s_add_u32 s38, s38, 0x20000
  s_branch L3_setup
L3_chk:
  s_lshl_b32 s62, 1, s58
  s_mov_b32 s49, 1024
L3_chkp:
  buffer_load_dword v245, v238, s[4:7], 0 offen sc0 sc1
  s_sub_u32 s49, s49, 1
  s_waitcnt vmcnt(0)
  v_cmp_gt_u32 vcc, 4, v245
  s_nop 1
  s_and_b32 s48, vcc_lo, s62
  s_cbranch_scc0 L3_chkk
  s_cmp_lg_u32 s49, 0
  s_cbranch_scc1 L3_chkp
L3_chkk:
  s_mov_b32 s95, vcc_lo
  s_lshl_b32 s48, s3, 2
  v_mov_b32 v182, s95
  v_mov_b32 v183, s48
  ds_write_b32 v183, v182 offset:64
  s_waitcnt lgkmcnt(0)
  s_barrier
  ds_read_b128 v[182:185], v181 offset:64
  s_waitcnt lgkmcnt(0)
  v_or_b32 v182, v182, v183
  v_or3_b32 v182, v182, v184, v185
  s_nop 0
  v_readfirstlane_b32 s95, v182
  s_nop 1
  s_and_b32 s95, s95, 0x2a
  s_and_b32 s48, s95, s62
  s_cbranch_scc0 L3_chkb
L3_giveup:
  s_waitcnt vmcnt(0)
  s_cmp_lg_u32 s3, 0
  s_cbranch_scc1 L3_gu1
  s_lshr_b32 s48, s34, 4
  s_lshl_b32 s48, s48, 2
  s_and_b32 s49, s34, 15
  s_lshl_b32 s49, s49, 1
  s_lshl_b32 s56, 1, s49
  v_mov_b32 v182, s56
  s_mov_b64 exec, 1
  buffer_atomic_or v182, v181, s[72:75], s48 offen offset:64 sc0 sc1
  s_waitcnt vmcnt(0)
  v_lshrrev_b32 v182, s49, v182
  v_and_b32 v182, 2, v182
  ds_write_b32 v181, v182 offset:80
  s_mov_b64 exec, -1
  s_waitcnt lgkmcnt(0)
L3_gu1:
  s_waitcnt vmcnt(0)
  s_barrier
  ds_read_b32 v182, v181 offset:80
  s_waitcnt lgkmcnt(0)
  v_readfirstlane_b32 s48, v182
  s_nop 1
  s_cmp_eq_u32 s48, 0
  s_cbranch_scc1 L3_end
  s_branch L3_take
L3_wv:
  buffer_load_dwordx4 a[208:211], v166, s[12:15], s37 offen offset:0 sc1
  buffer_load_dwordx4 a[212:215], v166, s[12:15], s37 offen offset:1024 sc1
  buffer_load_dwordx4 a[216:219], v166, s[12:15], s37 offen offset:2048 sc1
  buffer_load_dwordx4 a[220:223], v166, s[12:15], s37 offen offset:3072 sc1
  s_add_u32 s37, s37, 4096
  buffer_load_dwordx4 a[192:195], v166, s[12:15], s36 offen offset:0 sc1
  buffer_load_dwordx4 a[196:199], v166, s[12:15], s36 offen offset:1024 sc1
  buffer_load_dwordx4 a[200:203], v166, s[12:15], s36 offen offset:2048 sc1
  buffer_load_dwordx4 a[204:207], v166, s[12:15], s36 offen offset:3072 sc1
  s_add_u32 s36, s36, 4096
  s_add_u32 m0, s45, 65536
  s_nop 0
  buffer_load_dwordx4 v224, s[8:11], s38 offen offset:0 lds
  buffer_load_dwordx4 v225, s[8:11], s38 offen offset:1024 lds
  buffer_load_dwordx4 v226, s[8:11], s38 offen offset:2048 lds
  buffer_load_dwordx4 v227, s[8:11], s38 offen offset:3072 lds
  s_add_u32 s38, s38, 0x20000
  v_and_b32 v172, 0x3c0, v166
  v_and_b32 v173, 0xf0, v166
  v_lshl_add_u32 v172, v172, 2, v173
  v_add_u32 v176, 32768, v172
  v_add_u32 v172, 98304, v172
  v_xor_b32 v173, 64, v172
  v_xor_b32 v174, 128, v172
  v_xor_b32 v175, 192, v172
  v_xor_b32 v177, 64, v176
  v_xor_b32 v178, 128, v176
  v_xor_b32 v179, 192, v176
  v_lshrrev_b32 v164, 2, v166
  v_accvgpr_read_b32 v144, a0
  v_accvgpr_read_b32 v145, a1
  v_accvgpr_read_b32 v146, a2
  v_accvgpr_read_b32 v147, a3
  v_accvgpr_read_b32 v148, a16
  v_accvgpr_read_b32 v149, a17
  v_accvgpr_read_b32 v150, a18
  v_accvgpr_read_b32 v151, a19
  v_pk_mul_f32 v[144:145], v[144:145], v[228:229]
  v_pk_mul_f32 v[146:147], v[146:147], v[228:229]
  v_pk_mul_f32 v[148:149], v[148:149], v[228:229]
  v_pk_mul_f32 v[150:151], v[150:151], v[228:229]
  v_cvt_pk_bf16_f32 v188, v144, v145
  v_cvt_pk_bf16_f32 v189, v146, v147
  v_cvt_pk_bf16_f32 v190, v148, v149
  v_cvt_pk_bf16_f32 v191, v150, v151
  v_accvgpr_read_b32 v144, a4
  v_accvgpr_read_b32 v145, a5
  v_accvgpr_read_b32 v146, a6
  v_accvgpr_read_b32 v147, a7
  v_accvgpr_read_b32 v148, a20
  v_accvgpr_read_b32 v149, a21
  v_accvgpr_read_b32 v150, a22
  v_accvgpr_read_b32 v151, a23
  v_pk_mul_f32 v[144:145], v[144:145], v[230:231]
  v_pk_mul_f32 v[146:147], v[146:147], v[230:231]
  v_pk_mul_f32 v[148:149], v[148:149], v[230:231]
  v_pk_mul_f32 v[150:151], v[150:151], v[230:231]
  v_cvt_pk_bf16_f32 v192, v144, v145
  v_cvt_pk_bf16_f32 v193, v146, v147
  v_cvt_pk_bf16_f32 v194, v148, v149
  v_cvt_pk_bf16_f32 v195, v150, v151
  v_accvgpr_read_b32 v144, a8
  v_accvgpr_read_b32 v145, a9
  v_accvgpr_read_b32 v146, a10
  v_accvgpr_read_b32 v147, a11
  v_accvgpr_read_b32 v148, a24
  v_accvgpr_read_b32 v149, a25
  v_accvgpr_read_b32 v150, a26
  v_accvgpr_read_b32 v151, a27
  v_pk_mul_f32 v[144:145], v[144:145], v[240:241]
  v_pk_mul_f32 v[146:147], v[146:147], v[240:241]
  v_pk_mul_f32 v[148:149], v[148:149], v[240:241]
  v_pk_mul_f32 v[150:151], v[150:151], v[240:241]
  v_cvt_pk_bf16_f32 v196, v144, v145
  v_cvt_pk_bf16_f32 v197, v146, v147
  v_cvt_pk_bf16_f32 v198, v148, v149
  v_cvt_pk_bf16_f32 v199, v150, v151
  v_accvgpr_read_b32 v144, a12
  v_accvgpr_read_b32 v145, a13
  v_accvgpr_read_b32 v146, a14
  v_accvgpr_read_b32 v147, a15
  v_accvgpr_read_b32 v148, a28
  v_accvgpr_read_b32 v149, a29
  v_accvgpr_read_b32 v150, a30
  v_accvgpr_read_b32 v151, a31
  v_pk_mul_f32 v[144:145], v[144:145], v[242:243]
  v_pk_mul_f32 v[146:147], v[146:147], v[242:243]
  v_pk_mul_f32 v[148:149], v[148:149], v[242:243]
  v_pk_mul_f32 v[150:151], v[150:151], v[242:243]
  v_cvt_pk_bf16_f32 v200, v144, v145
  v_cvt_pk_bf16_f32 v201, v146, v147
  v_cvt_pk_bf16_f32 v202, v148, v149
  v_cvt_pk_bf16_f32 v203, v150, v151
  buffer_load_dwordx4 a[16:19], v166, s[12:15], s37 offen offset:0 sc1
  buffer_load_dwordx4 a[20:23], v166, s[12:15], s37 offen offset:1024 sc1
  buffer_load_dwordx4 a[24:27], v166, s[12:15], s37 offen offset:2048 sc1
  buffer_load_dwordx4 a[28:31], v166, s[12:15], s37 offen offset:3072 sc1
  s_add_u32 s37, s37, 4096
  v_accvgpr_read_b32 v144, a32
  v_accvgpr_read_b32 v145, a33
  v_accvgpr_read_b32 v146, a34
  v_accvgpr_read_b32 v147, a35
  v_accvgpr_read_b32 v148, a48
  v_accvgpr_read_b32 v149, a49
  v_accvgpr_read_b32 v150, a50
  v_accvgpr_read_b32 v151, a51
  v_pk_mul_f32 v[144:145], v[144:145], v[228:229]
  v_pk_mul_f32 v[146:147], v[146:147], v[228:229]
  v_pk_mul_f32 v[148:149], v[148:149], v[228:229]
  v_pk_mul_f32 v[150:151], v[150:151], v[228:229]
  v_cvt_pk_bf16_f32 v204, v144, v145
  v_cvt_pk_bf16_f32 v205, v146, v147
  v_cvt_pk_bf16_f32 v206, v148, v149
  v_cvt_pk_bf16_f32 v207, v150, v151
  v_accvgpr_read_b32 v144, a36
  v_accvgpr_read_b32 v145, a37
  v_accvgpr_read_b32 v146, a38
  v_accvgpr_read_b32 v147, a39
  v_accvgpr_read_b32 v148, a52
  v_accvgpr_read_b32 v149, a53
  v_accvgpr_read_b32 v150, a54
  v_accvgpr_read_b32 v151, a55
  v_pk_mul_f32 v[144:145], v[144:145], v[230:231]
  v_pk_mul_f32 v[146:147], v[146:147], v[230:231]
  v_pk_mul_f32 v[148:149], v[148:149], v[230:231]
  v_pk_mul_f32 v[150:151], v[150:151], v[230:231]
  v_cvt_pk_bf16_f32 v208, v144, v145
  v_cvt_pk_bf16_f32 v209, v146, v147
  v_cvt_pk_bf16_f32 v210, v148, v149
  v_cvt_pk_bf16_f32 v211, v150, v151
  v_accvgpr_read_b32 v144, a40
  v_accvgpr_read_b32 v145, a41
  v_accvgpr_read_b32 v146, a42
  v_accvgpr_read_b32 v147, a43
  v_accvgpr_read_b32 v148, a56
  v_accvgpr_read_b32 v149, a57
  v_accvgpr_read_b32 v150, a58
  v_accvgpr_read_b32 v151, a59
  v_pk_mul_f32 v[144:145], v[144:145], v[240:241]
  v_pk_mul_f32 v[146:147], v[146:147], v[240:241]
  v_pk_mul_f32 v[148:149], v[148:149], v[240:241]
  v_pk_mul_f32 v[150:151], v[150:151], v[240:241]
  v_cvt_pk_bf16_f32 v212, v144, v145
  v_cvt_pk_bf16_f32 v213, v146, v147
  v_cvt_pk_bf16_f32 v214, v148, v149
  v_cvt_pk_bf16_f32 v215, v150, v151
  v_accvgpr_read_b32 v144, a44
  v_accvgpr_read_b32 v145, a45
  v_accvgpr_read_b32 v146, a46
  v_accvgpr_read_b32 v147, a47
  v_accvgpr_read_b32 v148, a60
  v_accvgpr_read_b32 v149, a61
  v_accvgpr_read_b32 v150, a62
  v_accvgpr_read_b32 v151, a63
  v_pk_mul_f32 v[144:145], v[144:145], v[242:243]
  v_pk_mul_f32 v[146:147], v[146:147], v[242:243]
  v_pk_mul_f32 v[148:149], v[148:149], v[242:243]
  v_pk_mul_f32 v[150:151], v[150:151], v[242:243]
  v_cvt_pk_bf16_f32 v216, v144, v145
  v_cvt_pk_bf16_f32 v217, v146, v147
  v_cvt_pk_bf16_f32 v218, v148, v149
  v_cvt_pk_bf16_f32 v219, v150, v151
  s_waitcnt vmcnt(20)
  s_barrier
  ds_read_b64_tr_b16 a[128:129], v172 offset:0
  ds_read_b64_tr_b16 a[130:131], v172 offset:4096
  ds_read_b64_tr_b16 a[132:133], v172 offset:8192
  ds_read_b64_tr_b16 a[134:135], v172 offset:12288
  ds_read_b64_tr_b16 a[136:137], v172 offset:8
  ds_read_b64_tr_b16 a[138:139], v172 offset:4104
  ds_read_b64_tr_b16 a[140:141], v172 offset:8200
  ds_read_b64_tr_b16 a[142:143], v172 offset:12296
  ds_read_b64_tr_b16 a[144:145], v173 offset:0
  ds_read_b64_tr_b16 a[146:147], v173 offset:4096
  ds_read_b64_tr_b16 a[148:149], v173 offset:8192
  ds_read_b64_tr_b16 a[150:151], v173 offset:12288
  s_waitcnt lgkmcnt(8)
L3_wv0:
  v_mfma_f32_16x16x32_bf16 v[0:3], a[128:131], v[128:131], 0
  v_accvgpr_read_b32 v144, a64
  v_accvgpr_read_b32 v145, a65
  v_accvgpr_read_b32 v146, a66
  v_mfma_f32_16x16x32_bf16 v[0:3], a[132:135], v[136:139], v[0:3]
  buffer_load_dwordx4 a[0:3], v166, s[12:15], s36 offen offset:0 sc1
  v_mfma_f32_16x16x32_bf16 v[8:11], a[128:131], v[132:135], 0
  ds_read_b64_tr_b16 a[152:153], v173 offset:8
  v_accvgpr_read_b32 v147, a67
  v_accvgpr_read_b32 v148, a80
  v_mfma_f32_16x16x32_bf16 v[8:11], a[132:135], v[140:143], v[8:11]
  ds_read_b64_tr_b16 a[154:155], v173 offset:4104
  v_accvgpr_read_b32 v149, a81
  v_mfma_f32_16x16x32_bf16 v[64:67], a[128:131], a[240:243], 0
  v_accvgpr_read_b32 v150, a82
  v_accvgpr_read_b32 v151, a83
  v_mfma_f32_16x16x32_bf16 v[64:67], a[132:135], a[248:251], v[64:67]
  buffer_load_dwordx4 a[4:7], v166, s[12:15], s36 offen offset:1024 sc1
  v_mul_f32 v144, v144, v228
  v_mfma_f32_16x16x32_bf16 v[72:75], a[128:131], a[244:247], 0
  ds_read_b64_tr_b16 a[156:157], v173 offset:8200
  v_mul_f32 v145, v145, v228
  v_mfma_f32_16x16x32_bf16 v[72:75], a[132:135], a[252:255], v[72:75]
  s_waitcnt lgkmcnt(7)
  v_mul_f32 v146, v146, v228
  v_mul_f32 v147, v147, v228
  v_mfma_f32_16x16x32_bf16 v[4:7], a[136:139], v[128:131], 0
  ds_read_b64_tr_b16 a[158:159], v173 offset:12296
  v_mul_f32 v148, v148, v228
  v_mfma_f32_16x16x32_bf16 v[4:7], a[140:143], v[136:139], v[4:7]
  buffer_load_dwordx4 a[8:11], v166, s[12:15], s36 offen offset:2048 sc1
  v_mul_f32 v149, v149, v228
  v_mfma_f32_16x16x32_bf16 v[12:15], a[136:139], v[132:135], 0
  ds_read_b64_tr_b16 a[160:161], v174 offset:0
  v_mul_f32 v150, v150, v228
  v_mfma_f32_16x16x32_bf16 v[12:15], a[140:143], v[140:143], v[12:15]
  ds_read_b64_tr_b16 a[162:163], v174 offset:4096
  v_mul_f32 v151, v151, v228
  v_cvt_pk_bf16_f32 v180, v144, v145
  v_mfma_f32_16x16x32_bf16 v[68:71], a[136:139], a[240:243], 0
  ds_read_b64_tr_b16 a[164:165], v174 offset:8192
  ds_read_b64_tr_b16 a[166:167], v174 offset:12288
  v_mfma_f32_16x16x32_bf16 v[68:71], a[140:143], a[248:251], v[68:71]
  v_cvt_pk_bf16_f32 v181, v146, v147
  v_cvt_pk_bf16_f32 v182, v148, v149
  v_cvt_pk_bf16_f32 v183, v150, v151
  v_mfma_f32_16x16x32_bf16 v[76:79], a[136:139], a[244:247], 0
  buffer_load_dwordx4 a[12:15], v166, s[12:15], s36 offen offset:3072 sc1
  v_mfma_f32_16x16x32_bf16 v[76:79], a[140:143], a[252:255], v[76:79]
  s_add_u32 s36, s36, 4096
  s_waitcnt lgkmcnt(8)
  v_accvgpr_read_b32 v144, a68
  v_mfma_f32_16x16x32_bf16 v[16:19], a[144:147], v[128:131], 0
  v_accvgpr_read_b32 v145, a69
  v_accvgpr_read_b32 v146, a70
  v_mfma_f32_16x16x32_bf16 v[16:19], a[148:151], v[136:139], v[16:19]
  ds_read_b64_tr_b16 a[168:169], v174 offset:8
  buffer_store_dwordx4 v[188:191], v166, s[28:31], s50 offen offset:0 sc1
  v_mfma_f32_16x16x32_bf16 v[24:27], a[144:147], v[132:135], 0
  v_accvgpr_read_b32 v147, a71
  v_accvgpr_read_b32 v148, a84
  v_mfma_f32_16x16x32_bf16 v[24:27], a[148:151], v[140:143], v[24:27]
  ds_read_b64_tr_b16 a[170:171], v174 offset:4104
  v_accvgpr_read_b32 v149, a85
  v_accvgpr_read_b32 v150, a86
  v_mfma_f32_16x16x32_bf16 v[80:83], a[144:147], a[240:243], 0
  ds_read_b64_tr_b16 a[172:173], v174 offset:8200
  ds_read_b64_tr_b16 a[174:175], v174 offset:12296
  v_mfma_f32_16x16x32_bf16 v[80:83], a[148:151], a[248:251], v[80:83]
  buffer_store_dwordx4 v[192:195], v166, s[28:31], s50 offen offset:1024 sc1
  v_accvgpr_read_b32 v151, a87
  v_mfma_f32_16x16x32_bf16 v[88:91], a[144:147], a[244:247], 0
  v_mul_f32 v144, v144, v230
  v_mul_f32 v145, v145, v230
  v_mfma_f32_16x16x32_bf16 v[88:91], a[148:151], a[252:255], v[88:91]
  s_waitcnt lgkmcnt(8)
  v_mul_f32 v146, v146, v230
  v_mul_f32 v147, v147, v230
  v_mfma_f32_16x16x32_bf16 v[20:23], a[152:155], v[128:131], 0
  buffer_load_dwordx4 a[48:51], v166, s[12:15], s37 offen offset:0 sc1
  v_mfma_f32_16x16x32_bf16 v[20:23], a[156:159], v[136:139], v[20:23]
  buffer_store_dwordx4 v[196:199], v166, s[28:31], s51 offen offset:0 sc1
  v_mul_f32 v148, v148, v230
  v_mfma_f32_16x16x32_bf16 v[28:31], a[152:155], v[132:135], 0
  ds_read_b64_tr_b16 a[176:177], v175 offset:0
  ds_read_b64_tr_b16 a[178:179], v175 offset:4096
  v_mul_f32 v149, v149, v230
  v_mfma_f32_16x16x32_bf16 v[28:31], a[156:159], v[140:143], v[28:31]
  buffer_load_dwordx4 a[52:55], v166, s[12:15], s37 offen offset:1024 sc1
  v_mfma_f32_16x16x32_bf16 v[84:87], a[152:155], a[240:243], 0
  ds_read_b64_tr_b16 a[180:181], v175 offset:8192
  ds_read_b64_tr_b16 a[182:183], v175 offset:12288
  v_mul_f32 v150, v150, v230
  v_mfma_f32_16x16x32_bf16 v[84:87], a[156:159], a[248:251], v[84:87]
  buffer_store_dwordx4 v[200:203], v166, s[28:31], s51 offen offset:1024 sc1
  v_mul_f32 v151, v151, v230
  v_mfma_f32_16x16x32_bf16 v[92:95], a[152:155], a[244:247], 0
  v_cvt_pk_bf16_f32 v184, v144, v145
  v_cvt_pk_bf16_f32 v185, v146, v147
  v_mfma_f32_16x16x32_bf16 v[92:95], a[156:159], a[252:255], v[92:95]
  s_waitcnt lgkmcnt(8)
  v_cvt_pk_bf16_f32 v186, v148, v149
  v_mfma_f32_16x16x32_bf16 v[32:35], a[160:163], v[128:131], 0
  buffer_load_dwordx4 a[56:59], v166, s[12:15], s37 offen offset:2048 sc1
  v_cvt_pk_bf16_f32 v187, v150, v151
  v_mfma_f32_16x16x32_bf16 v[32:35], a[164:167], v[136:139], v[32:35]
  v_accvgpr_read_b32 v144, a72
  v_accvgpr_read_b32 v145, a73
  v_mfma_f32_16x16x32_bf16 v[40:43], a[160:163], v[132:135], 0
  ds_read_b64_tr_b16 a[184:185], v175 offset:8
  ds_read_b64_tr_b16 a[186:187], v175 offset:4104
  v_accvgpr_read_b32 v146, a74
  v_mfma_f32_16x16x32_bf16 v[40:43], a[164:167], v[140:143], v[40:43]
  ds_read_b64_tr_b16 a[188:189], v175 offset:8200
  ds_read_b64_tr_b16 a[190:191], v175 offset:12296
  v_accvgpr_read_b32 v147, a75
  v_mfma_f32_16x16x32_bf16 v[96:99], a[160:163], a[240:243], 0
  buffer_load_dwordx4 a[60:63], v166, s[12:15], s37 offen offset:3072 sc1
  v_mfma_f32_16x16x32_bf16 v[96:99], a[164:167], a[248:251], v[96:99]
  s_add_u32 s37, s37, 4096
  v_accvgpr_read_b32 v148, a88
  v_accvgpr_read_b32 v149, a89
  v_mfma_f32_16x16x32_bf16 v[104:107], a[160:163], a[244:247], 0
  v_accvgpr_read_b32 v150, a90
  v_accvgpr_read_b32 v151, a91
  v_mfma_f32_16x16x32_bf16 v[104:107], a[164:167], a[252:255], v[104:107]
  s_waitcnt lgkmcnt(8)
  v_mul_f32 v144, v144, v240
  v_mfma_f32_16x16x32_bf16 v[36:39], a[168:171], v[128:131], 0
  v_mul_f32 v145, v145, v240
  v_mul_f32 v146, v146, v240
  v_mfma_f32_16x16x32_bf16 v[36:39], a[172:175], v[136:139], v[36:39]
  v_mul_f32 v147, v147, v240
  v_mul_f32 v148, v148, v240
  v_mul_f32 v149, v149, v240
  v_mfma_f32_16x16x32_bf16 v[44:47], a[168:171], v[132:135], 0
  v_mul_f32 v150, v150, v240
  v_mul_f32 v151, v151, v240
  v_mfma_f32_16x16x32_bf16 v[44:47], a[172:175], v[140:143], v[44:47]
  v_cvt_pk_bf16_f32 v160, v144, v145
  v_cvt_pk_bf16_f32 v161, v146, v147
  v_mfma_f32_16x16x32_bf16 v[100:103], a[168:171], a[240:243], 0
  v_cvt_pk_bf16_f32 v162, v148, v149
  v_cvt_pk_bf16_f32 v163, v150, v151
  v_mfma_f32_16x16x32_bf16 v[100:103], a[172:175], a[248:251], v[100:103]
  v_accvgpr_read_b32 v144, a76
  v_accvgpr_read_b32 v145, a77
  v_mfma_f32_16x16x32_bf16 v[108:111], a[168:171], a[244:247], 0
  s_waitcnt vmcnt(28)
  s_barrier
  v_accvgpr_read_b32 v146, a78
  v_mfma_f32_16x16x32_bf16 v[108:111], a[172:175], a[252:255], v[108:111]
  s_add_u32 m0, s45, 81920
  s_waitcnt lgkmcnt(4)
  v_accvgpr_read_b32 v147, a79
  v_mfma_f32_16x16x32_bf16 v[48:51], a[176:179], v[128:131], 0
  buffer_load_dwordx4 v224, s[8:11], s38 offen offset:0 lds
  v_mfma_f32_16x16x32_bf16 v[48:51], a[180:183], v[136:139], v[48:51]
  v_accvgpr_read_b32 v148, a92
  v_accvgpr_read_b32 v149, a93
  v_mfma_f32_16x16x32_bf16 v[56:59], a[176:179], v[132:135], 0
  ds_read_b64_tr_b16 a[128:129], v172 offset:16384
  ds_read_b64_tr_b16 a[130:131], v172 offset:20480
  v_accvgpr_read_b32 v150, a94
  v_mfma_f32_16x16x32_bf16 v[56:59], a[180:183], v[140:143], v[56:59]
  ds_read_b64_tr_b16 a[132:133], v172 offset:24576
  ds_read_b64_tr_b16 a[134:135], v172 offset:28672
  v_accvgpr_read_b32 v151, a95
  v_mfma_f32_16x16x32_bf16 v[112:115], a[176:179], a[240:243], 0
  buffer_load_dwordx4 v225, s[8:11], s38 offen offset:1024 lds
  v_mfma_f32_16x16x32_bf16 v[112:115], a[180:183], a[248:251], v[112:115]
  ds_read_b64_tr_b16 a[136:137], v172 offset:16392
  ds_read_b64_tr_b16 a[138:139], v172 offset:20488
  v_mul_f32 v144, v144, v242
  v_mfma_f32_16x16x32_bf16 v[120:123], a[176:179], a[244:247], 0
  v_mul_f32 v145, v145, v242
  v_mul_f32 v146, v146, v242
  v_mfma_f32_16x16x32_bf16 v[120:123], a[180:183], a[252:255], v[120:123]
  ds_read_b64_tr_b16 a[140:141], v172 offset:24584
  s_waitcnt lgkmcnt(7)
  v_mul_f32 v147, v147, v242
  v_mfma_f32_16x16x32_bf16 v[52:55], a[184:187], v[128:131], 0
  buffer_load_dwordx4 v226, s[8:11], s38 offen offset:2048 lds
  v_mul_f32 v148, v148, v242
  v_mfma_f32_16x16x32_bf16 v[52:55], a[188:191], v[136:139], v[52:55]
  ds_read_b64_tr_b16 a[142:143], v172 offset:28680
  ds_read_b64_tr_b16 a[144:145], v173 offset:16384
  v_mfma_f32_16x16x32_bf16 v[60:63], a[184:187], v[132:135], 0
  v_mul_f32 v149, v149, v242
  v_mul_f32 v150, v150, v242
  v_mul_f32 v151, v151, v242
  v_mfma_f32_16x16x32_bf16 v[60:63], a[188:191], v[140:143], v[60:63]
  ds_read_b64_tr_b16 a[146:147], v173 offset:20480
  v_cvt_pk_bf16_f32 v168, v144, v145
  v_mfma_f32_16x16x32_bf16 v[116:119], a[184:187], a[240:243], 0
  buffer_load_dwordx4 v227, s[8:11], s38 offen offset:3072 lds
  v_cvt_pk_bf16_f32 v169, v146, v147
  v_mfma_f32_16x16x32_bf16 v[116:119], a[188:191], a[248:251], v[116:119]
  s_add_u32 s38, s38, 0x20000
  v_cvt_pk_bf16_f32 v170, v148, v149
  v_mfma_f32_16x16x32_bf16 v[124:127], a[184:187], a[244:247], 0
  ds_read_b64_tr_b16 a[148:149], v173 offset:24576
  s_waitcnt vmcnt(24)
  v_cvt_pk_bf16_f32 v171, v150, v151
  v_mfma_f32_16x16x32_bf16 v[124:127], a[188:191], a[252:255], v[124:127]
  ds_read_b64_tr_b16 a[150:151], v173 offset:28672
  s_waitcnt lgkmcnt(8)
  v_mfma_f32_16x16x32_bf16 v[0:3], a[128:131], a[192:195], v[0:3]
  v_accvgpr_read_b32 v144, a96
  v_accvgpr_read_b32 v145, a97
  v_accvgpr_read_b32 v146, a98
  s_sub_u32 s57, s57, 0x20000
  v_mfma_f32_16x16x32_bf16 v[0:3], a[132:135], a[200:203], v[0:3]
  buffer_load_dwordx4 a[32:35], v166, s[12:15], s36 offen offset:0 sc1
  v_mfma_f32_16x16x32_bf16 v[8:11], a[128:131], a[196:199], v[8:11]
  ds_read_b64_tr_b16 a[152:153], v173 offset:16392
  v_accvgpr_read_b32 v147, a99
  v_accvgpr_read_b32 v148, a112
  v_mfma_f32_16x16x32_bf16 v[8:11], a[132:135], a[204:207], v[8:11]
  ds_read_b64_tr_b16 a[154:155], v173 offset:20488
  v_accvgpr_read_b32 v149, a113
  v_mfma_f32_16x16x32_bf16 v[64:67], a[128:131], a[208:211], v[64:67]
  v_accvgpr_read_b32 v150, a114
  v_accvgpr_read_b32 v151, a115
  v_mfma_f32_16x16x32_bf16 v[64:67], a[132:135], a[216:219], v[64:67]
  buffer_load_dwordx4 a[36:39], v166, s[12:15], s36 offen offset:1024 sc1
  v_mul_f32 v144, v144, v228
  v_mfma_f32_16x16x32_bf16 v[72:75], a[128:131], a[212:215], v[72:75]
  ds_read_b64_tr_b16 a[156:157], v173 offset:24584
  v_mul_f32 v145, v145, v228
  v_mfma_f32_16x16x32_bf16 v[72:75], a[132:135], a[220:223], v[72:75]
  s_waitcnt lgkmcnt(7)
  v_mul_f32 v146, v146, v228
  v_mul_f32 v147, v147, v228
  v_mfma_f32_16x16x32_bf16 v[4:7], a[136:139], a[192:195], v[4:7]
  ds_read_b64_tr_b16 a[158:159], v173 offset:28680
  v_mul_f32 v148, v148, v228
  v_mfma_f32_16x16x32_bf16 v[4:7], a[140:143], a[200:203], v[4:7]
  buffer_load_dwordx4 a[40:43], v166, s[12:15], s36 offen offset:2048 sc1
  v_mul_f32 v149, v149, v228
  v_mfma_f32_16x16x32_bf16 v[12:15], a[136:139], a[196:199], v[12:15]
  ds_read_b64_tr_b16 a[160:161], v174 offset:16384
  v_mul_f32 v150, v150, v228
  v_mfma_f32_16x16x32_bf16 v[12:15], a[140:143], a[204:207], v[12:15]
  ds_read_b64_tr_b16 a[162:163], v174 offset:20480
  v_mul_f32 v151, v151, v228
  v_cvt_pk_bf16_f32 v128, v144, v145
  v_mfma_f32_16x16x32_bf16 v[68:71], a[136:139], a[208:211], v[68:71]
  ds_read_b64_tr_b16 a[164:165], v174 offset:24576
  ds_read_b64_tr_b16 a[166:167], v174 offset:28672
  v_mfma_f32_16x16x32_bf16 v[68:71], a[140:143], a[216:219], v[68:71]
  v_cvt_pk_bf16_f32 v129, v146, v147
  v_cvt_pk_bf16_f32 v130, v148, v149
  v_cvt_pk_bf16_f32 v131, v150, v151
  v_mfma_f32_16x16x32_bf16 v[76:79], a[136:139], a[212:215], v[76:79]
  buffer_load_dwordx4 a[44:47], v166, s[12:15], s36 offen offset:3072 sc1
  v_mfma_f32_16x16x32_bf16 v[76:79], a[140:143], a[220:223], v[76:79]
  s_add_u32 s36, s36, 4096
  s_waitcnt lgkmcnt(8)
  v_accvgpr_read_b32 v144, a100
  v_mfma_f32_16x16x32_bf16 v[16:19], a[144:147], a[192:195], v[16:19]
  v_accvgpr_read_b32 v145, a101
  v_accvgpr_read_b32 v146, a102
  v_mfma_f32_16x16x32_bf16 v[16:19], a[148:151], a[200:203], v[16:19]
  ds_read_b64_tr_b16 a[168:169], v174 offset:16392
  buffer_store_dwordx4 v[204:207], v166, s[28:31], s50 offen offset:2048 sc1
  v_mfma_f32_16x16x32_bf16 v[24:27], a[144:147], a[196:199], v[24:27]
  v_accvgpr_read_b32 v147, a103
  v_accvgpr_read_b32 v148, a116
  v_mfma_f32_16x16x32_bf16 v[24:27], a[148:151], a[204:207], v[24:27]
  ds_read_b64_tr_b16 a[170:171], v174 offset:20488
  v_accvgpr_read_b32 v149, a117
  v_accvgpr_read_b32 v150, a118
  v_mfma_f32_16x16x32_bf16 v[80:83], a[144:147], a[208:211], v[80:83]
  ds_read_b64_tr_b16 a[172:173], v174 offset:24584
  ds_read_b64_tr_b16 a[174:175], v174 offset:28680
  v_mfma_f32_16x16x32_bf16 v[80:83], a[148:151], a[216:219], v[80:83]
  buffer_store_dwordx4 v[208:211], v166, s[28:31], s50 offen offset:3072 sc1
  v_accvgpr_read_b32 v151, a119
  s_sub_u32 s58, s58, 1
  v_mfma_f32_16x16x32_bf16 v[88:91], a[144:147], a[212:215], v[88:91]
  v_mul_f32 v144, v144, v230
  v_mul_f32 v145, v145, v230
  v_mfma_f32_16x16x32_bf16 v[88:91], a[148:151], a[220:223], v[88:91]
  s_waitcnt lgkmcnt(8)
  v_mul_f32 v146, v146, v230
  v_mul_f32 v147, v147, v230
  v_mfma_f32_16x16x32_bf16 v[20:23], a[152:155], a[192:195], v[20:23]
  buffer_load_dwordx4 a[80:83], v166, s[12:15], s37 offen offset:0 sc1
  v_mfma_f32_16x16x32_bf16 v[20:23], a[156:159], a[200:203], v[20:23]
  buffer_store_dwordx4 v[212:215], v166, s[28:31], s51 offen offset:2048 sc1
  v_mul_f32 v148, v148, v230
  v_mfma_f32_16x16x32_bf16 v[28:31], a[152:155], a[196:199], v[28:31]
  ds_read_b64_tr_b16 a[176:177], v175 offset:16384
  ds_read_b64_tr_b16 a[178:179], v175 offset:20480
  v_mul_f32 v149, v149, v230
  v_mfma_f32_16x16x32_bf16 v[28:31], a[156:159], a[204:207], v[28:31]
  buffer_load_dwordx4 a[84:87], v166, s[12:15], s37 offen offset:1024 sc1
  v_mfma_f32_16x16x32_bf16 v[84:87], a[152:155], a[208:211], v[84:87]
  ds_read_b64_tr_b16 a[180:181], v175 offset:24576
  ds_read_b64_tr_b16 a[182:183], v175 offset:28672
  v_mul_f32 v150, v150, v230
  v_mfma_f32_16x16x32_bf16 v[84:87], a[156:159], a[216:219], v[84:87]
  buffer_store_dwordx4 v[216:219], v166, s[28:31], s51 offen offset:3072 sc1
  v_mul_f32 v151, v151, v230
  v_mfma_f32_16x16x32_bf16 v[92:95], a[152:155], a[212:215], v[92:95]
  v_cvt_pk_bf16_f32 v132, v144, v145
  v_cvt_pk_bf16_f32 v133, v146, v147
  v_mfma_f32_16x16x32_bf16 v[92:95], a[156:159], a[220:223], v[92:95]
  s_waitcnt lgkmcnt(8)
  v_cvt_pk_bf16_f32 v134, v148, v149
  v_mfma_f32_16x16x32_bf16 v[32:35], a[160:163], a[192:195], v[32:35]
  buffer_load_dwordx4 a[88:91], v166, s[12:15], s37 offen offset:2048 sc1
  v_cvt_pk_bf16_f32 v135, v150, v151
  v_mfma_f32_16x16x32_bf16 v[32:35], a[164:167], a[200:203], v[32:35]
  v_accvgpr_read_b32 v144, a104
  v_accvgpr_read_b32 v145, a105
  v_mfma_f32_16x16x32_bf16 v[40:43], a[160:163], a[196:199], v[40:43]
  ds_read_b64_tr_b16 a[184:185], v175 offset:16392
  ds_read_b64_tr_b16 a[186:187], v175 offset:20488
  v_accvgpr_read_b32 v146, a106
  v_mfma_f32_16x16x32_bf16 v[40:43], a[164:167], a[204:207], v[40:43]
  ds_read_b64_tr_b16 a[188:189], v175 offset:24584
  ds_read_b64_tr_b16 a[190:191], v175 offset:28680
  v_accvgpr_read_b32 v147, a107
  v_mfma_f32_16x16x32_bf16 v[96:99], a[160:163], a[208:211], v[96:99]
  buffer_load_dwordx4 a[92:95], v166, s[12:15], s37 offen offset:3072 sc1
  v_mfma_f32_16x16x32_bf16 v[96:99], a[164:167], a[216:219], v[96:99]
  s_add_u32 s37, s37, 4096
  v_accvgpr_read_b32 v148, a120
  v_accvgpr_read_b32 v149, a121
  v_mfma_f32_16x16x32_bf16 v[104:107], a[160:163], a[212:215], v[104:107]
  v_accvgpr_read_b32 v150, a122
  v_accvgpr_read_b32 v151, a123
  v_mfma_f32_16x16x32_bf16 v[104:107], a[164:167], a[220:223], v[104:107]
  s_waitcnt lgkmcnt(8)
  v_mul_f32 v144, v144, v240
  v_mfma_f32_16x16x32_bf16 v[36:39], a[168:171], a[192:195], v[36:39]
  v_mul_f32 v145, v145, v240
  v_mul_f32 v146, v146, v240
  v_mfma_f32_16x16x32_bf16 v[36:39], a[172:175], a[200:203], v[36:39]
  v_mul_f32 v147, v147, v240
  v_mul_f32 v148, v148, v240
  v_mul_f32 v149, v149, v240
  v_mfma_f32_16x16x32_bf16 v[44:47], a[168:171], a[196:199], v[44:47]
  v_mul_f32 v150, v150, v240
  v_mul_f32 v151, v151, v240
  s_mov_b32 s59, 2
  v_mfma_f32_16x16x32_bf16 v[44:47], a[172:175], a[204:207], v[44:47]
  v_cvt_pk_bf16_f32 v136, v144, v145
  v_cvt_pk_bf16_f32 v137, v146, v147
  v_mfma_f32_16x16x32_bf16 v[100:103], a[168:171], a[208:211], v[100:103]
  v_cvt_pk_bf16_f32 v138, v148, v149
  v_cvt_pk_bf16_f32 v139, v150, v151
  v_mfma_f32_16x16x32_bf16 v[100:103], a[172:175], a[216:219], v[100:103]
  v_accvgpr_read_b32 v144, a108
  v_accvgpr_read_b32 v145, a109
  v_mfma_f32_16x16x32_bf16 v[108:111], a[168:171], a[212:215], v[108:111]
  s_waitcnt vmcnt(32)
  s_barrier
  v_accvgpr_read_b32 v146, a110
  v_mfma_f32_16x16x32_bf16 v[108:111], a[172:175], a[220:223], v[108:111]
  s_add_u32 m0, s45, 131072
  s_waitcnt lgkmcnt(4)
  v_accvgpr_read_b32 v147, a111
  v_mfma_f32_16x16x32_bf16 v[48:51], a[176:179], a[192:195], v[48:51]
  buffer_load_dwordx4 v224, s[8:11], s38 offen offset:0 lds
  v_mfma_f32_16x16x32_bf16 v[48:51], a[180:183], a[200:203], v[48:51]
  v_accvgpr_read_b32 v148, a124
  v_accvgpr_read_b32 v149, a125
  v_mfma_f32_16x16x32_bf16 v[56:59], a[176:179], a[196:199], v[56:59]
  ds_read_b64_tr_b16 a[128:129], v176 offset:32768
  ds_read_b64_tr_b16 a[130:131], v176 offset:36864
  v_accvgpr_read_b32 v150, a126
  v_mfma_f32_16x16x32_bf16 v[56:59], a[180:183], a[204:207], v[56:59]
  ds_read_b64_tr_b16 a[132:133], v176 offset:40960
  ds_read_b64_tr_b16 a[134:135], v176 offset:45056
  v_accvgpr_read_b32 v151, a127
  v_mfma_f32_16x16x32_bf16 v[112:115], a[176:179], a[208:211], v[112:115]
  buffer_load_dwordx4 v225, s[8:11], s38 offen offset:1024 lds
  v_mfma_f32_16x16x32_bf16 v[112:115], a[180:183], a[216:219], v[112:115]
  ds_read_b64_tr_b16 a[136:137], v176 offset:32776
  ds_read_b64_tr_b16 a[138:139], v176 offset:36872
  v_mul_f32 v144, v144, v242
  v_mfma_f32_16x16x32_bf16 v[120:123], a[176:179], a[212:215], v[120:123]
  v_mul_f32 v145, v145, v242
  v_mul_f32 v146, v146, v242
  v_mfma_f32_16x16x32_bf16 v[120:123], a[180:183], a[220:223], v[120:123]
  ds_read_b64_tr_b16 a[140:141], v176 offset:40968
  s_waitcnt lgkmcnt(7)
  v_mul_f32 v147, v147, v242
  v_mfma_f32_16x16x32_bf16 v[52:55], a[184:187], a[192:195], v[52:55]
  buffer_load_dwordx4 v226, s[8:11], s38 offen offset:2048 lds
  v_mul_f32 v148, v148, v242
  v_mfma_f32_16x16x32_bf16 v[52:55], a[188:191], a[200:203], v[52:55]
  ds_read_b64_tr_b16 a[142:143], v176 offset:45064
  ds_read_b64_tr_b16 a[144:145], v177 offset:32768
  v_mfma_f32_16x16x32_bf16 v[60:63], a[184:187], a[196:199], v[60:63]
  v_mul_f32 v149, v149, v242
  v_mul_f32 v150, v150, v242
  v_mul_f32 v151, v151, v242
  v_mfma_f32_16x16x32_bf16 v[60:63], a[188:191], a[204:207], v[60:63]
  ds_read_b64_tr_b16 a[146:147], v177 offset:36864
  v_cvt_pk_bf16_f32 v140, v144, v145
  v_mfma_f32_16x16x32_bf16 v[116:119], a[184:187], a[208:211], v[116:119]
  buffer_load_dwordx4 v227, s[8:11], s38 offen offset:3072 lds
  v_cvt_pk_bf16_f32 v141, v146, v147
  v_mfma_f32_16x16x32_bf16 v[116:119], a[188:191], a[216:219], v[116:119]
  s_add_u32 s38, s38, 0x20000
  v_cvt_pk_bf16_f32 v142, v148, v149
  v_mfma_f32_16x16x32_bf16 v[124:127], a[184:187], a[212:215], v[124:127]
  ds_read_b64_tr_b16 a[148:149], v177 offset:40960
  s_waitcnt vmcnt(28)
  v_cvt_pk_bf16_f32 v143, v150, v151
  v_mfma_f32_16x16x32_bf16 v[124:127], a[188:191], a[220:223], v[124:127]
  ds_read_b64_tr_b16 a[150:151], v177 offset:45056
  s_waitcnt lgkmcnt(8)
  v_mfma_f32_16x16x32_bf16 v[0:3], a[128:131], a[0:3], v[0:3]
  v_mfma_f32_16x16x32_bf16 v[0:3], a[132:135], a[8:11], v[0:3]
  buffer_load_dwordx4 a[64:67], v166, s[12:15], s36 offen offset:0 sc1
  v_mfma_f32_16x16x32_bf16 v[8:11], a[128:131], a[4:7], v[8:11]
  s_lshl_b32 s56, s58, 14
  ds_read_b64_tr_b16 a[152:153], v177 offset:32776
  v_mfma_f32_16x16x32_bf16 v[8:11], a[132:135], a[12:15], v[8:11]
  s_sub_u32 s56, 98304, s56
  ds_read_b64_tr_b16 a[154:155], v177 offset:36872
  v_mfma_f32_16x16x32_bf16 v[64:67], a[128:131], a[16:19], v[64:67]
  s_max_u32 s56, s56, 0x4000
  v_mfma_f32_16x16x32_bf16 v[64:67], a[132:135], a[24:27], v[64:67]
  buffer_load_dwordx4 a[68:71], v166, s[12:15], s36 offen offset:1024 sc1
  v_mfma_f32_16x16x32_bf16 v[72:75], a[128:131], a[20:23], v[72:75]
  ds_read_b64_tr_b16 a[156:157], v177 offset:40968
  v_mfma_f32_16x16x32_bf16 v[72:75], a[132:135], a[28:31], v[72:75]
  s_waitcnt lgkmcnt(7)
  v_mfma_f32_16x16x32_bf16 v[4:7], a[136:139], a[0:3], v[4:7]
  ds_read_b64_tr_b16 a[158:159], v177 offset:45064
  v_mfma_f32_16x16x32_bf16 v[4:7], a[140:143], a[8:11], v[4:7]
  buffer_load_dwordx4 a[72:75], v166, s[12:15], s36 offen offset:2048 sc1
  v_mfma_f32_16x16x32_bf16 v[12:15], a[136:139], a[4:7], v[12:15]
  ds_read_b64_tr_b16 a[160:161], v178 offset:32768
  v_mfma_f32_16x16x32_bf16 v[12:15], a[140:143], a[12:15], v[12:15]
  ds_read_b64_tr_b16 a[162:163], v178 offset:36864
  v_mfma_f32_16x16x32_bf16 v[68:71], a[136:139], a[16:19], v[68:71]
  ds_read_b64_tr_b16 a[164:165], v178 offset:40960
  ds_read_b64_tr_b16 a[166:167], v178 offset:45056
  v_mfma_f32_16x16x32_bf16 v[68:71], a[140:143], a[24:27], v[68:71]
  v_mfma_f32_16x16x32_bf16 v[76:79], a[136:139], a[20:23], v[76:79]
  buffer_load_dwordx4 a[76:79], v166, s[12:15], s36 offen offset:3072 sc1
  v_mfma_f32_16x16x32_bf16 v[76:79], a[140:143], a[28:31], v[76:79]
  s_add_u32 s36, s36, 4096
  s_waitcnt lgkmcnt(8)
  v_mfma_f32_16x16x32_bf16 v[16:19], a[144:147], a[0:3], v[16:19]
  v_mfma_f32_16x16x32_bf16 v[16:19], a[148:151], a[8:11], v[16:19]
  s_add_u32 m0, s45, s56
  ds_read_b64_tr_b16 a[168:169], v178 offset:32776
  v_mfma_f32_16x16x32_bf16 v[24:27], a[144:147], a[4:7], v[24:27]
  buffer_load_dwordx4 v224, s[8:11], s57 offen offset:0 lds
  v_mfma_f32_16x16x32_bf16 v[24:27], a[148:151], a[12:15], v[24:27]
  ds_read_b64_tr_b16 a[170:171], v178 offset:36872
  buffer_store_dwordx4 v[180:183], v166, s[28:31], s66 offen offset:0 sc1
  v_mfma_f32_16x16x32_bf16 v[80:83], a[144:147], a[16:19], v[80:83]
  ds_read_b64_tr_b16 a[172:173], v178 offset:40968
  ds_read_b64_tr_b16 a[174:175], v178 offset:45064
  v_mfma_f32_16x16x32_bf16 v[80:83], a[148:151], a[24:27], v[80:83]
  v_mfma_f32_16x16x32_bf16 v[88:91], a[144:147], a[20:23], v[88:91]
  v_mfma_f32_16x16x32_bf16 v[88:91], a[148:151], a[28:31], v[88:91]
  s_waitcnt lgkmcnt(8)
  buffer_store_dwordx4 v[184:187], v166, s[28:31], s66 offen offset:1024 sc1
  v_mfma_f32_16x16x32_bf16 v[20:23], a[152:155], a[0:3], v[20:23]
  buffer_load_dwordx4 a[112:115], v166, s[12:15], s37 offen offset:0 sc1
  v_mfma_f32_16x16x32_bf16 v[20:23], a[156:159], a[8:11], v[20:23]
  v_mfma_f32_16x16x32_bf16 v[28:31], a[152:155], a[4:7], v[28:31]
  ds_read_b64_tr_b16 a[176:177], v179 offset:32768
  ds_read_b64_tr_b16 a[178:179], v179 offset:36864
  v_mfma_f32_16x16x32_bf16 v[28:31], a[156:159], a[12:15], v[28:31]
  buffer_load_dwordx4 a[116:119], v166, s[12:15], s37 offen offset:1024 sc1
  v_mfma_f32_16x16x32_bf16 v[84:87], a[152:155], a[16:19], v[84:87]
  ds_read_b64_tr_b16 a[180:181], v179 offset:40960
  ds_read_b64_tr_b16 a[182:183], v179 offset:45056
  v_mfma_f32_16x16x32_bf16 v[84:87], a[156:159], a[24:27], v[84:87]
  buffer_store_dwordx4 v[160:163], v166, s[28:31], s67 offen offset:0 sc1
  v_mfma_f32_16x16x32_bf16 v[92:95], a[152:155], a[20:23], v[92:95]
  v_mfma_f32_16x16x32_bf16 v[92:95], a[156:159], a[28:31], v[92:95]
  s_waitcnt lgkmcnt(8)
  v_mfma_f32_16x16x32_bf16 v[32:35], a[160:163], a[0:3], v[32:35]
  buffer_load_dwordx4 a[120:123], v166, s[12:15], s37 offen offset:2048 sc1
  v_mfma_f32_16x16x32_bf16 v[32:35], a[164:167], a[8:11], v[32:35]
  buffer_store_dwordx4 v[168:171], v166, s[28:31], s67 offen offset:1024 sc1
  v_mfma_f32_16x16x32_bf16 v[40:43], a[160:163], a[4:7], v[40:43]
  ds_read_b64_tr_b16 a[184:185], v179 offset:32776
  ds_read_b64_tr_b16 a[186:187], v179 offset:36872
  v_mfma_f32_16x16x32_bf16 v[40:43], a[164:167], a[12:15], v[40:43]
  ds_read_b64_tr_b16 a[188:189], v179 offset:40968
  ds_read_b64_tr_b16 a[190:191], v179 offset:45064
  v_mfma_f32_16x16x32_bf16 v[96:99], a[160:163], a[16:19], v[96:99]
  buffer_load_dwordx4 a[124:127], v166, s[12:15], s37 offen offset:3072 sc1
  v_mfma_f32_16x16x32_bf16 v[96:99], a[164:167], a[24:27], v[96:99]
  s_add_u32 s37, s37, 4096
  v_mfma_f32_16x16x32_bf16 v[104:107], a[160:163], a[20:23], v[104:107]
  v_mfma_f32_16x16x32_bf16 v[104:107], a[164:167], a[28:31], v[104:107]
  s_waitcnt lgkmcnt(8)
  v_mfma_f32_16x16x32_bf16 v[36:39], a[168:171], a[0:3], v[36:39]
  v_mfma_f32_16x16x32_bf16 v[36:39], a[172:175], a[8:11], v[36:39]
  v_mfma_f32_16x16x32_bf16 v[44:47], a[168:171], a[4:7], v[44:47]
  v_mfma_f32_16x16x32_bf16 v[44:47], a[172:175], a[12:15], v[44:47]
  v_mfma_f32_16x16x32_bf16 v[100:103], a[168:171], a[16:19], v[100:103]
  v_mfma_f32_16x16x32_bf16 v[100:103], a[172:175], a[24:27], v[100:103]
  v_mfma_f32_16x16x32_bf16 v[108:111], a[168:171], a[20:23], v[108:111]
  s_waitcnt vmcnt(29)
  s_barrier
  v_mfma_f32_16x16x32_bf16 v[108:111], a[172:175], a[28:31], v[108:111]
  s_add_u32 m0, s45, 147456
  s_waitcnt lgkmcnt(4)
  v_mfma_f32_16x16x32_bf16 v[48:51], a[176:179], a[0:3], v[48:51]
  buffer_load_dwordx4 v224, s[8:11], s38 offen offset:0 lds
  v_mfma_f32_16x16x32_bf16 v[48:51], a[180:183], a[8:11], v[48:51]
  v_mfma_f32_16x16x32_bf16 v[56:59], a[176:179], a[4:7], v[56:59]
  ds_read_b64_tr_b16 a[128:129], v176 offset:49152
  ds_read_b64_tr_b16 a[130:131], v176 offset:53248
  v_mfma_f32_16x16x32_bf16 v[56:59], a[180:183], a[12:15], v[56:59]
  ds_read_b64_tr_b16 a[132:133], v176 offset:57344
  ds_read_b64_tr_b16 a[134:135], v176 offset:61440
  v_mfma_f32_16x16x32_bf16 v[112:115], a[176:179], a[16:19], v[112:115]
  buffer_load_dwordx4 v225, s[8:11], s38 offen offset:1024 lds
  v_mfma_f32_16x16x32_bf16 v[112:115], a[180:183], a[24:27], v[112:115]
  ds_read_b64_tr_b16 a[136:137], v176 offset:49160
  ds_read_b64_tr_b16 a[138:139], v176 offset:53256
  v_mfma_f32_16x16x32_bf16 v[120:123], a[176:179], a[20:23], v[120:123]
  v_mfma_f32_16x16x32_bf16 v[120:123], a[180:183], a[28:31], v[120:123]
  ds_read_b64_tr_b16 a[140:141], v176 offset:57352
  s_waitcnt lgkmcnt(7)
  v_mfma_f32_16x16x32_bf16 v[52:55], a[184:187], a[0:3], v[52:55]
  buffer_load_dwordx4 v226, s[8:11], s38 offen offset:2048 lds
  v_mfma_f32_16x16x32_bf16 v[52:55], a[188:191], a[8:11], v[52:55]
  ds_read_b64_tr_b16 a[142:143], v176 offset:61448
  ds_read_b64_tr_b16 a[144:145], v177 offset:49152
  v_mfma_f32_16x16x32_bf16 v[60:63], a[184:187], a[4:7], v[60:63]
  v_mfma_f32_16x16x32_bf16 v[60:63], a[188:191], a[12:15], v[60:63]
  ds_read_b64_tr_b16 a[146:147], v177 offset:53248
  v_mfma_f32_16x16x32_bf16 v[116:119], a[184:187], a[16:19], v[116:119]
  buffer_load_dwordx4 v227, s[8:11], s38 offen offset:3072 lds
  v_mfma_f32_16x16x32_bf16 v[116:119], a[188:191], a[24:27], v[116:119]
  s_add_u32 s38, s38, 0x20000
  v_mfma_f32_16x16x32_bf16 v[124:127], a[184:187], a[20:23], v[124:127]
  ds_read_b64_tr_b16 a[148:149], v177 offset:57344
  s_waitcnt vmcnt(29)
  v_mfma_f32_16x16x32_bf16 v[124:127], a[188:191], a[28:31], v[124:127]
  ds_read_b64_tr_b16 a[150:151], v177 offset:61440
  s_waitcnt lgkmcnt(8)
  v_mfma_f32_16x16x32_bf16 v[0:3], a[128:131], a[32:35], v[0:3]
  v_mfma_f32_16x16x32_bf16 v[0:3], a[132:135], a[40:43], v[0:3]
  buffer_load_dwordx4 a[96:99], v166, s[12:15], s36 offen offset:0 sc1
  v_mfma_f32_16x16x32_bf16 v[8:11], a[128:131], a[36:39], v[8:11]
  ds_read_b64_tr_b16 a[152:153], v177 offset:49160
  v_mfma_f32_16x16x32_bf16 v[8:11], a[132:135], a[44:47], v[8:11]
  ds_read_b64_tr_b16 a[154:155], v177 offset:53256
  v_mfma_f32_16x16x32_bf16 v[64:67], a[128:131], a[48:51], v[64:67]
  v_mfma_f32_16x16x32_bf16 v[64:67], a[132:135], a[56:59], v[64:67]
  buffer_load_dwordx4 a[100:103], v166, s[12:15], s36 offen offset:1024 sc1
  v_mfma_f32_16x16x32_bf16 v[72:75], a[128:131], a[52:55], v[72:75]
  ds_read_b64_tr_b16 a[156:157], v177 offset:57352
  v_mfma_f32_16x16x32_bf16 v[72:75], a[132:135], a[60:63], v[72:75]
  s_waitcnt lgkmcnt(7)
  v_mfma_f32_16x16x32_bf16 v[4:7], a[136:139], a[32:35], v[4:7]
  ds_read_b64_tr_b16 a[158:159], v177 offset:61448
  v_mfma_f32_16x16x32_bf16 v[4:7], a[140:143], a[40:43], v[4:7]
  buffer_load_dwordx4 a[104:107], v166, s[12:15], s36 offen offset:2048 sc1
  v_mfma_f32_16x16x32_bf16 v[12:15], a[136:139], a[36:39], v[12:15]
  ds_read_b64_tr_b16 a[160:161], v178 offset:49152
  v_mfma_f32_16x16x32_bf16 v[12:15], a[140:143], a[44:47], v[12:15]
  ds_read_b64_tr_b16 a[162:163], v178 offset:53248
  v_mfma_f32_16x16x32_bf16 v[68:71], a[136:139], a[48:51], v[68:71]
  ds_read_b64_tr_b16 a[164:165], v178 offset:57344
  ds_read_b64_tr_b16 a[166:167], v178 offset:61440
  v_mfma_f32_16x16x32_bf16 v[68:71], a[140:143], a[56:59], v[68:71]
  v_mfma_f32_16x16x32_bf16 v[76:79], a[136:139], a[52:55], v[76:79]
  buffer_load_dwordx4 a[108:111], v166, s[12:15], s36 offen offset:3072 sc1
  v_mfma_f32_16x16x32_bf16 v[76:79], a[140:143], a[60:63], v[76:79]
  s_add_u32 s36, s36, 4096
  s_waitcnt lgkmcnt(8)
  v_mfma_f32_16x16x32_bf16 v[16:19], a[144:147], a[32:35], v[16:19]
  v_mfma_f32_16x16x32_bf16 v[16:19], a[148:151], a[40:43], v[16:19]
  s_add_u32 m0, s45, s56
  ds_read_b64_tr_b16 a[168:169], v178 offset:49160
  v_mfma_f32_16x16x32_bf16 v[24:27], a[144:147], a[36:39], v[24:27]
  buffer_load_dwordx4 v225, s[8:11], s57 offen offset:1024 lds
  v_mfma_f32_16x16x32_bf16 v[24:27], a[148:151], a[44:47], v[24:27]
  ds_read_b64_tr_b16 a[170:171], v178 offset:53256
  buffer_store_dwordx4 v[128:131], v166, s[28:31], s66 offen offset:2048 sc1
  v_mfma_f32_16x16x32_bf16 v[80:83], a[144:147], a[48:51], v[80:83]
  ds_read_b64_tr_b16 a[172:173], v178 offset:57352
  ds_read_b64_tr_b16 a[174:175], v178 offset:61448
  v_mfma_f32_16x16x32_bf16 v[80:83], a[148:151], a[56:59], v[80:83]
  v_mfma_f32_16x16x32_bf16 v[88:91], a[144:147], a[52:55], v[88:91]
  v_mfma_f32_16x16x32_bf16 v[88:91], a[148:151], a[60:63], v[88:91]
  s_waitcnt lgkmcnt(8)
  buffer_store_dwordx4 v[132:135], v166, s[28:31], s66 offen offset:3072 sc1
  v_mfma_f32_16x16x32_bf16 v[20:23], a[152:155], a[32:35], v[20:23]
  buffer_load_dwordx4 a[16:19], v166, s[12:15], s37 offen offset:0 sc1
  v_mfma_f32_16x16x32_bf16 v[20:23], a[156:159], a[40:43], v[20:23]
  v_mfma_f32_16x16x32_bf16 v[28:31], a[152:155], a[36:39], v[28:31]
  ds_read_b64_tr_b16 a[176:177], v179 offset:49152
  ds_read_b64_tr_b16 a[178:179], v179 offset:53248
  v_mfma_f32_16x16x32_bf16 v[28:31], a[156:159], a[44:47], v[28:31]
  buffer_load_dwordx4 a[20:23], v166, s[12:15], s37 offen offset:1024 sc1
  v_mfma_f32_16x16x32_bf16 v[84:87], a[152:155], a[48:51], v[84:87]
  ds_read_b64_tr_b16 a[180:181], v179 offset:57344
  ds_read_b64_tr_b16 a[182:183], v179 offset:61440
  v_mfma_f32_16x16x32_bf16 v[84:87], a[156:159], a[56:59], v[84:87]
  buffer_store_dwordx4 v[136:139], v166, s[28:31], s67 offen offset:2048 sc1
  v_mfma_f32_16x16x32_bf16 v[92:95], a[152:155], a[52:55], v[92:95]
  v_mfma_f32_16x16x32_bf16 v[92:95], a[156:159], a[60:63], v[92:95]
  s_waitcnt lgkmcnt(8)
  v_mfma_f32_16x16x32_bf16 v[32:35], a[160:163], a[32:35], v[32:35]
  buffer_load_dwordx4 a[24:27], v166, s[12:15], s37 offen offset:2048 sc1
  v_mfma_f32_16x16x32_bf16 v[32:35], a[164:167], a[40:43], v[32:35]
  buffer_store_dwordx4 v[140:143], v166, s[28:31], s67 offen offset:3072 sc1
  v_mfma_f32_16x16x32_bf16 v[40:43], a[160:163], a[36:39], v[40:43]
  ds_read_b64_tr_b16 a[184:185], v179 offset:49160
  ds_read_b64_tr_b16 a[186:187], v179 offset:53256
  v_mfma_f32_16x16x32_bf16 v[40:43], a[164:167], a[44:47], v[40:43]
  ds_read_b64_tr_b16 a[188:189], v179 offset:57352
  ds_read_b64_tr_b16 a[190:191], v179 offset:61448
  v_mfma_f32_16x16x32_bf16 v[96:99], a[160:163], a[48:51], v[96:99]
  buffer_load_dwordx4 a[28:31], v166, s[12:15], s37 offen offset:3072 sc1
  v_mfma_f32_16x16x32_bf16 v[96:99], a[164:167], a[56:59], v[96:99]
  s_add_u32 s37, s37, 4096
  v_mfma_f32_16x16x32_bf16 v[104:107], a[160:163], a[52:55], v[104:107]
  v_mfma_f32_16x16x32_bf16 v[104:107], a[164:167], a[60:63], v[104:107]
  s_waitcnt lgkmcnt(8)
  v_mfma_f32_16x16x32_bf16 v[36:39], a[168:171], a[32:35], v[36:39]
  v_mfma_f32_16x16x32_bf16 v[36:39], a[172:175], a[40:43], v[36:39]
  v_mfma_f32_16x16x32_bf16 v[44:47], a[168:171], a[36:39], v[44:47]
  v_mfma_f32_16x16x32_bf16 v[44:47], a[172:175], a[44:47], v[44:47]
  v_mfma_f32_16x16x32_bf16 v[100:103], a[168:171], a[48:51], v[100:103]
  v_mfma_f32_16x16x32_bf16 v[100:103], a[172:175], a[56:59], v[100:103]
  v_mfma_f32_16x16x32_bf16 v[108:111], a[168:171], a[52:55], v[108:111]
  s_waitcnt vmcnt(30)
  s_barrier
  v_mfma_f32_16x16x32_bf16 v[108:111], a[172:175], a[60:63], v[108:111]
  s_add_u32 m0, s45, 98304
  s_waitcnt lgkmcnt(4)
  v_mfma_f32_16x16x32_bf16 v[48:51], a[176:179], a[32:35], v[48:51]
  buffer_load_dwordx4 v224, s[8:11], s38 offen offset:0 lds
  v_mfma_f32_16x16x32_bf16 v[48:51], a[180:183], a[40:43], v[48:51]
  v_mfma_f32_16x16x32_bf16 v[56:59], a[176:179], a[36:39], v[56:59]
  ds_read_b64_tr_b16 a[128:129], v172 offset:32768
  ds_read_b64_tr_b16 a[130:131], v172 offset:36864
  v_mfma_f32_16x16x32_bf16 v[56:59], a[180:183], a[44:47], v[56:59]
  ds_read_b64_tr_b16 a[132:133], v172 offset:40960
  ds_read_b64_tr_b16 a[134:135], v172 offset:45056
  v_mfma_f32_16x16x32_bf16 v[112:115], a[176:179], a[48:51], v[112:115]
  buffer_load_dwordx4 v225, s[8:11], s38 offen offset:1024 lds
  v_mfma_f32_16x16x32_bf16 v[112:115], a[180:183], a[56:59], v[112:115]
  ds_read_b64_tr_b16 a[136:137], v172 offset:32776
  ds_read_b64_tr_b16 a[138:139], v172 offset:36872
  v_mfma_f32_16x16x32_bf16 v[120:123], a[176:179], a[52:55], v[120:123]
  v_mfma_f32_16x16x32_bf16 v[120:123], a[180:183], a[60:63], v[120:123]
  ds_read_b64_tr_b16 a[140:141], v172 offset:40968
  s_waitcnt lgkmcnt(7)
  v_mfma_f32_16x16x32_bf16 v[52:55], a[184:187], a[32:35], v[52:55]
  buffer_load_dwordx4 v226, s[8:11], s38 offen offset:2048 lds
  v_mfma_f32_16x16x32_bf16 v[52:55], a[188:191], a[40:43], v[52:55]
  ds_read_b64_tr_b16 a[142:143], v172 offset:45064
  ds_read_b64_tr_b16 a[144:145], v173 offset:32768
  v_mfma_f32_16x16x32_bf16 v[60:63], a[184:187], a[36:39], v[60:63]
  v_mfma_f32_16x16x32_bf16 v[60:63], a[188:191], a[44:47], v[60:63]
  ds_read_b64_tr_b16 a[146:147], v173 offset:36864
  v_mfma_f32_16x16x32_bf16 v[116:119], a[184:187], a[48:51], v[116:119]
  buffer_load_dwordx4 v227, s[8:11], s38 offen offset:3072 lds
  v_mfma_f32_16x16x32_bf16 v[116:119], a[188:191], a[56:59], v[116:119]
  s_add_u32 s38, s38, 0x20000
  v_mfma_f32_16x16x32_bf16 v[124:127], a[184:187], a[52:55], v[124:127]
  ds_read_b64_tr_b16 a[148:149], v173 offset:40960
  s_waitcnt vmcnt(30)
  v_mfma_f32_16x16x32_bf16 v[124:127], a[188:191], a[60:63], v[124:127]
  ds_read_b64_tr_b16 a[150:151], v173 offset:45056
  s_waitcnt lgkmcnt(8)
  v_mfma_f32_16x16x32_bf16 v[0:3], a[128:131], a[64:67], v[0:3]
  v_mov_b32 v181, 0
  s_mov_b32 s42, 4096
  v_mfma_f32_16x16x32_bf16 v[0:3], a[132:135], a[72:75], v[0:3]
  buffer_load_dwordx4 a[0:3], v166, s[12:15], s36 offen offset:0 sc1
  s_mov_b32 s43, 8192
  v_mfma_f32_16x16x32_bf16 v[8:11], a[128:131], a[68:71], v[8:11]
  ds_read_b64_tr_b16 a[152:153], v173 offset:32776
  s_mov_b32 s44, 12288
  v_mfma_f32_16x16x32_bf16 v[8:11], a[132:135], a[76:79], v[8:11]
  ds_read_b64_tr_b16 a[154:155], v173 offset:36872
  s_lshl_b32 s62, s41, 3
  v_mfma_f32_16x16x32_bf16 v[64:67], a[128:131], a[80:83], v[64:67]
  s_add_u32 s62, s62, s40
  s_lshl_b32 s48, s62, 14
  v_mfma_f32_16x16x32_bf16 v[64:67], a[132:135], a[88:91], v[64:67]
  buffer_load_dwordx4 a[4:7], v166, s[12:15], s36 offen offset:1024 sc1
  v_mfma_f32_16x16x32_bf16 v[72:75], a[128:131], a[84:87], v[72:75]
  ds_read_b64_tr_b16 a[156:157], v173 offset:40968
  s_lshl_b32 s63, s35, 23
  v_mfma_f32_16x16x32_bf16 v[72:75], a[132:135], a[92:95], v[72:75]
  s_waitcnt lgkmcnt(7)
  s_add_u32 s48, s48, s63
  v_mfma_f32_16x16x32_bf16 v[4:7], a[136:139], a[64:67], v[4:7]
  ds_read_b64_tr_b16 a[158:159], v173 offset:45064
  s_add_u32 s48, s48, 67108864
  s_add_u32 s20, s60, s48
  s_addc_u32 s21, s61, 0
  v_mfma_f32_16x16x32_bf16 v[4:7], a[140:143], a[72:75], v[4:7]
  buffer_load_dwordx4 a[8:11], v166, s[12:15], s36 offen offset:2048 sc1
  v_mfma_f32_16x16x32_bf16 v[12:15], a[136:139], a[68:71], v[12:15]
  ds_read_b64_tr_b16 a[160:161], v174 offset:32768
  v_mfma_f32_16x16x32_bf16 v[12:15], a[140:143], a[76:79], v[12:15]
  ds_read_b64_tr_b16 a[162:163], v174 offset:36864
  s_mov_b32 s22, 16384
  v_mfma_f32_16x16x32_bf16 v[68:71], a[136:139], a[80:83], v[68:71]
  ds_read_b64_tr_b16 a[164:165], v174 offset:40960
  ds_read_b64_tr_b16 a[166:167], v174 offset:45056
  s_mov_b32 s23, 0x20000
  v_mfma_f32_16x16x32_bf16 v[68:71], a[140:143], a[88:91], v[68:71]
  s_lshl_b32 s48, s62, 13
  s_cmp_eq_u32 s35, 0
  s_mov_b32 s63, 41943040
  s_mov_b32 s50, 37748736
  s_cselect_b32 s63, s63, 37748736
  s_cselect_b32 s50, s50, 41943040
  v_mfma_f32_16x16x32_bf16 v[76:79], a[136:139], a[84:87], v[76:79]
  buffer_load_dwordx4 a[12:15], v166, s[12:15], s36 offen offset:3072 sc1
  v_mfma_f32_16x16x32_bf16 v[76:79], a[140:143], a[92:95], v[76:79]
  s_add_u32 s36, s36, 4096
  s_waitcnt lgkmcnt(8)
  v_mfma_f32_16x16x32_bf16 v[16:19], a[144:147], a[64:67], v[16:19]
  v_mfma_f32_16x16x32_bf16 v[16:19], a[148:151], a[72:75], v[16:19]
  s_add_u32 m0, s45, s56
  ds_read_b64_tr_b16 a[168:169], v174 offset:32776
  v_mfma_f32_16x16x32_bf16 v[24:27], a[144:147], a[68:71], v[24:27]
  buffer_load_dwordx4 v226, s[8:11], s57 offen offset:2048 lds
  v_mfma_f32_16x16x32_bf16 v[24:27], a[148:151], a[76:79], v[24:27]
  ds_read_b64_tr_b16 a[170:171], v174 offset:36872
  s_add_u32 s63, s63, s48
  v_mfma_f32_16x16x32_bf16 v[80:83], a[144:147], a[80:83], v[80:83]
  ds_read_b64_tr_b16 a[172:173], v174 offset:40968
  ds_read_b64_tr_b16 a[174:175], v174 offset:45064
  v_mfma_f32_16x16x32_bf16 v[80:83], a[148:151], a[88:91], v[80:83]
  s_add_u32 s50, s50, s48
  s_add_u32 s68, s60, s63
  s_addc_u32 s69, s61, 0
  v_mfma_f32_16x16x32_bf16 v[88:91], a[144:147], a[84:87], v[88:91]
  s_mov_b32 s70, 8192
  v_mfma_f32_16x16x32_bf16 v[88:91], a[148:151], a[92:95], v[88:91]
  s_waitcnt lgkmcnt(8)
  s_mov_b32 s71, 0x20000
  v_mfma_f32_16x16x32_bf16 v[20:23], a[152:155], a[64:67], v[20:23]
  buffer_load_dwordx4 a[48:51], v166, s[12:15], s37 offen offset:0 sc1
  v_mfma_f32_16x16x32_bf16 v[20:23], a[156:159], a[72:75], v[20:23]
  s_add_u32 s64, s60, s50
  s_addc_u32 s65, s61, 0
  v_mfma_f32_16x16x32_bf16 v[28:31], a[152:155], a[68:71], v[28:31]
  ds_read_b64_tr_b16 a[176:177], v175 offset:32768
  ds_read_b64_tr_b16 a[178:179], v175 offset:36864
  v_mfma_f32_16x16x32_bf16 v[28:31], a[156:159], a[76:79], v[28:31]
  buffer_load_dwordx4 a[52:55], v166, s[12:15], s37 offen offset:1024 sc1
  s_mov_b32 s66, 8192
  v_mfma_f32_16x16x32_bf16 v[84:87], a[152:155], a[80:83], v[84:87]
  ds_read_b64_tr_b16 a[180:181], v175 offset:40960
  ds_read_b64_tr_b16 a[182:183], v175 offset:45056
  s_mov_b32 s67, 0x20000
  v_mfma_f32_16x16x32_bf16 v[84:87], a[156:159], a[88:91], v[84:87]
  s_lshl_b32 s48, s41, 16
  v_mfma_f32_16x16x32_bf16 v[92:95], a[152:155], a[84:87], v[92:95]
  s_lshl_b32 s63, s40, 8
  s_add_u32 s48, s48, s63
  v_mfma_f32_16x16x32_bf16 v[92:95], a[156:159], a[92:95], v[92:95]
  s_waitcnt lgkmcnt(8)
  s_add_u32 s28, s54, s48
  s_addc_u32 s29, s55, 0
  v_mfma_f32_16x16x32_bf16 v[32:35], a[160:163], a[64:67], v[32:35]
  buffer_load_dwordx4 a[56:59], v166, s[12:15], s37 offen offset:2048 sc1
  v_mfma_f32_16x16x32_bf16 v[32:35], a[164:167], a[72:75], v[32:35]
  s_mov_b32 s30, 65536
  v_mfma_f32_16x16x32_bf16 v[40:43], a[160:163], a[68:71], v[40:43]
  ds_read_b64_tr_b16 a[184:185], v175 offset:32776
  ds_read_b64_tr_b16 a[186:187], v175 offset:36872
  s_mov_b32 s31, 0x20000
  v_mfma_f32_16x16x32_bf16 v[40:43], a[164:167], a[76:79], v[40:43]
  ds_read_b64_tr_b16 a[188:189], v175 offset:40968
  ds_read_b64_tr_b16 a[190:191], v175 offset:45064
  v_mfma_f32_16x16x32_bf16 v[96:99], a[160:163], a[80:83], v[96:99]
  buffer_load_dwordx4 a[60:63], v166, s[12:15], s37 offen offset:3072 sc1
  s_sub_u32 s30, s30, s63
  v_mfma_f32_16x16x32_bf16 v[96:99], a[164:167], a[88:91], v[96:99]
  s_add_u32 s37, s37, 4096
  s_lshr_b32 s50, s62, 6
  v_mfma_f32_16x16x32_bf16 v[104:107], a[160:163], a[84:87], v[104:107]
  s_lshl_b32 s50, s50, 13
  s_and_b32 s48, s62, 63
  v_mfma_f32_16x16x32_bf16 v[104:107], a[164:167], a[92:95], v[104:107]
  s_waitcnt lgkmcnt(8)
  s_lshl_b32 s48, s48, 6
  v_mfma_f32_16x16x32_bf16 v[36:39], a[168:171], a[64:67], v[36:39]
  s_add_u32 s50, s50, s48
  s_add_u32 s50, s50, 4096
  v_mfma_f32_16x16x32_bf16 v[36:39], a[172:175], a[72:75], v[36:39]
  s_xor_b32 s48, s62, 8
  v_mfma_f32_16x16x32_bf16 v[44:47], a[168:171], a[68:71], v[44:47]
  s_lshl_b32 s48, s48, 14
  s_lshl_b32 s63, s35, 23
  v_mfma_f32_16x16x32_bf16 v[44:47], a[172:175], a[76:79], v[44:47]
  s_add_u32 s48, s48, s63
  s_add_u32 s48, s48, 67108864
  v_mfma_f32_16x16x32_bf16 v[100:103], a[168:171], a[80:83], v[100:103]
  s_add_u32 s16, s60, s48
  s_addc_u32 s17, s61, 0
  v_mfma_f32_16x16x32_bf16 v[100:103], a[172:175], a[88:91], v[100:103]
  s_mov_b32 s18, 16384
  v_mfma_f32_16x16x32_bf16 v[108:111], a[168:171], a[84:87], v[108:111]
  s_waitcnt vmcnt(26)
  s_barrier
  s_mov_b32 s19, 0x20000
  v_mfma_f32_16x16x32_bf16 v[108:111], a[172:175], a[92:95], v[108:111]
  s_add_u32 m0, s45, 114688
  s_waitcnt lgkmcnt(4)
  v_mfma_f32_16x16x32_bf16 v[48:51], a[176:179], a[64:67], v[48:51]
  buffer_load_dwordx4 v224, s[8:11], s38 offen offset:0 lds
  s_xor_b32 s51, s50, 512
  v_mfma_f32_16x16x32_bf16 v[48:51], a[180:183], a[72:75], v[48:51]
  s_lshl_b32 s48, s35, 2
  v_mfma_f32_16x16x32_bf16 v[56:59], a[176:179], a[68:71], v[56:59]
  ds_read_b64_tr_b16 a[128:129], v172 offset:49152
  ds_read_b64_tr_b16 a[130:131], v172 offset:53248
  s_add_u32 s51, s51, s48
  v_mfma_f32_16x16x32_bf16 v[56:59], a[180:183], a[76:79], v[56:59]
  ds_read_b64_tr_b16 a[132:133], v172 offset:57344
  ds_read_b64_tr_b16 a[134:135], v172 offset:61440
  v_mfma_f32_16x16x32_bf16 v[112:115], a[176:179], a[80:83], v[112:115]
  buffer_load_dwordx4 v225, s[8:11], s38 offen offset:1024 lds
  v_mov_b32 v244, 1
  v_mfma_f32_16x16x32_bf16 v[112:115], a[180:183], a[88:91], v[112:115]
  ds_read_b64_tr_b16 a[136:137], v172 offset:49160
  ds_read_b64_tr_b16 a[138:139], v172 offset:53256
  s_lshl_b32 s62, s41, 9
  v_mfma_f32_16x16x32_bf16 v[120:123], a[176:179], a[84:87], v[120:123]
  s_add_u32 s62, s62, 98304
  v_mfma_f32_16x16x32_bf16 v[120:123], a[180:183], a[92:95], v[120:123]
  ds_read_b64_tr_b16 a[140:141], v172 offset:57352
  s_waitcnt lgkmcnt(7)
  v_and_b32 v185, 0xf0, v166
  v_mfma_f32_16x16x32_bf16 v[52:55], a[184:187], a[64:67], v[52:55]
  buffer_load_dwordx4 v226, s[8:11], s38 offen offset:2048 lds
  v_mfma_f32_16x16x32_bf16 v[52:55], a[188:191], a[72:75], v[52:55]
  ds_read_b64_tr_b16 a[142:143], v172 offset:61448
  ds_read_b64_tr_b16 a[144:145], v173 offset:49152
  buffer_load_dwordx2 v[220:221], v185, s[4:7], s62 offen offset:0 sc1
  v_mfma_f32_16x16x32_bf16 v[60:63], a[184:187], a[68:71], v[60:63]
  buffer_load_dwordx2 v[222:223], v185, s[4:7], s62 offen offset:256 sc1
  v_mfma_f32_16x16x32_bf16 v[60:63], a[188:191], a[76:79], v[60:63]
  ds_read_b64_tr_b16 a[146:147], v173 offset:53248
  v_mfma_f32_16x16x32_bf16 v[116:119], a[184:187], a[80:83], v[116:119]
  buffer_load_dwordx4 v227, s[8:11], s38 offen offset:3072 lds
  v_mfma_f32_16x16x32_bf16 v[116:119], a[188:191], a[88:91], v[116:119]
  s_add_u32 s38, s38, 0x20000
  s_mov_b32 s26, 0
  v_mfma_f32_16x16x32_bf16 v[124:127], a[184:187], a[84:87], v[124:127]
  ds_read_b64_tr_b16 a[148:149], v173 offset:57344
  s_waitcnt vmcnt(28)
  s_mov_b32 s46, 0
  v_mfma_f32_16x16x32_bf16 v[124:127], a[188:191], a[92:95], v[124:127]
  ds_read_b64_tr_b16 a[150:151], v173 offset:61440
  s_waitcnt lgkmcnt(8)
  v_mfma_f32_16x16x32_bf16 v[0:3], a[128:131], a[96:99], v[0:3]
  v_mfma_f32_16x16x32_bf16 v[0:3], a[132:135], a[104:107], v[0:3]
  buffer_load_dwordx4 a[32:35], v166, s[12:15], s36 offen offset:0 sc1
  v_mfma_f32_16x16x32_bf16 v[8:11], a[128:131], a[100:103], v[8:11]
  ds_read_b64_tr_b16 a[152:153], v173 offset:49160
  s_lshl_b32 s48, s33, 13
  v_mfma_f32_16x16x32_bf16 v[8:11], a[132:135], a[108:111], v[8:11]
  ds_read_b64_tr_b16 a[154:155], v173 offset:53256
  v_mfma_f32_16x16x32_bf16 v[64:67], a[128:131], a[112:115], v[64:67]
  v_mfma_f32_16x16x32_bf16 v[64:67], a[132:135], a[120:123], v[64:67]
  buffer_load_dwordx4 a[36:39], v166, s[12:15], s36 offen offset:1024 sc1
  v_mfma_f32_16x16x32_bf16 v[72:75], a[128:131], a[116:119], v[72:75]
  ds_read_b64_tr_b16 a[156:157], v173 offset:57352
  v_mfma_f32_16x16x32_bf16 v[72:75], a[132:135], a[124:127], v[72:75]
  s_waitcnt lgkmcnt(7)
  v_mfma_f32_16x16x32_bf16 v[4:7], a[136:139], a[96:99], v[4:7]
  ds_read_b64_tr_b16 a[158:159], v173 offset:61448
  v_mfma_f32_16x16x32_bf16 v[4:7], a[140:143], a[104:107], v[4:7]
  buffer_load_dwordx4 a[40:43], v166, s[12:15], s36 offen offset:2048 sc1
  s_and_b32 s63, s32, 16
  v_mfma_f32_16x16x32_bf16 v[12:15], a[136:139], a[100:103], v[12:15]
  ds_read_b64_tr_b16 a[160:161], v174 offset:49152
  v_mfma_f32_16x16x32_bf16 v[12:15], a[140:143], a[108:111], v[12:15]
  ds_read_b64_tr_b16 a[162:163], v174 offset:53248
  v_mfma_f32_16x16x32_bf16 v[68:71], a[136:139], a[112:115], v[68:71]
  ds_read_b64_tr_b16 a[164:165], v174 offset:57344
  ds_read_b64_tr_b16 a[166:167], v174 offset:61440
  v_mfma_f32_16x16x32_bf16 v[68:71], a[140:143], a[120:123], v[68:71]
  v_mfma_f32_16x16x32_bf16 v[76:79], a[136:139], a[116:119], v[76:79]
  buffer_load_dwordx4 a[44:47], v166, s[12:15], s36 offen offset:3072 sc1
  v_mfma_f32_16x16x32_bf16 v[76:79], a[140:143], a[124:127], v[76:79]
  s_add_u32 s36, s36, 4096
  s_waitcnt lgkmcnt(8)
  v_mfma_f32_16x16x32_bf16 v[16:19], a[144:147], a[96:99], v[16:19]
  v_mfma_f32_16x16x32_bf16 v[16:19], a[148:151], a[104:107], v[16:19]
  s_add_u32 m0, s45, s56
  ds_read_b64_tr_b16 a[168:169], v174 offset:49160
  v_mfma_f32_16x16x32_bf16 v[24:27], a[144:147], a[100:103], v[24:27]
  buffer_load_dwordx4 v227, s[8:11], s57 offen offset:3072 lds
  s_lshl_b32 s63, s63, 3
  v_mfma_f32_16x16x32_bf16 v[24:27], a[148:151], a[108:111], v[24:27]
  s_add_u32 s57, s57, 0x20000
  ds_read_b64_tr_b16 a[170:171], v174 offset:53256
  v_mfma_f32_16x16x32_bf16 v[80:83], a[144:147], a[112:115], v[80:83]
  ds_read_b64_tr_b16 a[172:173], v174 offset:57352
  ds_read_b64_tr_b16 a[174:175], v174 offset:61448
  v_mfma_f32_16x16x32_bf16 v[80:83], a[148:151], a[120:123], v[80:83]
  v_mfma_f32_16x16x32_bf16 v[88:91], a[144:147], a[116:119], v[88:91]
  v_mfma_f32_16x16x32_bf16 v[88:91], a[148:151], a[124:127], v[88:91]
  s_waitcnt lgkmcnt(8)
  v_mfma_f32_16x16x32_bf16 v[20:23], a[152:155], a[96:99], v[20:23]
  buffer_load_dwordx4 a[80:83], v166, s[12:15], s37 offen offset:0 sc1
  v_mfma_f32_16x16x32_bf16 v[20:23], a[156:159], a[104:107], v[20:23]
  s_add_u32 s48, s48, s63
  v_mfma_f32_16x16x32_bf16 v[28:31], a[152:155], a[100:103], v[28:31]
  ds_read_b64_tr_b16 a[176:177], v175 offset:49152
  ds_read_b64_tr_b16 a[178:179], v175 offset:53248
  v_mfma_f32_16x16x32_bf16 v[28:31], a[156:159], a[108:111], v[28:31]
  buffer_load_dwordx4 a[84:87], v166, s[12:15], s37 offen offset:1024 sc1
  v_mfma_f32_16x16x32_bf16 v[84:87], a[152:155], a[112:115], v[84:87]
  ds_read_b64_tr_b16 a[180:181], v175 offset:57344
  ds_read_b64_tr_b16 a[182:183], v175 offset:61440
  v_mfma_f32_16x16x32_bf16 v[84:87], a[156:159], a[120:123], v[84:87]
  v_mfma_f32_16x16x32_bf16 v[92:95], a[152:155], a[116:119], v[92:95]
  v_mfma_f32_16x16x32_bf16 v[92:95], a[156:159], a[124:127], v[92:95]
  s_waitcnt lgkmcnt(8)
  v_mfma_f32_16x16x32_bf16 v[32:35], a[160:163], a[96:99], v[32:35]
  buffer_load_dwordx4 a[88:91], v166, s[12:15], s37 offen offset:2048 sc1
  v_mfma_f32_16x16x32_bf16 v[32:35], a[164:167], a[104:107], v[32:35]
  s_and_b32 s63, s32, 12
  v_mfma_f32_16x16x32_bf16 v[40:43], a[160:163], a[100:103], v[40:43]
  ds_read_b64_tr_b16 a[184:185], v175 offset:49160
  ds_read_b64_tr_b16 a[186:187], v175 offset:53256
  v_mfma_f32_16x16x32_bf16 v[40:43], a[164:167], a[108:111], v[40:43]
  ds_read_b64_tr_b16 a[188:189], v175 offset:57352
  ds_read_b64_tr_b16 a[190:191], v175 offset:61448
  v_mfma_f32_16x16x32_bf16 v[96:99], a[160:163], a[112:115], v[96:99]
  buffer_load_dwordx4 a[92:95], v166, s[12:15], s37 offen offset:3072 sc1
  v_mfma_f32_16x16x32_bf16 v[96:99], a[164:167], a[120:123], v[96:99]
  s_add_u32 s37, s37, 4096
  v_mfma_f32_16x16x32_bf16 v[104:107], a[160:163], a[116:119], v[104:107]
  v_mfma_f32_16x16x32_bf16 v[104:107], a[164:167], a[124:127], v[104:107]
  s_waitcnt lgkmcnt(8)
  v_mfma_f32_16x16x32_bf16 v[36:39], a[168:171], a[96:99], v[36:39]
  v_mfma_f32_16x16x32_bf16 v[36:39], a[172:175], a[104:107], v[36:39]
  s_add_u32 s48, s48, s63
  v_mfma_f32_16x16x32_bf16 v[44:47], a[168:171], a[100:103], v[44:47]
  v_mfma_f32_16x16x32_bf16 v[44:47], a[172:175], a[108:111], v[44:47]
  v_mfma_f32_16x16x32_bf16 v[100:103], a[168:171], a[112:115], v[100:103]
  v_mfma_f32_16x16x32_bf16 v[100:103], a[172:175], a[120:123], v[100:103]
  v_mfma_f32_16x16x32_bf16 v[108:111], a[168:171], a[116:119], v[108:111]
  s_waitcnt vmcnt(24)
  s_barrier
  s_cmp_lg_u32 s3, 0
  s_cbranch_scc1 L3_wp
  s_mov_b64 exec, 1
  buffer_atomic_add v233, v232, s[4:7], s48 offen offset:128 sc1
  buffer_atomic_add v235, v232, s[72:75], 0 offen offset:32 sc0 sc1
  s_mov_b64 exec, -1
L3_wp:
  v_mfma_f32_16x16x32_bf16 v[108:111], a[172:175], a[124:127], v[108:111]
  s_add_u32 m0, s45, 131072
  s_waitcnt lgkmcnt(4)
  v_mfma_f32_16x16x32_bf16 v[48:51], a[176:179], a[96:99], v[48:51]
  buffer_load_dwordx4 v224, s[8:11], s38 offen offset:0 lds
  v_mfma_f32_16x16x32_bf16 v[48:51], a[180:183], a[104:107], v[48:51]
  v_mfma_f32_16x16x32_bf16 v[56:59], a[176:179], a[100:103], v[56:59]
  ds_read_b64_tr_b16 a[128:129], v172 offset:0
  ds_read_b64_tr_b16 a[130:131], v172 offset:4096
  v_mfma_f32_16x16x32_bf16 v[56:59], a[180:183], a[108:111], v[56:59]
  ds_read_b64_tr_b16 a[132:133], v172 offset:8192
  ds_read_b64_tr_b16 a[134:135], v172 offset:12288
  v_mfma_f32_16x16x32_bf16 v[112:115], a[176:179], a[112:115], v[112:115]
  buffer_load_dwordx4 v225, s[8:11], s38 offen offset:1024 lds
  v_mfma_f32_16x16x32_bf16 v[112:115], a[180:183], a[120:123], v[112:115]
  ds_read_b64_tr_b16 a[136:137], v172 offset:8
  ds_read_b64_tr_b16 a[138:139], v172 offset:4104
  v_mfma_f32_16x16x32_bf16 v[120:123], a[176:179], a[116:119], v[120:123]
  v_mfma_f32_16x16x32_bf16 v[120:123], a[180:183], a[124:127], v[120:123]
  ds_read_b64_tr_b16 a[140:141], v172 offset:8200
  s_waitcnt lgkmcnt(7)
  v_mfma_f32_16x16x32_bf16 v[52:55], a[184:187], a[96:99], v[52:55]
  buffer_load_dwordx4 v226, s[8:11], s38 offen offset:2048 lds
  v_mfma_f32_16x16x32_bf16 v[52:55], a[188:191], a[104:107], v[52:55]
  ds_read_b64_tr_b16 a[142:143], v172 offset:12296
  ds_read_b64_tr_b16 a[144:145], v173 offset:0
  v_mfma_f32_16x16x32_bf16 v[60:63], a[184:187], a[100:103], v[60:63]
  v_mfma_f32_16x16x32_bf16 v[60:63], a[188:191], a[108:111], v[60:63]
  ds_read_b64_tr_b16 a[146:147], v173 offset:4096
  v_mfma_f32_16x16x32_bf16 v[116:119], a[184:187], a[112:115], v[116:119]
  buffer_load_dwordx4 v227, s[8:11], s38 offen offset:3072 lds
  v_mfma_f32_16x16x32_bf16 v[116:119], a[188:191], a[120:123], v[116:119]
  s_add_u32 s38, s38, 0x20000
  v_mfma_f32_16x16x32_bf16 v[124:127], a[184:187], a[116:119], v[124:127]
  ds_read_b64_tr_b16 a[148:149], v173 offset:8192
  s_waitcnt vmcnt(24)
  v_mfma_f32_16x16x32_bf16 v[124:127], a[188:191], a[124:127], v[124:127]
  ds_read_b64_tr_b16 a[150:151], v173 offset:12288
  s_waitcnt lgkmcnt(8)
  s_sub_u32 s58, s58, 1
  s_branch L3_loop
L3_oh:
  v_accvgpr_read_b32 v0, a64
  v_accvgpr_read_b32 v1, a65
  v_accvgpr_read_b32 v2, a66
  v_accvgpr_read_b32 v3, a67
  v_accvgpr_read_b32 v4, a80
  v_accvgpr_read_b32 v5, a81
  v_accvgpr_read_b32 v6, a82
  v_accvgpr_read_b32 v7, a83
  v_pk_mul_f32 v[0:1], v[0:1], v[228:229]
  v_pk_mul_f32 v[2:3], v[2:3], v[228:229]
  v_pk_mul_f32 v[4:5], v[4:5], v[228:229]
  v_pk_mul_f32 v[6:7], v[6:7], v[228:229]
  v_cvt_pk_bf16_f32 v188, v0, v1
  v_cvt_pk_bf16_f32 v189, v2, v3
  v_cvt_pk_bf16_f32 v190, v4, v5
  v_cvt_pk_bf16_f32 v191, v6, v7
  buffer_store_dwordx4 v[188:191], v166, s[28:31], s66 offen offset:0 sc1
  v_accvgpr_read_b32 v8, a68
  v_accvgpr_read_b32 v9, a69
  v_accvgpr_read_b32 v10, a70
  v_accvgpr_read_b32 v11, a71
  v_accvgpr_read_b32 v12, a84
  v_accvgpr_read_b32 v13, a85
  v_accvgpr_read_b32 v14, a86
  v_accvgpr_read_b32 v15, a87
  v_pk_mul_f32 v[8:9], v[8:9], v[230:231]
  v_pk_mul_f32 v[10:11], v[10:11], v[230:231]
  v_pk_mul_f32 v[12:13], v[12:13], v[230:231]
  v_pk_mul_f32 v[14:15], v[14:15], v[230:231]
  v_cvt_pk_bf16_f32 v192, v8, v9
  v_cvt_pk_bf16_f32 v193, v10, v11
  v_cvt_pk_bf16_f32 v194, v12, v13
  v_cvt_pk_bf16_f32 v195, v14, v15
  buffer_store_dwordx4 v[192:195], v166, s[28:31], s66 offen offset:1024 sc1
  v_accvgpr_read_b32 v16, a72
  v_accvgpr_read_b32 v17, a73
  v_accvgpr_read_b32 v18, a74
  v_accvgpr_read_b32 v19, a75
  v_accvgpr_read_b32 v20, a88
  v_accvgpr_read_b32 v21, a89
  v_accvgpr_read_b32 v22, a90
  v_accvgpr_read_b32 v23, a91
  v_pk_mul_f32 v[16:17], v[16:17], v[240:241]
  v_pk_mul_f32 v[18:19], v[18:19], v[240:241]
  v_pk_mul_f32 v[20:21], v[20:21], v[240:241]
  v_pk_mul_f32 v[22:23], v[22:23], v[240:241]
  v_cvt_pk_bf16_f32 v204, v16, v17
  v_cvt_pk_bf16_f32 v205, v18, v19
  v_cvt_pk_bf16_f32 v206, v20, v21
  v_cvt_pk_bf16_f32 v207, v22, v23
  buffer_store_dwordx4 v[204:207], v166, s[28:31], s67 offen offset:0 sc1
  v_accvgpr_read_b32 v24, a76
  v_accvgpr_read_b32 v25, a77
  v_accvgpr_read_b32 v26, a78
  v_accvgpr_read_b32 v27, a79
  v_accvgpr_read_b32 v28, a92
  v_accvgpr_read_b32 v29, a93
  v_accvgpr_read_b32 v30, a94
  v_accvgpr_read_b32 v31, a95
  v_pk_mul_f32 v[24:25], v[24:25], v[242:243]
  v_pk_mul_f32 v[26:27], v[26:27], v[242:243]
  v_pk_mul_f32 v[28:29], v[28:29], v[242:243]
  v_pk_mul_f32 v[30:31], v[30:31], v[242:243]
  v_cvt_pk_bf16_f32 v208, v24, v25
  v_cvt_pk_bf16_f32 v209, v26, v27
  v_cvt_pk_bf16_f32 v210, v28, v29
  v_cvt_pk_bf16_f32 v211, v30, v31
  buffer_store_dwordx4 v[208:211], v166, s[28:31], s67 offen offset:1024 sc1
  v_accvgpr_read_b32 v0, a96
  v_accvgpr_read_b32 v1, a97
  v_accvgpr_read_b32 v2, a98
  v_accvgpr_read_b32 v3, a99
  v_accvgpr_read_b32 v4, a112
  v_accvgpr_read_b32 v5, a113
  v_accvgpr_read_b32 v6, a114
  v_accvgpr_read_b32 v7, a115
  v_pk_mul_f32 v[0:1], v[0:1], v[228:229]
  v_pk_mul_f32 v[2:3], v[2:3], v[228:229]
  v_pk_mul_f32 v[4:5], v[4:5], v[228:229]
  v_pk_mul_f32 v[6:7], v[6:7], v[228:229]
  v_cvt_pk_bf16_f32 v196, v0, v1
  v_cvt_pk_bf16_f32 v197, v2, v3
  v_cvt_pk_bf16_f32 v198, v4, v5
  v_cvt_pk_bf16_f32 v199, v6, v7
  buffer_store_dwordx4 v[196:199], v166, s[28:31], s66 offen offset:2048 sc1
  v_accvgpr_read_b32 v8, a100
  v_accvgpr_read_b32 v9, a101
  v_accvgpr_read_b32 v10, a102
  v_accvgpr_read_b32 v11, a103
  v_accvgpr_read_b32 v12, a116
  v_accvgpr_read_b32 v13, a117
  v_accvgpr_read_b32 v14, a118
  v_accvgpr_read_b32 v15, a119
  v_pk_mul_f32 v[8:9], v[8:9], v[230:231]
  v_pk_mul_f32 v[10:11], v[10:11], v[230:231]
  v_pk_mul_f32 v[12:13], v[12:13], v[230:231]
  v_pk_mul_f32 v[14:15], v[14:15], v[230:231]
  v_cvt_pk_bf16_f32 v200, v8, v9
  v_cvt_pk_bf16_f32 v201, v10, v11
  v_cvt_pk_bf16_f32 v202, v12, v13
  v_cvt_pk_bf16_f32 v203, v14, v15
  buffer_store_dwordx4 v[200:203], v166, s[28:31], s66 offen offset:3072 sc1
  v_accvgpr_read_b32 v16, a104
  v_accvgpr_read_b32 v17, a105
  v_accvgpr_read_b32 v18, a106
  v_accvgpr_read_b32 v19, a107
  v_accvgpr_read_b32 v20, a120
  v_accvgpr_read_b32 v21, a121
  v_accvgpr_read_b32 v22, a122
  v_accvgpr_read_b32 v23, a123
  v_pk_mul_f32 v[16:17], v[16:17], v[240:241]
  v_pk_mul_f32 v[18:19], v[18:19], v[240:241]
  v_pk_mul_f32 v[20:21], v[20:21], v[240:241]
  v_pk_mul_f32 v[22:23], v[22:23], v[240:241]
  v_cvt_pk_bf16_f32 v212, v16, v17
  v_cvt_pk_bf16_f32 v213, v18, v19
  v_cvt_pk_bf16_f32 v214, v20, v21
  v_cvt_pk_bf16_f32 v215, v22, v23
  buffer_store_dwordx4 v[212:215], v166, s[28:31], s67 offen offset:2048 sc1
  v_accvgpr_read_b32 v24, a108
  v_accvgpr_read_b32 v25, a109
  v_accvgpr_read_b32 v26, a110
  v_accvgpr_read_b32 v27, a111
  v_accvgpr_read_b32 v28, a124
  v_accvgpr_read_b32 v29, a125
  v_accvgpr_read_b32 v30, a126
  v_accvgpr_read_b32 v31, a127
  v_pk_mul_f32 v[24:25], v[24:25], v[242:243]
  v_pk_mul_f32 v[26:27], v[26:27], v[242:243]
  v_pk_mul_f32 v[28:29], v[28:29], v[242:243]
  v_pk_mul_f32 v[30:31], v[30:31], v[242:243]
  v_cvt_pk_bf16_f32 v216, v24, v25
  v_cvt_pk_bf16_f32 v217, v26, v27
  v_cvt_pk_bf16_f32 v218, v28, v29
  v_cvt_pk_bf16_f32 v219, v30, v31
  buffer_store_dwordx4 v[216:219], v166, s[28:31], s67 offen offset:3072 sc1
  v_mfma_f32_16x16x32_bf16 a[0:3], a[192:195], v[64:67], a[0:3]
  ds_read_b64_tr_b16 a[220:221], v155 offset:8192
  ds_read_b64_tr_b16 a[222:223], v155 offset:12288
  v_readlane_b32 s101, v238, 7
  v_mfma_f32_16x16x32_bf16 a[4:7], a[192:195], v[80:83], a[4:7]
  s_and_b32 s48, s46, 3
  v_mfma_f32_16x16x32_bf16 a[8:11], a[192:195], v[96:99], a[8:11]
  v_mfma_f32_16x16x32_bf16 a[12:15], a[192:195], v[112:115], a[12:15]
  s_lshl_b32 s48, s48, 15
  v_mfma_f32_16x16x32_bf16 a[16:19], a[196:199], v[64:67], a[16:19]
  v_mfma_f32_16x16x32_bf16 a[20:23], a[196:199], v[80:83], a[20:23]
  s_add_u32 s36, s36, s48
  v_mfma_f32_16x16x32_bf16 a[24:27], a[196:199], v[96:99], a[24:27]
  v_mfma_f32_16x16x32_bf16 a[28:31], a[196:199], v[112:115], a[28:31]
  s_add_u32 s37, s37, s48
  v_mfma_f32_16x16x32_bf16 a[32:35], a[200:203], v[64:67], a[32:35]
  v_and_b32 v172, 0x3c0, v166
  v_mfma_f32_16x16x32_bf16 a[36:39], a[200:203], v[80:83], a[36:39]
  v_mfma_f32_16x16x32_bf16 a[40:43], a[200:203], v[96:99], a[40:43]
  v_and_b32 v173, 0xf0, v166
  v_mfma_f32_16x16x32_bf16 a[44:47], a[200:203], v[112:115], a[44:47]
  v_mfma_f32_16x16x32_bf16 a[48:51], a[204:207], v[64:67], a[48:51]
  v_lshl_add_u32 v172, v172, 2, v173
  v_mfma_f32_16x16x32_bf16 a[52:55], a[204:207], v[80:83], a[52:55]
  v_mfma_f32_16x16x32_bf16 a[56:59], a[204:207], v[96:99], a[56:59]
  v_add_u32 v176, 32768, v172
  v_mfma_f32_16x16x32_bf16 a[60:63], a[204:207], v[112:115], a[60:63]
  v_mfma_f32_16x16x32_bf16 a[0:3], a[208:211], v[68:71], a[0:3]
  v_add_u32 v172, 98304, v172
  v_mfma_f32_16x16x32_bf16 a[4:7], a[208:211], v[84:87], a[4:7]
  v_xor_b32 v173, 64, v172
  v_mfma_f32_16x16x32_bf16 a[8:11], a[208:211], v[100:103], a[8:11]
  v_mfma_f32_16x16x32_bf16 a[12:15], a[208:211], v[116:119], a[12:15]
  v_xor_b32 v174, 128, v172
  s_waitcnt lgkmcnt(4)
  v_mfma_f32_16x16x32_bf16 a[16:19], a[212:215], v[68:71], a[16:19]
  v_mfma_f32_16x16x32_bf16 a[20:23], a[212:215], v[84:87], a[20:23]
  v_xor_b32 v175, 192, v172
  v_mfma_f32_16x16x32_bf16 a[24:27], a[212:215], v[100:103], a[24:27]
  v_mfma_f32_16x16x32_bf16 a[28:31], a[212:215], v[116:119], a[28:31]
  v_xor_b32 v177, 64, v176
  s_waitcnt lgkmcnt(2)
  v_mfma_f32_16x16x32_bf16 a[32:35], a[216:219], v[68:71], a[32:35]
  v_xor_b32 v178, 128, v176
  v_mfma_f32_16x16x32_bf16 a[36:39], a[216:219], v[84:87], a[36:39]
  v_mfma_f32_16x16x32_bf16 a[40:43], a[216:219], v[100:103], a[40:43]
  v_xor_b32 v179, 192, v176
  v_mfma_f32_16x16x32_bf16 a[44:47], a[216:219], v[116:119], a[44:47]
  s_waitcnt lgkmcnt(0)
  v_mfma_f32_16x16x32_bf16 a[48:51], a[220:223], v[68:71], a[48:51]
  v_lshrrev_b32 v164, 2, v166
  v_mfma_f32_16x16x32_bf16 a[52:55], a[220:223], v[84:87], a[52:55]
  v_mfma_f32_16x16x32_bf16 a[56:59], a[220:223], v[100:103], a[56:59]
  ds_write_b32 v232, v232 offset:96
  v_mfma_f32_16x16x32_bf16 a[60:63], a[220:223], v[116:119], a[60:63]
  v_accvgpr_read_b32 v0, a0
  v_accvgpr_read_b32 v1, a1
  v_accvgpr_read_b32 v2, a2
  v_accvgpr_read_b32 v3, a3
  v_accvgpr_read_b32 v4, a16
  v_accvgpr_read_b32 v5, a17
  v_accvgpr_read_b32 v6, a18
  v_accvgpr_read_b32 v7, a19
  v_pk_mul_f32 v[0:1], v[0:1], v[228:229]
  v_pk_mul_f32 v[2:3], v[2:3], v[228:229]
  v_pk_mul_f32 v[4:5], v[4:5], v[228:229]
  v_pk_mul_f32 v[6:7], v[6:7], v[228:229]
  v_cvt_pk_bf16_f32 v128, v0, v1
  v_cvt_pk_bf16_f32 v129, v2, v3
  v_cvt_pk_bf16_f32 v130, v4, v5
  v_cvt_pk_bf16_f32 v131, v6, v7
  buffer_store_dwordx4 v[128:131], v166, s[28:31], s50 offen offset:0 sc1
  v_accvgpr_read_b32 v8, a4
  v_accvgpr_read_b32 v9, a5
  v_accvgpr_read_b32 v10, a6
  v_accvgpr_read_b32 v11, a7
  v_accvgpr_read_b32 v12, a20
  v_accvgpr_read_b32 v13, a21
  v_accvgpr_read_b32 v14, a22
  v_accvgpr_read_b32 v15, a23
  v_pk_mul_f32 v[8:9], v[8:9], v[230:231]
  v_pk_mul_f32 v[10:11], v[10:11], v[230:231]
  v_pk_mul_f32 v[12:13], v[12:13], v[230:231]
  v_pk_mul_f32 v[14:15], v[14:15], v[230:231]
  v_cvt_pk_bf16_f32 v132, v8, v9
  v_cvt_pk_bf16_f32 v133, v10, v11
  v_cvt_pk_bf16_f32 v134, v12, v13
  v_cvt_pk_bf16_f32 v135, v14, v15
  buffer_store_dwordx4 v[132:135], v166, s[28:31], s50 offen offset:1024 sc1
  v_accvgpr_read_b32 v16, a8
  v_accvgpr_read_b32 v17, a9
  v_accvgpr_read_b32 v18, a10
  v_accvgpr_read_b32 v19, a11
  v_accvgpr_read_b32 v20, a24
  v_accvgpr_read_b32 v21, a25
  v_accvgpr_read_b32 v22, a26
  v_accvgpr_read_b32 v23, a27
  v_pk_mul_f32 v[16:17], v[16:17], v[240:241]
  v_pk_mul_f32 v[18:19], v[18:19], v[240:241]
  v_pk_mul_f32 v[20:21], v[20:21], v[240:241]
  v_pk_mul_f32 v[22:23], v[22:23], v[240:241]
  v_cvt_pk_bf16_f32 v144, v16, v17
  v_cvt_pk_bf16_f32 v145, v18, v19
  v_cvt_pk_bf16_f32 v146, v20, v21
  v_cvt_pk_bf16_f32 v147, v22, v23
  buffer_store_dwordx4 v[144:147], v166, s[28:31], s51 offen offset:0 sc1
  v_accvgpr_read_b32 v24, a12
  v_accvgpr_read_b32 v25, a13
  v_accvgpr_read_b32 v26, a14
  v_accvgpr_read_b32 v27, a15
  v_accvgpr_read_b32 v28, a28
  v_accvgpr_read_b32 v29, a29
  v_accvgpr_read_b32 v30, a30
  v_accvgpr_read_b32 v31, a31
  v_pk_mul_f32 v[24:25], v[24:25], v[242:243]
  v_pk_mul_f32 v[26:27], v[26:27], v[242:243]
  v_pk_mul_f32 v[28:29], v[28:29], v[242:243]
  v_pk_mul_f32 v[30:31], v[30:31], v[242:243]
  v_cvt_pk_bf16_f32 v148, v24, v25
  v_cvt_pk_bf16_f32 v149, v26, v27
  v_cvt_pk_bf16_f32 v150, v28, v29
  v_cvt_pk_bf16_f32 v151, v30, v31
  buffer_store_dwordx4 v[148:151], v166, s[28:31], s51 offen offset:1024 sc1
  v_accvgpr_read_b32 v0, a32
  v_accvgpr_read_b32 v1, a33
  v_accvgpr_read_b32 v2, a34
  v_accvgpr_read_b32 v3, a35
  v_accvgpr_read_b32 v4, a48
  v_accvgpr_read_b32 v5, a49
  v_accvgpr_read_b32 v6, a50
  v_accvgpr_read_b32 v7, a51
  v_pk_mul_f32 v[0:1], v[0:1], v[228:229]
  v_pk_mul_f32 v[2:3], v[2:3], v[228:229]
  v_pk_mul_f32 v[4:5], v[4:5], v[228:229]
  v_pk_mul_f32 v[6:7], v[6:7], v[228:229]
  v_cvt_pk_bf16_f32 v136, v0, v1
  v_cvt_pk_bf16_f32 v137, v2, v3
  v_cvt_pk_bf16_f32 v138, v4, v5
  v_cvt_pk_bf16_f32 v139, v6, v7
  buffer_store_dwordx4 v[136:139], v166, s[28:31], s50 offen offset:2048 sc1
  v_accvgpr_read_b32 v8, a36
  v_accvgpr_read_b32 v9, a37
  v_accvgpr_read_b32 v10, a38
  v_accvgpr_read_b32 v11, a39
  v_accvgpr_read_b32 v12, a52
  v_accvgpr_read_b32 v13, a53
  v_accvgpr_read_b32 v14, a54
  v_accvgpr_read_b32 v15, a55
  v_pk_mul_f32 v[8:9], v[8:9], v[230:231]
  v_pk_mul_f32 v[10:11], v[10:11], v[230:231]
  v_pk_mul_f32 v[12:13], v[12:13], v[230:231]
  v_pk_mul_f32 v[14:15], v[14:15], v[230:231]
  v_cvt_pk_bf16_f32 v140, v8, v9
  v_cvt_pk_bf16_f32 v141, v10, v11
  v_cvt_pk_bf16_f32 v142, v12, v13
  v_cvt_pk_bf16_f32 v143, v14, v15
  buffer_store_dwordx4 v[140:143], v166, s[28:31], s50 offen offset:3072 sc1
  v_accvgpr_read_b32 v16, a40
  v_accvgpr_read_b32 v17, a41
  v_accvgpr_read_b32 v18, a42
  v_accvgpr_read_b32 v19, a43
  v_accvgpr_read_b32 v20, a56
  v_accvgpr_read_b32 v21, a57
  v_accvgpr_read_b32 v22, a58
  v_accvgpr_read_b32 v23, a59
  v_pk_mul_f32 v[16:17], v[16:17], v[240:241]
  v_pk_mul_f32 v[18:19], v[18:19], v[240:241]
  v_pk_mul_f32 v[20:21], v[20:21], v[240:241]
  v_pk_mul_f32 v[22:23], v[22:23], v[240:241]
  v_cvt_pk_bf16_f32 v160, v16, v17
  v_cvt_pk_bf16_f32 v161, v18, v19
  v_cvt_pk_bf16_f32 v162, v20, v21
  v_cvt_pk_bf16_f32 v163, v22, v23
  buffer_store_dwordx4 v[160:163], v166, s[28:31], s51 offen offset:2048 sc1
  v_accvgpr_read_b32 v24, a44
  v_accvgpr_read_b32 v25, a45
  v_accvgpr_read_b32 v26, a46
  v_accvgpr_read_b32 v27, a47
  v_accvgpr_read_b32 v28, a60
  v_accvgpr_read_b32 v29, a61
  v_accvgpr_read_b32 v30, a62
  v_accvgpr_read_b32 v31, a63
  v_pk_mul_f32 v[24:25], v[24:25], v[242:243]
  v_pk_mul_f32 v[26:27], v[26:27], v[242:243]
  v_pk_mul_f32 v[28:29], v[28:29], v[242:243]
  v_pk_mul_f32 v[30:31], v[30:31], v[242:243]
  v_cvt_pk_bf16_f32 v168, v24, v25
  v_cvt_pk_bf16_f32 v169, v26, v27
  v_cvt_pk_bf16_f32 v170, v28, v29
  v_cvt_pk_bf16_f32 v171, v30, v31
  buffer_store_dwordx4 v[168:171], v166, s[28:31], s51 offen offset:3072 sc1
  s_add_u32 m0, s45, 98304
  s_nop 0
  buffer_load_dwordx4 v224, s[8:11], s38 offen offset:0 lds
  buffer_load_dwordx4 v225, s[8:11], s38 offen offset:1024 lds
  buffer_load_dwordx4 v226, s[8:11], s38 offen offset:2048 lds
  buffer_load_dwordx4 v227, s[8:11], s38 offen offset:3072 lds
  s_xor_b32 s38, s38, 0x20000
  s_add_u32 m0, s45, 114688
  s_nop 0
  buffer_load_dwordx4 v224, s[8:11], s38 offen offset:0 lds
  buffer_load_dwordx4 v225, s[8:11], s38 offen offset:1024 lds
  buffer_load_dwordx4 v226, s[8:11], s38 offen offset:2048 lds
  buffer_load_dwordx4 v227, s[8:11], s38 offen offset:3072 lds
  s_and_b32 s38, s46, 3
  s_lshl_b32 s38, s38, 20
  s_lshl_b32 s48, s33, 13
  s_and_b32 s63, s32, 16
  s_lshl_b32 s63, s63, 3
  s_add_u32 s48, s48, s63
  s_and_b32 s63, s32, 12
  s_add_u32 s48, s48, s63
  s_waitcnt vmcnt(8)
  s_barrier
  s_cmp_lg_u32 s3, 0
  s_cbranch_scc1 L3_op
  s_mov_b64 exec, 1
  buffer_atomic_add v233, v232, s[4:7], s48 offen offset:128 sc1
  buffer_atomic_add v235, v232, s[72:75], 0 offen offset:32 sc0 sc1
  s_mov_b64 exec, -1
  s_waitcnt vmcnt(2)
  s_branch L3_op2
L3_op:
  s_waitcnt vmcnt(0)
L3_op2:
  s_mov_b32 s100, 0
  s_waitcnt lgkmcnt(0)
  s_barrier
  ds_read_b64_tr_b16 a[128:129], v172 offset:0
  ds_read_b64_tr_b16 a[130:131], v172 offset:4096
  ds_read_b64_tr_b16 a[132:133], v172 offset:8192
  ds_read_b64_tr_b16 a[134:135], v172 offset:12288
  ds_read_b64_tr_b16 a[136:137], v172 offset:8
  ds_read_b64_tr_b16 a[138:139], v172 offset:4104
  ds_read_b64_tr_b16 a[140:141], v172 offset:8200
  ds_read_b64_tr_b16 a[142:143], v172 offset:12296
  ds_read_b64_tr_b16 a[144:145], v173 offset:0
  ds_read_b64_tr_b16 a[146:147], v173 offset:4096
  ds_read_b64_tr_b16 a[148:149], v173 offset:8192
  ds_read_b64_tr_b16 a[150:151], v173 offset:12288
  s_waitcnt lgkmcnt(8)
  v_mfma_f32_16x16x32_bf16 v[0:3], a[128:131], v[188:191], 0
  s_and_b32 s47, s32, 15
  s_xor_b32 s47, s47, 1
  s_and_b32 s48, s46, 3
  v_mfma_f32_16x16x32_bf16 v[0:3], a[132:135], v[196:199], v[0:3]
  s_lshl_b32 s48, s48, 2
  s_sub_u32 s39, s47, s48
  v_mfma_f32_16x16x32_bf16 v[8:11], a[128:131], v[192:195], 0
  ds_read_b64_tr_b16 a[152:153], v173 offset:8
  s_sub_u32 s39, s39, 4
  s_and_b32 s39, s39, 63
  v_mfma_f32_16x16x32_bf16 v[8:11], a[132:135], v[200:203], v[8:11]
  ds_read_b64_tr_b16 a[154:155], v173 offset:4104
  s_xor_b32 s49, s47, 3
  s_and_b32 s49, s49, 14
  v_mfma_f32_16x16x32_bf16 v[64:67], a[128:131], v[204:207], 0
  s_add_u32 m0, s45, 131072
  s_sub_u32 s48, s49, s47
  s_sub_u32 s48, s48, 1
  v_mfma_f32_16x16x32_bf16 v[64:67], a[132:135], v[212:215], v[64:67]
  buffer_load_dwordx4 v224, s[8:11], s38 offen offset:0 lds
  s_and_b32 s48, s48, 63
  v_mfma_f32_16x16x32_bf16 v[72:75], a[128:131], v[208:211], 0
  ds_read_b64_tr_b16 a[156:157], v173 offset:8200
  buffer_load_dwordx4 v225, s[8:11], s38 offen offset:1024 lds
  s_lshl_b32 s48, s48, 6
  v_mfma_f32_16x16x32_bf16 v[72:75], a[132:135], v[216:219], v[72:75]
  s_waitcnt lgkmcnt(7)
  buffer_load_dwordx4 v226, s[8:11], s38 offen offset:2048 lds
  s_or_b32 s39, s39, s48
  v_mfma_f32_16x16x32_bf16 v[4:7], a[136:139], v[188:191], 0
  ds_read_b64_tr_b16 a[158:159], v173 offset:12296
  buffer_load_dwordx4 v227, s[8:11], s38 offen offset:3072 lds
  v_mfma_f32_16x16x32_bf16 v[4:7], a[140:143], v[196:199], v[4:7]
  s_add_u32 s38, s38, 0x20000
  s_bfe_u32 s47, s46, 0x20008
  s_lshl_b32 s47, s47, 2
  v_mfma_f32_16x16x32_bf16 v[12:15], a[136:139], v[192:195], 0
  ds_read_b64_tr_b16 a[160:161], v174 offset:0
  s_add_u32 m0, s45, 147456
  s_sub_u32 s48, s47, s49
  v_mfma_f32_16x16x32_bf16 v[12:15], a[140:143], v[200:203], v[12:15]
  ds_read_b64_tr_b16 a[162:163], v174 offset:4096
  buffer_load_dwordx4 v224, s[8:11], s38 offen offset:0 lds
  s_sub_u32 s48, s48, 2
  v_mfma_f32_16x16x32_bf16 v[68:71], a[136:139], v[204:207], 0
  ds_read_b64_tr_b16 a[164:165], v174 offset:8192
  ds_read_b64_tr_b16 a[166:167], v174 offset:12288
  s_and_b32 s48, s48, 63
  v_mfma_f32_16x16x32_bf16 v[68:71], a[140:143], v[212:215], v[68:71]
  buffer_load_dwordx4 v225, s[8:11], s38 offen offset:1024 lds
  s_lshl_b32 s48, s48, 12
  v_mfma_f32_16x16x32_bf16 v[76:79], a[136:139], v[208:211], 0
  buffer_load_dwordx4 v226, s[8:11], s38 offen offset:2048 lds
  s_or_b32 s39, s39, s48
  s_bfe_u32 s57, s46, 0x2000c
  v_mfma_f32_16x16x32_bf16 v[76:79], a[140:143], v[216:219], v[76:79]
  s_waitcnt lgkmcnt(8)
  buffer_load_dwordx4 v227, s[8:11], s38 offen offset:3072 lds
  v_mfma_f32_16x16x32_bf16 v[16:19], a[144:147], v[188:191], 0
  s_add_u32 s38, s38, 0x20000
  s_lshl_b32 s57, s57, 2
  s_sub_u32 s48, s57, s47
  v_mfma_f32_16x16x32_bf16 v[16:19], a[148:151], v[196:199], v[16:19]
  ds_read_b64_tr_b16 a[168:169], v174 offset:8
  s_sub_u32 s48, s48, 4
  s_lshl_b32 s48, s48, 24
  v_mfma_f32_16x16x32_bf16 v[24:27], a[144:147], v[192:195], 0
  s_or_b32 s39, s39, s48
  s_lshl_b32 s57, s57, 18
  s_add_u32 s57, s57, 0x80000
  v_mfma_f32_16x16x32_bf16 v[24:27], a[148:151], v[200:203], v[24:27]
  ds_read_b64_tr_b16 a[170:171], v174 offset:4104
  s_mov_b32 s95, 0x2a
  v_mfma_f32_16x16x32_bf16 v[80:83], a[144:147], v[204:207], 0
  ds_read_b64_tr_b16 a[172:173], v174 offset:8200
  ds_read_b64_tr_b16 a[174:175], v174 offset:12296
  s_mov_b32 s59, 2
  s_mov_b32 s58, 5
  v_mfma_f32_16x16x32_bf16 v[80:83], a[148:151], v[212:215], v[80:83]
  v_bfe_u32 v183, v166, 4, 4
  v_lshrrev_b32 v182, 8, v166
  v_mfma_f32_16x16x32_bf16 v[88:91], a[144:147], v[208:211], 0
  v_lshlrev_b32 v180, 11, v183
  s_mov_b32 s46, 32768
  v_lshl_add_u32 v180, v182, 4, v180
  v_mfma_f32_16x16x32_bf16 v[88:91], a[148:151], v[216:219], v[88:91]
  s_waitcnt lgkmcnt(8)
  s_lshl_b32 s48, s41, 16
  s_lshl_b32 s63, s40, 8
  v_mfma_f32_16x16x32_bf16 v[20:23], a[152:155], v[188:191], 0
  s_add_u32 s48, s48, s63
  s_lshl_b32 s27, s45, 3
  v_mfma_f32_16x16x32_bf16 v[20:23], a[156:159], v[196:199], v[20:23]
  s_sub_u32 s48, s48, s27
  s_sub_u32 s63, s63, s27
  s_add_u32 s24, s52, s48
  s_addc_u32 s25, s53, 0
  v_mfma_f32_16x16x32_bf16 v[28:31], a[152:155], v[192:195], 0
  ds_read_b64_tr_b16 a[176:177], v175 offset:0
  ds_read_b64_tr_b16 a[178:179], v175 offset:4096
  v_mfma_f32_16x16x32_bf16 v[28:31], a[156:159], v[200:203], v[28:31]
  s_mov_b32 s26, 65536
  s_mov_b32 s27, 0x20000
  v_mfma_f32_16x16x32_bf16 v[84:87], a[152:155], v[204:207], 0
  ds_read_b64_tr_b16 a[180:181], v175 offset:8192
  ds_read_b64_tr_b16 a[182:183], v175 offset:12288
  s_sub_u32 s26, s26, s63
  v_mfma_f32_16x16x32_bf16 v[84:87], a[156:159], v[212:215], v[84:87]
  v_mfma_f32_16x16x32_bf16 v[92:95], a[152:155], v[208:211], 0
  v_mfma_f32_16x16x32_bf16 v[92:95], a[156:159], v[216:219], v[92:95]
  s_waitcnt lgkmcnt(8)
  v_mfma_f32_16x16x32_bf16 v[32:35], a[160:163], v[188:191], 0
  v_mfma_f32_16x16x32_bf16 v[32:35], a[164:167], v[196:199], v[32:35]
  v_mfma_f32_16x16x32_bf16 v[40:43], a[160:163], v[192:195], 0
  ds_read_b64_tr_b16 a[184:185], v175 offset:8
  ds_read_b64_tr_b16 a[186:187], v175 offset:4104
  v_mfma_f32_16x16x32_bf16 v[40:43], a[164:167], v[200:203], v[40:43]
  ds_read_b64_tr_b16 a[188:189], v175 offset:8200
  ds_read_b64_tr_b16 a[190:191], v175 offset:12296
  v_mfma_f32_16x16x32_bf16 v[96:99], a[160:163], v[204:207], 0
  v_mfma_f32_16x16x32_bf16 v[96:99], a[164:167], v[212:215], v[96:99]
  v_mfma_f32_16x16x32_bf16 v[104:107], a[160:163], v[208:211], 0
  v_mfma_f32_16x16x32_bf16 v[104:107], a[164:167], v[216:219], v[104:107]
  s_waitcnt lgkmcnt(8)
  v_mfma_f32_16x16x32_bf16 v[36:39], a[168:171], v[188:191], 0
  buffer_load_dword v246, v232, s[4:7], s101 offen sc0 sc1
  v_mfma_f32_16x16x32_bf16 v[36:39], a[172:175], v[196:199], v[36:39]
  v_mfma_f32_16x16x32_bf16 v[44:47], a[168:171], v[192:195], 0
  v_mfma_f32_16x16x32_bf16 v[44:47], a[172:175], v[200:203], v[44:47]
  v_mfma_f32_16x16x32_bf16 v[100:103], a[168:171], v[204:207], 0
  v_mfma_f32_16x16x32_bf16 v[100:103], a[172:175], v[212:215], v[100:103]
  v_mfma_f32_16x16x32_bf16 v[108:111], a[168:171], v[208:211], 0
  v_mfma_f32_16x16x32_bf16 v[108:111], a[172:175], v[216:219], v[108:111]
  s_waitcnt lgkmcnt(4)
  v_mfma_f32_16x16x32_bf16 v[48:51], a[176:179], v[188:191], 0
  v_mfma_f32_16x16x32_bf16 v[48:51], a[180:183], v[196:199], v[48:51]
  v_mfma_f32_16x16x32_bf16 v[56:59], a[176:179], v[192:195], 0
  ds_read_b64_tr_b16 a[128:129], v172 offset:16384
  ds_read_b64_tr_b16 a[130:131], v172 offset:20480
  v_mfma_f32_16x16x32_bf16 v[56:59], a[180:183], v[200:203], v[56:59]
  ds_read_b64_tr_b16 a[132:133], v172 offset:24576
  ds_read_b64_tr_b16 a[134:135], v172 offset:28672
  v_mfma_f32_16x16x32_bf16 v[112:115], a[176:179], v[204:207], 0
  v_mfma_f32_16x16x32_bf16 v[112:115], a[180:183], v[212:215], v[112:115]
  ds_read_b64_tr_b16 a[136:137], v172 offset:16392
  ds_read_b64_tr_b16 a[138:139], v172 offset:20488
  v_mfma_f32_16x16x32_bf16 v[120:123], a[176:179], v[208:211], 0
  v_mfma_f32_16x16x32_bf16 v[120:123], a[180:183], v[216:219], v[120:123]
  ds_read_b64_tr_b16 a[140:141], v172 offset:24584
  s_waitcnt lgkmcnt(7)
  v_mfma_f32_16x16x32_bf16 v[52:55], a[184:187], v[188:191], 0
  v_mfma_f32_16x16x32_bf16 v[52:55], a[188:191], v[196:199], v[52:55]
  ds_read_b64_tr_b16 a[142:143], v172 offset:28680
  ds_read_b64_tr_b16 a[144:145], v173 offset:16384
  v_mfma_f32_16x16x32_bf16 v[60:63], a[184:187], v[192:195], 0
  v_mfma_f32_16x16x32_bf16 v[60:63], a[188:191], v[200:203], v[60:63]
  ds_read_b64_tr_b16 a[146:147], v173 offset:20480
  v_mfma_f32_16x16x32_bf16 v[116:119], a[184:187], v[204:207], 0
  v_mfma_f32_16x16x32_bf16 v[116:119], a[188:191], v[212:215], v[116:119]
  v_mfma_f32_16x16x32_bf16 v[124:127], a[184:187], v[208:211], 0
  ds_read_b64_tr_b16 a[148:149], v173 offset:24576
  v_mfma_f32_16x16x32_bf16 v[124:127], a[188:191], v[216:219], v[124:127]
  ds_read_b64_tr_b16 a[150:151], v173 offset:28672
  s_waitcnt lgkmcnt(8)
  buffer_load_dword v247, v232, s[4:7], s101 offen sc0 sc1
  s_waitcnt vmcnt(1)
  s_mov_b32 s49, 1024
  v_cmp_gt_u32 vcc, 4, v246
  buffer_load_dword v246, v232, s[4:7], s101 offen sc0 sc1
  s_cbranch_vccz L3_go
  s_branch L3_gw1
L3_gw:
  s_waitcnt vmcnt(1)
  v_cmp_gt_u32 vcc, 4, v246
  buffer_load_dword v246, v232, s[4:7], s101 offen sc0 sc1
  s_cbranch_vccz L3_go
L3_gw1:
  s_waitcnt vmcnt(1)
  v_cmp_gt_u32 vcc, 4, v247
  buffer_load_dword v247, v232, s[4:7], s101 offen sc0 sc1
  s_cbranch_vccz L3_go
  s_sub_u32 s49, s49, 1
  s_cbranch_scc0 L3_gw
  ds_write_b32 v232, v233 offset:96
  s_waitcnt lgkmcnt(0)
L3_go:
  buffer_load_dwordx4 a[64:67], v166, s[12:15], s36 offen offset:0 sc1
  buffer_load_dwordx4 a[68:71], v166, s[12:15], s36 offen offset:1024 sc1
  buffer_load_dwordx4 a[72:75], v166, s[12:15], s36 offen offset:2048 sc1
  buffer_load_dwordx4 a[76:79], v166, s[12:15], s36 offen offset:3072 sc1
  s_add_u32 s36, s36, 4096
  buffer_load_dwordx4 a[80:83], v166, s[12:15], s37 offen offset:0 sc1
  buffer_load_dwordx4 a[84:87], v166, s[12:15], s37 offen offset:1024 sc1
  buffer_load_dwordx4 a[88:91], v166, s[12:15], s37 offen offset:2048 sc1
  buffer_load_dwordx4 a[92:95], v166, s[12:15], s37 offen offset:3072 sc1
  s_add_u32 s37, s37, 4096
  buffer_load_dwordx4 a[112:115], v166, s[12:15], s37 offen offset:0 sc1
  buffer_load_dwordx4 a[116:119], v166, s[12:15], s37 offen offset:1024 sc1
  buffer_load_dwordx4 a[120:123], v166, s[12:15], s37 offen offset:2048 sc1
  buffer_load_dwordx4 a[124:127], v166, s[12:15], s37 offen offset:3072 sc1
  s_add_u32 s37, s37, 4096
  v_mfma_f32_16x16x32_bf16 v[0:3], a[128:131], v[128:131], v[0:3]
  v_mfma_f32_16x16x32_bf16 v[0:3], a[132:135], v[136:139], v[0:3]
  buffer_load_dwordx4 a[96:99], v166, s[12:15], s36 offen offset:0 sc1
  v_mfma_f32_16x16x32_bf16 v[8:11], a[128:131], v[132:135], v[8:11]
  ds_read_b64_tr_b16 a[152:153], v173 offset:16392
  v_mfma_f32_16x16x32_bf16 v[8:11], a[132:135], v[140:143], v[8:11]
  ds_read_b64_tr_b16 a[154:155], v173 offset:20488
  v_mfma_f32_16x16x32_bf16 v[64:67], a[128:131], v[144:147], v[64:67]
  v_mfma_f32_16x16x32_bf16 v[64:67], a[132:135], v[160:163], v[64:67]
  buffer_load_dwordx4 a[100:103], v166, s[12:15], s36 offen offset:1024 sc1
  v_mfma_f32_16x16x32_bf16 v[72:75], a[128:131], v[148:151], v[72:75]
  ds_read_b64_tr_b16 a[156:157], v173 offset:24584
  v_mfma_f32_16x16x32_bf16 v[72:75], a[132:135], v[168:171], v[72:75]
  s_waitcnt lgkmcnt(7)
  v_mfma_f32_16x16x32_bf16 v[4:7], a[136:139], v[128:131], v[4:7]
  ds_read_b64_tr_b16 a[158:159], v173 offset:28680
  v_mfma_f32_16x16x32_bf16 v[4:7], a[140:143], v[136:139], v[4:7]
  buffer_load_dwordx4 a[104:107], v166, s[12:15], s36 offen offset:2048 sc1
  v_mfma_f32_16x16x32_bf16 v[12:15], a[136:139], v[132:135], v[12:15]
  ds_read_b64_tr_b16 a[160:161], v174 offset:16384
  v_mfma_f32_16x16x32_bf16 v[12:15], a[140:143], v[140:143], v[12:15]
  ds_read_b64_tr_b16 a[162:163], v174 offset:20480
  v_mfma_f32_16x16x32_bf16 v[68:71], a[136:139], v[144:147], v[68:71]
  ds_read_b64_tr_b16 a[164:165], v174 offset:24576
  ds_read_b64_tr_b16 a[166:167], v174 offset:28672
  v_mfma_f32_16x16x32_bf16 v[68:71], a[140:143], v[160:163], v[68:71]
  v_mfma_f32_16x16x32_bf16 v[76:79], a[136:139], v[148:151], v[76:79]
  buffer_load_dwordx4 a[108:111], v166, s[12:15], s36 offen offset:3072 sc1
  v_mfma_f32_16x16x32_bf16 v[76:79], a[140:143], v[168:171], v[76:79]
  s_add_u32 s36, s36, 4096
  s_waitcnt lgkmcnt(8)
  v_mfma_f32_16x16x32_bf16 v[16:19], a[144:147], v[128:131], v[16:19]
  v_mfma_f32_16x16x32_bf16 v[16:19], a[148:151], v[136:139], v[16:19]
  ds_read_b64_tr_b16 a[168:169], v174 offset:16392
  v_mfma_f32_16x16x32_bf16 v[24:27], a[144:147], v[132:135], v[24:27]
  v_mfma_f32_16x16x32_bf16 v[24:27], a[148:151], v[140:143], v[24:27]
  ds_read_b64_tr_b16 a[170:171], v174 offset:20488
  v_mfma_f32_16x16x32_bf16 v[80:83], a[144:147], v[144:147], v[80:83]
  ds_read_b64_tr_b16 a[172:173], v174 offset:24584
  ds_read_b64_tr_b16 a[174:175], v174 offset:28680
  v_mfma_f32_16x16x32_bf16 v[80:83], a[148:151], v[160:163], v[80:83]
  v_mfma_f32_16x16x32_bf16 v[88:91], a[144:147], v[148:151], v[88:91]
  v_mfma_f32_16x16x32_bf16 v[88:91], a[148:151], v[168:171], v[88:91]
  s_waitcnt lgkmcnt(8)
  v_mfma_f32_16x16x32_bf16 v[20:23], a[152:155], v[128:131], v[20:23]
  buffer_load_dwordx4 a[16:19], v166, s[12:15], s37 offen offset:0 sc1
  v_mfma_f32_16x16x32_bf16 v[20:23], a[156:159], v[136:139], v[20:23]
  v_mfma_f32_16x16x32_bf16 v[28:31], a[152:155], v[132:135], v[28:31]
  ds_read_b64_tr_b16 a[176:177], v175 offset:16384
  ds_read_b64_tr_b16 a[178:179], v175 offset:20480
  v_mfma_f32_16x16x32_bf16 v[28:31], a[156:159], v[140:143], v[28:31]
  buffer_load_dwordx4 a[20:23], v166, s[12:15], s37 offen offset:1024 sc1
  v_mfma_f32_16x16x32_bf16 v[84:87], a[152:155], v[144:147], v[84:87]
  ds_read_b64_tr_b16 a[180:181], v175 offset:24576
  ds_read_b64_tr_b16 a[182:183], v175 offset:28672
  v_mfma_f32_16x16x32_bf16 v[84:87], a[156:159], v[160:163], v[84:87]
  v_mfma_f32_16x16x32_bf16 v[92:95], a[152:155], v[148:151], v[92:95]
  v_mfma_f32_16x16x32_bf16 v[92:95], a[156:159], v[168:171], v[92:95]
  s_waitcnt lgkmcnt(8)
  v_mfma_f32_16x16x32_bf16 v[32:35], a[160:163], v[128:131], v[32:35]
  buffer_load_dwordx4 a[24:27], v166, s[12:15], s37 offen offset:2048 sc1
  v_mfma_f32_16x16x32_bf16 v[32:35], a[164:167], v[136:139], v[32:35]
  v_mfma_f32_16x16x32_bf16 v[40:43], a[160:163], v[132:135], v[40:43]
  ds_read_b64_tr_b16 a[184:185], v175 offset:16392
  ds_read_b64_tr_b16 a[186:187], v175 offset:20488
  v_mfma_f32_16x16x32_bf16 v[40:43], a[164:167], v[140:143], v[40:43]
  ds_read_b64_tr_b16 a[188:189], v175 offset:24584
  ds_read_b64_tr_b16 a[190:191], v175 offset:28680
  v_mfma_f32_16x16x32_bf16 v[96:99], a[160:163], v[144:147], v[96:99]
  buffer_load_dwordx4 a[28:31], v166, s[12:15], s37 offen offset:3072 sc1
  v_mov_b32 v181, 0
  v_mfma_f32_16x16x32_bf16 v[96:99], a[164:167], v[160:163], v[96:99]
  s_add_u32 s37, s37, 4096
  v_mfma_f32_16x16x32_bf16 v[104:107], a[160:163], v[148:151], v[104:107]
  s_mov_b32 s42, 4096
  v_mfma_f32_16x16x32_bf16 v[104:107], a[164:167], v[168:171], v[104:107]
  s_waitcnt lgkmcnt(8)
  v_mfma_f32_16x16x32_bf16 v[36:39], a[168:171], v[128:131], v[36:39]
  s_mov_b32 s43, 8192
  v_mfma_f32_16x16x32_bf16 v[36:39], a[172:175], v[136:139], v[36:39]
  s_mov_b32 s44, 12288
  v_mfma_f32_16x16x32_bf16 v[44:47], a[168:171], v[132:135], v[44:47]
  v_mfma_f32_16x16x32_bf16 v[44:47], a[172:175], v[140:143], v[44:47]
  s_lshl_b32 s62, s41, 3
  v_mfma_f32_16x16x32_bf16 v[100:103], a[168:171], v[144:147], v[100:103]
  s_add_u32 s62, s62, s40
  v_mfma_f32_16x16x32_bf16 v[100:103], a[172:175], v[160:163], v[100:103]
  v_mfma_f32_16x16x32_bf16 v[108:111], a[168:171], v[148:151], v[108:111]
  s_barrier
  v_mfma_f32_16x16x32_bf16 v[108:111], a[172:175], v[168:171], v[108:111]
  s_add_u32 m0, s45, 98304
  s_waitcnt lgkmcnt(4)
  s_lshl_b32 s48, s62, 14
  v_mfma_f32_16x16x32_bf16 v[48:51], a[176:179], v[128:131], v[48:51]
  buffer_load_dwordx4 v224, s[8:11], s38 offen offset:0 lds
  v_mfma_f32_16x16x32_bf16 v[48:51], a[180:183], v[136:139], v[48:51]
  v_mfma_f32_16x16x32_bf16 v[56:59], a[176:179], v[132:135], v[56:59]
  ds_read_b64_tr_b16 a[128:129], v172 offset:32768
  ds_read_b64_tr_b16 a[130:131], v172 offset:36864
  s_lshl_b32 s63, s35, 23
  v_mfma_f32_16x16x32_bf16 v[56:59], a[180:183], v[140:143], v[56:59]
  ds_read_b64_tr_b16 a[132:133], v172 offset:40960
  ds_read_b64_tr_b16 a[134:135], v172 offset:45056
  v_mfma_f32_16x16x32_bf16 v[112:115], a[176:179], v[144:147], v[112:115]
  buffer_load_dwordx4 v225, s[8:11], s38 offen offset:1024 lds
  v_mfma_f32_16x16x32_bf16 v[112:115], a[180:183], v[160:163], v[112:115]
  ds_read_b64_tr_b16 a[136:137], v172 offset:32776
  ds_read_b64_tr_b16 a[138:139], v172 offset:36872
  v_mfma_f32_16x16x32_bf16 v[120:123], a[176:179], v[148:151], v[120:123]
  s_add_u32 s48, s48, s63
  v_mfma_f32_16x16x32_bf16 v[120:123], a[180:183], v[168:171], v[120:123]
  ds_read_b64_tr_b16 a[140:141], v172 offset:40968
  s_waitcnt lgkmcnt(7)
  v_mfma_f32_16x16x32_bf16 v[52:55], a[184:187], v[128:131], v[52:55]
  buffer_load_dwordx4 v226, s[8:11], s38 offen offset:2048 lds
  v_mfma_f32_16x16x32_bf16 v[52:55], a[188:191], v[136:139], v[52:55]
  ds_read_b64_tr_b16 a[142:143], v172 offset:45064
  ds_read_b64_tr_b16 a[144:145], v173 offset:32768
  s_add_u32 s48, s48, 67108864
  v_mfma_f32_16x16x32_bf16 v[60:63], a[184:187], v[132:135], v[60:63]
  v_mfma_f32_16x16x32_bf16 v[60:63], a[188:191], v[140:143], v[60:63]
  ds_read_b64_tr_b16 a[146:147], v173 offset:36864
  s_add_u32 s20, s60, s48
  s_addc_u32 s21, s61, 0
  v_mfma_f32_16x16x32_bf16 v[116:119], a[184:187], v[144:147], v[116:119]
  buffer_load_dwordx4 v227, s[8:11], s38 offen offset:3072 lds
  v_mfma_f32_16x16x32_bf16 v[116:119], a[188:191], v[160:163], v[116:119]
  s_add_u32 s38, s38, 0x20000
  v_mfma_f32_16x16x32_bf16 v[124:127], a[184:187], v[148:151], v[124:127]
  ds_read_b64_tr_b16 a[148:149], v173 offset:40960
  v_mfma_f32_16x16x32_bf16 v[124:127], a[188:191], v[168:171], v[124:127]
  ds_read_b64_tr_b16 a[150:151], v173 offset:45056
  s_waitcnt lgkmcnt(8)
  s_waitcnt vmcnt(12)
  v_mfma_f32_16x16x32_bf16 v[0:3], a[128:131], a[64:67], v[0:3]
  v_mfma_f32_16x16x32_bf16 v[0:3], a[132:135], a[72:75], v[0:3]
  buffer_load_dwordx4 a[0:3], v166, s[12:15], s36 offen offset:0 sc1
  v_mfma_f32_16x16x32_bf16 v[8:11], a[128:131], a[68:71], v[8:11]
  ds_read_b64_tr_b16 a[152:153], v173 offset:32776
  s_mov_b32 s22, 16384
  v_mfma_f32_16x16x32_bf16 v[8:11], a[132:135], a[76:79], v[8:11]
  ds_read_b64_tr_b16 a[154:155], v173 offset:36872
  v_mfma_f32_16x16x32_bf16 v[64:67], a[128:131], a[80:83], v[64:67]
  s_mov_b32 s23, 0x20000
  v_mfma_f32_16x16x32_bf16 v[64:67], a[132:135], a[88:91], v[64:67]
  buffer_load_dwordx4 a[4:7], v166, s[12:15], s36 offen offset:1024 sc1
  v_mfma_f32_16x16x32_bf16 v[72:75], a[128:131], a[84:87], v[72:75]
  ds_read_b64_tr_b16 a[156:157], v173 offset:40968
  s_lshl_b32 s48, s62, 13
  v_mfma_f32_16x16x32_bf16 v[72:75], a[132:135], a[92:95], v[72:75]
  s_waitcnt lgkmcnt(7)
  v_mfma_f32_16x16x32_bf16 v[4:7], a[136:139], a[64:67], v[4:7]
  ds_read_b64_tr_b16 a[158:159], v173 offset:45064
  s_cmp_eq_u32 s35, 0
  s_mov_b32 s63, 41943040
  s_mov_b32 s50, 37748736
  s_cselect_b32 s63, s63, 37748736
  s_cselect_b32 s50, s50, 41943040
  v_mfma_f32_16x16x32_bf16 v[4:7], a[140:143], a[72:75], v[4:7]
  buffer_load_dwordx4 a[8:11], v166, s[12:15], s36 offen offset:2048 sc1
  v_mfma_f32_16x16x32_bf16 v[12:15], a[136:139], a[68:71], v[12:15]
  ds_read_b64_tr_b16 a[160:161], v174 offset:32768
  v_mfma_f32_16x16x32_bf16 v[12:15], a[140:143], a[76:79], v[12:15]
  ds_read_b64_tr_b16 a[162:163], v174 offset:36864
  v_mfma_f32_16x16x32_bf16 v[68:71], a[136:139], a[80:83], v[68:71]
  ds_read_b64_tr_b16 a[164:165], v174 offset:40960
  ds_read_b64_tr_b16 a[166:167], v174 offset:45056
  v_mfma_f32_16x16x32_bf16 v[68:71], a[140:143], a[88:91], v[68:71]
  v_mfma_f32_16x16x32_bf16 v[76:79], a[136:139], a[84:87], v[76:79]
  buffer_load_dwordx4 a[12:15], v166, s[12:15], s36 offen offset:3072 sc1
  v_mfma_f32_16x16x32_bf16 v[76:79], a[140:143], a[92:95], v[76:79]
  s_add_u32 s36, s36, 4096
  s_waitcnt lgkmcnt(8)
  v_mfma_f32_16x16x32_bf16 v[16:19], a[144:147], a[64:67], v[16:19]
  s_lshl1_add_u32 m0, s45, 65536
  v_mfma_f32_16x16x32_bf16 v[16:19], a[148:151], a[72:75], v[16:19]
  ds_read_b64_tr_b16 a[168:169], v174 offset:32776
  buffer_load_dwordx4 v224, s[24:27], 0 offen offset:0 lds
  v_mfma_f32_16x16x32_bf16 v[24:27], a[144:147], a[68:71], v[24:27]
  v_mfma_f32_16x16x32_bf16 v[24:27], a[148:151], a[76:79], v[24:27]
  ds_read_b64_tr_b16 a[170:171], v174 offset:36872
  v_mfma_f32_16x16x32_bf16 v[80:83], a[144:147], a[80:83], v[80:83]
  ds_read_b64_tr_b16 a[172:173], v174 offset:40968
  ds_read_b64_tr_b16 a[174:175], v174 offset:45064
  v_mfma_f32_16x16x32_bf16 v[80:83], a[148:151], a[88:91], v[80:83]
  s_lshl1_add_u32 m0, s45, 65536
  v_mfma_f32_16x16x32_bf16 v[88:91], a[144:147], a[84:87], v[88:91]
  buffer_load_dwordx4 v225, s[24:27], 0 offen offset:1024 lds
  v_mfma_f32_16x16x32_bf16 v[88:91], a[148:151], a[92:95], v[88:91]
  s_waitcnt lgkmcnt(8)
  s_add_u32 s63, s63, s48
  v_mfma_f32_16x16x32_bf16 v[20:23], a[152:155], a[64:67], v[20:23]
  buffer_load_dwordx4 a[48:51], v166, s[12:15], s37 offen offset:0 sc1
  v_mfma_f32_16x16x32_bf16 v[20:23], a[156:159], a[72:75], v[20:23]
  s_add_u32 s50, s50, s48
  v_mfma_f32_16x16x32_bf16 v[28:31], a[152:155], a[68:71], v[28:31]
  ds_read_b64_tr_b16 a[176:177], v175 offset:32768
  ds_read_b64_tr_b16 a[178:179], v175 offset:36864
  v_mfma_f32_16x16x32_bf16 v[28:31], a[156:159], a[76:79], v[28:31]
  buffer_load_dwordx4 a[52:55], v166, s[12:15], s37 offen offset:1024 sc1
  v_mfma_f32_16x16x32_bf16 v[84:87], a[152:155], a[80:83], v[84:87]
  ds_read_b64_tr_b16 a[180:181], v175 offset:40960
  ds_read_b64_tr_b16 a[182:183], v175 offset:45056
  v_mfma_f32_16x16x32_bf16 v[84:87], a[156:159], a[88:91], v[84:87]
  s_add_u32 s68, s60, s63
  s_addc_u32 s69, s61, 0
  v_mfma_f32_16x16x32_bf16 v[92:95], a[152:155], a[84:87], v[92:95]
  v_mfma_f32_16x16x32_bf16 v[92:95], a[156:159], a[92:95], v[92:95]
  s_waitcnt lgkmcnt(8)
  v_mfma_f32_16x16x32_bf16 v[32:35], a[160:163], a[64:67], v[32:35]
  buffer_load_dwordx4 a[56:59], v166, s[12:15], s37 offen offset:2048 sc1
  v_mfma_f32_16x16x32_bf16 v[32:35], a[164:167], a[72:75], v[32:35]
  s_mov_b32 s70, 8192
  v_mfma_f32_16x16x32_bf16 v[40:43], a[160:163], a[68:71], v[40:43]
  ds_read_b64_tr_b16 a[184:185], v175 offset:32776
  ds_read_b64_tr_b16 a[186:187], v175 offset:36872
  v_mfma_f32_16x16x32_bf16 v[40:43], a[164:167], a[76:79], v[40:43]
  ds_read_b64_tr_b16 a[188:189], v175 offset:40968
  ds_read_b64_tr_b16 a[190:191], v175 offset:45064
  v_mfma_f32_16x16x32_bf16 v[96:99], a[160:163], a[80:83], v[96:99]
  buffer_load_dwordx4 a[60:63], v166, s[12:15], s37 offen offset:3072 sc1
  s_mov_b32 s71, 0x20000
  v_mfma_f32_16x16x32_bf16 v[96:99], a[164:167], a[88:91], v[96:99]
  s_add_u32 s37, s37, 4096
  v_mfma_f32_16x16x32_bf16 v[104:107], a[160:163], a[84:87], v[104:107]
  s_lshl1_add_u32 m0, s45, 65536
  v_mfma_f32_16x16x32_bf16 v[104:107], a[164:167], a[92:95], v[104:107]
  s_waitcnt lgkmcnt(8)
  buffer_load_dwordx4 v226, s[24:27], 0 offen offset:2048 lds
  v_mfma_f32_16x16x32_bf16 v[36:39], a[168:171], a[64:67], v[36:39]
  s_add_u32 s64, s60, s50
  s_addc_u32 s65, s61, 0
  v_mfma_f32_16x16x32_bf16 v[36:39], a[172:175], a[72:75], v[36:39]
  v_mfma_f32_16x16x32_bf16 v[44:47], a[168:171], a[68:71], v[44:47]
  v_mfma_f32_16x16x32_bf16 v[44:47], a[172:175], a[76:79], v[44:47]
  s_mov_b32 s66, 8192
  v_mfma_f32_16x16x32_bf16 v[100:103], a[168:171], a[80:83], v[100:103]
  s_mov_b32 s67, 0x20000
  v_mfma_f32_16x16x32_bf16 v[100:103], a[172:175], a[88:91], v[100:103]
  v_mfma_f32_16x16x32_bf16 v[108:111], a[168:171], a[84:87], v[108:111]
  s_barrier
  s_lshl_b32 s48, s41, 16
  v_mfma_f32_16x16x32_bf16 v[108:111], a[172:175], a[92:95], v[108:111]
  s_add_u32 m0, s45, 114688
  s_waitcnt lgkmcnt(4)
  v_mfma_f32_16x16x32_bf16 v[48:51], a[176:179], a[64:67], v[48:51]
  buffer_load_dwordx4 v224, s[8:11], s38 offen offset:0 lds
  v_mfma_f32_16x16x32_bf16 v[48:51], a[180:183], a[72:75], v[48:51]
  s_lshl_b32 s63, s40, 8
  v_mfma_f32_16x16x32_bf16 v[56:59], a[176:179], a[68:71], v[56:59]
  ds_read_b64_tr_b16 a[128:129], v172 offset:49152
  ds_read_b64_tr_b16 a[130:131], v172 offset:53248
  v_mfma_f32_16x16x32_bf16 v[56:59], a[180:183], a[76:79], v[56:59]
  ds_read_b64_tr_b16 a[132:133], v172 offset:57344
  ds_read_b64_tr_b16 a[134:135], v172 offset:61440
  v_mfma_f32_16x16x32_bf16 v[112:115], a[176:179], a[80:83], v[112:115]
  buffer_load_dwordx4 v225, s[8:11], s38 offen offset:1024 lds
  v_mfma_f32_16x16x32_bf16 v[112:115], a[180:183], a[88:91], v[112:115]
  ds_read_b64_tr_b16 a[136:137], v172 offset:49160
  ds_read_b64_tr_b16 a[138:139], v172 offset:53256
  v_mfma_f32_16x16x32_bf16 v[120:123], a[176:179], a[84:87], v[120:123]
  s_add_u32 s48, s48, s63
  v_mfma_f32_16x16x32_bf16 v[120:123], a[180:183], a[92:95], v[120:123]
  ds_read_b64_tr_b16 a[140:141], v172 offset:57352
  s_waitcnt lgkmcnt(7)
  v_mfma_f32_16x16x32_bf16 v[52:55], a[184:187], a[64:67], v[52:55]
  buffer_load_dwordx4 v226, s[8:11], s38 offen offset:2048 lds
  s_add_u32 s28, s54, s48
  s_addc_u32 s29, s55, 0
  v_mfma_f32_16x16x32_bf16 v[52:55], a[188:191], a[72:75], v[52:55]
  ds_read_b64_tr_b16 a[142:143], v172 offset:61448
  ds_read_b64_tr_b16 a[144:145], v173 offset:49152
  v_mfma_f32_16x16x32_bf16 v[60:63], a[184:187], a[68:71], v[60:63]
  v_mfma_f32_16x16x32_bf16 v[60:63], a[188:191], a[76:79], v[60:63]
  ds_read_b64_tr_b16 a[146:147], v173 offset:53248
  v_mfma_f32_16x16x32_bf16 v[116:119], a[184:187], a[80:83], v[116:119]
  buffer_load_dwordx4 v227, s[8:11], s38 offen offset:3072 lds
  v_mfma_f32_16x16x32_bf16 v[116:119], a[188:191], a[88:91], v[116:119]
  s_add_u32 s38, s38, 0x20000
  s_mov_b32 s30, 65536
  v_mfma_f32_16x16x32_bf16 v[124:127], a[184:187], a[84:87], v[124:127]
  ds_read_b64_tr_b16 a[148:149], v173 offset:57344
  s_waitcnt vmcnt(23)
  v_mfma_f32_16x16x32_bf16 v[124:127], a[188:191], a[92:95], v[124:127]
  ds_read_b64_tr_b16 a[150:151], v173 offset:61440
  s_waitcnt lgkmcnt(8)
  v_mfma_f32_16x16x32_bf16 v[0:3], a[128:131], a[96:99], v[0:3]
  s_mov_b32 s31, 0x20000
  v_mfma_f32_16x16x32_bf16 v[0:3], a[132:135], a[104:107], v[0:3]
  buffer_load_dwordx4 a[32:35], v166, s[12:15], s36 offen offset:0 sc1
  v_mfma_f32_16x16x32_bf16 v[8:11], a[128:131], a[100:103], v[8:11]
  ds_read_b64_tr_b16 a[152:153], v173 offset:49160
  v_mfma_f32_16x16x32_bf16 v[8:11], a[132:135], a[108:111], v[8:11]
  ds_read_b64_tr_b16 a[154:155], v173 offset:53256
  s_sub_u32 s30, s30, s63
  v_mfma_f32_16x16x32_bf16 v[64:67], a[128:131], a[112:115], v[64:67]
  v_mfma_f32_16x16x32_bf16 v[64:67], a[132:135], a[120:123], v[64:67]
  buffer_load_dwordx4 a[36:39], v166, s[12:15], s36 offen offset:1024 sc1
  s_lshr_b32 s50, s62, 6
  v_mfma_f32_16x16x32_bf16 v[72:75], a[128:131], a[116:119], v[72:75]
  ds_read_b64_tr_b16 a[156:157], v173 offset:57352
  v_mfma_f32_16x16x32_bf16 v[72:75], a[132:135], a[124:127], v[72:75]
  s_waitcnt lgkmcnt(7)
  v_mfma_f32_16x16x32_bf16 v[4:7], a[136:139], a[96:99], v[4:7]
  ds_read_b64_tr_b16 a[158:159], v173 offset:61448
  s_lshl_b32 s50, s50, 13
  v_mfma_f32_16x16x32_bf16 v[4:7], a[140:143], a[104:107], v[4:7]
  buffer_load_dwordx4 a[40:43], v166, s[12:15], s36 offen offset:2048 sc1
  v_mfma_f32_16x16x32_bf16 v[12:15], a[136:139], a[100:103], v[12:15]
  ds_read_b64_tr_b16 a[160:161], v174 offset:49152
  s_and_b32 s48, s62, 63
  v_mfma_f32_16x16x32_bf16 v[12:15], a[140:143], a[108:111], v[12:15]
  ds_read_b64_tr_b16 a[162:163], v174 offset:53248
  v_mfma_f32_16x16x32_bf16 v[68:71], a[136:139], a[112:115], v[68:71]
  ds_read_b64_tr_b16 a[164:165], v174 offset:57344
  ds_read_b64_tr_b16 a[166:167], v174 offset:61440
  v_mfma_f32_16x16x32_bf16 v[68:71], a[140:143], a[120:123], v[68:71]
  s_lshl_b32 s48, s48, 6
  v_mfma_f32_16x16x32_bf16 v[76:79], a[136:139], a[116:119], v[76:79]
  buffer_load_dwordx4 a[44:47], v166, s[12:15], s36 offen offset:3072 sc1
  v_mfma_f32_16x16x32_bf16 v[76:79], a[140:143], a[124:127], v[76:79]
  s_add_u32 s36, s36, 4096
  s_waitcnt lgkmcnt(8)
  v_mfma_f32_16x16x32_bf16 v[16:19], a[144:147], a[96:99], v[16:19]
  s_lshl1_add_u32 m0, s45, 65536
  s_add_u32 s50, s50, s48
  v_mfma_f32_16x16x32_bf16 v[16:19], a[148:151], a[104:107], v[16:19]
  ds_read_b64_tr_b16 a[168:169], v174 offset:49160
  buffer_load_dwordx4 v227, s[24:27], 0 offen offset:3072 lds
  v_mfma_f32_16x16x32_bf16 v[24:27], a[144:147], a[100:103], v[24:27]
  v_mfma_f32_16x16x32_bf16 v[24:27], a[148:151], a[108:111], v[24:27]
  ds_read_b64_tr_b16 a[170:171], v174 offset:53256
  s_add_u32 s50, s50, 4096
  v_mfma_f32_16x16x32_bf16 v[80:83], a[144:147], a[112:115], v[80:83]
  ds_read_b64_tr_b16 a[172:173], v174 offset:57352
  ds_read_b64_tr_b16 a[174:175], v174 offset:61448
  v_mfma_f32_16x16x32_bf16 v[80:83], a[148:151], a[120:123], v[80:83]
  s_lshl1_add_u32 m0, s45, 69632
  v_mfma_f32_16x16x32_bf16 v[88:91], a[144:147], a[116:119], v[88:91]
  buffer_load_dwordx4 v224, s[24:27], s46 offen offset:0 lds
  s_xor_b32 s48, s62, 8
  v_mfma_f32_16x16x32_bf16 v[88:91], a[148:151], a[124:127], v[88:91]
  s_waitcnt lgkmcnt(8)
  v_mfma_f32_16x16x32_bf16 v[20:23], a[152:155], a[96:99], v[20:23]
  buffer_load_dwordx4 a[80:83], v166, s[12:15], s37 offen offset:0 sc1
  v_mfma_f32_16x16x32_bf16 v[20:23], a[156:159], a[104:107], v[20:23]
  s_lshl_b32 s48, s48, 14
  v_mfma_f32_16x16x32_bf16 v[28:31], a[152:155], a[100:103], v[28:31]
  ds_read_b64_tr_b16 a[176:177], v175 offset:49152
  ds_read_b64_tr_b16 a[178:179], v175 offset:53248
  v_mfma_f32_16x16x32_bf16 v[28:31], a[156:159], a[108:111], v[28:31]
  buffer_load_dwordx4 a[84:87], v166, s[12:15], s37 offen offset:1024 sc1
  v_mfma_f32_16x16x32_bf16 v[84:87], a[152:155], a[112:115], v[84:87]
  ds_read_b64_tr_b16 a[180:181], v175 offset:57344
  ds_read_b64_tr_b16 a[182:183], v175 offset:61440
  s_lshl_b32 s63, s35, 23
  v_mfma_f32_16x16x32_bf16 v[84:87], a[156:159], a[120:123], v[84:87]
  s_lshl1_add_u32 m0, s45, 69632
  v_mfma_f32_16x16x32_bf16 v[92:95], a[152:155], a[116:119], v[92:95]
  buffer_load_dwordx4 v225, s[24:27], s46 offen offset:1024 lds
  v_mfma_f32_16x16x32_bf16 v[92:95], a[156:159], a[124:127], v[92:95]
  s_waitcnt lgkmcnt(8)
  s_add_u32 s48, s48, s63
  v_mfma_f32_16x16x32_bf16 v[32:35], a[160:163], a[96:99], v[32:35]
  buffer_load_dwordx4 a[88:91], v166, s[12:15], s37 offen offset:2048 sc1
  v_mfma_f32_16x16x32_bf16 v[32:35], a[164:167], a[104:107], v[32:35]
  s_add_u32 s48, s48, 67108864
  v_mfma_f32_16x16x32_bf16 v[40:43], a[160:163], a[100:103], v[40:43]
  ds_read_b64_tr_b16 a[184:185], v175 offset:49160
  ds_read_b64_tr_b16 a[186:187], v175 offset:53256
  v_mfma_f32_16x16x32_bf16 v[40:43], a[164:167], a[108:111], v[40:43]
  ds_read_b64_tr_b16 a[188:189], v175 offset:57352
  ds_read_b64_tr_b16 a[190:191], v175 offset:61448
  v_mfma_f32_16x16x32_bf16 v[96:99], a[160:163], a[112:115], v[96:99]
  buffer_load_dwordx4 a[92:95], v166, s[12:15], s37 offen offset:3072 sc1
  v_mfma_f32_16x16x32_bf16 v[96:99], a[164:167], a[120:123], v[96:99]
  s_add_u32 s37, s37, 4096
  s_add_u32 s16, s60, s48
  s_addc_u32 s17, s61, 0
  v_mfma_f32_16x16x32_bf16 v[104:107], a[160:163], a[116:119], v[104:107]
  s_lshl1_add_u32 m0, s45, 69632
  v_mfma_f32_16x16x32_bf16 v[104:107], a[164:167], a[124:127], v[104:107]
  s_waitcnt lgkmcnt(8)
  buffer_load_dwordx4 v226, s[24:27], s46 offen offset:2048 lds
  v_mfma_f32_16x16x32_bf16 v[36:39], a[168:171], a[96:99], v[36:39]
  v_mfma_f32_16x16x32_bf16 v[36:39], a[172:175], a[104:107], v[36:39]
  v_mfma_f32_16x16x32_bf16 v[44:47], a[168:171], a[100:103], v[44:47]
  s_mov_b32 s18, 16384
  v_mfma_f32_16x16x32_bf16 v[44:47], a[172:175], a[108:111], v[44:47]
  s_mov_b32 s19, 0x20000
  v_mfma_f32_16x16x32_bf16 v[100:103], a[168:171], a[112:115], v[100:103]
  v_mfma_f32_16x16x32_bf16 v[100:103], a[172:175], a[120:123], v[100:103]
  s_xor_b32 s51, s50, 512
  v_mfma_f32_16x16x32_bf16 v[108:111], a[168:171], a[116:119], v[108:111]
  s_waitcnt vmcnt(27)
  s_barrier
  v_mfma_f32_16x16x32_bf16 v[108:111], a[172:175], a[124:127], v[108:111]
  s_add_u32 m0, s45, 131072
  s_waitcnt lgkmcnt(4)
  v_mfma_f32_16x16x32_bf16 v[48:51], a[176:179], a[96:99], v[48:51]
  buffer_load_dwordx4 v224, s[8:11], s38 offen offset:0 lds
  s_lshl_b32 s48, s35, 2
  v_mfma_f32_16x16x32_bf16 v[48:51], a[180:183], a[104:107], v[48:51]
  v_mfma_f32_16x16x32_bf16 v[56:59], a[176:179], a[100:103], v[56:59]
  ds_read_b64_tr_b16 a[128:129], v172 offset:0
  ds_read_b64_tr_b16 a[130:131], v172 offset:4096
  s_add_u32 s51, s51, s48
  v_mfma_f32_16x16x32_bf16 v[56:59], a[180:183], a[108:111], v[56:59]
  ds_read_b64_tr_b16 a[132:133], v172 offset:8192
  ds_read_b64_tr_b16 a[134:135], v172 offset:12288
  v_mfma_f32_16x16x32_bf16 v[112:115], a[176:179], a[112:115], v[112:115]
  buffer_load_dwordx4 v225, s[8:11], s38 offen offset:1024 lds
  v_mfma_f32_16x16x32_bf16 v[112:115], a[180:183], a[120:123], v[112:115]
  ds_read_b64_tr_b16 a[136:137], v172 offset:8
  ds_read_b64_tr_b16 a[138:139], v172 offset:4104
  v_mfma_f32_16x16x32_bf16 v[120:123], a[176:179], a[116:119], v[120:123]
  v_mov_b32 v244, 1
  v_mfma_f32_16x16x32_bf16 v[120:123], a[180:183], a[124:127], v[120:123]
  ds_read_b64_tr_b16 a[140:141], v172 offset:8200
  s_waitcnt lgkmcnt(7)
  v_mfma_f32_16x16x32_bf16 v[52:55], a[184:187], a[96:99], v[52:55]
  buffer_load_dwordx4 v226, s[8:11], s38 offen offset:2048 lds
  v_mfma_f32_16x16x32_bf16 v[52:55], a[188:191], a[104:107], v[52:55]
  ds_read_b64_tr_b16 a[142:143], v172 offset:12296
  ds_read_b64_tr_b16 a[144:145], v173 offset:0
  v_mfma_f32_16x16x32_bf16 v[60:63], a[184:187], a[100:103], v[60:63]
  v_mfma_f32_16x16x32_bf16 v[60:63], a[188:191], a[108:111], v[60:63]
  ds_read_b64_tr_b16 a[146:147], v173 offset:4096
  v_mfma_f32_16x16x32_bf16 v[116:119], a[184:187], a[112:115], v[116:119]
  buffer_load_dwordx4 v227, s[8:11], s38 offen offset:3072 lds
  v_mfma_f32_16x16x32_bf16 v[116:119], a[188:191], a[120:123], v[116:119]
  s_add_u32 s38, s38, 0x20000
  v_mfma_f32_16x16x32_bf16 v[124:127], a[184:187], a[116:119], v[124:127]
  ds_read_b64_tr_b16 a[148:149], v173 offset:8192
  s_waitcnt vmcnt(27)
  v_mfma_f32_16x16x32_bf16 v[124:127], a[188:191], a[124:127], v[124:127]
  ds_read_b64_tr_b16 a[150:151], v173 offset:12288
  s_waitcnt lgkmcnt(8)
  v_mfma_f32_16x16x32_bf16 v[0:3], a[128:131], a[0:3], v[0:3]
  v_mfma_f32_16x16x32_bf16 v[0:3], a[132:135], a[8:11], v[0:3]
  buffer_load_dwordx4 a[64:67], v166, s[12:15], s36 offen offset:0 sc1
  v_mfma_f32_16x16x32_bf16 v[8:11], a[128:131], a[4:7], v[8:11]
  s_lshl_b32 s56, s58, 14
  ds_read_b64_tr_b16 a[152:153], v173 offset:8
  v_mfma_f32_16x16x32_bf16 v[8:11], a[132:135], a[12:15], v[8:11]
  s_sub_u32 s56, 98304, s56
  ds_read_b64_tr_b16 a[154:155], v173 offset:4104
  v_mfma_f32_16x16x32_bf16 v[64:67], a[128:131], a[16:19], v[64:67]
  s_max_u32 s56, s56, 0x4000
  v_mfma_f32_16x16x32_bf16 v[64:67], a[132:135], a[24:27], v[64:67]
  buffer_load_dwordx4 a[68:71], v166, s[12:15], s36 offen offset:1024 sc1
  v_mfma_f32_16x16x32_bf16 v[72:75], a[128:131], a[20:23], v[72:75]
  ds_read_b64_tr_b16 a[156:157], v173 offset:8200
  v_mfma_f32_16x16x32_bf16 v[72:75], a[132:135], a[28:31], v[72:75]
  s_waitcnt lgkmcnt(7)
  v_mfma_f32_16x16x32_bf16 v[4:7], a[136:139], a[0:3], v[4:7]
  ds_read_b64_tr_b16 a[158:159], v173 offset:12296
  v_mfma_f32_16x16x32_bf16 v[4:7], a[140:143], a[8:11], v[4:7]
  buffer_load_dwordx4 a[72:75], v166, s[12:15], s36 offen offset:2048 sc1
  v_mfma_f32_16x16x32_bf16 v[12:15], a[136:139], a[4:7], v[12:15]
  ds_read_b64_tr_b16 a[160:161], v174 offset:0
  v_mfma_f32_16x16x32_bf16 v[12:15], a[140:143], a[12:15], v[12:15]
  ds_read_b64_tr_b16 a[162:163], v174 offset:4096
  v_mfma_f32_16x16x32_bf16 v[68:71], a[136:139], a[16:19], v[68:71]
  ds_read_b64_tr_b16 a[164:165], v174 offset:8192
  ds_read_b64_tr_b16 a[166:167], v174 offset:12288
  v_mfma_f32_16x16x32_bf16 v[68:71], a[140:143], a[24:27], v[68:71]
  v_mfma_f32_16x16x32_bf16 v[76:79], a[136:139], a[20:23], v[76:79]
  buffer_load_dwordx4 a[76:79], v166, s[12:15], s36 offen offset:3072 sc1
  v_mfma_f32_16x16x32_bf16 v[76:79], a[140:143], a[28:31], v[76:79]
  s_add_u32 s36, s36, 4096
  s_waitcnt lgkmcnt(8)
  v_mfma_f32_16x16x32_bf16 v[16:19], a[144:147], a[0:3], v[16:19]
  v_mfma_f32_16x16x32_bf16 v[16:19], a[148:151], a[8:11], v[16:19]
  s_add_u32 m0, s45, s56
  ds_read_b64_tr_b16 a[168:169], v174 offset:8
  v_mfma_f32_16x16x32_bf16 v[24:27], a[144:147], a[4:7], v[24:27]
  buffer_load_dwordx4 v224, s[8:11], s10 offen offset:0 lds
  v_mfma_f32_16x16x32_bf16 v[24:27], a[148:151], a[12:15], v[24:27]
  ds_read_b64_tr_b16 a[170:171], v174 offset:4104
  v_mfma_f32_16x16x32_bf16 v[80:83], a[144:147], a[16:19], v[80:83]
  ds_read_b64_tr_b16 a[172:173], v174 offset:8200
  ds_read_b64_tr_b16 a[174:175], v174 offset:12296
  v_mfma_f32_16x16x32_bf16 v[80:83], a[148:151], a[24:27], v[80:83]
  s_lshl1_add_u32 m0, s45, 69632
  v_mfma_f32_16x16x32_bf16 v[88:91], a[144:147], a[20:23], v[88:91]
  buffer_load_dwordx4 v227, s[24:27], s46 offen offset:3072 lds
  v_mfma_f32_16x16x32_bf16 v[88:91], a[148:151], a[28:31], v[88:91]
  s_waitcnt lgkmcnt(8)
  v_mfma_f32_16x16x32_bf16 v[20:23], a[152:155], a[0:3], v[20:23]
  buffer_load_dwordx4 a[112:115], v166, s[12:15], s37 offen offset:0 sc1
  v_mfma_f32_16x16x32_bf16 v[20:23], a[156:159], a[8:11], v[20:23]
  v_mfma_f32_16x16x32_bf16 v[28:31], a[152:155], a[4:7], v[28:31]
  ds_read_b64_tr_b16 a[176:177], v175 offset:0
  ds_read_b64_tr_b16 a[178:179], v175 offset:4096
  v_mfma_f32_16x16x32_bf16 v[28:31], a[156:159], a[12:15], v[28:31]
  buffer_load_dwordx4 a[116:119], v166, s[12:15], s37 offen offset:1024 sc1
  v_mfma_f32_16x16x32_bf16 v[84:87], a[152:155], a[16:19], v[84:87]
  ds_read_b64_tr_b16 a[180:181], v175 offset:8192
  ds_read_b64_tr_b16 a[182:183], v175 offset:12288
  v_mfma_f32_16x16x32_bf16 v[84:87], a[156:159], a[24:27], v[84:87]
  v_mfma_f32_16x16x32_bf16 v[92:95], a[152:155], a[20:23], v[92:95]
  v_mfma_f32_16x16x32_bf16 v[92:95], a[156:159], a[28:31], v[92:95]
  s_waitcnt lgkmcnt(8)
  v_mfma_f32_16x16x32_bf16 v[32:35], a[160:163], a[0:3], v[32:35]
  buffer_load_dwordx4 a[120:123], v166, s[12:15], s37 offen offset:2048 sc1
  v_mfma_f32_16x16x32_bf16 v[32:35], a[164:167], a[8:11], v[32:35]
  v_mfma_f32_16x16x32_bf16 v[40:43], a[160:163], a[4:7], v[40:43]
  ds_read_b64_tr_b16 a[184:185], v175 offset:8
  ds_read_b64_tr_b16 a[186:187], v175 offset:4104
  v_mfma_f32_16x16x32_bf16 v[40:43], a[164:167], a[12:15], v[40:43]
  ds_read_b64_tr_b16 a[188:189], v175 offset:8200
  ds_read_b64_tr_b16 a[190:191], v175 offset:12296
  v_mfma_f32_16x16x32_bf16 v[96:99], a[160:163], a[16:19], v[96:99]
  buffer_load_dwordx4 a[124:127], v166, s[12:15], s37 offen offset:3072 sc1
  v_mfma_f32_16x16x32_bf16 v[96:99], a[164:167], a[24:27], v[96:99]
  s_add_u32 s37, s37, 4096
  v_mfma_f32_16x16x32_bf16 v[104:107], a[160:163], a[20:23], v[104:107]
  v_mfma_f32_16x16x32_bf16 v[104:107], a[164:167], a[28:31], v[104:107]
  s_add_u32 m0, s45, 512
  s_waitcnt lgkmcnt(8)
  v_mfma_f32_16x16x32_bf16 v[36:39], a[168:171], a[0:3], v[36:39]
  buffer_load_dword v238, s[4:7], 0 offen sc0 sc1 lds
  v_mfma_f32_16x16x32_bf16 v[36:39], a[172:175], a[8:11], v[36:39]
  v_mfma_f32_16x16x32_bf16 v[44:47], a[168:171], a[4:7], v[44:47]
  v_mfma_f32_16x16x32_bf16 v[44:47], a[172:175], a[12:15], v[44:47]
  v_mfma_f32_16x16x32_bf16 v[100:103], a[168:171], a[16:19], v[100:103]
  v_mfma_f32_16x16x32_bf16 v[100:103], a[172:175], a[24:27], v[100:103]
  v_mfma_f32_16x16x32_bf16 v[108:111], a[168:171], a[20:23], v[108:111]
  s_waitcnt vmcnt(27)
  s_barrier
  v_mfma_f32_16x16x32_bf16 v[108:111], a[172:175], a[28:31], v[108:111]
  s_add_u32 m0, s45, 147456
  s_waitcnt lgkmcnt(4)
  v_mfma_f32_16x16x32_bf16 v[48:51], a[176:179], a[0:3], v[48:51]
  buffer_load_dwordx4 v224, s[8:11], s38 offen offset:0 lds
  v_mfma_f32_16x16x32_bf16 v[48:51], a[180:183], a[8:11], v[48:51]
  v_mfma_f32_16x16x32_bf16 v[56:59], a[176:179], a[4:7], v[56:59]
  ds_read_b64_tr_b16 a[128:129], v172 offset:16384
  ds_read_b64_tr_b16 a[130:131], v172 offset:20480
  v_mfma_f32_16x16x32_bf16 v[56:59], a[180:183], a[12:15], v[56:59]
  ds_read_b64_tr_b16 a[132:133], v172 offset:24576
  ds_read_b64_tr_b16 a[134:135], v172 offset:28672
  v_mfma_f32_16x16x32_bf16 v[112:115], a[176:179], a[16:19], v[112:115]
  buffer_load_dwordx4 v225, s[8:11], s38 offen offset:1024 lds
  v_mfma_f32_16x16x32_bf16 v[112:115], a[180:183], a[24:27], v[112:115]
  ds_read_b64_tr_b16 a[136:137], v172 offset:16392
  ds_read_b64_tr_b16 a[138:139], v172 offset:20488
  v_mfma_f32_16x16x32_bf16 v[120:123], a[176:179], a[20:23], v[120:123]
  v_mfma_f32_16x16x32_bf16 v[120:123], a[180:183], a[28:31], v[120:123]
  ds_read_b64_tr_b16 a[140:141], v172 offset:24584
  s_waitcnt lgkmcnt(7)
  v_mfma_f32_16x16x32_bf16 v[52:55], a[184:187], a[0:3], v[52:55]
  buffer_load_dwordx4 v226, s[8:11], s38 offen offset:2048 lds
  v_mfma_f32_16x16x32_bf16 v[52:55], a[188:191], a[8:11], v[52:55]
  ds_read_b64_tr_b16 a[142:143], v172 offset:28680
  ds_read_b64_tr_b16 a[144:145], v173 offset:16384
  v_mfma_f32_16x16x32_bf16 v[60:63], a[184:187], a[4:7], v[60:63]
  v_mfma_f32_16x16x32_bf16 v[60:63], a[188:191], a[12:15], v[60:63]
  ds_read_b64_tr_b16 a[146:147], v173 offset:20480
  v_mfma_f32_16x16x32_bf16 v[116:119], a[184:187], a[16:19], v[116:119]
  buffer_load_dwordx4 v227, s[8:11], s38 offen offset:3072 lds
  v_mfma_f32_16x16x32_bf16 v[116:119], a[188:191], a[24:27], v[116:119]
  s_add_u32 s38, s38, 0x20000
  v_mfma_f32_16x16x32_bf16 v[124:127], a[184:187], a[20:23], v[124:127]
  ds_read_b64_tr_b16 a[148:149], v173 offset:24576
  s_waitcnt vmcnt(27)
  v_mfma_f32_16x16x32_bf16 v[124:127], a[188:191], a[28:31], v[124:127]
  ds_read_b64_tr_b16 a[150:151], v173 offset:28672
  s_waitcnt lgkmcnt(8)
  v_mfma_f32_16x16x32_bf16 v[0:3], a[128:131], a[32:35], v[0:3]
  v_mfma_f32_16x16x32_bf16 v[0:3], a[132:135], a[40:43], v[0:3]
  buffer_load_dwordx4 a[96:99], v166, s[12:15], s36 offen offset:0 sc1
  v_mfma_f32_16x16x32_bf16 v[8:11], a[128:131], a[36:39], v[8:11]
  ds_read_b64_tr_b16 a[152:153], v173 offset:16392
  v_mfma_f32_16x16x32_bf16 v[8:11], a[132:135], a[44:47], v[8:11]
  ds_read_b64_tr_b16 a[154:155], v173 offset:20488
  v_mfma_f32_16x16x32_bf16 v[64:67], a[128:131], a[48:51], v[64:67]
  v_mfma_f32_16x16x32_bf16 v[64:67], a[132:135], a[56:59], v[64:67]
  buffer_load_dwordx4 a[100:103], v166, s[12:15], s36 offen offset:1024 sc1
  v_mfma_f32_16x16x32_bf16 v[72:75], a[128:131], a[52:55], v[72:75]
  ds_read_b64_tr_b16 a[156:157], v173 offset:24584
  v_mfma_f32_16x16x32_bf16 v[72:75], a[132:135], a[60:63], v[72:75]
  s_waitcnt lgkmcnt(7)
  v_mfma_f32_16x16x32_bf16 v[4:7], a[136:139], a[32:35], v[4:7]
  ds_read_b64_tr_b16 a[158:159], v173 offset:28680
  v_mfma_f32_16x16x32_bf16 v[4:7], a[140:143], a[40:43], v[4:7]
  buffer_load_dwordx4 a[104:107], v166, s[12:15], s36 offen offset:2048 sc1
  v_mfma_f32_16x16x32_bf16 v[12:15], a[136:139], a[36:39], v[12:15]
  ds_read_b64_tr_b16 a[160:161], v174 offset:16384
  v_and_b32 v182, 0xf0, v166
  v_mfma_f32_16x16x32_bf16 v[12:15], a[140:143], a[44:47], v[12:15]
  ds_read_b64_tr_b16 a[162:163], v174 offset:20480
  v_bfe_u32 v183, v166, 8, 2
  v_mfma_f32_16x16x32_bf16 v[68:71], a[136:139], a[48:51], v[68:71]
  ds_read_b64_tr_b16 a[164:165], v174 offset:24576
  ds_read_b64_tr_b16 a[166:167], v174 offset:28672
  v_lshlrev_b32 v182, 4, v182
  v_mfma_f32_16x16x32_bf16 v[68:71], a[140:143], a[56:59], v[68:71]
  s_lshl1_add_u32 s48, s45, 65536
  v_mfma_f32_16x16x32_bf16 v[76:79], a[136:139], a[52:55], v[76:79]
  buffer_load_dwordx4 a[108:111], v166, s[12:15], s36 offen offset:3072 sc1
  v_lshl_add_u32 v182, v183, 4, v182
  v_mfma_f32_16x16x32_bf16 v[76:79], a[140:143], a[60:63], v[76:79]
  s_add_u32 s36, s36, 4096
  s_waitcnt lgkmcnt(8)
  v_and_b32 v183, 0x30, v166
  v_mfma_f32_16x16x32_bf16 v[16:19], a[144:147], a[32:35], v[16:19]
  v_add_u32 v182, s48, v182
  v_mfma_f32_16x16x32_bf16 v[16:19], a[148:151], a[40:43], v[16:19]
  s_add_u32 m0, s45, s56
  ds_read_b64_tr_b16 a[168:169], v174 offset:16392
  v_lshl_add_u32 v182, v183, 2, v182
  v_mfma_f32_16x16x32_bf16 v[24:27], a[144:147], a[36:39], v[24:27]
  buffer_load_dwordx4 v225, s[8:11], s10 offen offset:1024 lds
  v_xor_b32 v183, 64, v182
  v_mfma_f32_16x16x32_bf16 v[24:27], a[148:151], a[44:47], v[24:27]
  ds_read_b64_tr_b16 a[170:171], v174 offset:20488
  v_xor_b32 v184, 128, v182
  v_mfma_f32_16x16x32_bf16 v[80:83], a[144:147], a[48:51], v[80:83]
  ds_read_b64_tr_b16 a[172:173], v174 offset:24584
  ds_read_b64_tr_b16 a[174:175], v174 offset:28680
  v_xor_b32 v185, 192, v182
  v_mfma_f32_16x16x32_bf16 v[80:83], a[148:151], a[56:59], v[80:83]
  s_waitcnt vmcnt(14)
  v_mfma_f32_16x16x32_bf16 v[88:91], a[144:147], a[52:55], v[88:91]
  ds_read_b128 v[188:191], v182 offset:0
  v_mfma_f32_16x16x32_bf16 v[88:91], a[148:151], a[60:63], v[88:91]
  s_waitcnt lgkmcnt(9)
  v_mfma_f32_16x16x32_bf16 v[20:23], a[152:155], a[32:35], v[20:23]
  buffer_load_dwordx4 a[16:19], v166, s[12:15], s37 offen offset:0 sc1
  ds_read_b128 v[192:195], v182 offset:4096
  v_mfma_f32_16x16x32_bf16 v[20:23], a[156:159], a[40:43], v[20:23]
  v_mfma_f32_16x16x32_bf16 v[28:31], a[152:155], a[36:39], v[28:31]
  ds_read_b64_tr_b16 a[176:177], v175 offset:16384
  ds_read_b64_tr_b16 a[178:179], v175 offset:20480
  ds_read_b128 v[196:199], v183 offset:0
  v_mfma_f32_16x16x32_bf16 v[28:31], a[156:159], a[44:47], v[28:31]
  buffer_load_dwordx4 a[20:23], v166, s[12:15], s37 offen offset:1024 sc1
  v_mfma_f32_16x16x32_bf16 v[84:87], a[152:155], a[48:51], v[84:87]
  ds_read_b64_tr_b16 a[180:181], v175 offset:24576
  ds_read_b64_tr_b16 a[182:183], v175 offset:28672
  ds_read_b128 v[200:203], v183 offset:4096
  v_mfma_f32_16x16x32_bf16 v[84:87], a[156:159], a[56:59], v[84:87]
  v_mfma_f32_16x16x32_bf16 v[92:95], a[152:155], a[52:55], v[92:95]
  ds_read_b128 v[204:207], v184 offset:0
  v_mfma_f32_16x16x32_bf16 v[92:95], a[156:159], a[60:63], v[92:95]
  s_waitcnt lgkmcnt(13)
  v_mfma_f32_16x16x32_bf16 v[32:35], a[160:163], a[32:35], v[32:35]
  buffer_load_dwordx4 a[24:27], v166, s[12:15], s37 offen offset:2048 sc1
  ds_read_b128 v[208:211], v184 offset:4096
  v_mfma_f32_16x16x32_bf16 v[32:35], a[164:167], a[40:43], v[32:35]
  v_mfma_f32_16x16x32_bf16 v[40:43], a[160:163], a[36:39], v[40:43]
  ds_read_b64_tr_b16 a[184:185], v175 offset:16392
  ds_read_b64_tr_b16 a[186:187], v175 offset:20488
  ds_read_b128 v[212:215], v185 offset:0
  v_mfma_f32_16x16x32_bf16 v[40:43], a[164:167], a[44:47], v[40:43]
  ds_read_b64_tr_b16 a[188:189], v175 offset:24584
  ds_read_b64_tr_b16 a[190:191], v175 offset:28680
  v_mfma_f32_16x16x32_bf16 v[96:99], a[160:163], a[48:51], v[96:99]
  buffer_load_dwordx4 a[28:31], v166, s[12:15], s37 offen offset:3072 sc1
  ds_read_b128 v[216:219], v185 offset:4096
  v_mfma_f32_16x16x32_bf16 v[96:99], a[164:167], a[56:59], v[96:99]
  s_add_u32 s37, s37, 4096
  v_mfma_f32_16x16x32_bf16 v[104:107], a[160:163], a[52:55], v[104:107]
  v_mfma_f32_16x16x32_bf16 v[104:107], a[164:167], a[60:63], v[104:107]
  s_waitcnt lgkmcnt(15)
  v_mfma_f32_16x16x32_bf16 v[36:39], a[168:171], a[32:35], v[36:39]
  v_mfma_f32_16x16x32_bf16 v[36:39], a[172:175], a[40:43], v[36:39]
  v_mfma_f32_16x16x32_bf16 v[44:47], a[168:171], a[36:39], v[44:47]
  v_mfma_f32_16x16x32_bf16 v[44:47], a[172:175], a[44:47], v[44:47]
  v_mfma_f32_16x16x32_bf16 v[100:103], a[168:171], a[48:51], v[100:103]
  v_mfma_f32_16x16x32_bf16 v[100:103], a[172:175], a[56:59], v[100:103]
  v_mfma_f32_16x16x32_bf16 v[108:111], a[168:171], a[52:55], v[108:111]
  s_barrier
  v_mfma_f32_16x16x32_bf16 v[108:111], a[172:175], a[60:63], v[108:111]
  s_add_u32 m0, s45, 98304
  s_waitcnt lgkmcnt(9)
  v_mfma_f32_16x16x32_bf16 v[48:51], a[176:179], a[32:35], v[48:51]
  buffer_load_dwordx4 v224, s[8:11], s38 offen offset:0 lds
  v_mfma_f32_16x16x32_bf16 v[48:51], a[180:183], a[40:43], v[48:51]
  v_mfma_f32_16x16x32_bf16 v[56:59], a[176:179], a[36:39], v[56:59]
  ds_read_b64_tr_b16 a[128:129], v172 offset:32768
  ds_read_b64_tr_b16 a[130:131], v172 offset:36864
  v_mfma_f32_16x16x32_bf16 v[56:59], a[180:183], a[44:47], v[56:59]
  ds_read_b64_tr_b16 a[132:133], v172 offset:40960
  ds_read_b64_tr_b16 a[134:135], v172 offset:45056
  v_mfma_f32_16x16x32_bf16 v[112:115], a[176:179], a[48:51], v[112:115]
  buffer_load_dwordx4 v225, s[8:11], s38 offen offset:1024 lds
  v_mfma_f32_16x16x32_bf16 v[112:115], a[180:183], a[56:59], v[112:115]
  ds_read_b64_tr_b16 a[136:137], v172 offset:32776
  ds_read_b64_tr_b16 a[138:139], v172 offset:36872
  v_mfma_f32_16x16x32_bf16 v[120:123], a[176:179], a[52:55], v[120:123]
  v_mfma_f32_16x16x32_bf16 v[120:123], a[180:183], a[60:63], v[120:123]
  ds_read_b64_tr_b16 a[140:141], v172 offset:40968
  s_waitcnt lgkmcnt(8)
  v_mfma_f32_16x16x32_bf16 v[52:55], a[184:187], a[32:35], v[52:55]
  buffer_load_dwordx4 v226, s[8:11], s38 offen offset:2048 lds
  v_mfma_f32_16x16x32_bf16 v[52:55], a[188:191], a[40:43], v[52:55]
  ds_read_b64_tr_b16 a[142:143], v172 offset:45064
  ds_read_b64_tr_b16 a[144:145], v173 offset:32768
  v_mfma_f32_16x16x32_bf16 v[60:63], a[184:187], a[36:39], v[60:63]
  v_mfma_f32_16x16x32_bf16 v[60:63], a[188:191], a[44:47], v[60:63]
  ds_read_b64_tr_b16 a[146:147], v173 offset:36864
  v_mfma_f32_16x16x32_bf16 v[116:119], a[184:187], a[48:51], v[116:119]
  buffer_load_dwordx4 v227, s[8:11], s38 offen offset:3072 lds
  v_mfma_f32_16x16x32_bf16 v[116:119], a[188:191], a[56:59], v[116:119]
  s_add_u32 s38, s38, 0x20000
  v_mfma_f32_16x16x32_bf16 v[124:127], a[184:187], a[52:55], v[124:127]
  ds_read_b64_tr_b16 a[148:149], v173 offset:40960
  v_mfma_f32_16x16x32_bf16 v[124:127], a[188:191], a[60:63], v[124:127]
  ds_read_b64_tr_b16 a[150:151], v173 offset:45056
  s_waitcnt lgkmcnt(8)
  v_mfma_f32_16x16x32_bf16 v[0:3], a[128:131], a[64:67], v[0:3]
  v_mfma_f32_16x16x32_bf16 v[0:3], a[132:135], a[72:75], v[0:3]
  buffer_load_dwordx4 a[0:3], v166, s[12:15], s36 offen offset:0 sc1
  v_mfma_f32_16x16x32_bf16 v[8:11], a[128:131], a[68:71], v[8:11]
  ds_read_b64_tr_b16 a[152:153], v173 offset:32776
  v_mfma_f32_16x16x32_bf16 v[8:11], a[132:135], a[76:79], v[8:11]
  ds_read_b64_tr_b16 a[154:155], v173 offset:36872
  v_mfma_f32_16x16x32_bf16 v[64:67], a[128:131], a[80:83], v[64:67]
  v_mfma_f32_16x16x32_bf16 v[64:67], a[132:135], a[88:91], v[64:67]
  buffer_load_dwordx4 a[4:7], v166, s[12:15], s36 offen offset:1024 sc1
  v_mfma_f32_16x16x32_bf16 v[72:75], a[128:131], a[84:87], v[72:75]
  ds_read_b64_tr_b16 a[156:157], v173 offset:40968
  v_mfma_f32_16x16x32_bf16 v[72:75], a[132:135], a[92:95], v[72:75]
  s_waitcnt lgkmcnt(7)
  v_mfma_f32_16x16x32_bf16 v[4:7], a[136:139], a[64:67], v[4:7]
  ds_read_b64_tr_b16 a[158:159], v173 offset:45064
  v_mfma_f32_16x16x32_bf16 v[4:7], a[140:143], a[72:75], v[4:7]
  buffer_load_dwordx4 a[8:11], v166, s[12:15], s36 offen offset:2048 sc1
  v_mfma_f32_16x16x32_bf16 v[12:15], a[136:139], a[68:71], v[12:15]
  ds_read_b64_tr_b16 a[160:161], v174 offset:32768
  v_mfma_f32_16x16x32_bf16 v[12:15], a[140:143], a[76:79], v[12:15]
  ds_read_b64_tr_b16 a[162:163], v174 offset:36864
  v_mfma_f32_16x16x32_bf16 v[68:71], a[136:139], a[80:83], v[68:71]
  ds_read_b64_tr_b16 a[164:165], v174 offset:40960
  ds_read_b64_tr_b16 a[166:167], v174 offset:45056
  v_mfma_f32_16x16x32_bf16 v[68:71], a[140:143], a[88:91], v[68:71]
  v_mfma_f32_16x16x32_bf16 v[76:79], a[136:139], a[84:87], v[76:79]
  buffer_load_dwordx4 a[12:15], v166, s[12:15], s36 offen offset:3072 sc1
  v_mfma_f32_16x16x32_bf16 v[76:79], a[140:143], a[92:95], v[76:79]
  s_add_u32 s36, s36, 4096
  s_waitcnt lgkmcnt(8)
  v_mfma_f32_16x16x32_bf16 v[16:19], a[144:147], a[64:67], v[16:19]
  v_mfma_f32_16x16x32_bf16 v[16:19], a[148:151], a[72:75], v[16:19]
  s_add_u32 m0, s45, s56
  ds_read_b64_tr_b16 a[168:169], v174 offset:32776
  v_mfma_f32_16x16x32_bf16 v[24:27], a[144:147], a[68:71], v[24:27]
  buffer_load_dwordx4 v226, s[8:11], s10 offen offset:2048 lds
  v_mfma_f32_16x16x32_bf16 v[24:27], a[148:151], a[76:79], v[24:27]
  ds_read_b64_tr_b16 a[170:171], v174 offset:36872
  v_mfma_f32_16x16x32_bf16 v[80:83], a[144:147], a[80:83], v[80:83]
  ds_read_b64_tr_b16 a[172:173], v174 offset:40968
  ds_read_b64_tr_b16 a[174:175], v174 offset:45064
  v_mfma_f32_16x16x32_bf16 v[80:83], a[148:151], a[88:91], v[80:83]
  v_mfma_f32_16x16x32_bf16 v[88:91], a[144:147], a[84:87], v[88:91]
  v_mfma_f32_16x16x32_bf16 v[88:91], a[148:151], a[92:95], v[88:91]
  s_waitcnt lgkmcnt(8)
  v_mfma_f32_16x16x32_bf16 v[20:23], a[152:155], a[64:67], v[20:23]
  buffer_load_dwordx4 a[48:51], v166, s[12:15], s37 offen offset:0 sc1
  v_mfma_f32_16x16x32_bf16 v[20:23], a[156:159], a[72:75], v[20:23]
  v_mfma_f32_16x16x32_bf16 v[28:31], a[152:155], a[68:71], v[28:31]
  ds_read_b64_tr_b16 a[176:177], v175 offset:32768
  ds_read_b64_tr_b16 a[178:179], v175 offset:36864
  v_mfma_f32_16x16x32_bf16 v[28:31], a[156:159], a[76:79], v[28:31]
  buffer_load_dwordx4 a[52:55], v166, s[12:15], s37 offen offset:1024 sc1
  v_mfma_f32_16x16x32_bf16 v[84:87], a[152:155], a[80:83], v[84:87]
  ds_read_b64_tr_b16 a[180:181], v175 offset:40960
  ds_read_b64_tr_b16 a[182:183], v175 offset:45056
  v_mfma_f32_16x16x32_bf16 v[84:87], a[156:159], a[88:91], v[84:87]
  v_mfma_f32_16x16x32_bf16 v[92:95], a[152:155], a[84:87], v[92:95]
  v_mfma_f32_16x16x32_bf16 v[92:95], a[156:159], a[92:95], v[92:95]
  s_waitcnt lgkmcnt(8)
  v_mfma_f32_16x16x32_bf16 v[32:35], a[160:163], a[64:67], v[32:35]
  buffer_load_dwordx4 a[56:59], v166, s[12:15], s37 offen offset:2048 sc1
  v_mfma_f32_16x16x32_bf16 v[32:35], a[164:167], a[72:75], v[32:35]
  v_mfma_f32_16x16x32_bf16 v[40:43], a[160:163], a[68:71], v[40:43]
  ds_read_b64_tr_b16 a[184:185], v175 offset:32776
  ds_read_b64_tr_b16 a[186:187], v175 offset:36872
  v_mfma_f32_16x16x32_bf16 v[40:43], a[164:167], a[76:79], v[40:43]
  ds_read_b64_tr_b16 a[188:189], v175 offset:40968
  ds_read_b64_tr_b16 a[190:191], v175 offset:45064
  v_mfma_f32_16x16x32_bf16 v[96:99], a[160:163], a[80:83], v[96:99]
  buffer_load_dwordx4 a[60:63], v166, s[12:15], s37 offen offset:3072 sc1
  v_mfma_f32_16x16x32_bf16 v[96:99], a[164:167], a[88:91], v[96:99]
  s_add_u32 s37, s37, 4096
  v_mfma_f32_16x16x32_bf16 v[104:107], a[160:163], a[84:87], v[104:107]
  v_mfma_f32_16x16x32_bf16 v[104:107], a[164:167], a[92:95], v[104:107]
  s_waitcnt lgkmcnt(8)
  v_mfma_f32_16x16x32_bf16 v[36:39], a[168:171], a[64:67], v[36:39]
  v_mfma_f32_16x16x32_bf16 v[36:39], a[172:175], a[72:75], v[36:39]
  v_mfma_f32_16x16x32_bf16 v[44:47], a[168:171], a[68:71], v[44:47]
  v_mfma_f32_16x16x32_bf16 v[44:47], a[172:175], a[76:79], v[44:47]
  v_mfma_f32_16x16x32_bf16 v[100:103], a[168:171], a[80:83], v[100:103]
  v_mfma_f32_16x16x32_bf16 v[100:103], a[172:175], a[88:91], v[100:103]
  v_mfma_f32_16x16x32_bf16 v[108:111], a[168:171], a[84:87], v[108:111]
  s_waitcnt vmcnt(22)
  s_barrier
  v_mfma_f32_16x16x32_bf16 v[108:111], a[172:175], a[92:95], v[108:111]
  s_add_u32 m0, s45, 114688
  s_waitcnt lgkmcnt(4)
  v_mfma_f32_16x16x32_bf16 v[48:51], a[176:179], a[64:67], v[48:51]
  buffer_load_dwordx4 v224, s[8:11], s38 offen offset:0 lds
  v_mfma_f32_16x16x32_bf16 v[48:51], a[180:183], a[72:75], v[48:51]
  ds_read_b32 v165, v164 offset:512
  v_mfma_f32_16x16x32_bf16 v[56:59], a[176:179], a[68:71], v[56:59]
  ds_read_b64_tr_b16 a[128:129], v172 offset:49152
  ds_read_b64_tr_b16 a[130:131], v172 offset:53248
  v_mfma_f32_16x16x32_bf16 v[56:59], a[180:183], a[76:79], v[56:59]
  ds_read_b64_tr_b16 a[132:133], v172 offset:57344
  ds_read_b64_tr_b16 a[134:135], v172 offset:61440
  v_mfma_f32_16x16x32_bf16 v[112:115], a[176:179], a[80:83], v[112:115]
  buffer_load_dwordx4 v225, s[8:11], s38 offen offset:1024 lds
  v_mfma_f32_16x16x32_bf16 v[112:115], a[180:183], a[88:91], v[112:115]
  ds_read_b64_tr_b16 a[136:137], v172 offset:49160
  ds_read_b64_tr_b16 a[138:139], v172 offset:53256
  v_mfma_f32_16x16x32_bf16 v[120:123], a[176:179], a[84:87], v[120:123]
  v_mfma_f32_16x16x32_bf16 v[120:123], a[180:183], a[92:95], v[120:123]
  ds_read_b64_tr_b16 a[140:141], v172 offset:57352
  s_waitcnt lgkmcnt(8)
  v_mfma_f32_16x16x32_bf16 v[52:55], a[184:187], a[64:67], v[52:55]
  buffer_load_dwordx4 v226, s[8:11], s38 offen offset:2048 lds
  v_mfma_f32_16x16x32_bf16 v[52:55], a[188:191], a[72:75], v[52:55]
  ds_read_b64_tr_b16 a[142:143], v172 offset:61448
  ds_read_b64_tr_b16 a[144:145], v173 offset:49152
  v_mfma_f32_16x16x32_bf16 v[60:63], a[184:187], a[68:71], v[60:63]
  v_mfma_f32_16x16x32_bf16 v[60:63], a[188:191], a[76:79], v[60:63]
  s_waitcnt lgkmcnt(9)
  v_cmp_gt_u32 vcc, 4, v165
  ds_read_b64_tr_b16 a[146:147], v173 offset:53248
  v_mfma_f32_16x16x32_bf16 v[116:119], a[184:187], a[80:83], v[116:119]
  buffer_load_dwordx4 v227, s[8:11], s38 offen offset:3072 lds
  v_mfma_f32_16x16x32_bf16 v[116:119], a[188:191], a[88:91], v[116:119]
  s_add_u32 s38, s38, 0x20000
  s_and_b32 s95, s95, vcc_lo
  v_mfma_f32_16x16x32_bf16 v[124:127], a[184:187], a[84:87], v[124:127]
  ds_read_b64_tr_b16 a[148:149], v173 offset:57344
  s_waitcnt vmcnt(22)
  v_mfma_f32_16x16x32_bf16 v[124:127], a[188:191], a[92:95], v[124:127]
  ds_read_b64_tr_b16 a[150:151], v173 offset:61440
  s_waitcnt lgkmcnt(8)
  v_mfma_f32_16x16x32_bf16 v[0:3], a[128:131], a[96:99], v[0:3]
  s_bitcmp1_b32 s95, s58
  s_cbranch_scc1 L3_ohc
L3_ohb:
  v_mfma_f32_16x16x32_bf16 v[0:3], a[132:135], a[104:107], v[0:3]
  buffer_load_dwordx4 a[32:35], v166, s[12:15], s36 offen offset:0 sc1
  v_mfma_f32_16x16x32_bf16 v[8:11], a[128:131], a[100:103], v[8:11]
  ds_read_b64_tr_b16 a[152:153], v173 offset:49160
  v_mfma_f32_16x16x32_bf16 v[8:11], a[132:135], a[108:111], v[8:11]
  ds_read_b64_tr_b16 a[154:155], v173 offset:53256
  v_mfma_f32_16x16x32_bf16 v[64:67], a[128:131], a[112:115], v[64:67]
  s_bfe_i32 s47, s39, 0x60000
  v_mfma_f32_16x16x32_bf16 v[64:67], a[132:135], a[120:123], v[64:67]
  buffer_load_dwordx4 a[36:39], v166, s[12:15], s36 offen offset:1024 sc1
  v_mfma_f32_16x16x32_bf16 v[72:75], a[128:131], a[116:119], v[72:75]
  s_lshl_b32 s49, s47, 18
  ds_read_b64_tr_b16 a[156:157], v173 offset:57352
  v_mfma_f32_16x16x32_bf16 v[72:75], a[132:135], a[124:127], v[72:75]
  s_add_u32 s38, s38, s49
  s_waitcnt lgkmcnt(7)
  v_mfma_f32_16x16x32_bf16 v[4:7], a[136:139], a[96:99], v[4:7]
  s_lshr_b32 s39, s39, 6
  ds_read_b64_tr_b16 a[158:159], v173 offset:61448
  v_mfma_f32_16x16x32_bf16 v[4:7], a[140:143], a[104:107], v[4:7]
  buffer_load_dwordx4 a[40:43], v166, s[12:15], s36 offen offset:2048 sc1
  v_mfma_f32_16x16x32_bf16 v[12:15], a[136:139], a[100:103], v[12:15]
  s_lshl_b32 s49, s47, 13
  ds_read_b64_tr_b16 a[160:161], v174 offset:49152
  v_mfma_f32_16x16x32_bf16 v[12:15], a[140:143], a[108:111], v[12:15]
  s_add_u32 s37, s37, s49
  ds_read_b64_tr_b16 a[162:163], v174 offset:53248
  v_mfma_f32_16x16x32_bf16 v[68:71], a[136:139], a[112:115], v[68:71]
  ds_read_b64_tr_b16 a[164:165], v174 offset:57344
  ds_read_b64_tr_b16 a[166:167], v174 offset:61440
  v_mfma_f32_16x16x32_bf16 v[68:71], a[140:143], a[120:123], v[68:71]
  v_mfma_f32_16x16x32_bf16 v[76:79], a[136:139], a[116:119], v[76:79]
  buffer_load_dwordx4 a[44:47], v166, s[12:15], s36 offen offset:3072 sc1
  v_mfma_f32_16x16x32_bf16 v[76:79], a[140:143], a[124:127], v[76:79]
  s_add_u32 s36, s36, 4096
  s_waitcnt lgkmcnt(8)
  v_mfma_f32_16x16x32_bf16 v[16:19], a[144:147], a[96:99], v[16:19]
  v_mfma_f32_16x16x32_bf16 v[16:19], a[148:151], a[104:107], v[16:19]
  s_add_u32 m0, s45, s56
  ds_read_b64_tr_b16 a[168:169], v174 offset:49160
  v_mfma_f32_16x16x32_bf16 v[24:27], a[144:147], a[100:103], v[24:27]
  buffer_load_dwordx4 v227, s[8:11], s10 offen offset:3072 lds
  v_mfma_f32_16x16x32_bf16 v[24:27], a[148:151], a[108:111], v[24:27]
  s_mov_b32 s34, s2
  ds_read_b64_tr_b16 a[170:171], v174 offset:53256
  v_mfma_f32_16x16x32_bf16 v[80:83], a[144:147], a[112:115], v[80:83]
  ds_read_b64_tr_b16 a[172:173], v174 offset:57352
  ds_read_b64_tr_b16 a[174:175], v174 offset:61448
  v_mfma_f32_16x16x32_bf16 v[80:83], a[148:151], a[120:123], v[80:83]
  v_mfma_f32_16x16x32_bf16 v[88:91], a[144:147], a[116:119], v[88:91]
  v_mfma_f32_16x16x32_bf16 v[88:91], a[148:151], a[124:127], v[88:91]
  s_waitcnt lgkmcnt(8)
  v_mfma_f32_16x16x32_bf16 v[20:23], a[152:155], a[96:99], v[20:23]
  buffer_load_dwordx4 a[80:83], v166, s[12:15], s37 offen offset:0 sc1
  v_mfma_f32_16x16x32_bf16 v[20:23], a[156:159], a[104:107], v[20:23]
  v_mfma_f32_16x16x32_bf16 v[28:31], a[152:155], a[100:103], v[28:31]
  ds_read_b64_tr_b16 a[176:177], v175 offset:49152
  ds_read_b64_tr_b16 a[178:179], v175 offset:53248
  v_mfma_f32_16x16x32_bf16 v[28:31], a[156:159], a[108:111], v[28:31]
  buffer_load_dwordx4 a[84:87], v166, s[12:15], s37 offen offset:1024 sc1
  v_mfma_f32_16x16x32_bf16 v[84:87], a[152:155], a[112:115], v[84:87]
  ds_read_b64_tr_b16 a[180:181], v175 offset:57344
  ds_read_b64_tr_b16 a[182:183], v175 offset:61440
  v_mfma_f32_16x16x32_bf16 v[84:87], a[156:159], a[120:123], v[84:87]
  v_mfma_f32_16x16x32_bf16 v[92:95], a[152:155], a[116:119], v[92:95]
  v_mfma_f32_16x16x32_bf16 v[92:95], a[156:159], a[124:127], v[92:95]
  s_waitcnt lgkmcnt(8)
  v_mfma_f32_16x16x32_bf16 v[32:35], a[160:163], a[96:99], v[32:35]
  buffer_load_dwordx4 a[88:91], v166, s[12:15], s37 offen offset:2048 sc1
  v_mfma_f32_16x16x32_bf16 v[32:35], a[164:167], a[104:107], v[32:35]
  v_mfma_f32_16x16x32_bf16 v[40:43], a[160:163], a[100:103], v[40:43]
  ds_read_b64_tr_b16 a[184:185], v175 offset:49160
  ds_read_b64_tr_b16 a[186:187], v175 offset:53256
  v_mfma_f32_16x16x32_bf16 v[40:43], a[164:167], a[108:111], v[40:43]
  ds_read_b64_tr_b16 a[188:189], v175 offset:57352
  ds_read_b64_tr_b16 a[190:191], v175 offset:61448
  v_mfma_f32_16x16x32_bf16 v[96:99], a[160:163], a[112:115], v[96:99]
  buffer_load_dwordx4 a[92:95], v166, s[12:15], s37 offen offset:3072 sc1
  v_mfma_f32_16x16x32_bf16 v[96:99], a[164:167], a[120:123], v[96:99]
  s_add_u32 s37, s37, 4096
  v_mfma_f32_16x16x32_bf16 v[104:107], a[160:163], a[116:119], v[104:107]
  v_mfma_f32_16x16x32_bf16 v[104:107], a[164:167], a[124:127], v[104:107]
  s_waitcnt lgkmcnt(8)
  v_mfma_f32_16x16x32_bf16 v[36:39], a[168:171], a[96:99], v[36:39]
  v_mfma_f32_16x16x32_bf16 v[36:39], a[172:175], a[104:107], v[36:39]
  v_mfma_f32_16x16x32_bf16 v[44:47], a[168:171], a[100:103], v[44:47]
  v_mfma_f32_16x16x32_bf16 v[44:47], a[172:175], a[108:111], v[44:47]
  v_mfma_f32_16x16x32_bf16 v[100:103], a[168:171], a[112:115], v[100:103]
  v_mfma_f32_16x16x32_bf16 v[100:103], a[172:175], a[120:123], v[100:103]
  v_mfma_f32_16x16x32_bf16 v[108:111], a[168:171], a[116:119], v[108:111]
  s_waitcnt vmcnt(22)
  s_barrier
  ds_read_b32 v185, v232 offset:96
  v_mfma_f32_16x16x32_bf16 v[108:111], a[172:175], a[124:127], v[108:111]
  s_add_u32 m0, s45, 131072
  s_waitcnt lgkmcnt(5)
  v_mfma_f32_16x16x32_bf16 v[48:51], a[176:179], a[96:99], v[48:51]
  buffer_load_dwordx4 v224, s[8:11], s38 offen offset:0 lds
  v_mfma_f32_16x16x32_bf16 v[48:51], a[180:183], a[104:107], v[48:51]
  s_add_u32 s36, s36, s49
  v_mfma_f32_16x16x32_bf16 v[56:59], a[176:179], a[100:103], v[56:59]
  ds_read_b64_tr_b16 a[128:129], v172 offset:0
  ds_read_b64_tr_b16 a[130:131], v172 offset:4096
  v_mfma_f32_16x16x32_bf16 v[56:59], a[180:183], a[108:111], v[56:59]
  ds_read_b64_tr_b16 a[132:133], v172 offset:8192
  ds_read_b64_tr_b16 a[134:135], v172 offset:12288
  v_mfma_f32_16x16x32_bf16 v[112:115], a[176:179], a[112:115], v[112:115]
  buffer_load_dwordx4 v225, s[8:11], s38 offen offset:1024 lds
  v_mfma_f32_16x16x32_bf16 v[112:115], a[180:183], a[120:123], v[112:115]
  ds_read_b64_tr_b16 a[136:137], v172 offset:8
  ds_read_b64_tr_b16 a[138:139], v172 offset:4104
  v_mfma_f32_16x16x32_bf16 v[120:123], a[176:179], a[116:119], v[120:123]
  v_mfma_f32_16x16x32_bf16 v[120:123], a[180:183], a[124:127], v[120:123]
  ds_read_b64_tr_b16 a[140:141], v172 offset:8200
  s_waitcnt lgkmcnt(8)
  v_mfma_f32_16x16x32_bf16 v[52:55], a[184:187], a[96:99], v[52:55]
  buffer_load_dwordx4 v226, s[8:11], s38 offen offset:2048 lds
  v_mfma_f32_16x16x32_bf16 v[52:55], a[188:191], a[104:107], v[52:55]
  ds_read_b64_tr_b16 a[142:143], v172 offset:12296
  ds_read_b64_tr_b16 a[144:145], v173 offset:0
  v_mfma_f32_16x16x32_bf16 v[60:63], a[184:187], a[100:103], v[60:63]
  s_waitcnt lgkmcnt(9)
  v_readfirstlane_b32 s33, v185
  v_mfma_f32_16x16x32_bf16 v[60:63], a[188:191], a[108:111], v[60:63]
  ds_read_b64_tr_b16 a[146:147], v173 offset:4096
  v_mfma_f32_16x16x32_bf16 v[116:119], a[184:187], a[112:115], v[116:119]
  buffer_load_dwordx4 v227, s[8:11], s38 offen offset:3072 lds
  s_cmp_lg_u32 s33, 0
  s_cbranch_scc1 L3_giveup
  v_mfma_f32_16x16x32_bf16 v[116:119], a[188:191], a[120:123], v[116:119]
  s_add_u32 s38, s38, 0x20000
  v_mfma_f32_16x16x32_bf16 v[124:127], a[184:187], a[116:119], v[124:127]
  ds_read_b64_tr_b16 a[148:149], v173 offset:8192
  s_waitcnt vmcnt(22)
  v_mfma_f32_16x16x32_bf16 v[124:127], a[188:191], a[124:127], v[124:127]
  ds_read_b64_tr_b16 a[150:151], v173 offset:12288
  s_waitcnt lgkmcnt(8)
  s_mov_b32 s58, 4
  s_branch L3_loop
L3_ohc:
  s_lshl_b32 s62, 1, s58
  s_mov_b32 s49, 1024
L3_ohcp:
  buffer_load_dword v245, v238, s[4:7], 0 offen sc0 sc1
  s_sub_u32 s49, s49, 1
  s_waitcnt vmcnt(0)
  v_cmp_gt_u32 vcc, 4, v245
  s_nop 1
  s_and_b32 s48, vcc_lo, s62
  s_cbranch_scc0 L3_ohck
  s_cmp_lg_u32 s49, 0
  s_cbranch_scc1 L3_ohcp
L3_ohck:
  s_mov_b32 s95, vcc_lo
  s_lshl_b32 s48, s3, 2
  v_mov_b32 v182, s95
  v_mov_b32 v183, s48
  ds_write_b32 v183, v182 offset:64
  s_waitcnt lgkmcnt(0)
  s_barrier
  ds_read_b128 v[182:185], v181 offset:64
  s_waitcnt lgkmcnt(0)
  v_or_b32 v182, v182, v183
  v_or3_b32 v182, v182, v184, v185
  s_nop 0
  v_readfirstlane_b32 s95, v182
  s_nop 1
  s_and_b32 s95, s95, 0x2a
  s_and_b32 s48, s95, s62
  s_cbranch_scc0 L3_ohb
  s_branch L3_giveup
L3_exit:
L_k2_end:
  s_endpgm
L_hook:
  s_cmp_eq_u32 s42, 7
  s_cbranch_scc1 L_chpost
  s_cmp_eq_u32 s42, 3
  s_cbranch_scc1 L_tk1
  s_cmp_eq_u32 s42, 2
  s_cbranch_scc1 L_tk2
  s_mov_b32 s48, m0
  s_mov_b32 m0, 208
  v_lshrrev_b32 v239, 2, v166
  s_mov_b32 s95, 99
  s_mov_b64 exec, 3
  buffer_load_dword v239, s[72:75], 0 offen offset:48 sc0 sc1 lds
  s_mov_b32 m0, 272
  s_mov_b64 exec, 0xff
  buffer_load_dword v234, s[4:7], 0 offen sc0 sc1 lds
  s_mov_b64 exec, -1
  s_mov_b32 m0, s48
  s_lshr_b32 s48, s2, 3
  s_lshl_b32 s48, s48, 11
  s_add_u32 s48, s48, L_att_tail-L_pc0
  v_and_b32 v239, 255, v166
  v_lshl_add_u32 v239, v239, 3, s48
  v_min_u32 v239, L_code_end-L_pc0-4, v239
  global_load_dword v248, v239, s[100:101]
  s_branch L_chback
L_tk1:
  s_and_b32 s48, s2, 4
  s_mov_b32 s95, 2
  s_mov_b64 exec, 1
  buffer_atomic_add v239, v232, s[72:75], s48 offen offset:40 sc0 sc1
  s_mov_b64 exec, -1
  s_branch L_chback
L_tk2:
  s_and_b32 s48, s2, 3
  s_lshl_b32 s95, s48, 2
  s_add_u32 s95, s95, 16
  s_or_b32 s48, s48, 4
  v_and_b32 v239, 3, v239
  v_or_b32 v249, 4, v239
  v_lshlrev_b32 v249, s95, v249
  v_lshlrev_b32 v239, 2, v239
  v_lshlrev_b32 v239, v239, s48
  v_or_b32 v239, v239, v249
  s_and_b32 s48, s2, 4
  s_mov_b32 s95, 1
  s_mov_b64 exec, 1
  buffer_atomic_or v239, v232, s[72:75], s48 offen offset:48 sc1
  s_mov_b64 exec, -1
  s_branch L_chback
L_chpost:
  s_lshl_b32 s48, s33, 13
  s_and_b32 s95, s32, 16
  s_lshl_b32 s95, s95, 3
  s_add_u32 s48, s48, s95
  s_and_b32 s95, s32, 12
  s_add_u32 s48, s48, s95
  s_cmp_lt_u32 s2, 8
  s_cselect_b32 s95, 3, 1
  s_mov_b64 exec, 1
  buffer_atomic_add v233, v232, s[4:7], s48 offen offset:384 sc1
  s_mov_b64 exec, -1
  s_branch L_chback
L_post:
  s_cmp_eq_u32 s58, 0
  s_cbranch_scc1 L_postb
  s_mov_b32 s35, 256
L_ckl:
  v_cmp_ne_u32 vcc, 0, v220
  s_nop 1
  s_cmp_eq_u64 vcc, exec
  s_cbranch_scc1 L_ckok
  buffer_load_dword v220, v223, s[24:27], 0 offen sc0 sc1
  s_sub_u32 s35, s35, 1
  s_waitcnt vmcnt(0)
  s_cmp_lg_u32 s35, 0
  s_cbranch_scc1 L_ckl
  ds_write_b32 v218, v233 offset:512
  s_waitcnt lgkmcnt(0)
  s_branch L_postb
L_ckok:
  v_mov_b32 v222, 1
  s_mov_b64 exec, 1
  buffer_atomic_add v222, v221, s[28:31], s47 offen offset:0 sc1
  s_mov_b64 exec, -1
  s_mov_b32 s59, 1
  s_mov_b32 s95, 7
  s_bfe_u32 s48, s2, 0x20003
  s_lshl_b32 s48, s48, 13
  s_and_b32 s35, s2, 4
  s_lshl_b32 s35, s35, 13
  s_add_u32 s48, s48, s35
  s_add_u32 s48, s48, 384
  v_and_b32 v234, 4, v0
  v_and_b32 v208, 3, v0
  v_lshl_add_u32 v234, v234, 5, s48
  v_lshl_add_u32 v234, v208, 2, v234
  s_branch L_postb
L_spin:
  s_mov_b32 s35, 256
L_spl:
  buffer_load_dword v222, v221, s[28:31], s47 offen offset:0 sc0 sc1
  s_sub_u32 s35, s35, 1
  s_waitcnt vmcnt(0)
  v_readfirstlane_b32 s48, v222
  s_nop 1
  s_cmp_ge_u32 s48, s58
  s_cbranch_scc1 L_spinb
  s_cmp_lg_u32 s35, 0
  s_cbranch_scc1 L_spl
  ds_write_b32 v218, v233 offset:512
  s_waitcnt lgkmcnt(0)
  s_branch L_spinb
L_fallback:
  s_waitcnt lgkmcnt(0)
  s_mov_b32 s64, 1
  s_mov_b32 s43, 0
  s_mov_b32 s42, 32
  s_waitcnt vmcnt(0)
  v_mov_b32 v168, 0xff800000
  v_mov_b32 v169, 0xff800000
  v_mov_b32 v170, 0xff800000
  v_mov_b32 v171, 0xff800000
L_fb_loop:
  s_barrier
  s_add_u32 m0, s45, 147456
  s_nop 0
  buffer_load_dwordx4 v160, s[16:19], s43 offen offset:0 lds
  buffer_load_dwordx4 v161, s[16:19], s43 offen offset:1024 lds
  buffer_load_dwordx4 v162, s[16:19], s43 offen offset:2048 lds
  buffer_load_dwordx4 v163, s[16:19], s43 offen offset:3072 lds
  s_add_u32 s43, s43, 16384
  s_waitcnt vmcnt(0)
  s_barrier
  ds_read_b128 a[192:195], v148 offset:49152
  ds_read_b128 a[196:199], v149 offset:49152
  ds_read_b128 a[200:203], v150 offset:49152
  ds_read_b128 a[204:207], v151 offset:49152
  ds_read_b128 a[208:211], v148 offset:53248
  ds_read_b128 a[212:215], v149 offset:53248
  ds_read_b128 a[216:219], v150 offset:53248
  ds_read_b128 a[220:223], v151 offset:53248
  s_waitcnt lgkmcnt(7)
  v_mfma_f32_16x16x32_bf16 v[0:3], a[192:195], a[128:131], 0
  s_waitcnt lgkmcnt(6)
  v_mfma_f32_16x16x32_bf16 v[0:3], a[196:199], a[132:135], v[0:3]
  s_waitcnt lgkmcnt(5)
  v_mfma_f32_16x16x32_bf16 v[0:3], a[200:203], a[136:139], v[0:3]
  s_waitcnt lgkmcnt(4)
  v_mfma_f32_16x16x32_bf16 v[0:3], a[204:207], a[140:143], v[0:3]
  v_mfma_f32_16x16x32_bf16 v[16:19], a[192:195], a[144:147], 0
  v_mfma_f32_16x16x32_bf16 v[16:19], a[196:199], a[148:151], v[16:19]
  v_mfma_f32_16x16x32_bf16 v[16:19], a[200:203], a[152:155], v[16:19]
  v_mfma_f32_16x16x32_bf16 v[16:19], a[204:207], a[156:159], v[16:19]
  v_mfma_f32_16x16x32_bf16 v[32:35], a[192:195], a[160:163], 0
  v_mfma_f32_16x16x32_bf16 v[32:35], a[196:199], a[164:167], v[32:35]
  v_mfma_f32_16x16x32_bf16 v[32:35], a[200:203], a[168:171], v[32:35]
  v_mfma_f32_16x16x32_bf16 v[32:35], a[204:207], a[172:175], v[32:35]
  v_mfma_f32_16x16x32_bf16 v[48:51], a[192:195], a[176:179], 0
  v_mfma_f32_16x16x32_bf16 v[48:51], a[196:199], a[180:183], v[48:51]
  ds_read_b128 a[192:195], v148 offset:57344
  v_mfma_f32_16x16x32_bf16 v[48:51], a[200:203], a[184:187], v[48:51]
  ds_read_b128 a[196:199], v149 offset:57344
  v_mfma_f32_16x16x32_bf16 v[48:51], a[204:207], a[188:191], v[48:51]
  ds_read_b128 a[200:203], v150 offset:57344
  s_waitcnt lgkmcnt(6)
  v_mfma_f32_16x16x32_bf16 v[4:7], a[208:211], a[128:131], 0
  ds_read_b128 a[204:207], v151 offset:57344
  s_waitcnt lgkmcnt(6)
  v_mfma_f32_16x16x32_bf16 v[4:7], a[212:215], a[132:135], v[4:7]
  s_waitcnt lgkmcnt(5)
  v_mfma_f32_16x16x32_bf16 v[4:7], a[216:219], a[136:139], v[4:7]
  s_waitcnt lgkmcnt(4)
  v_mfma_f32_16x16x32_bf16 v[4:7], a[220:223], a[140:143], v[4:7]
  v_mfma_f32_16x16x32_bf16 v[20:23], a[208:211], a[144:147], 0
  v_mfma_f32_16x16x32_bf16 v[20:23], a[212:215], a[148:151], v[20:23]
  v_mfma_f32_16x16x32_bf16 v[20:23], a[216:219], a[152:155], v[20:23]
  v_mfma_f32_16x16x32_bf16 v[20:23], a[220:223], a[156:159], v[20:23]
  v_mfma_f32_16x16x32_bf16 v[36:39], a[208:211], a[160:163], 0
  v_mfma_f32_16x16x32_bf16 v[36:39], a[212:215], a[164:167], v[36:39]
  v_mfma_f32_16x16x32_bf16 v[36:39], a[216:219], a[168:171], v[36:39]
  v_mfma_f32_16x16x32_bf16 v[36:39], a[220:223], a[172:175], v[36:39]
  v_mfma_f32_16x16x32_bf16 v[52:55], a[208:211], a[176:179], 0
  v_mfma_f32_16x16x32_bf16 v[52:55], a[212:215], a[180:183], v[52:55]
  ds_read_b128 a[208:211], v148 offset:61440
  v_mfma_f32_16x16x32_bf16 v[52:55], a[216:219], a[184:187], v[52:55]
  ds_read_b128 a[212:215], v149 offset:61440
  v_mfma_f32_16x16x32_bf16 v[52:55], a[220:223], a[188:191], v[52:55]
  ds_read_b128 a[216:219], v150 offset:61440
  s_waitcnt lgkmcnt(6)
  v_mfma_f32_16x16x32_bf16 v[8:11], a[192:195], a[128:131], 0
  ds_read_b128 a[220:223], v151 offset:61440
  s_waitcnt lgkmcnt(6)
  v_mfma_f32_16x16x32_bf16 v[8:11], a[196:199], a[132:135], v[8:11]
  s_waitcnt lgkmcnt(5)
  v_mfma_f32_16x16x32_bf16 v[8:11], a[200:203], a[136:139], v[8:11]
  s_waitcnt lgkmcnt(4)
  v_mfma_f32_16x16x32_bf16 v[8:11], a[204:207], a[140:143], v[8:11]
  v_mfma_f32_16x16x32_bf16 v[24:27], a[192:195], a[144:147], 0
  v_mfma_f32_16x16x32_bf16 v[24:27], a[196:199], a[148:151], v[24:27]
  v_mfma_f32_16x16x32_bf16 v[24:27], a[200:203], a[152:155], v[24:27]
  v_mfma_f32_16x16x32_bf16 v[24:27], a[204:207], a[156:159], v[24:27]
  v_mfma_f32_16x16x32_bf16 v[40:43], a[192:195], a[160:163], 0
  v_mfma_f32_16x16x32_bf16 v[40:43], a[196:199], a[164:167], v[40:43]
  v_mfma_f32_16x16x32_bf16 v[40:43], a[200:203], a[168:171], v[40:43]
  v_mfma_f32_16x16x32_bf16 v[40:43], a[204:207], a[172:175], v[40:43]
  v_mfma_f32_16x16x32_bf16 v[56:59], a[192:195], a[176:179], 0
  v_mfma_f32_16x16x32_bf16 v[56:59], a[196:199], a[180:183], v[56:59]
  v_mfma_f32_16x16x32_bf16 v[56:59], a[200:203], a[184:187], v[56:59]
  v_mfma_f32_16x16x32_bf16 v[56:59], a[204:207], a[188:191], v[56:59]
  s_waitcnt lgkmcnt(3)
  v_mfma_f32_16x16x32_bf16 v[12:15], a[208:211], a[128:131], 0
  s_waitcnt lgkmcnt(2)
  v_mfma_f32_16x16x32_bf16 v[12:15], a[212:215], a[132:135], v[12:15]
  s_waitcnt lgkmcnt(1)
  v_mfma_f32_16x16x32_bf16 v[12:15], a[216:219], a[136:139], v[12:15]
  s_waitcnt lgkmcnt(0)
  v_mfma_f32_16x16x32_bf16 v[12:15], a[220:223], a[140:143], v[12:15]
  v_mfma_f32_16x16x32_bf16 v[28:31], a[208:211], a[144:147], 0
  v_mfma_f32_16x16x32_bf16 v[28:31], a[212:215], a[148:151], v[28:31]
  v_mfma_f32_16x16x32_bf16 v[28:31], a[216:219], a[152:155], v[28:31]
  v_mfma_f32_16x16x32_bf16 v[28:31], a[220:223], a[156:159], v[28:31]
  v_mfma_f32_16x16x32_bf16 v[44:47], a[208:211], a[160:163], 0
  v_mfma_f32_16x16x32_bf16 v[44:47], a[212:215], a[164:167], v[44:47]
  v_mfma_f32_16x16x32_bf16 v[44:47], a[216:219], a[168:171], v[44:47]
  v_mfma_f32_16x16x32_bf16 v[44:47], a[220:223], a[172:175], v[44:47]
  v_mfma_f32_16x16x32_bf16 v[60:63], a[208:211], a[176:179], 0
  v_mfma_f32_16x16x32_bf16 v[60:63], a[212:215], a[180:183], v[60:63]
  v_mfma_f32_16x16x32_bf16 v[60:63], a[216:219], a[184:187], v[60:63]
  v_mfma_f32_16x16x32_bf16 v[60:63], a[220:223], a[188:191], v[60:63]
  s_nop 15
  v_max3_f32 v168, v168, v0, v1
  v_max3_f32 v168, v168, v2, v3
  v_max3_f32 v168, v168, v4, v5
  v_max3_f32 v168, v168, v6, v7
  v_max3_f32 v168, v168, v8, v9
  v_max3_f32 v168, v168, v10, v11
  v_max3_f32 v168, v168, v12, v13
  v_max3_f32 v168, v168, v14, v15
  v_max3_f32 v169, v169, v16, v17
  v_max3_f32 v169, v169, v18, v19
  v_max3_f32 v169, v169, v20, v21
  v_max3_f32 v169, v169, v22, v23
  v_max3_f32 v169, v169, v24, v25
  v_max3_f32 v169, v169, v26, v27
  v_max3_f32 v169, v169, v28, v29
  v_max3_f32 v169, v169, v30, v31
  v_max3_f32 v170, v170, v32, v33
  v_max3_f32 v170, v170, v34, v35
  v_max3_f32 v170, v170, v36, v37
  v_max3_f32 v170, v170, v38, v39
  v_max3_f32 v170, v170, v40, v41
  v_max3_f32 v170, v170, v42, v43
  v_max3_f32 v170, v170, v44, v45
  v_max3_f32 v170, v170, v46, v47
  v_max3_f32 v171, v171, v48, v49
  v_max3_f32 v171, v171, v50, v51
  v_max3_f32 v171, v171, v52, v53
  v_max3_f32 v171, v171, v54, v55
  v_max3_f32 v171, v171, v56, v57
  v_max3_f32 v171, v171, v58, v59
  v_max3_f32 v171, v171, v60, v61
  v_max3_f32 v171, v171, v62, v63
  s_sub_u32 s42, s42, 1
  s_cmp_lg_u32 s42, 0
  s_cbranch_scc1 L_fb_loop
  v_mov_b32 v208, v168
  v_mov_b32 v209, v169
  v_mov_b32 v210, v170
  v_mov_b32 v211, v171
  s_nop 1
  v_permlane32_swap_b32 v168, v208
  v_permlane32_swap_b32 v169, v209
  v_permlane32_swap_b32 v170, v210
  v_permlane32_swap_b32 v171, v211
  v_max_f32 v168, v168, v208
  v_max_f32 v169, v169, v209
  v_max_f32 v170, v170, v210
  v_max_f32 v171, v171, v211
  v_mov_b32 v208, v168
  v_mov_b32 v209, v169
  v_mov_b32 v210, v170
  v_mov_b32 v211, v171
  s_nop 1
  v_permlane16_swap_b32 v168, v208
  v_permlane16_swap_b32 v169, v209
  v_permlane16_swap_b32 v170, v210
  v_permlane16_swap_b32 v171, v211
  v_max_f32 v168, v168, v208
  v_max_f32 v169, v169, v209
  v_max_f32 v170, v170, v210
  v_max_f32 v171, v171, v211
  s_mov_b32 s43, 0
  s_mov_b32 s44, 0
  s_barrier
  s_add_u32 m0, s45, 147456
  s_nop 0
  buffer_load_dwordx4 v160, s[16:19], s43 offen offset:0 lds
  buffer_load_dwordx4 v161, s[16:19], s43 offen offset:1024 lds
  buffer_load_dwordx4 v162, s[16:19], s43 offen offset:2048 lds
  buffer_load_dwordx4 v163, s[16:19], s43 offen offset:3072 lds
  s_add_u32 s43, s43, 16384
  s_add_u32 m0, s45, 49152
  s_nop 0
  buffer_load_dwordx4 v164, s[20:23], s44 offen offset:0 lds
  buffer_load_dwordx4 v165, s[20:23], s44 offen offset:1024 lds
  buffer_load_dwordx4 v164, s[20:23], s44 offen offset:2048 lds
  buffer_load_dwordx4 v165, s[20:23], s44 offen offset:3072 lds
  s_add_u32 s44, s44, 16384
  s_add_u32 m0, s45, 65536
  s_nop 0
  buffer_load_dwordx4 v164, s[20:23], s44 offen offset:0 lds
  buffer_load_dwordx4 v165, s[20:23], s44 offen offset:1024 lds
  buffer_load_dwordx4 v164, s[20:23], s44 offen offset:2048 lds
  buffer_load_dwordx4 v165, s[20:23], s44 offen offset:3072 lds
  s_add_u32 s44, s44, 16384
  s_add_u32 m0, s45, 98304
  s_nop 0
  buffer_load_dwordx4 v160, s[16:19], s43 offen offset:0 lds
  buffer_load_dwordx4 v161, s[16:19], s43 offen offset:1024 lds
  buffer_load_dwordx4 v162, s[16:19], s43 offen offset:2048 lds
  buffer_load_dwordx4 v163, s[16:19], s43 offen offset:3072 lds
  s_add_u32 s43, s43, 16384
  s_add_u32 m0, s45, 114688
  s_nop 0
  buffer_load_dwordx4 v160, s[16:19], s43 offen offset:0 lds
  buffer_load_dwordx4 v161, s[16:19], s43 offen offset:1024 lds
  buffer_load_dwordx4 v162, s[16:19], s43 offen offset:2048 lds
  buffer_load_dwordx4 v163, s[16:19], s43 offen offset:3072 lds
  s_add_u32 s43, s43, 16384
  s_add_u32 m0, s45, 131072
  s_nop 0
  buffer_load_dwordx4 v160, s[16:19], s43 offen offset:0 lds
  buffer_load_dwordx4 v161, s[16:19], s43 offen offset:1024 lds
  buffer_load_dwordx4 v162, s[16:19], s43 offen offset:2048 lds
  buffer_load_dwordx4 v163, s[16:19], s43 offen offset:3072 lds
  s_add_u32 s43, s43, 16384
  s_waitcnt vmcnt(0)
  s_barrier
  ds_read_b128 a[192:195], v148 offset:49152
  ds_read_b128 a[196:199], v149 offset:49152
  ds_read_b128 a[200:203], v150 offset:49152
  ds_read_b128 a[204:207], v151 offset:49152
  ds_read_b128 a[208:211], v148 offset:53248
  ds_read_b128 a[212:215], v149 offset:53248
  ds_read_b128 a[216:219], v150 offset:53248
  ds_read_b128 a[220:223], v151 offset:53248
  s_waitcnt lgkmcnt(7)
  v_mfma_f32_16x16x32_bf16 v[0:3], a[192:195], a[128:131], 0
  s_waitcnt lgkmcnt(6)
  v_mfma_f32_16x16x32_bf16 v[0:3], a[196:199], a[132:135], v[0:3]
  s_waitcnt lgkmcnt(5)
  v_mfma_f32_16x16x32_bf16 v[0:3], a[200:203], a[136:139], v[0:3]
  s_waitcnt lgkmcnt(4)
  v_mfma_f32_16x16x32_bf16 v[0:3], a[204:207], a[140:143], v[0:3]
  v_mfma_f32_16x16x32_bf16 v[16:19], a[192:195], a[144:147], 0
  v_mfma_f32_16x16x32_bf16 v[16:19], a[196:199], a[148:151], v[16:19]
  v_mfma_f32_16x16x32_bf16 v[16:19], a[200:203], a[152:155], v[16:19]
  v_mfma_f32_16x16x32_bf16 v[16:19], a[204:207], a[156:159], v[16:19]
  v_mfma_f32_16x16x32_bf16 v[32:35], a[192:195], a[160:163], 0
  v_mfma_f32_16x16x32_bf16 v[32:35], a[196:199], a[164:167], v[32:35]
  v_mfma_f32_16x16x32_bf16 v[32:35], a[200:203], a[168:171], v[32:35]
  v_mfma_f32_16x16x32_bf16 v[32:35], a[204:207], a[172:175], v[32:35]
  v_mfma_f32_16x16x32_bf16 v[48:51], a[192:195], a[176:179], 0
  v_mfma_f32_16x16x32_bf16 v[48:51], a[196:199], a[180:183], v[48:51]
  ds_read_b128 a[192:195], v148 offset:57344
  v_mfma_f32_16x16x32_bf16 v[48:51], a[200:203], a[184:187], v[48:51]
  ds_read_b128 a[196:199], v149 offset:57344
  v_mfma_f32_16x16x32_bf16 v[48:51], a[204:207], a[188:191], v[48:51]
  ds_read_b128 a[200:203], v150 offset:57344
  s_waitcnt lgkmcnt(6)
  v_mfma_f32_16x16x32_bf16 v[4:7], a[208:211], a[128:131], 0
  ds_read_b128 a[204:207], v151 offset:57344
  s_waitcnt lgkmcnt(6)
  v_mfma_f32_16x16x32_bf16 v[4:7], a[212:215], a[132:135], v[4:7]
  s_waitcnt lgkmcnt(5)
  v_mfma_f32_16x16x32_bf16 v[4:7], a[216:219], a[136:139], v[4:7]
  s_waitcnt lgkmcnt(4)
  v_mfma_f32_16x16x32_bf16 v[4:7], a[220:223], a[140:143], v[4:7]
  v_mfma_f32_16x16x32_bf16 v[20:23], a[208:211], a[144:147], 0
  v_mfma_f32_16x16x32_bf16 v[20:23], a[212:215], a[148:151], v[20:23]
  v_mfma_f32_16x16x32_bf16 v[20:23], a[216:219], a[152:155], v[20:23]
  v_mfma_f32_16x16x32_bf16 v[20:23], a[220:223], a[156:159], v[20:23]
  v_mfma_f32_16x16x32_bf16 v[36:39], a[208:211], a[160:163], 0
  v_mfma_f32_16x16x32_bf16 v[36:39], a[212:215], a[164:167], v[36:39]
  v_mfma_f32_16x16x32_bf16 v[36:39], a[216:219], a[168:171], v[36:39]
  v_mfma_f32_16x16x32_bf16 v[36:39], a[220:223], a[172:175], v[36:39]
  v_mfma_f32_16x16x32_bf16 v[52:55], a[208:211], a[176:179], 0
  v_mfma_f32_16x16x32_bf16 v[52:55], a[212:215], a[180:183], v[52:55]
  ds_read_b128 a[208:211], v148 offset:61440
  v_mfma_f32_16x16x32_bf16 v[52:55], a[216:219], a[184:187], v[52:55]
  ds_read_b128 a[212:215], v149 offset:61440
  v_mfma_f32_16x16x32_bf16 v[52:55], a[220:223], a[188:191], v[52:55]
  ds_read_b128 a[216:219], v150 offset:61440
  s_waitcnt lgkmcnt(6)
  v_mfma_f32_16x16x32_bf16 v[8:11], a[192:195], a[128:131], 0
  ds_read_b128 a[220:223], v151 offset:61440
  s_waitcnt lgkmcnt(6)
  v_mfma_f32_16x16x32_bf16 v[8:11], a[196:199], a[132:135], v[8:11]
  s_waitcnt lgkmcnt(5)
  v_mfma_f32_16x16x32_bf16 v[8:11], a[200:203], a[136:139], v[8:11]
  s_waitcnt lgkmcnt(4)
  v_mfma_f32_16x16x32_bf16 v[8:11], a[204:207], a[140:143], v[8:11]
  v_mfma_f32_16x16x32_bf16 v[24:27], a[192:195], a[144:147], 0
  v_mfma_f32_16x16x32_bf16 v[24:27], a[196:199], a[148:151], v[24:27]
  v_mfma_f32_16x16x32_bf16 v[24:27], a[200:203], a[152:155], v[24:27]
  v_mfma_f32_16x16x32_bf16 v[24:27], a[204:207], a[156:159], v[24:27]
  v_mfma_f32_16x16x32_bf16 v[40:43], a[192:195], a[160:163], 0
  v_mfma_f32_16x16x32_bf16 v[40:43], a[196:199], a[164:167], v[40:43]
  v_mfma_f32_16x16x32_bf16 v[40:43], a[200:203], a[168:171], v[40:43]
  v_mfma_f32_16x16x32_bf16 v[40:43], a[204:207], a[172:175], v[40:43]
  v_mfma_f32_16x16x32_bf16 v[56:59], a[192:195], a[176:179], 0
  v_mfma_f32_16x16x32_bf16 v[56:59], a[196:199], a[180:183], v[56:59]
  v_mfma_f32_16x16x32_bf16 v[56:59], a[200:203], a[184:187], v[56:59]
  v_mfma_f32_16x16x32_bf16 v[56:59], a[204:207], a[188:191], v[56:59]
  s_waitcnt lgkmcnt(3)
  v_mfma_f32_16x16x32_bf16 v[12:15], a[208:211], a[128:131], 0
  s_waitcnt lgkmcnt(2)
  v_mfma_f32_16x16x32_bf16 v[12:15], a[212:215], a[132:135], v[12:15]
  s_waitcnt lgkmcnt(1)
  v_mfma_f32_16x16x32_bf16 v[12:15], a[216:219], a[136:139], v[12:15]
  s_waitcnt lgkmcnt(0)
  v_mfma_f32_16x16x32_bf16 v[12:15], a[220:223], a[140:143], v[12:15]
  v_mfma_f32_16x16x32_bf16 v[28:31], a[208:211], a[144:147], 0
  v_mfma_f32_16x16x32_bf16 v[28:31], a[212:215], a[148:151], v[28:31]
  v_mfma_f32_16x16x32_bf16 v[28:31], a[216:219], a[152:155], v[28:31]
  v_mfma_f32_16x16x32_bf16 v[28:31], a[220:223], a[156:159], v[28:31]
  v_mfma_f32_16x16x32_bf16 v[44:47], a[208:211], a[160:163], 0
  v_mfma_f32_16x16x32_bf16 v[44:47], a[212:215], a[164:167], v[44:47]
  v_mfma_f32_16x16x32_bf16 v[44:47], a[216:219], a[168:171], v[44:47]
  v_mfma_f32_16x16x32_bf16 v[44:47], a[220:223], a[172:175], v[44:47]
  v_mfma_f32_16x16x32_bf16 v[60:63], a[208:211], a[176:179], 0
  v_mfma_f32_16x16x32_bf16 v[60:63], a[212:215], a[180:183], v[60:63]
  v_mfma_f32_16x16x32_bf16 v[60:63], a[216:219], a[184:187], v[60:63]
  v_mfma_f32_16x16x32_bf16 v[60:63], a[220:223], a[188:191], v[60:63]
  s_branch L_att_go
L_lnfb:
  s_lshl_b32 s42, s33, 5
  s_mov_b32 s35, 32
  s_mov_b32 s58, 0
  s_waitcnt vmcnt(0) lgkmcnt(0)
  s_barrier
L_lnfb_loop:
  s_lshl_b32 s66, s42, 14
  s_lshl_b32 s48, s3, 9
  s_add_u32 s66, s66, s48
  s_lshr_b32 s67, s42, 2
  s_lshl_b32 s67, s67, 16
  s_and_b32 s48, s42, 2
  s_lshl_b32 s48, s48, 9
  s_add_u32 s67, s67, s48
  s_and_b32 s48, s42, 1
  s_lshl_b32 s48, s48, 7
  s_add_u32 s67, s67, s48
  s_lshl_b32 s48, s3, 14
  s_add_u32 s67, s67, s48
  buffer_load_dwordx4 v[64:67], v216, s[72:75], s66 offen offset:0
  buffer_load_dwordx4 v[68:71], v216, s[72:75], s66 offen offset:128
  buffer_load_dwordx4 v[72:75], v216, s[72:75], s66 offen offset:256
  buffer_load_dwordx4 v[76:79], v216, s[72:75], s66 offen offset:384
  s_waitcnt vmcnt(0)
  v_lshlrev_b32 v80, 16, v64
  v_and_b32 v81, 0xffff0000, v64
  v_lshlrev_b32 v82, 16, v65
  v_and_b32 v83, 0xffff0000, v65
  v_lshlrev_b32 v84, 16, v66
  v_and_b32 v85, 0xffff0000, v66
  v_lshlrev_b32 v86, 16, v67
  v_and_b32 v87, 0xffff0000, v67
  v_lshlrev_b32 v88, 16, v68
  v_and_b32 v89, 0xffff0000, v68
  v_lshlrev_b32 v90, 16, v69
  v_and_b32 v91, 0xffff0000, v69
  v_lshlrev_b32 v92, 16, v70
  v_and_b32 v93, 0xffff0000, v70
  v_lshlrev_b32 v94, 16, v71
  v_and_b32 v95, 0xffff0000, v71
  v_lshlrev_b32 v96, 16, v72
  v_and_b32 v97, 0xffff0000, v72
  v_lshlrev_b32 v98, 16, v73
  v_and_b32 v99, 0xffff0000, v73
  v_lshlrev_b32 v100, 16, v74
  v_and_b32 v101, 0xffff0000, v74
  v_lshlrev_b32 v102, 16, v75
  v_and_b32 v103, 0xffff0000, v75
  v_lshlrev_b32 v104, 16, v76
  v_and_b32 v105, 0xffff0000, v76
  v_lshlrev_b32 v106, 16, v77
  v_and_b32 v107, 0xffff0000, v77
  v_lshlrev_b32 v108, 16, v78
  v_and_b32 v109, 0xffff0000, v78
  v_lshlrev_b32 v110, 16, v79
  v_and_b32 v111, 0xffff0000, v79
  v_pk_add_f32 v[112:113], v[80:81], v[82:83]
  v_pk_add_f32 v[114:115], v[84:85], v[86:87]
  v_pk_add_f32 v[116:117], v[88:89], v[90:91]
  v_pk_add_f32 v[118:119], v[92:93], v[94:95]
  v_pk_add_f32 v[120:121], v[96:97], v[98:99]
  v_pk_add_f32 v[122:123], v[100:101], v[102:103]
  v_pk_add_f32 v[124:125], v[104:105], v[106:107]
  v_pk_add_f32 v[126:127], v[108:109], v[110:111]
  v_pk_add_f32 v[112:113], v[112:113], v[114:115]
  v_pk_add_f32 v[114:115], v[116:117], v[118:119]
  v_pk_add_f32 v[116:117], v[120:121], v[122:123]
  v_pk_add_f32 v[118:119], v[124:125], v[126:127]
  v_pk_add_f32 v[112:113], v[112:113], v[114:115]
  v_pk_add_f32 v[114:115], v[116:117], v[118:119]
  v_pk_add_f32 v[112:113], v[112:113], v[114:115]
  v_add_f32 v64, v112, v113
  s_nop 1
  v_add_f32_dpp v64, v64, v64 row_ror:8 row_mask:0xf bank_mask:0xf
  v_mov_b32 v65, v64
  s_nop 1
  v_permlane16_swap_b32 v64, v65
  v_add_f32 v64, v64, v65
  v_mov_b32 v65, v64
  s_nop 1
  v_permlane32_swap_b32 v64, v65
  v_add_f32 v64, v64, v65
  v_mul_f32 v66, 0xbb800000, v64
  v_mul_f32 v64, 0x3b800000, v64
  v_mov_b32 v67, v66
  v_pk_add_f32 v[112:113], v[80:81], v[66:67]
  v_pk_add_f32 v[114:115], v[82:83], v[66:67]
  v_pk_add_f32 v[116:117], v[84:85], v[66:67]
  v_pk_add_f32 v[118:119], v[86:87], v[66:67]
  v_pk_add_f32 v[120:121], v[88:89], v[66:67]
  v_pk_add_f32 v[122:123], v[90:91], v[66:67]
  v_pk_add_f32 v[124:125], v[92:93], v[66:67]
  v_pk_add_f32 v[126:127], v[94:95], v[66:67]
  v_pk_add_f32 v[128:129], v[96:97], v[66:67]
  v_pk_add_f32 v[130:131], v[98:99], v[66:67]
  v_pk_add_f32 v[132:133], v[100:101], v[66:67]
  v_pk_add_f32 v[134:135], v[102:103], v[66:67]
  v_pk_add_f32 v[136:137], v[104:105], v[66:67]
  v_pk_add_f32 v[138:139], v[106:107], v[66:67]
  v_pk_add_f32 v[140:141], v[108:109], v[66:67]
  v_pk_add_f32 v[142:143], v[110:111], v[66:67]
  v_pk_mul_f32 v[68:69], v[112:113], v[112:113]
  v_pk_mul_f32 v[70:71], v[114:115], v[114:115]
  v_pk_mul_f32 v[72:73], v[116:117], v[116:117]
  v_pk_mul_f32 v[74:75], v[118:119], v[118:119]
  v_pk_fma_f32 v[68:69], v[120:121], v[120:121], v[68:69]
  v_pk_fma_f32 v[70:71], v[122:123], v[122:123], v[70:71]
  v_pk_fma_f32 v[72:73], v[124:125], v[124:125], v[72:73]
  v_pk_fma_f32 v[74:75], v[126:127], v[126:127], v[74:75]
  v_pk_fma_f32 v[68:69], v[128:129], v[128:129], v[68:69]
  v_pk_fma_f32 v[70:71], v[130:131], v[130:131], v[70:71]
  v_pk_fma_f32 v[72:73], v[132:133], v[132:133], v[72:73]
  v_pk_fma_f32 v[74:75], v[134:135], v[134:135], v[74:75]
  v_pk_fma_f32 v[68:69], v[136:137], v[136:137], v[68:69]
  v_pk_fma_f32 v[70:71], v[138:139], v[138:139], v[70:71]
  v_pk_fma_f32 v[72:73], v[140:141], v[140:141], v[72:73]
  v_pk_fma_f32 v[74:75], v[142:143], v[142:143], v[74:75]
  v_pk_add_f32 v[68:69], v[68:69], v[70:71]
  v_pk_add_f32 v[72:73], v[72:73], v[74:75]
  v_pk_add_f32 v[68:69], v[68:69], v[72:73]
  v_add_f32 v65, v68, v69
  s_nop 1
  v_add_f32_dpp v65, v65, v65 row_ror:8 row_mask:0xf bank_mask:0xf
  v_mov_b32 v68, v65
  s_nop 1
  v_permlane16_swap_b32 v65, v68
  v_add_f32 v65, v65, v68
  v_mov_b32 v68, v65
  s_nop 1
  v_permlane32_swap_b32 v65, v68
  v_add_f32 v65, v65, v68
  s_lshl_b32 s48, s3, 3
  v_add_u32 v68, s48, v218
  s_mov_b64 exec, 0xff
  ds_write_b64 v68, v[64:65]
  s_mov_b64 exec, -1
  s_waitcnt lgkmcnt(0)
  s_barrier
  ds_read_b128 v[112:115], v218
  ds_read_b128 v[116:119], v218 offset:16
  s_waitcnt lgkmcnt(0)
  v_add_f32 v64, v112, v114
  v_add_f32 v65, v116, v118
  v_add_f32 v66, v113, v115
  v_add_f32 v67, v117, v119
  v_add_f32 v64, v64, v65
  v_add_f32 v66, v66, v67
  v_mul_f32 v64, 0.25, v64
  v_sub_f32 v112, v112, v64
  v_sub_f32 v114, v114, v64
  v_sub_f32 v116, v116, v64
  v_sub_f32 v118, v118, v64
  v_mul_f32 v112, v112, v112
  v_mul_f32 v116, v116, v116
  v_fmac_f32 v112, v114, v114
  v_fmac_f32 v116, v118, v118
  v_add_f32 v112, v112, v116
  v_fmac_f32 v66, 0x43800000, v112
  v_mul_f32 v66, 0x3a800000, v66
  v_cvt_pk_bf16_f32 v65, v64, v66
  v_lshlrev_b32 v64, 16, v65
  v_and_b32 v66, 0xffff0000, v65
  v_add_f32 v66, 0x3727c5ac, v66
  v_cvt_pk_bf16_f32 v66, v66, v66
  v_and_b32 v66, 0xffff0000, v66
  v_sqrt_f32 v66, v66
  v_sub_f32 v112, 0, v64
  v_sub_f32 v113, 0, v64
  v_cvt_pk_bf16_f32 v66, v66, v66
  v_and_b32 v66, 0xffff0000, v66
  v_rcp_f32 v68, v66
  v_rcp_f32 v69, v66
  v_pk_add_f32 v[80:81], v[80:81], v[112:113]
  v_pk_add_f32 v[82:83], v[82:83], v[112:113]
  v_pk_add_f32 v[84:85], v[84:85], v[112:113]
  v_pk_add_f32 v[86:87], v[86:87], v[112:113]
  v_pk_add_f32 v[88:89], v[88:89], v[112:113]
  v_pk_add_f32 v[90:91], v[90:91], v[112:113]
  v_pk_add_f32 v[92:93], v[92:93], v[112:113]
  v_pk_add_f32 v[94:95], v[94:95], v[112:113]
  v_pk_add_f32 v[96:97], v[96:97], v[112:113]
  v_pk_add_f32 v[98:99], v[98:99], v[112:113]
  v_pk_add_f32 v[100:101], v[100:101], v[112:113]
  v_pk_add_f32 v[102:103], v[102:103], v[112:113]
  v_pk_add_f32 v[104:105], v[104:105], v[112:113]
  v_pk_add_f32 v[106:107], v[106:107], v[112:113]
  v_pk_add_f32 v[108:109], v[108:109], v[112:113]
  v_pk_add_f32 v[110:111], v[110:111], v[112:113]
  v_mul_f32 v114, 0x3e0293ee, v68
  v_mov_b32 v116, v68
  v_mov_b32 v117, v69
  v_mov_b32 v115, v114
  v_cvt_pk_bf16_f32 v64, v80, v81
  v_cvt_pk_bf16_f32 v65, v82, v83
  v_cvt_pk_bf16_f32 v66, v84, v85
  v_cvt_pk_bf16_f32 v67, v86, v87
  v_cvt_pk_bf16_f32 v68, v88, v89
  v_cvt_pk_bf16_f32 v69, v90, v91
  v_cvt_pk_bf16_f32 v70, v92, v93
  v_cvt_pk_bf16_f32 v71, v94, v95
  v_cvt_pk_bf16_f32 v72, v96, v97
  v_cvt_pk_bf16_f32 v73, v98, v99
  v_cvt_pk_bf16_f32 v74, v100, v101
  v_cvt_pk_bf16_f32 v75, v102, v103
  v_cvt_pk_bf16_f32 v76, v104, v105
  v_cvt_pk_bf16_f32 v77, v106, v107
  v_cvt_pk_bf16_f32 v78, v108, v109
  v_cvt_pk_bf16_f32 v79, v110, v111
  s_lshl_b32 s48, s42, 7
  s_add_u32 s48, s48, 65536
  s_add_u32 s49, s48, 32768
  s_mov_b64 exec, 0xff
  buffer_store_dwordx4 v[112:115], v166, s[28:31], s48 offen sc0 sc1
  buffer_store_dwordx2 v[116:117], v166, s[28:31], s49 offen sc0 sc1
  s_mov_b64 exec, -1
  buffer_store_dwordx4 v[64:67], v217, s[4:7], s67 offen sc0 sc1
  s_add_u32 s67, s67, 4096
  buffer_store_dwordx4 v[68:71], v217, s[4:7], s67 offen sc0 sc1
  s_add_u32 s67, s67, 4096
  buffer_store_dwordx4 v[72:75], v217, s[4:7], s67 offen sc0 sc1
  s_add_u32 s67, s67, 4096
  buffer_store_dwordx4 v[76:79], v217, s[4:7], s67 offen sc0 sc1
  s_add_u32 s42, s42, 1
  s_sub_u32 s35, s35, 1
  s_barrier
  s_cmp_lg_u32 s35, 0
  s_cbranch_scc1 L_lnfb_loop
  ds_write_b32 v218, v221 offset:512
  s_lshl_b32 s36, s50, 16
  s_lshl_b32 s37, s51, 16
  s_mov_b32 s38, 0
  s_mov_b32 s39, 0
  s_mov_b32 s40, 0
  s_mov_b32 s41, 0
  v_mov_b32 v14, v10
  v_mov_b32 v15, v11
  v_mov_b32 v16, v12
  v_mov_b32 v17, v13
  v_mov_b32 v25, v18
  v_mov_b32 v26, v19
  v_mov_b32 v27, v20
  v_mov_b32 v28, v21
  v_mov_b32 v29, v22
  v_mov_b32 v30, v23
  v_mov_b32 v31, v24
  v_mov_b64 v[32:33], 0
  v_mov_b64 v[36:37], 0
  v_mov_b64 v[40:41], 0
  v_mov_b64 v[44:45], 0
  v_mov_b64 v[48:49], 0
  s_add_u32 m0, s40, s45
  s_nop 0
  buffer_load_dwordx4 v2, s[8:11], s38 offen offset:0 lds
  buffer_load_dwordx4 v3, s[8:11], s38 offen offset:1024 lds
  buffer_load_dwordx4 v4, s[8:11], s38 offen offset:2048 lds
  buffer_load_dwordx4 v5, s[8:11], s38 offen offset:3072 lds
  s_add_u32 s38, s38, 0x80000
  s_add_u32 m0, s40, s46
  s_nop 0
  buffer_load_dwordx4 v6, s[12:15], s39 offen offset:0 lds
  buffer_load_dwordx4 v7, s[12:15], s39 offen offset:1024 lds
  buffer_load_dwordx4 v8, s[12:15], s39 offen offset:2048 lds
  buffer_load_dwordx4 v9, s[12:15], s39 offen offset:3072 lds
  s_add_u32 s39, s39, 0x70000
  s_mov_b32 s41, s49
  s_mov_b32 s49, s40
  s_add_u32 s40, s40, 32768
  s_cmp_lt_u32 s40, 98304
  s_cselect_b32 s40, s40, 0
  s_lshl1_add_u32 m0, s45, 98304
  s_nop 0
  buffer_load_dwordx4 v58, s[72:75], s36 offen offset:0 lds
  buffer_load_dwordx4 v59, s[72:75], s36 offen offset:1024 lds
  buffer_load_dwordx4 v60, s[72:75], s36 offen offset:2048 lds
  buffer_load_dwordx4 v61, s[72:75], s36 offen offset:3072 lds
  s_add_u32 s36, s36, 128
  s_lshl1_add_u32 m0, s45, 102400
  s_nop 0
  buffer_load_dwordx4 v58, s[72:75], s37 offen offset:0 lds
  buffer_load_dwordx4 v59, s[72:75], s37 offen offset:1024 lds
  buffer_load_dwordx4 v60, s[72:75], s37 offen offset:2048 lds
  buffer_load_dwordx4 v61, s[72:75], s37 offen offset:3072 lds
  s_add_u32 s37, s37, 128
  s_waitcnt vmcnt(0) lgkmcnt(0)
  s_branch L_p1go
L_code_end:
.section .rodata,"a"
.p2align 6
.amdhsa_kernel att_kernel
  .amdhsa_next_free_vgpr 512
  .amdhsa_next_free_sgpr 102
  .amdhsa_accum_offset 256
  .amdhsa_group_segment_fixed_size 0
  .amdhsa_kernarg_size 88
  .amdhsa_user_sgpr_count 2
  .amdhsa_user_sgpr_kernarg_segment_ptr 1
  .amdhsa_system_sgpr_workgroup_id_x 1
.end_amdhsa_kernel
```
